```python
import torch

def _softmax(x, axis=-1):
    return torch.softmax(x, dim=axis)
def _gelu(x):
    return torch.nn.functional.gelu(x, approximate="tanh")
def _silu(x):
    return torch.nn.functional.silu(x)
def _sigmoid(x):
    return torch.sigmoid(x)
def _layernorm(x, axis=-1, eps=1e-5):
    m = x.mean(dim=axis, keepdim=True)
    v = x.var(dim=axis, keepdim=True, unbiased=False)
    return (x - m) / torch.sqrt(v + eps)
def _scatter_add(tgt, idx, src, axis=0):
    return tgt.clone().index_add_(axis, idx, src)
def _segment_sum(src, seg, n):
    out = torch.zeros((n,) + src.shape[1:], dtype=src.dtype)
    return out.index_add_(0, seg, src)
def _pad(x, pw):
    flat = tuple(v for pair in reversed(pw) for v in pair)
    return torch.nn.functional.pad(x, flat)

kernel_name = 'gated_mix__linear_attn_block__dense_activation_mish__prompt'

def setup_inputs():

    _w = (lambda a: (lambda t: t.to(torch.bfloat16) if t.is_floating_point() else t)(torch.as_tensor(a)))
    def _A_setup():
        B, S, D = 1, 2048, 1024
        return {
            "x": _w((lambda *s: torch.randn(*s, dtype=torch.bfloat16) * 0.05)(B, S, D)),
            "wqkv": _w((lambda *s: torch.randn(*s, dtype=torch.bfloat16) * 0.8)(D, 3 * D)),
            "wo": _w((lambda *s: torch.randn(*s, dtype=torch.bfloat16) * 0.05)(D, D)),
        }
    _A_in = _A_setup()

    def _B_setup():
        B, S, D, F = 1, 2048, 1024, 3584
        return {
            "x": _w((lambda *s: torch.randn(*s, dtype=torch.bfloat16) * 0.05)(B, S, D)),
            "w1": _w((lambda *s: torch.randn(*s, dtype=torch.bfloat16) * 12.8)(D, F) * (D ** -0.5)),
            "b1": _w((lambda *s: torch.randn(*s, dtype=torch.bfloat16) * 0.4)(F)),
            "w2": _w((lambda *s: torch.randn(*s, dtype=torch.bfloat16) * 0.05)(F, D) * (F ** -0.5)),
        }
    _B_in = _B_setup()

    return {
        "A_x": _A_in["x"],
        "A_wqkv": _A_in["wqkv"],
        "A_wo": _A_in["wo"],
        "B_x": _B_in["x"],
        "B_w1": _B_in["w1"],
        "B_b1": _B_in["b1"],
        "B_w2": _B_in["w2"],
        "gate_w": _w((lambda *s: torch.randn(*s, dtype=torch.bfloat16) * 0.05)(1024) * 16.0),
    }

def reference(A_x, A_wqkv, A_wo, B_x, B_w1, B_b1, B_w2, gate_w):
    def _A_ref(x, wqkv, wo):
        B, S, D = x.shape
        H = 32; Dh = D // H
        qkv = (lambda x, *d: x.permute(*d))((x @ wqkv).reshape(B, S, 3, H, Dh), 2, 0, 3, 1, 4)
        q, k, v = qkv[0], qkv[1], qkv[2]
        phi = lambda t: torch.where(t > 0, t + 1, torch.exp(t)) + 1e-6
        pq, pk = phi(q), phi(k)
        kv = torch.einsum("bhsd,bhse->bhde", pk, v)
        z = torch.einsum("bhsd->bhd", pk)
        num = torch.einsum("bhqd,bhde->bhqe", pq, kv)
        den = torch.einsum("bhqd,bhd->bhq", pq, z)[..., None] + 1e-6
        o = num / den
        return (lambda x, *d: x.permute(*d))(o, 0, 2, 1, 3).reshape(B, S, D) @ wo

    def _B_ref(x, w1, b1, w2):
        h = torch.einsum("bsd,df->bsf", x, w1) + b1
        sp = torch.log1p(torch.exp(-torch.abs(h))) + torch.where(h > 0, h, torch.zeros_like(h))
        act = h * torch.tanh(sp)
        return torch.einsum("bsf,fd->bsd", act, w2)

    x = A_x
    g = _sigmoid((x * gate_w).sum(-1, keepdims=True))
    a = _A_ref(x, A_wqkv, A_wo)
    b = _B_ref(x, B_w1, B_b1, B_w2)
    return g * a + (1 - g) * b
```

```asm
; @launch grid=(256,1,1) block=(256,1,1) lds=155648
.amdgcn_target "amdgcn-amd-amdhsa--gfx950"
.text
.globl gated_mix__linear_attn_block__dense_activation_mish__prompt_kernel
.p2align 8
.type gated_mix__linear_attn_block__dense_activation_mish__prompt_kernel,@function
gated_mix__linear_attn_block__dense_activation_mish__prompt_kernel:
  s_cmp_ge_u32 s2, 256
  s_cbranch_scc1 L_k1_exit
  s_load_dwordx16 s[36:51], s[0:1], 0
  s_getpc_b64 s[100:101]
L_pc_0:
  s_sub_u32 s100, s100, L_pc_0-gated_mix__linear_attn_block__dense_activation_mish__prompt_kernel
  s_subb_u32 s101, s101, 0
  s_lshl_b32 s60, s2, 12
  s_and_b32 s60, s60, 0x18000
  v_lshlrev_b32 v47, 7, v0
  v_add_u32 v47, s60, v47
  v_min_u32 v47, L_code_end-gated_mix__linear_attn_block__dense_activation_mish__prompt_kernel-4, v47
  global_load_dword v46, v47, s[100:101]
  s_load_dwordx4 s[52:55], s[0:1], 64
  s_load_dwordx2 s[56:57], s[0:1], 80
  v_and_b32 v1, 63, v0
  v_lshrrev_b32 v18, 6, v0
  s_and_b32 s60, s2, 7
  v_readfirstlane_b32 s24, v18
  s_lshr_b32 s61, s2, 3
  s_and_b32 s25, s60, 1
  s_lshl_b32 s25, s25, 2
  s_and_b32 s62, s61, 3
  s_add_u32 s25, s25, s62
  s_lshr_b32 s60, s60, 1
  s_lshl_b32 s60, s60, 3
  s_lshr_b32 s61, s61, 2
  s_add_u32 s60, s60, s61
  s_lshr_b32 s26, s60, 1
  s_and_b32 s63, s60, 1
  s_cmp_lg_u32 s63, 0
  s_cbranch_scc1 L_k1_typeB
  v_and_b32 v18, 15, v1
  v_lshrrev_b32 v19, 4, v1
  s_mul_i32 s62, s26, 448
  s_lshr_b32 s68, s24, 1
  s_lshl_b32 s68, s68, 4
  s_and_b32 s69, s24, 1
  s_lshl_b32 s69, s69, 2
  s_add_u32 s68, s68, s69
  v_lshrrev_b32 v20, 3, v1
  v_lshrrev_b32 v22, 2, v20
  v_lshlrev_b32 v22, 3, v22
  v_and_b32 v21, 3, v20
  v_add3_u32 v21, v21, v22, s68
  v_mul_u32_u24 v21, 6144, v21
  v_lshrrev_b32 v22, 1, v20
  v_and_b32 v22, 3, v22
  v_lshlrev_b32 v22, 1, v22
  v_and_b32 v23, 7, v1
  v_xor_b32 v23, v23, v22
  v_lshlrev_b32 v23, 4, v23
  v_add_u32 v21, v21, v23
  s_lshl_b32 s69, s26, 7
  s_add_u32 s69, s69, 6144
  v_add_u32 v13, s69, v21
  v_add_u32 v14, 1024, v13
  v_add_u32 v20, 0, v1
  v_mul_u32_u24 v21, 205, v20
  v_lshrrev_b32 v21, 11, v21
  v_mul_u32_u24 v22, 10, v21
  v_sub_u32 v20, v20, v22
  v_and_b32 v21, 7, v21
  v_lshrrev_b32 v23, 2, v21
  v_lshlrev_b32 v23, 3, v23
  v_and_b32 v22, 3, v21
  v_add3_u32 v22, v22, v23, s68
  v_mul_u32_u24 v22, 7168, v22
  v_lshlrev_b32 v20, 4, v20
  v_add3_u32 v20, v20, v22, s62
  v_add_u32 v15, 2048, v20
  v_add_u32 v20, 64, v1
  v_mul_u32_u24 v21, 205, v20
  v_lshrrev_b32 v21, 11, v21
  v_mul_u32_u24 v22, 10, v21
  v_sub_u32 v20, v20, v22
  v_and_b32 v21, 7, v21
  v_lshrrev_b32 v23, 2, v21
  v_lshlrev_b32 v23, 3, v23
  v_and_b32 v22, 3, v21
  v_add3_u32 v22, v22, v23, s68
  v_mul_u32_u24 v22, 7168, v22
  v_lshlrev_b32 v20, 4, v20
  v_add3_u32 v20, v20, v22, s62
  v_add_u32 v16, 1024, v20
  s_lshl_b32 s69, s25, 8
  s_lshl_b32 s70, s24, 6
  s_add_u32 s69, s69, s70
  s_lshl_b32 s69, s69, 11
  v_lshrrev_b32 v20, 3, v1
  v_lshrrev_b32 v21, 1, v20
  v_and_b32 v22, 7, v1
  v_xor_b32 v22, v22, v21
  v_lshlrev_b32 v20, 11, v20
  v_add_u32 v20, s69, v20
  v_lshlrev_b32 v23, 4, v22
  v_add_u32 v23, v23, v20
  v_add_u32 v9, 0, v23
  v_xor_b32 v23, 4, v22
  v_lshlrev_b32 v23, 4, v23
  v_add_u32 v23, v23, v20
  v_add_u32 v10, 15360, v23
  v_lshlrev_b32 v23, 4, v22
  v_add_u32 v23, v23, v20
  v_add_u32 v11, 30720, v23
  v_xor_b32 v23, 4, v22
  v_lshlrev_b32 v23, 4, v23
  v_add_u32 v23, v23, v20
  v_add_u32 v12, 46080, v23
  s_mul_i32 s31, s24, 3328
  s_lshl_b32 s32, s24, 14
  s_add_u32 s32, s32, 53248
  s_mov_b32 s27, 0
  s_mov_b32 s28, 65536
  s_mov_b32 s29, 0
  s_mov_b32 s30, 0
  s_mov_b32 s34, 0xffff
  s_mov_b32 s35, 0
  s_waitcnt lgkmcnt(0)
  s_sub_u32 s8, s38, 4096
  s_subb_u32 s9, s39, 0
  s_and_b32 s9, s9, 0xffff
  s_mov_b32 s10, 6295552
  s_mov_b32 s11, 0x20000
  s_sub_u32 s12, s44, 4096
  s_subb_u32 s13, s45, 0
  s_and_b32 s13, s13, 0xffff
  s_mov_b32 s14, 7344128
  s_mov_b32 s15, 0x20000
  s_mov_b32 s4, s36
  s_and_b32 s5, s37, 0xffff
  s_mov_b32 s6, 4194304
  s_mov_b32 s7, 0x20000
  s_add_u32 m0, s31, 0
  s_nop 0
  buffer_load_dwordx4 v13, s[8:11], s29 offen offset:0  lds
  buffer_load_dwordx4 v14, s[8:11], s29 offen offset:1024  lds
  buffer_load_dwordx4 v15, s[12:15], s30 offen offset:2048  lds
  s_mov_b64 exec, s[34:35]
  buffer_load_dwordx4 v16, s[12:15], s30 offen offset:3072  lds
  s_mov_b64 exec, -1
  s_add_u32 s29, s29, 196608
  s_add_u32 s30, s30, 229376
  s_add_u32 m0, s32, 0
  s_nop 0
  buffer_load_dwordx4 v9, s[4:7], s27 offen offset:0  lds
  buffer_load_dwordx4 v10, s[4:7], s27 offen offset:1024  lds
  buffer_load_dwordx4 v11, s[4:7], s27 offen offset:2048  lds
  buffer_load_dwordx4 v12, s[4:7], s27 offen offset:3072  lds
  s_add_u32 m0, s32, 4096
  s_nop 0
  buffer_load_dwordx4 v9, s[4:7], s28 offen offset:0  lds
  buffer_load_dwordx4 v10, s[4:7], s28 offen offset:1024  lds
  buffer_load_dwordx4 v11, s[4:7], s28 offen offset:2048  lds
  buffer_load_dwordx4 v12, s[4:7], s28 offen offset:3072  lds
  s_add_u32 s27, s27, 128
  s_add_u32 s28, s28, 128
  s_mov_b32 s64, s46
  s_and_b32 s65, s47, 0xffff
  s_mov_b32 s66, 7168
  s_mov_b32 s67, 0x20000
  v_lshlrev_b32 v21, 3, v19
  buffer_load_dwordx2 v[188:189], v21, s[64:67], s62 offen offset:0
  buffer_load_dwordx2 v[204:205], v21, s[64:67], s62 offen offset:32
  buffer_load_dwordx2 v[220:221], v21, s[64:67], s62 offen offset:64
  buffer_load_dwordx2 v[236:237], v21, s[64:67], s62 offen offset:96
  buffer_load_dwordx2 v[252:253], v21, s[64:67], s62 offen offset:128
  s_add_u32 m0, s31, 13312
  s_nop 0
  buffer_load_dwordx4 v13, s[8:11], s29 offen offset:0  lds
  buffer_load_dwordx4 v14, s[8:11], s29 offen offset:1024  lds
  buffer_load_dwordx4 v15, s[12:15], s30 offen offset:2048  lds
  s_mov_b64 exec, s[34:35]
  buffer_load_dwordx4 v16, s[12:15], s30 offen offset:3072  lds
  s_mov_b64 exec, -1
  s_add_u32 s29, s29, 196608
  s_add_u32 s30, s30, 229376
  s_add_u32 m0, s31, 26624
  s_nop 0
  buffer_load_dwordx4 v13, s[8:11], s29 offen offset:0  lds
  buffer_load_dwordx4 v14, s[8:11], s29 offen offset:1024  lds
  buffer_load_dwordx4 v15, s[12:15], s30 offen offset:2048  lds
  s_mov_b64 exec, s[34:35]
  buffer_load_dwordx4 v16, s[12:15], s30 offen offset:3072  lds
  s_mov_b64 exec, -1
  s_add_u32 s29, s29, 196608
  s_add_u32 s30, s30, 229376
  s_add_u32 m0, s32, 8192
  s_nop 0
  buffer_load_dwordx4 v9, s[4:7], s27 offen offset:0  lds
  buffer_load_dwordx4 v10, s[4:7], s27 offen offset:1024  lds
  buffer_load_dwordx4 v11, s[4:7], s27 offen offset:2048  lds
  buffer_load_dwordx4 v12, s[4:7], s27 offen offset:3072  lds
  s_add_u32 m0, s32, 12288
  s_nop 0
  buffer_load_dwordx4 v9, s[4:7], s28 offen offset:0  lds
  buffer_load_dwordx4 v10, s[4:7], s28 offen offset:1024  lds
  buffer_load_dwordx4 v11, s[4:7], s28 offen offset:2048  lds
  buffer_load_dwordx4 v12, s[4:7], s28 offen offset:3072  lds
  s_add_u32 s27, s27, 128
  s_add_u32 s28, s28, 128
  s_add_u32 m0, s31, 39936
  s_nop 0
  buffer_load_dwordx4 v13, s[8:11], s29 offen offset:0  lds
  buffer_load_dwordx4 v14, s[8:11], s29 offen offset:1024  lds
  buffer_load_dwordx4 v15, s[12:15], s30 offen offset:2048  lds
  s_mov_b64 exec, s[34:35]
  buffer_load_dwordx4 v16, s[12:15], s30 offen offset:3072  lds
  s_mov_b64 exec, -1
  s_add_u32 s29, s29, 196608
  s_add_u32 s30, s30, 229376
  v_lshrrev_b32 v20, 3, v18
  v_lshlrev_b32 v20, 6, v20
  v_and_b32 v21, 7, v18
  v_lshlrev_b32 v21, 3, v21
  v_add_u32 v20, v20, v21
  v_lshrrev_b32 v21, 1, v18
  v_xor_b32 v21, v21, v19
  v_add_u32 v22, v20, v21
  v_lshlrev_b32 v22, 4, v22
  v_add_u32 v2, s32, v22
  v_xor_b32 v21, 4, v21
  v_add_u32 v22, v20, v21
  v_lshlrev_b32 v22, 4, v22
  v_add_u32 v3, s32, v22
  v_and_b32 v20, 1, v19
  v_lshlrev_b32 v20, 2, v20
  v_lshrrev_b32 v21, 2, v18
  v_add_u32 v20, v20, v21
  v_lshrrev_b32 v21, 1, v19
  v_mul_u32_u24 v21, 6656, v21
  v_and_b32 v22, 3, v18
  v_lshlrev_b32 v22, 3, v22
  v_add_u32 v21, v21, v22
  v_mul_u32_u24 v23, 160, v20
  v_add3_u32 v8, v21, v23, 0
  v_add_u32 v8, 2048, v8
  v_lshlrev_b32 v23, 7, v20
  v_add_u32 v21, v21, v23
  v_lshrrev_b32 v22, 1, v20
  v_and_b32 v22, 3, v22
  v_xor_b32 v23, 0, v22
  v_lshlrev_b32 v23, 5, v23
  v_add_u32 v4, v21, v23
  v_xor_b32 v23, 1, v22
  v_lshlrev_b32 v23, 5, v23
  v_add_u32 v5, v21, v23
  v_xor_b32 v23, 2, v22
  v_lshlrev_b32 v23, 5, v23
  v_add_u32 v6, v21, v23
  v_xor_b32 v23, 3, v22
  v_lshlrev_b32 v23, 5, v23
  v_add_u32 v7, v21, v23
  v_lshlrev_b32 v17, 4, v1
  s_or_b32 s60, s2, s24
  s_cmp_lg_u32 s60, 0
  s_cbranch_scc1 L_notok
  s_memrealtime s[68:69]
  s_mov_b32 s64, s54
  s_and_b32 s65, s55, 0xffff
  s_mov_b32 s66, 256
  s_mov_b32 s67, 0x20000
  s_waitcnt lgkmcnt(0)
  s_or_b32 s69, s69, 0x40000000
  s_lshl_b32 s69, s69, 1
  s_and_b32 s60, s68, 1
  s_or_b32 s69, s69, s60
  s_or_b32 s68, s68, 1
  v_mov_b32 v42, s68
  v_mov_b32 v43, s69
  v_mov_b32 v45, 0
  s_mov_b64 exec, 1
  buffer_store_dwordx2 v[42:43], v45, s[64:67], 0 offen sc1
  s_mov_b64 exec, -1
  s_nop 1
L_notok:
  v_lshlrev_b32 v42, 5, v1
  s_lshl_b32 s73, s25, 8
  s_lshl_b32 s61, s24, 6
  s_add_u32 s73, s73, s61
  s_lshl_b32 s61, s26, 2
  s_add_u32 s73, s73, s61
  s_lshl_b32 s61, s73, 11
  s_mov_b32 s20, s50
  s_and_b32 s21, s51, 0xffff
  s_mov_b32 s22, 2048
  s_mov_b32 s23, 0x20000
  buffer_load_dwordx4 v[18:21], v42, s[20:23], 0 offen
  buffer_load_dwordx4 v[22:25], v42, s[20:23], 0 offen offset:16
  buffer_load_dwordx4 v[26:29], v42, s[4:7], s61 offen
  buffer_load_dwordx4 v[30:33], v42, s[4:7], s61 offen offset:16
  buffer_load_dwordx4 v[34:37], v42, s[4:7], s61 offen offset:2048
  buffer_load_dwordx4 v[38:41], v42, s[4:7], s61 offen offset:2064
  s_mov_b32 s96, s48
  s_and_b32 s97, s49, 0xffff
  s_mov_b32 s98, 7340032
  s_mov_b32 s99, 0x20000
  s_mov_b32 s20, s40
  s_and_b32 s21, s41, 0xffff
  s_mov_b32 s22, 2097152
  s_mov_b32 s23, 0x20000
  v_min_u32 v44, 55, v1
  v_lshlrev_b32 v44, 7, v44
  v_min_u32 v45, 15, v1
  v_lshlrev_b32 v45, 7, v45
  s_lshl_b32 s60, s2, 2
  s_add_u32 s60, s60, s24
  s_mul_i32 s74, s60, 7168
  s_lshl_b32 s3, s60, 11
  s_waitcnt vmcnt(26)
  v_lshlrev_b32 v176, 16, v188
  v_and_b32 v177, 0xffff0000, v188
  v_lshlrev_b32 v178, 16, v189
  v_and_b32 v179, 0xffff0000, v189
  v_lshlrev_b32 v192, 16, v204
  v_and_b32 v193, 0xffff0000, v204
  v_lshlrev_b32 v194, 16, v205
  v_and_b32 v195, 0xffff0000, v205
  v_lshlrev_b32 v208, 16, v220
  v_and_b32 v209, 0xffff0000, v220
  v_lshlrev_b32 v210, 16, v221
  v_and_b32 v211, 0xffff0000, v221
  v_lshlrev_b32 v224, 16, v236
  v_and_b32 v225, 0xffff0000, v236
  v_lshlrev_b32 v226, 16, v237
  v_and_b32 v227, 0xffff0000, v237
  v_lshlrev_b32 v240, 16, v252
  v_and_b32 v241, 0xffff0000, v252
  v_lshlrev_b32 v242, 16, v253
  v_and_b32 v243, 0xffff0000, v253
  v_mov_b32 v48, 0x358637bd
  v_mov_b32 v49, 0x358637bd
  v_mov_b32 v50, 0x358637bd
  v_mov_b32 v51, 0x358637bd
  v_mov_b32 v64, 0x358637bd
  v_mov_b32 v65, 0x358637bd
  v_mov_b32 v66, 0x358637bd
  v_mov_b32 v67, 0x358637bd
  v_mov_b32 v80, 0x358637bd
  v_mov_b32 v81, 0x358637bd
  v_mov_b32 v82, 0x358637bd
  v_mov_b32 v83, 0x358637bd
  v_mov_b32 v96, 0x358637bd
  v_mov_b32 v97, 0x358637bd
  v_mov_b32 v98, 0x358637bd
  v_mov_b32 v99, 0x358637bd
  s_barrier
  ds_read_b128 a[104:107], v2 offset:0
  ds_read_b128 a[108:111], v2 offset:2048
  ds_read_b128 a[112:115], v2 offset:4096
  ds_read_b128 a[116:119], v2 offset:6144
  ds_read_b128 a[120:123], v3 offset:0
  ds_read_b128 a[124:127], v3 offset:2048
  ds_read_b128 a[128:131], v3 offset:4096
  ds_read_b128 a[132:135], v3 offset:6144
  ds_read_b64_tr_b16 a[0:1], v4 offset:0
  ds_read_b64_tr_b16 a[2:3], v4 offset:3328
  ds_read_b64_tr_b16 a[4:5], v5 offset:0
  ds_read_b64_tr_b16 a[6:7], v5 offset:3328
  ds_read_b64_tr_b16 a[8:9], v6 offset:0
  ds_read_b64_tr_b16 a[10:11], v6 offset:3328
  ds_read_b64_tr_b16 a[12:13], v7 offset:0
  ds_read_b64_tr_b16 a[14:15], v7 offset:3328
  ds_read_b64_tr_b16 a[16:17], v4 offset:1024
  ds_read_b64_tr_b16 a[18:19], v4 offset:4352
  ds_read_b64_tr_b16 a[20:21], v5 offset:1024
  ds_read_b64_tr_b16 a[22:23], v5 offset:4352
  ds_read_b64_tr_b16 a[24:25], v6 offset:1024
  ds_read_b64_tr_b16 a[26:27], v6 offset:4352
  ds_read_b64_tr_b16 a[28:29], v7 offset:1024
  ds_read_b64_tr_b16 a[30:31], v7 offset:4352
  ds_read_b64_tr_b16 a[32:33], v8 offset:0
  ds_read_b64_tr_b16 a[34:35], v8 offset:3328
  ds_read_b64_tr_b16 a[36:37], v8 offset:32
  ds_read_b64_tr_b16 a[38:39], v8 offset:3360
  ds_read_b64_tr_b16 a[40:41], v8 offset:64
  ds_read_b64_tr_b16 a[42:43], v8 offset:3392
  ds_read_b64_tr_b16 a[44:45], v8 offset:96
  ds_read_b64_tr_b16 a[46:47], v8 offset:3424
  ds_read_b64_tr_b16 a[48:49], v8 offset:128
  ds_read_b64_tr_b16 a[50:51], v8 offset:3456
  s_waitcnt vmcnt(22) lgkmcnt(0)
  s_barrier
  v_mfma_f32_16x16x32_bf16 v[52:55], a[108:111], a[0:3], v[48:51]
  s_add_u32 m0, s32, 0
  v_mfma_f32_16x16x32_bf16 v[56:59], a[112:115], a[0:3], v[48:51]
  ds_read_b64_tr_b16 a[52:53], v4 offset:13312
  v_mfma_f32_16x16x32_bf16 v[60:63], a[116:119], a[0:3], v[48:51]
  ds_read_b64_tr_b16 a[54:55], v4 offset:16640
  v_mfma_f32_16x16x32_bf16 v[48:51], a[104:107], a[0:3], v[48:51]
  buffer_load_dwordx4 v9, s[4:7], s27 offen offset:0  lds
  v_mfma_f32_16x16x32_bf16 v[68:71], a[108:111], a[4:7], v[64:67]
  ds_read_b64_tr_b16 a[56:57], v5 offset:13312
  v_mfma_f32_16x16x32_bf16 v[72:75], a[112:115], a[4:7], v[64:67]
  buffer_load_dwordx4 v10, s[4:7], s27 offen offset:1024  lds
  v_mfma_f32_16x16x32_bf16 v[76:79], a[116:119], a[4:7], v[64:67]
  ds_read_b64_tr_b16 a[58:59], v5 offset:16640
  v_mfma_f32_16x16x32_bf16 v[64:67], a[104:107], a[4:7], v[64:67]
  ds_read_b64_tr_b16 a[60:61], v6 offset:13312
  v_mfma_f32_16x16x32_bf16 v[84:87], a[108:111], a[8:11], v[80:83]
  buffer_load_dwordx4 v11, s[4:7], s27 offen offset:2048  lds
  v_mfma_f32_16x16x32_bf16 v[88:91], a[112:115], a[8:11], v[80:83]
  ds_read_b64_tr_b16 a[62:63], v6 offset:16640
  v_mfma_f32_16x16x32_bf16 v[92:95], a[116:119], a[8:11], v[80:83]
  buffer_load_dwordx4 v12, s[4:7], s27 offen offset:3072  lds
  v_mfma_f32_16x16x32_bf16 v[80:83], a[104:107], a[8:11], v[80:83]
  ds_read_b64_tr_b16 a[64:65], v7 offset:13312
  v_mfma_f32_16x16x32_bf16 v[100:103], a[108:111], a[12:15], v[96:99]
  s_add_u32 m0, s32, 4096
  v_mfma_f32_16x16x32_bf16 v[104:107], a[112:115], a[12:15], v[96:99]
  ds_read_b64_tr_b16 a[66:67], v7 offset:16640
  v_mfma_f32_16x16x32_bf16 v[108:111], a[116:119], a[12:15], v[96:99]
  ds_read_b64_tr_b16 a[68:69], v4 offset:14336
  v_mfma_f32_16x16x32_bf16 v[96:99], a[104:107], a[12:15], v[96:99]
  v_mfma_f32_16x16x32_bf16 v[116:119], a[108:111], a[16:19], 0
  buffer_load_dwordx4 v9, s[4:7], s28 offen offset:0  lds
  v_mfma_f32_16x16x32_bf16 v[120:123], a[112:115], a[16:19], 0
  ds_read_b64_tr_b16 a[70:71], v4 offset:17664
  v_mfma_f32_16x16x32_bf16 v[124:127], a[116:119], a[16:19], 0
  buffer_load_dwordx4 v10, s[4:7], s28 offen offset:1024  lds
  v_mfma_f32_16x16x32_bf16 v[112:115], a[104:107], a[16:19], 0
  ds_read_b64_tr_b16 a[72:73], v5 offset:14336
  v_mfma_f32_16x16x32_bf16 v[132:135], a[108:111], a[20:23], 0
  buffer_load_dwordx4 v11, s[4:7], s28 offen offset:2048  lds
  v_mfma_f32_16x16x32_bf16 v[136:139], a[112:115], a[20:23], 0
  ds_read_b64_tr_b16 a[74:75], v5 offset:17664
  v_mfma_f32_16x16x32_bf16 v[140:143], a[116:119], a[20:23], 0
  ds_read_b64_tr_b16 a[76:77], v6 offset:14336
  v_mfma_f32_16x16x32_bf16 v[128:131], a[104:107], a[20:23], 0
  buffer_load_dwordx4 v12, s[4:7], s28 offen offset:3072  lds
  v_mfma_f32_16x16x32_bf16 v[148:151], a[108:111], a[24:27], 0
  ds_read_b64_tr_b16 a[78:79], v6 offset:17664
  v_mfma_f32_16x16x32_bf16 v[152:155], a[112:115], a[24:27], 0
  s_add_u32 s27, s27, 128
  v_mfma_f32_16x16x32_bf16 v[156:159], a[116:119], a[24:27], 0
  ds_read_b64_tr_b16 a[80:81], v7 offset:14336
  v_mfma_f32_16x16x32_bf16 v[144:147], a[104:107], a[24:27], 0
  ds_read_b64_tr_b16 a[82:83], v7 offset:17664
  v_mfma_f32_16x16x32_bf16 v[164:167], a[108:111], a[28:31], 0
  s_add_u32 s28, s28, 128
  v_mfma_f32_16x16x32_bf16 v[168:171], a[112:115], a[28:31], 0
  ds_read_b64_tr_b16 a[84:85], v8 offset:13312
  v_mfma_f32_16x16x32_bf16 v[172:175], a[116:119], a[28:31], 0
  s_add_u32 m0, s31, 0
  v_mfma_f32_16x16x32_bf16 v[160:163], a[104:107], a[28:31], 0
  v_mfma_f32_16x16x32_bf16 v[180:183], a[32:35], a[108:111], v[176:179]
  ds_read_b64_tr_b16 a[86:87], v8 offset:16640
  v_mfma_f32_16x16x32_bf16 v[184:187], a[32:35], a[112:115], v[176:179]
  buffer_load_dwordx4 v13, s[8:11], s29 offen offset:0  lds
  v_mfma_f32_16x16x32_bf16 v[188:191], a[32:35], a[116:119], v[176:179]
  ds_read_b64_tr_b16 a[88:89], v8 offset:13344
  v_mfma_f32_16x16x32_bf16 v[176:179], a[32:35], a[104:107], v[176:179]
  ds_read_b64_tr_b16 a[90:91], v8 offset:16672
  v_mfma_f32_16x16x32_bf16 v[196:199], a[36:39], a[108:111], v[192:195]
  buffer_load_dwordx4 v14, s[8:11], s29 offen offset:1024  lds
  v_mfma_f32_16x16x32_bf16 v[200:203], a[36:39], a[112:115], v[192:195]
  ds_read_b64_tr_b16 a[92:93], v8 offset:13376
  v_mfma_f32_16x16x32_bf16 v[204:207], a[36:39], a[116:119], v[192:195]
  buffer_load_dwordx4 v15, s[12:15], s30 offen offset:2048  lds
  v_mfma_f32_16x16x32_bf16 v[192:195], a[36:39], a[104:107], v[192:195]
  ds_read_b64_tr_b16 a[94:95], v8 offset:16704
  v_mfma_f32_16x16x32_bf16 v[212:215], a[40:43], a[108:111], v[208:211]
  s_mov_b64 exec, s[34:35]
  buffer_load_dwordx4 v16, s[12:15], s30 offen offset:3072  lds
  s_mov_b64 exec, -1
  v_mfma_f32_16x16x32_bf16 v[216:219], a[40:43], a[112:115], v[208:211]
  ds_read_b64_tr_b16 a[96:97], v8 offset:13408
  v_mfma_f32_16x16x32_bf16 v[220:223], a[40:43], a[116:119], v[208:211]
  ds_read_b64_tr_b16 a[98:99], v8 offset:16736
  v_mfma_f32_16x16x32_bf16 v[208:211], a[40:43], a[104:107], v[208:211]
  s_add_u32 s29, s29, 196608
  v_mfma_f32_16x16x32_bf16 v[228:231], a[44:47], a[108:111], v[224:227]
  ds_read_b64_tr_b16 a[100:101], v8 offset:13440
  v_mfma_f32_16x16x32_bf16 v[232:235], a[44:47], a[112:115], v[224:227]
  s_add_u32 s30, s30, 229376
  v_mfma_f32_16x16x32_bf16 v[236:239], a[44:47], a[116:119], v[224:227]
  ds_read_b64_tr_b16 a[102:103], v8 offset:16768
  v_mfma_f32_16x16x32_bf16 v[224:227], a[44:47], a[104:107], v[224:227]
  v_mfma_f32_16x16x32_bf16 v[244:247], a[48:51], a[108:111], v[240:243]
  v_mfma_f32_16x16x32_bf16 v[248:251], a[48:51], a[112:115], v[240:243]
  v_mfma_f32_16x16x32_bf16 v[252:255], a[48:51], a[116:119], v[240:243]
  v_mfma_f32_16x16x32_bf16 v[240:243], a[48:51], a[104:107], v[240:243]
  s_waitcnt vmcnt(22) lgkmcnt(0)
  s_barrier
  v_mfma_f32_16x16x32_bf16 v[48:51], a[120:123], a[52:55], v[48:51]
  s_add_u32 m0, s31, 13312
  v_mfma_f32_16x16x32_bf16 v[52:55], a[124:127], a[52:55], v[52:55]
  ds_read_b128 a[104:107], v2 offset:8192
  v_mfma_f32_16x16x32_bf16 v[56:59], a[128:131], a[52:55], v[56:59]
  ds_read_b128 a[108:111], v2 offset:10240
  v_mfma_f32_16x16x32_bf16 v[60:63], a[132:135], a[52:55], v[60:63]
  ds_read_b128 a[112:115], v2 offset:12288
  v_mfma_f32_16x16x32_bf16 v[64:67], a[120:123], a[56:59], v[64:67]
  ds_read_b128 a[116:119], v2 offset:14336
  v_mfma_f32_16x16x32_bf16 v[68:71], a[124:127], a[56:59], v[68:71]
  ds_read_b128 a[136:139], v3 offset:8192
  v_mfma_f32_16x16x32_bf16 v[72:75], a[128:131], a[56:59], v[72:75]
  v_mfma_f32_16x16x32_bf16 v[76:79], a[132:135], a[56:59], v[76:79]
  buffer_load_dwordx4 v13, s[8:11], s29 offen offset:0  lds
  v_mfma_f32_16x16x32_bf16 v[80:83], a[120:123], a[60:63], v[80:83]
  ds_read_b128 a[140:143], v3 offset:10240
  v_mfma_f32_16x16x32_bf16 v[84:87], a[124:127], a[60:63], v[84:87]
  ds_read_b128 a[144:147], v3 offset:12288
  v_mfma_f32_16x16x32_bf16 v[88:91], a[128:131], a[60:63], v[88:91]
  ds_read_b128 a[148:151], v3 offset:14336
  v_mfma_f32_16x16x32_bf16 v[92:95], a[132:135], a[60:63], v[92:95]
  ds_read_b64_tr_b16 a[0:1], v4 offset:26624
  v_mfma_f32_16x16x32_bf16 v[96:99], a[120:123], a[64:67], v[96:99]
  ds_read_b64_tr_b16 a[2:3], v4 offset:29952
  v_mfma_f32_16x16x32_bf16 v[100:103], a[124:127], a[64:67], v[100:103]
  v_mfma_f32_16x16x32_bf16 v[104:107], a[128:131], a[64:67], v[104:107]
  buffer_load_dwordx4 v14, s[8:11], s29 offen offset:1024  lds
  v_mfma_f32_16x16x32_bf16 v[108:111], a[132:135], a[64:67], v[108:111]
  ds_read_b64_tr_b16 a[4:5], v5 offset:26624
  v_mfma_f32_16x16x32_bf16 v[112:115], a[120:123], a[68:71], v[112:115]
  ds_read_b64_tr_b16 a[6:7], v5 offset:29952
  v_mfma_f32_16x16x32_bf16 v[116:119], a[124:127], a[68:71], v[116:119]
  ds_read_b64_tr_b16 a[8:9], v6 offset:26624
  v_mfma_f32_16x16x32_bf16 v[120:123], a[128:131], a[68:71], v[120:123]
  ds_read_b64_tr_b16 a[10:11], v6 offset:29952
  v_mfma_f32_16x16x32_bf16 v[124:127], a[132:135], a[68:71], v[124:127]
  ds_read_b64_tr_b16 a[12:13], v7 offset:26624
  v_mfma_f32_16x16x32_bf16 v[128:131], a[120:123], a[72:75], v[128:131]
  v_mfma_f32_16x16x32_bf16 v[132:135], a[124:127], a[72:75], v[132:135]
  buffer_load_dwordx4 v15, s[12:15], s30 offen offset:2048  lds
  v_mfma_f32_16x16x32_bf16 v[136:139], a[128:131], a[72:75], v[136:139]
  ds_read_b64_tr_b16 a[14:15], v7 offset:29952
  v_mfma_f32_16x16x32_bf16 v[140:143], a[132:135], a[72:75], v[140:143]
  ds_read_b64_tr_b16 a[16:17], v4 offset:27648
  v_mfma_f32_16x16x32_bf16 v[144:147], a[120:123], a[76:79], v[144:147]
  ds_read_b64_tr_b16 a[18:19], v4 offset:30976
  v_mfma_f32_16x16x32_bf16 v[148:151], a[124:127], a[76:79], v[148:151]
  ds_read_b64_tr_b16 a[20:21], v5 offset:27648
  v_mfma_f32_16x16x32_bf16 v[152:155], a[128:131], a[76:79], v[152:155]
  ds_read_b64_tr_b16 a[22:23], v5 offset:30976
  v_mfma_f32_16x16x32_bf16 v[156:159], a[132:135], a[76:79], v[156:159]
  v_mfma_f32_16x16x32_bf16 v[160:163], a[120:123], a[80:83], v[160:163]
  s_mov_b64 exec, s[34:35]
  buffer_load_dwordx4 v16, s[12:15], s30 offen offset:3072  lds
  s_mov_b64 exec, -1
  v_mfma_f32_16x16x32_bf16 v[164:167], a[124:127], a[80:83], v[164:167]
  ds_read_b64_tr_b16 a[24:25], v6 offset:27648
  v_mfma_f32_16x16x32_bf16 v[168:171], a[128:131], a[80:83], v[168:171]
  ds_read_b64_tr_b16 a[26:27], v6 offset:30976
  v_mfma_f32_16x16x32_bf16 v[172:175], a[132:135], a[80:83], v[172:175]
  ds_read_b64_tr_b16 a[28:29], v7 offset:27648
  v_mfma_f32_16x16x32_bf16 v[176:179], a[84:87], a[120:123], v[176:179]
  ds_read_b64_tr_b16 a[30:31], v7 offset:30976
  v_mfma_f32_16x16x32_bf16 v[180:183], a[84:87], a[124:127], v[180:183]
  ds_read_b64_tr_b16 a[32:33], v8 offset:26624
  v_mfma_f32_16x16x32_bf16 v[184:187], a[84:87], a[128:131], v[184:187]
  v_mfma_f32_16x16x32_bf16 v[188:191], a[84:87], a[132:135], v[188:191]
  s_add_u32 s29, s29, 196608
  v_mfma_f32_16x16x32_bf16 v[192:195], a[88:91], a[120:123], v[192:195]
  ds_read_b64_tr_b16 a[34:35], v8 offset:29952
  v_mfma_f32_16x16x32_bf16 v[196:199], a[88:91], a[124:127], v[196:199]
  ds_read_b64_tr_b16 a[36:37], v8 offset:26656
  v_mfma_f32_16x16x32_bf16 v[200:203], a[88:91], a[128:131], v[200:203]
  ds_read_b64_tr_b16 a[38:39], v8 offset:29984
  v_mfma_f32_16x16x32_bf16 v[204:207], a[88:91], a[132:135], v[204:207]
  ds_read_b64_tr_b16 a[40:41], v8 offset:26688
  v_mfma_f32_16x16x32_bf16 v[208:211], a[92:95], a[120:123], v[208:211]
  ds_read_b64_tr_b16 a[42:43], v8 offset:30016
  v_mfma_f32_16x16x32_bf16 v[212:215], a[92:95], a[124:127], v[212:215]
  v_mfma_f32_16x16x32_bf16 v[216:219], a[92:95], a[128:131], v[216:219]
  s_add_u32 s30, s30, 229376
  v_mfma_f32_16x16x32_bf16 v[220:223], a[92:95], a[132:135], v[220:223]
  ds_read_b64_tr_b16 a[44:45], v8 offset:26720
  v_mfma_f32_16x16x32_bf16 v[224:227], a[96:99], a[120:123], v[224:227]
  ds_read_b64_tr_b16 a[46:47], v8 offset:30048
  v_mfma_f32_16x16x32_bf16 v[228:231], a[96:99], a[124:127], v[228:231]
  ds_read_b64_tr_b16 a[48:49], v8 offset:26752
  v_mfma_f32_16x16x32_bf16 v[232:235], a[96:99], a[128:131], v[232:235]
  ds_read_b64_tr_b16 a[50:51], v8 offset:30080
  v_mfma_f32_16x16x32_bf16 v[236:239], a[96:99], a[132:135], v[236:239]
  v_mfma_f32_16x16x32_bf16 v[240:243], a[100:103], a[120:123], v[240:243]
  v_mfma_f32_16x16x32_bf16 v[244:247], a[100:103], a[124:127], v[244:247]
  v_mfma_f32_16x16x32_bf16 v[248:251], a[100:103], a[128:131], v[248:251]
  v_mfma_f32_16x16x32_bf16 v[252:255], a[100:103], a[132:135], v[252:255]
  s_waitcnt vmcnt(22) lgkmcnt(0)
  s_barrier
  v_mfma_f32_16x16x32_bf16 v[48:51], a[104:107], a[0:3], v[48:51]
  s_add_u32 m0, s32, 8192
  v_mfma_f32_16x16x32_bf16 v[52:55], a[108:111], a[0:3], v[52:55]
  ds_read_b64_tr_b16 a[52:53], v4 offset:39936
  v_mfma_f32_16x16x32_bf16 v[56:59], a[112:115], a[0:3], v[56:59]
  ds_read_b64_tr_b16 a[54:55], v4 offset:43264
  v_mfma_f32_16x16x32_bf16 v[60:63], a[116:119], a[0:3], v[60:63]
  buffer_load_dwordx4 v9, s[4:7], s27 offen offset:0  lds
  v_mfma_f32_16x16x32_bf16 v[64:67], a[104:107], a[4:7], v[64:67]
  ds_read_b64_tr_b16 a[56:57], v5 offset:39936
  v_mfma_f32_16x16x32_bf16 v[68:71], a[108:111], a[4:7], v[68:71]
  buffer_load_dwordx4 v10, s[4:7], s27 offen offset:1024  lds
  v_mfma_f32_16x16x32_bf16 v[72:75], a[112:115], a[4:7], v[72:75]
  ds_read_b64_tr_b16 a[58:59], v5 offset:43264
  v_mfma_f32_16x16x32_bf16 v[76:79], a[116:119], a[4:7], v[76:79]
  ds_read_b64_tr_b16 a[60:61], v6 offset:39936
  v_mfma_f32_16x16x32_bf16 v[80:83], a[104:107], a[8:11], v[80:83]
  buffer_load_dwordx4 v11, s[4:7], s27 offen offset:2048  lds
  v_mfma_f32_16x16x32_bf16 v[84:87], a[108:111], a[8:11], v[84:87]
  ds_read_b64_tr_b16 a[62:63], v6 offset:43264
  v_mfma_f32_16x16x32_bf16 v[88:91], a[112:115], a[8:11], v[88:91]
  buffer_load_dwordx4 v12, s[4:7], s27 offen offset:3072  lds
  v_mfma_f32_16x16x32_bf16 v[92:95], a[116:119], a[8:11], v[92:95]
  ds_read_b64_tr_b16 a[64:65], v7 offset:39936
  v_mfma_f32_16x16x32_bf16 v[96:99], a[104:107], a[12:15], v[96:99]
  s_add_u32 m0, s32, 12288
  v_mfma_f32_16x16x32_bf16 v[100:103], a[108:111], a[12:15], v[100:103]
  ds_read_b64_tr_b16 a[66:67], v7 offset:43264
  v_mfma_f32_16x16x32_bf16 v[104:107], a[112:115], a[12:15], v[104:107]
  ds_read_b64_tr_b16 a[68:69], v4 offset:40960
  v_mfma_f32_16x16x32_bf16 v[108:111], a[116:119], a[12:15], v[108:111]
  v_mfma_f32_16x16x32_bf16 v[112:115], a[104:107], a[16:19], v[112:115]
  buffer_load_dwordx4 v9, s[4:7], s28 offen offset:0  lds
  v_mfma_f32_16x16x32_bf16 v[116:119], a[108:111], a[16:19], v[116:119]
  ds_read_b64_tr_b16 a[70:71], v4 offset:44288
  v_mfma_f32_16x16x32_bf16 v[120:123], a[112:115], a[16:19], v[120:123]
  buffer_load_dwordx4 v10, s[4:7], s28 offen offset:1024  lds
  v_mfma_f32_16x16x32_bf16 v[124:127], a[116:119], a[16:19], v[124:127]
  ds_read_b64_tr_b16 a[72:73], v5 offset:40960
  v_mfma_f32_16x16x32_bf16 v[128:131], a[104:107], a[20:23], v[128:131]
  buffer_load_dwordx4 v11, s[4:7], s28 offen offset:2048  lds
  v_mfma_f32_16x16x32_bf16 v[132:135], a[108:111], a[20:23], v[132:135]
  ds_read_b64_tr_b16 a[74:75], v5 offset:44288
  v_mfma_f32_16x16x32_bf16 v[136:139], a[112:115], a[20:23], v[136:139]
  ds_read_b64_tr_b16 a[76:77], v6 offset:40960
  v_mfma_f32_16x16x32_bf16 v[140:143], a[116:119], a[20:23], v[140:143]
  buffer_load_dwordx4 v12, s[4:7], s28 offen offset:3072  lds
  v_mfma_f32_16x16x32_bf16 v[144:147], a[104:107], a[24:27], v[144:147]
  ds_read_b64_tr_b16 a[78:79], v6 offset:44288
  v_mfma_f32_16x16x32_bf16 v[148:151], a[108:111], a[24:27], v[148:151]
  s_add_u32 s27, s27, 128
  v_mfma_f32_16x16x32_bf16 v[152:155], a[112:115], a[24:27], v[152:155]
  ds_read_b64_tr_b16 a[80:81], v7 offset:40960
  v_mfma_f32_16x16x32_bf16 v[156:159], a[116:119], a[24:27], v[156:159]
  ds_read_b64_tr_b16 a[82:83], v7 offset:44288
  v_mfma_f32_16x16x32_bf16 v[160:163], a[104:107], a[28:31], v[160:163]
  s_add_u32 s28, s28, 128
  v_mfma_f32_16x16x32_bf16 v[164:167], a[108:111], a[28:31], v[164:167]
  ds_read_b64_tr_b16 a[84:85], v8 offset:39936
  v_mfma_f32_16x16x32_bf16 v[168:171], a[112:115], a[28:31], v[168:171]
  s_add_u32 m0, s31, 26624
  v_mfma_f32_16x16x32_bf16 v[172:175], a[116:119], a[28:31], v[172:175]
  v_mfma_f32_16x16x32_bf16 v[176:179], a[32:35], a[104:107], v[176:179]
  ds_read_b64_tr_b16 a[86:87], v8 offset:43264
  v_mfma_f32_16x16x32_bf16 v[180:183], a[32:35], a[108:111], v[180:183]
  buffer_load_dwordx4 v13, s[8:11], s29 offen offset:0  lds
  v_mfma_f32_16x16x32_bf16 v[184:187], a[32:35], a[112:115], v[184:187]
  ds_read_b64_tr_b16 a[88:89], v8 offset:39968
  v_mfma_f32_16x16x32_bf16 v[188:191], a[32:35], a[116:119], v[188:191]
  ds_read_b64_tr_b16 a[90:91], v8 offset:43296
  v_mfma_f32_16x16x32_bf16 v[192:195], a[36:39], a[104:107], v[192:195]
  buffer_load_dwordx4 v14, s[8:11], s29 offen offset:1024  lds
  v_mfma_f32_16x16x32_bf16 v[196:199], a[36:39], a[108:111], v[196:199]
  ds_read_b64_tr_b16 a[92:93], v8 offset:40000
  v_mfma_f32_16x16x32_bf16 v[200:203], a[36:39], a[112:115], v[200:203]
  buffer_load_dwordx4 v15, s[12:15], s30 offen offset:2048  lds
  v_mfma_f32_16x16x32_bf16 v[204:207], a[36:39], a[116:119], v[204:207]
  ds_read_b64_tr_b16 a[94:95], v8 offset:43328
  v_mfma_f32_16x16x32_bf16 v[208:211], a[40:43], a[104:107], v[208:211]
  s_mov_b64 exec, s[34:35]
  buffer_load_dwordx4 v16, s[12:15], s30 offen offset:3072  lds
  s_mov_b64 exec, -1
  v_mfma_f32_16x16x32_bf16 v[212:215], a[40:43], a[108:111], v[212:215]
  ds_read_b64_tr_b16 a[96:97], v8 offset:40032
  v_mfma_f32_16x16x32_bf16 v[216:219], a[40:43], a[112:115], v[216:219]
  ds_read_b64_tr_b16 a[98:99], v8 offset:43360
  v_mfma_f32_16x16x32_bf16 v[220:223], a[40:43], a[116:119], v[220:223]
  s_add_u32 s29, s29, 196608
  v_mfma_f32_16x16x32_bf16 v[224:227], a[44:47], a[104:107], v[224:227]
  ds_read_b64_tr_b16 a[100:101], v8 offset:40064
  v_mfma_f32_16x16x32_bf16 v[228:231], a[44:47], a[108:111], v[228:231]
  s_add_u32 s30, s30, 229376
  v_mfma_f32_16x16x32_bf16 v[232:235], a[44:47], a[112:115], v[232:235]
  ds_read_b64_tr_b16 a[102:103], v8 offset:43392
  v_mfma_f32_16x16x32_bf16 v[236:239], a[44:47], a[116:119], v[236:239]
  v_mfma_f32_16x16x32_bf16 v[240:243], a[48:51], a[104:107], v[240:243]
  v_mfma_f32_16x16x32_bf16 v[244:247], a[48:51], a[108:111], v[244:247]
  v_mfma_f32_16x16x32_bf16 v[248:251], a[48:51], a[112:115], v[248:251]
  v_mfma_f32_16x16x32_bf16 v[252:255], a[48:51], a[116:119], v[252:255]
  s_waitcnt vmcnt(16) lgkmcnt(0)
  s_barrier
  v_mfma_f32_16x16x32_bf16 v[48:51], a[136:139], a[52:55], v[48:51]
  s_add_u32 m0, s31, 39936
  ds_read_b128 a[104:107], v2 offset:0
  v_mfma_f32_16x16x32_bf16 v[52:55], a[140:143], a[52:55], v[52:55]
  buffer_load_dwordx4 v13, s[8:11], s29 offen offset:0  lds
  ds_read_b128 a[108:111], v2 offset:2048
  v_mfma_f32_16x16x32_bf16 v[56:59], a[144:147], a[52:55], v[56:59]
  buffer_load_dwordx4 v14, s[8:11], s29 offen offset:1024  lds
  v_mfma_f32_16x16x32_bf16 v[60:63], a[148:151], a[52:55], v[60:63]
  ds_read_b128 a[112:115], v2 offset:4096
  buffer_load_dwordx4 v15, s[12:15], s30 offen offset:2048  lds
  v_mfma_f32_16x16x32_bf16 v[64:67], a[136:139], a[56:59], v[64:67]
  ds_read_b128 a[116:119], v2 offset:6144
  s_mov_b64 exec, s[34:35]
  buffer_load_dwordx4 v16, s[12:15], s30 offen offset:3072  lds
  s_mov_b64 exec, -1
  v_mfma_f32_16x16x32_bf16 v[68:71], a[140:143], a[56:59], v[68:71]
  s_add_u32 s29, s29, 196608
  v_mfma_f32_16x16x32_bf16 v[72:75], a[144:147], a[56:59], v[72:75]
  ds_read_b128 a[120:123], v3 offset:0
  s_add_u32 s30, s30, 229376
  v_mfma_f32_16x16x32_bf16 v[76:79], a[148:151], a[56:59], v[76:79]
  ds_read_b128 a[124:127], v3 offset:2048
  v_mfma_f32_16x16x32_bf16 v[80:83], a[136:139], a[60:63], v[80:83]
  s_mov_b32 s16, s56
  s_and_b32 s17, s57, 0xffff
  ds_read_b128 a[128:131], v3 offset:4096
  v_mfma_f32_16x16x32_bf16 v[84:87], a[140:143], a[60:63], v[84:87]
  s_mov_b32 s18, 33212416
  s_mov_b32 s19, 0x20000
  s_and_b32 s60, s2, 7
  s_lshr_b32 s61, s2, 3
  v_mfma_f32_16x16x32_bf16 v[88:91], a[144:147], a[60:63], v[88:91]
  ds_read_b128 a[132:135], v3 offset:6144
  v_mfma_f32_16x16x32_bf16 v[92:95], a[148:151], a[60:63], v[92:95]
  s_and_b32 s66, s60, 1
  s_lshr_b32 s60, s60, 1
  ds_read_b64_tr_b16 a[0:1], v4 offset:0
  v_mfma_f32_16x16x32_bf16 v[96:99], a[136:139], a[64:67], v[96:99]
  s_and_b32 s64, s60, 1
  s_lshl_b32 s64, s64, 3
  ds_read_b64_tr_b16 a[2:3], v4 offset:3328
  v_mfma_f32_16x16x32_bf16 v[100:103], a[140:143], a[64:67], v[100:103]
  s_and_b32 s67, s61, 7
  s_add_u32 s64, s64, s67
  v_mfma_f32_16x16x32_bf16 v[104:107], a[144:147], a[64:67], v[104:107]
  ds_read_b64_tr_b16 a[4:5], v5 offset:0
  s_lshr_b32 s65, s60, 1
  s_lshl_b32 s65, s65, 2
  v_mfma_f32_16x16x32_bf16 v[108:111], a[148:151], a[64:67], v[108:111]
  s_lshr_b32 s61, s61, 3
  s_add_u32 s65, s65, s61
  v_mfma_f32_16x16x32_bf16 v[112:115], a[136:139], a[68:71], v[112:115]
  ds_read_b64_tr_b16 a[6:7], v5 offset:3328
  s_lshl_b32 s67, s64, 3
  s_add_u32 s67, s67, s65
  v_mfma_f32_16x16x32_bf16 v[116:119], a[140:143], a[68:71], v[116:119]
  ds_read_b64_tr_b16 a[8:9], v6 offset:0
  s_lshl_b32 s60, s25, 1
  s_lshr_b32 s61, s24, 1
  v_mfma_f32_16x16x32_bf16 v[120:123], a[144:147], a[68:71], v[120:123]
  ds_read_b64_tr_b16 a[10:11], v6 offset:3328
  v_mfma_f32_16x16x32_bf16 v[124:127], a[148:151], a[68:71], v[124:127]
  s_add_u32 s60, s60, s61
  s_lshl_b32 s60, s60, 5
  s_lshl_b32 s61, s26, 1
  s_add_u32 s60, s60, s61
  v_mfma_f32_16x16x32_bf16 v[128:131], a[136:139], a[72:75], v[128:131]
  ds_read_b64_tr_b16 a[12:13], v7 offset:0
  s_lshl_b32 s60, s60, 1
  s_and_b32 s61, s24, 1
  v_mfma_f32_16x16x32_bf16 v[132:135], a[140:143], a[72:75], v[132:135]
  ds_read_b64_tr_b16 a[14:15], v7 offset:3328
  v_mfma_f32_16x16x32_bf16 v[136:139], a[144:147], a[72:75], v[136:139]
  s_add_u32 s60, s60, s61
  s_lshl_b32 s60, s60, 3
  ds_read_b64_tr_b16 a[16:17], v4 offset:1024
  v_mfma_f32_16x16x32_bf16 v[140:143], a[148:151], a[72:75], v[140:143]
  s_add_u32 s60, s60, 33136640
  v_writelane_b32 v0, s60, 4
  v_mfma_f32_16x16x32_bf16 v[144:147], a[136:139], a[76:79], v[144:147]
  s_lshl_b32 s60, s25, 1
  s_lshr_b32 s63, s24, 1
  ds_read_b64_tr_b16 a[18:19], v4 offset:4352
  v_mfma_f32_16x16x32_bf16 v[148:151], a[140:143], a[76:79], v[148:151]
  s_add_u32 s60, s60, s63
  s_lshl_b32 s60, s60, 5
  ds_read_b64_tr_b16 a[20:21], v5 offset:1024
  v_mfma_f32_16x16x32_bf16 v[152:155], a[144:147], a[76:79], v[152:155]
  s_add_u32 s60, s60, s26
  s_lshl_b32 s60, s60, 1
  v_mfma_f32_16x16x32_bf16 v[156:159], a[148:151], a[76:79], v[156:159]
  ds_read_b64_tr_b16 a[22:23], v5 offset:4352
  s_add_u32 s60, s60, s61
  s_lshl_b32 s60, s60, 3
  v_mfma_f32_16x16x32_bf16 v[160:163], a[136:139], a[80:83], v[160:163]
  ds_read_b64_tr_b16 a[24:25], v6 offset:1024
  s_add_u32 s60, s60, 33202176
  v_writelane_b32 v0, s60, 0
  v_mfma_f32_16x16x32_bf16 v[164:167], a[140:143], a[80:83], v[164:167]
  s_lshl_b32 s60, s26, 4
  s_add_u32 s60, s60, s25
  v_mfma_f32_16x16x32_bf16 v[168:171], a[144:147], a[80:83], v[168:171]
  ds_read_b64_tr_b16 a[26:27], v6 offset:4352
  s_lshl_b32 s60, s60, 2
  s_add_u32 s60, s60, s24
  v_mfma_f32_16x16x32_bf16 v[172:175], a[148:151], a[80:83], v[172:175]
  ds_read_b64_tr_b16 a[28:29], v7 offset:1024
  v_mfma_f32_16x16x32_bf16 v[176:179], a[84:87], a[136:139], v[176:179]
  s_lshl_b32 s60, s60, 3
  s_add_u32 s60, s60, 33144832
  ds_read_b64_tr_b16 a[30:31], v7 offset:4352
  v_mfma_f32_16x16x32_bf16 v[180:183], a[84:87], a[140:143], v[180:183]
  v_writelane_b32 v0, s60, 1
  s_lshr_b32 s60, s2, 5
  s_lshl_b32 s60, s60, 1
  s_lshr_b32 s61, s24, 1
  v_mfma_f32_16x16x32_bf16 v[184:187], a[84:87], a[144:147], v[184:187]
  ds_read_b64_tr_b16 a[32:33], v8 offset:0
  v_mfma_f32_16x16x32_bf16 v[188:191], a[84:87], a[148:151], v[188:191]
  s_add_u32 s60, s60, s61
  s_lshl_b32 s60, s60, 9
  ds_read_b64_tr_b16 a[34:35], v8 offset:3328
  v_mfma_f32_16x16x32_bf16 v[192:195], a[88:91], a[136:139], v[192:195]
  s_and_b32 s61, s2, 31
  s_lshl_b32 s61, s61, 4
  ds_read_b64_tr_b16 a[36:37], v8 offset:32
  v_mfma_f32_16x16x32_bf16 v[196:199], a[88:91], a[140:143], v[196:199]
  s_add_u32 s60, s60, s61
  s_and_b32 s61, s24, 1
  v_mfma_f32_16x16x32_bf16 v[200:203], a[88:91], a[144:147], v[200:203]
  ds_read_b64_tr_b16 a[38:39], v8 offset:3360
  s_lshl_b32 s61, s61, 3
  s_add_u32 s60, s60, s61
  v_mfma_f32_16x16x32_bf16 v[204:207], a[88:91], a[148:151], v[204:207]
  s_add_u32 s60, s60, 33153024
  s_lshl_b32 s61, s67, 8
  v_mfma_f32_16x16x32_bf16 v[208:211], a[92:95], a[136:139], v[208:211]
  ds_read_b64_tr_b16 a[40:41], v8 offset:64
  s_lshl_b32 s63, s24, 3
  s_add_u32 s61, s61, s63
  v_mfma_f32_16x16x32_bf16 v[212:215], a[92:95], a[140:143], v[212:215]
  ds_read_b64_tr_b16 a[42:43], v8 offset:3392
  s_add_u32 s61, s61, 33161216
  s_cmp_eq_u32 s66, 0
  s_cselect_b32 s61, s61, 0x7ffffff0
  v_mfma_f32_16x16x32_bf16 v[216:219], a[92:95], a[144:147], v[216:219]
  ds_read_b64_tr_b16 a[44:45], v8 offset:96
  v_mfma_f32_16x16x32_bf16 v[220:223], a[92:95], a[148:151], v[220:223]
  v_writelane_b32 v0, s60, 2
  v_writelane_b32 v0, s61, 3
  s_mul_i32 s60, s2, 171
  s_lshr_b32 s60, s60, 10
  v_mfma_f32_16x16x32_bf16 v[224:227], a[96:99], a[136:139], v[224:227]
  ds_read_b64_tr_b16 a[46:47], v8 offset:3424
  s_lshl_b32 s60, s60, 1
  s_add_u32 s60, s60, s2
  v_mfma_f32_16x16x32_bf16 v[228:231], a[96:99], a[140:143], v[228:231]
  ds_read_b64_tr_b16 a[48:49], v8 offset:128
  v_mfma_f32_16x16x32_bf16 v[232:235], a[96:99], a[144:147], v[232:235]
  s_lshl_b32 s60, s60, 3
  s_add_u32 s60, s60, 33210368
  ds_read_b64_tr_b16 a[50:51], v8 offset:3456
  v_mfma_f32_16x16x32_bf16 v[236:239], a[96:99], a[148:151], v[236:239]
  v_writelane_b32 v0, s60, 5
  v_mfma_f32_16x16x32_bf16 v[240:243], a[100:103], a[136:139], v[240:243]
  v_mfma_f32_16x16x32_bf16 v[244:247], a[100:103], a[140:143], v[244:247]
  v_mfma_f32_16x16x32_bf16 v[248:251], a[100:103], a[144:147], v[248:251]
  v_mfma_f32_16x16x32_bf16 v[252:255], a[100:103], a[148:151], v[252:255]
  s_waitcnt vmcnt(16) lgkmcnt(0)
  s_barrier
  s_mov_b32 s33, 6
L_k1A_loop:
  v_mfma_f32_16x16x32_bf16 v[48:51], a[104:107], a[0:3], v[48:51]
  s_add_u32 m0, s32, 0
  v_mfma_f32_16x16x32_bf16 v[52:55], a[108:111], a[0:3], v[52:55]
  ds_read_b64_tr_b16 a[52:53], v4 offset:13312
  v_mfma_f32_16x16x32_bf16 v[56:59], a[112:115], a[0:3], v[56:59]
  ds_read_b64_tr_b16 a[54:55], v4 offset:16640
  v_mfma_f32_16x16x32_bf16 v[60:63], a[116:119], a[0:3], v[60:63]
  buffer_load_dwordx4 v9, s[4:7], s27 offen offset:0  lds
  v_mfma_f32_16x16x32_bf16 v[64:67], a[104:107], a[4:7], v[64:67]
  ds_read_b64_tr_b16 a[56:57], v5 offset:13312
  v_mfma_f32_16x16x32_bf16 v[68:71], a[108:111], a[4:7], v[68:71]
  buffer_load_dwordx4 v10, s[4:7], s27 offen offset:1024  lds
  v_mfma_f32_16x16x32_bf16 v[72:75], a[112:115], a[4:7], v[72:75]
  ds_read_b64_tr_b16 a[58:59], v5 offset:16640
  v_mfma_f32_16x16x32_bf16 v[76:79], a[116:119], a[4:7], v[76:79]
  ds_read_b64_tr_b16 a[60:61], v6 offset:13312
  v_mfma_f32_16x16x32_bf16 v[80:83], a[104:107], a[8:11], v[80:83]
  buffer_load_dwordx4 v11, s[4:7], s27 offen offset:2048  lds
  v_mfma_f32_16x16x32_bf16 v[84:87], a[108:111], a[8:11], v[84:87]
  ds_read_b64_tr_b16 a[62:63], v6 offset:16640
  v_mfma_f32_16x16x32_bf16 v[88:91], a[112:115], a[8:11], v[88:91]
  buffer_load_dwordx4 v12, s[4:7], s27 offen offset:3072  lds
  v_mfma_f32_16x16x32_bf16 v[92:95], a[116:119], a[8:11], v[92:95]
  ds_read_b64_tr_b16 a[64:65], v7 offset:13312
  v_mfma_f32_16x16x32_bf16 v[96:99], a[104:107], a[12:15], v[96:99]
  s_add_u32 m0, s32, 4096
  v_mfma_f32_16x16x32_bf16 v[100:103], a[108:111], a[12:15], v[100:103]
  ds_read_b64_tr_b16 a[66:67], v7 offset:16640
  v_mfma_f32_16x16x32_bf16 v[104:107], a[112:115], a[12:15], v[104:107]
  ds_read_b64_tr_b16 a[68:69], v4 offset:14336
  v_mfma_f32_16x16x32_bf16 v[108:111], a[116:119], a[12:15], v[108:111]
  v_mfma_f32_16x16x32_bf16 v[112:115], a[104:107], a[16:19], v[112:115]
  buffer_load_dwordx4 v9, s[4:7], s28 offen offset:0  lds
  v_mfma_f32_16x16x32_bf16 v[116:119], a[108:111], a[16:19], v[116:119]
  ds_read_b64_tr_b16 a[70:71], v4 offset:17664
  v_mfma_f32_16x16x32_bf16 v[120:123], a[112:115], a[16:19], v[120:123]
  buffer_load_dwordx4 v10, s[4:7], s28 offen offset:1024  lds
  v_mfma_f32_16x16x32_bf16 v[124:127], a[116:119], a[16:19], v[124:127]
  ds_read_b64_tr_b16 a[72:73], v5 offset:14336
  v_mfma_f32_16x16x32_bf16 v[128:131], a[104:107], a[20:23], v[128:131]
  buffer_load_dwordx4 v11, s[4:7], s28 offen offset:2048  lds
  v_mfma_f32_16x16x32_bf16 v[132:135], a[108:111], a[20:23], v[132:135]
  ds_read_b64_tr_b16 a[74:75], v5 offset:17664
  v_mfma_f32_16x16x32_bf16 v[136:139], a[112:115], a[20:23], v[136:139]
  ds_read_b64_tr_b16 a[76:77], v6 offset:14336
  v_mfma_f32_16x16x32_bf16 v[140:143], a[116:119], a[20:23], v[140:143]
  buffer_load_dwordx4 v12, s[4:7], s28 offen offset:3072  lds
  v_mfma_f32_16x16x32_bf16 v[144:147], a[104:107], a[24:27], v[144:147]
  ds_read_b64_tr_b16 a[78:79], v6 offset:17664
  v_mfma_f32_16x16x32_bf16 v[148:151], a[108:111], a[24:27], v[148:151]
  s_add_u32 s27, s27, 128
  v_mfma_f32_16x16x32_bf16 v[152:155], a[112:115], a[24:27], v[152:155]
  ds_read_b64_tr_b16 a[80:81], v7 offset:14336
  v_mfma_f32_16x16x32_bf16 v[156:159], a[116:119], a[24:27], v[156:159]
  ds_read_b64_tr_b16 a[82:83], v7 offset:17664
  v_mfma_f32_16x16x32_bf16 v[160:163], a[104:107], a[28:31], v[160:163]
  s_add_u32 s28, s28, 128
  v_mfma_f32_16x16x32_bf16 v[164:167], a[108:111], a[28:31], v[164:167]
  ds_read_b64_tr_b16 a[84:85], v8 offset:13312
  v_mfma_f32_16x16x32_bf16 v[168:171], a[112:115], a[28:31], v[168:171]
  s_add_u32 m0, s31, 0
  v_mfma_f32_16x16x32_bf16 v[172:175], a[116:119], a[28:31], v[172:175]
  v_mfma_f32_16x16x32_bf16 v[176:179], a[32:35], a[104:107], v[176:179]
  ds_read_b64_tr_b16 a[86:87], v8 offset:16640
  v_mfma_f32_16x16x32_bf16 v[180:183], a[32:35], a[108:111], v[180:183]
  buffer_load_dwordx4 v13, s[8:11], s29 offen offset:0  lds
  v_mfma_f32_16x16x32_bf16 v[184:187], a[32:35], a[112:115], v[184:187]
  ds_read_b64_tr_b16 a[88:89], v8 offset:13344
  v_mfma_f32_16x16x32_bf16 v[188:191], a[32:35], a[116:119], v[188:191]
  ds_read_b64_tr_b16 a[90:91], v8 offset:16672
  v_mfma_f32_16x16x32_bf16 v[192:195], a[36:39], a[104:107], v[192:195]
  buffer_load_dwordx4 v14, s[8:11], s29 offen offset:1024  lds
  v_mfma_f32_16x16x32_bf16 v[196:199], a[36:39], a[108:111], v[196:199]
  ds_read_b64_tr_b16 a[92:93], v8 offset:13376
  v_mfma_f32_16x16x32_bf16 v[200:203], a[36:39], a[112:115], v[200:203]
  buffer_load_dwordx4 v15, s[12:15], s30 offen offset:2048  lds
  v_mfma_f32_16x16x32_bf16 v[204:207], a[36:39], a[116:119], v[204:207]
  ds_read_b64_tr_b16 a[94:95], v8 offset:16704
  v_mfma_f32_16x16x32_bf16 v[208:211], a[40:43], a[104:107], v[208:211]
  s_mov_b64 exec, s[34:35]
  buffer_load_dwordx4 v16, s[12:15], s30 offen offset:3072  lds
  s_mov_b64 exec, -1
  v_mfma_f32_16x16x32_bf16 v[212:215], a[40:43], a[108:111], v[212:215]
  ds_read_b64_tr_b16 a[96:97], v8 offset:13408
  v_mfma_f32_16x16x32_bf16 v[216:219], a[40:43], a[112:115], v[216:219]
  ds_read_b64_tr_b16 a[98:99], v8 offset:16736
  v_mfma_f32_16x16x32_bf16 v[220:223], a[40:43], a[116:119], v[220:223]
  s_add_u32 s29, s29, 196608
  v_mfma_f32_16x16x32_bf16 v[224:227], a[44:47], a[104:107], v[224:227]
  ds_read_b64_tr_b16 a[100:101], v8 offset:13440
  v_mfma_f32_16x16x32_bf16 v[228:231], a[44:47], a[108:111], v[228:231]
  s_add_u32 s30, s30, 229376
  v_mfma_f32_16x16x32_bf16 v[232:235], a[44:47], a[112:115], v[232:235]
  ds_read_b64_tr_b16 a[102:103], v8 offset:16768
  v_mfma_f32_16x16x32_bf16 v[236:239], a[44:47], a[116:119], v[236:239]
  v_mfma_f32_16x16x32_bf16 v[240:243], a[48:51], a[104:107], v[240:243]
  v_mfma_f32_16x16x32_bf16 v[244:247], a[48:51], a[108:111], v[244:247]
  v_mfma_f32_16x16x32_bf16 v[248:251], a[48:51], a[112:115], v[248:251]
  v_mfma_f32_16x16x32_bf16 v[252:255], a[48:51], a[116:119], v[252:255]
  s_waitcnt vmcnt(16) lgkmcnt(0)
  s_barrier
  v_mfma_f32_16x16x32_bf16 v[48:51], a[120:123], a[52:55], v[48:51]
  s_add_u32 m0, s31, 13312
  v_mfma_f32_16x16x32_bf16 v[52:55], a[124:127], a[52:55], v[52:55]
  ds_read_b128 a[104:107], v2 offset:8192
  v_mfma_f32_16x16x32_bf16 v[56:59], a[128:131], a[52:55], v[56:59]
  ds_read_b128 a[108:111], v2 offset:10240
  v_mfma_f32_16x16x32_bf16 v[60:63], a[132:135], a[52:55], v[60:63]
  ds_read_b128 a[112:115], v2 offset:12288
  v_mfma_f32_16x16x32_bf16 v[64:67], a[120:123], a[56:59], v[64:67]
  ds_read_b128 a[116:119], v2 offset:14336
  v_mfma_f32_16x16x32_bf16 v[68:71], a[124:127], a[56:59], v[68:71]
  ds_read_b128 a[136:139], v3 offset:8192
  v_mfma_f32_16x16x32_bf16 v[72:75], a[128:131], a[56:59], v[72:75]
  v_mfma_f32_16x16x32_bf16 v[76:79], a[132:135], a[56:59], v[76:79]
  buffer_load_dwordx4 v13, s[8:11], s29 offen offset:0  lds
  v_mfma_f32_16x16x32_bf16 v[80:83], a[120:123], a[60:63], v[80:83]
  ds_read_b128 a[140:143], v3 offset:10240
  v_mfma_f32_16x16x32_bf16 v[84:87], a[124:127], a[60:63], v[84:87]
  ds_read_b128 a[144:147], v3 offset:12288
  v_mfma_f32_16x16x32_bf16 v[88:91], a[128:131], a[60:63], v[88:91]
  ds_read_b128 a[148:151], v3 offset:14336
  v_mfma_f32_16x16x32_bf16 v[92:95], a[132:135], a[60:63], v[92:95]
  ds_read_b64_tr_b16 a[0:1], v4 offset:26624
  v_mfma_f32_16x16x32_bf16 v[96:99], a[120:123], a[64:67], v[96:99]
  ds_read_b64_tr_b16 a[2:3], v4 offset:29952
  v_mfma_f32_16x16x32_bf16 v[100:103], a[124:127], a[64:67], v[100:103]
  v_mfma_f32_16x16x32_bf16 v[104:107], a[128:131], a[64:67], v[104:107]
  buffer_load_dwordx4 v14, s[8:11], s29 offen offset:1024  lds
  v_mfma_f32_16x16x32_bf16 v[108:111], a[132:135], a[64:67], v[108:111]
  ds_read_b64_tr_b16 a[4:5], v5 offset:26624
  v_mfma_f32_16x16x32_bf16 v[112:115], a[120:123], a[68:71], v[112:115]
  ds_read_b64_tr_b16 a[6:7], v5 offset:29952
  v_mfma_f32_16x16x32_bf16 v[116:119], a[124:127], a[68:71], v[116:119]
  ds_read_b64_tr_b16 a[8:9], v6 offset:26624
  v_mfma_f32_16x16x32_bf16 v[120:123], a[128:131], a[68:71], v[120:123]
  ds_read_b64_tr_b16 a[10:11], v6 offset:29952
  v_mfma_f32_16x16x32_bf16 v[124:127], a[132:135], a[68:71], v[124:127]
  ds_read_b64_tr_b16 a[12:13], v7 offset:26624
  v_mfma_f32_16x16x32_bf16 v[128:131], a[120:123], a[72:75], v[128:131]
  v_mfma_f32_16x16x32_bf16 v[132:135], a[124:127], a[72:75], v[132:135]
  buffer_load_dwordx4 v15, s[12:15], s30 offen offset:2048  lds
  v_mfma_f32_16x16x32_bf16 v[136:139], a[128:131], a[72:75], v[136:139]
  ds_read_b64_tr_b16 a[14:15], v7 offset:29952
  v_mfma_f32_16x16x32_bf16 v[140:143], a[132:135], a[72:75], v[140:143]
  ds_read_b64_tr_b16 a[16:17], v4 offset:27648
  v_mfma_f32_16x16x32_bf16 v[144:147], a[120:123], a[76:79], v[144:147]
  ds_read_b64_tr_b16 a[18:19], v4 offset:30976
  v_mfma_f32_16x16x32_bf16 v[148:151], a[124:127], a[76:79], v[148:151]
  ds_read_b64_tr_b16 a[20:21], v5 offset:27648
  v_mfma_f32_16x16x32_bf16 v[152:155], a[128:131], a[76:79], v[152:155]
  ds_read_b64_tr_b16 a[22:23], v5 offset:30976
  v_mfma_f32_16x16x32_bf16 v[156:159], a[132:135], a[76:79], v[156:159]
  v_mfma_f32_16x16x32_bf16 v[160:163], a[120:123], a[80:83], v[160:163]
  s_mov_b64 exec, s[34:35]
  buffer_load_dwordx4 v16, s[12:15], s30 offen offset:3072  lds
  s_mov_b64 exec, -1
  v_mfma_f32_16x16x32_bf16 v[164:167], a[124:127], a[80:83], v[164:167]
  ds_read_b64_tr_b16 a[24:25], v6 offset:27648
  v_mfma_f32_16x16x32_bf16 v[168:171], a[128:131], a[80:83], v[168:171]
  ds_read_b64_tr_b16 a[26:27], v6 offset:30976
  v_mfma_f32_16x16x32_bf16 v[172:175], a[132:135], a[80:83], v[172:175]
  ds_read_b64_tr_b16 a[28:29], v7 offset:27648
  v_mfma_f32_16x16x32_bf16 v[176:179], a[84:87], a[120:123], v[176:179]
  ds_read_b64_tr_b16 a[30:31], v7 offset:30976
  v_mfma_f32_16x16x32_bf16 v[180:183], a[84:87], a[124:127], v[180:183]
  ds_read_b64_tr_b16 a[32:33], v8 offset:26624
  v_mfma_f32_16x16x32_bf16 v[184:187], a[84:87], a[128:131], v[184:187]
  v_mfma_f32_16x16x32_bf16 v[188:191], a[84:87], a[132:135], v[188:191]
  s_add_u32 s29, s29, 196608
  v_mfma_f32_16x16x32_bf16 v[192:195], a[88:91], a[120:123], v[192:195]
  ds_read_b64_tr_b16 a[34:35], v8 offset:29952
  v_mfma_f32_16x16x32_bf16 v[196:199], a[88:91], a[124:127], v[196:199]
  ds_read_b64_tr_b16 a[36:37], v8 offset:26656
  v_mfma_f32_16x16x32_bf16 v[200:203], a[88:91], a[128:131], v[200:203]
  ds_read_b64_tr_b16 a[38:39], v8 offset:29984
  v_mfma_f32_16x16x32_bf16 v[204:207], a[88:91], a[132:135], v[204:207]
  ds_read_b64_tr_b16 a[40:41], v8 offset:26688
  v_mfma_f32_16x16x32_bf16 v[208:211], a[92:95], a[120:123], v[208:211]
  ds_read_b64_tr_b16 a[42:43], v8 offset:30016
  v_mfma_f32_16x16x32_bf16 v[212:215], a[92:95], a[124:127], v[212:215]
  v_mfma_f32_16x16x32_bf16 v[216:219], a[92:95], a[128:131], v[216:219]
  s_add_u32 s30, s30, 229376
  v_mfma_f32_16x16x32_bf16 v[220:223], a[92:95], a[132:135], v[220:223]
  ds_read_b64_tr_b16 a[44:45], v8 offset:26720
  v_mfma_f32_16x16x32_bf16 v[224:227], a[96:99], a[120:123], v[224:227]
  ds_read_b64_tr_b16 a[46:47], v8 offset:30048
  v_mfma_f32_16x16x32_bf16 v[228:231], a[96:99], a[124:127], v[228:231]
  ds_read_b64_tr_b16 a[48:49], v8 offset:26752
  v_mfma_f32_16x16x32_bf16 v[232:235], a[96:99], a[128:131], v[232:235]
  ds_read_b64_tr_b16 a[50:51], v8 offset:30080
  v_mfma_f32_16x16x32_bf16 v[236:239], a[96:99], a[132:135], v[236:239]
  v_mfma_f32_16x16x32_bf16 v[240:243], a[100:103], a[120:123], v[240:243]
  v_mfma_f32_16x16x32_bf16 v[244:247], a[100:103], a[124:127], v[244:247]
  v_mfma_f32_16x16x32_bf16 v[248:251], a[100:103], a[128:131], v[248:251]
  v_mfma_f32_16x16x32_bf16 v[252:255], a[100:103], a[132:135], v[252:255]
  s_waitcnt vmcnt(16) lgkmcnt(0)
  s_barrier
  v_mfma_f32_16x16x32_bf16 v[48:51], a[104:107], a[0:3], v[48:51]
  s_add_u32 m0, s32, 8192
  v_mfma_f32_16x16x32_bf16 v[52:55], a[108:111], a[0:3], v[52:55]
  ds_read_b64_tr_b16 a[52:53], v4 offset:39936
  v_mfma_f32_16x16x32_bf16 v[56:59], a[112:115], a[0:3], v[56:59]
  ds_read_b64_tr_b16 a[54:55], v4 offset:43264
  v_mfma_f32_16x16x32_bf16 v[60:63], a[116:119], a[0:3], v[60:63]
  buffer_load_dwordx4 v9, s[4:7], s27 offen offset:0  lds
  v_mfma_f32_16x16x32_bf16 v[64:67], a[104:107], a[4:7], v[64:67]
  ds_read_b64_tr_b16 a[56:57], v5 offset:39936
  v_mfma_f32_16x16x32_bf16 v[68:71], a[108:111], a[4:7], v[68:71]
  buffer_load_dwordx4 v10, s[4:7], s27 offen offset:1024  lds
  v_mfma_f32_16x16x32_bf16 v[72:75], a[112:115], a[4:7], v[72:75]
  ds_read_b64_tr_b16 a[58:59], v5 offset:43264
  v_mfma_f32_16x16x32_bf16 v[76:79], a[116:119], a[4:7], v[76:79]
  ds_read_b64_tr_b16 a[60:61], v6 offset:39936
  v_mfma_f32_16x16x32_bf16 v[80:83], a[104:107], a[8:11], v[80:83]
  buffer_load_dwordx4 v11, s[4:7], s27 offen offset:2048  lds
  v_mfma_f32_16x16x32_bf16 v[84:87], a[108:111], a[8:11], v[84:87]
  ds_read_b64_tr_b16 a[62:63], v6 offset:43264
  v_mfma_f32_16x16x32_bf16 v[88:91], a[112:115], a[8:11], v[88:91]
  buffer_load_dwordx4 v12, s[4:7], s27 offen offset:3072  lds
  v_mfma_f32_16x16x32_bf16 v[92:95], a[116:119], a[8:11], v[92:95]
  ds_read_b64_tr_b16 a[64:65], v7 offset:39936
  v_mfma_f32_16x16x32_bf16 v[96:99], a[104:107], a[12:15], v[96:99]
  s_add_u32 m0, s32, 12288
  v_mfma_f32_16x16x32_bf16 v[100:103], a[108:111], a[12:15], v[100:103]
  ds_read_b64_tr_b16 a[66:67], v7 offset:43264
  v_mfma_f32_16x16x32_bf16 v[104:107], a[112:115], a[12:15], v[104:107]
  ds_read_b64_tr_b16 a[68:69], v4 offset:40960
  v_mfma_f32_16x16x32_bf16 v[108:111], a[116:119], a[12:15], v[108:111]
  v_mfma_f32_16x16x32_bf16 v[112:115], a[104:107], a[16:19], v[112:115]
  buffer_load_dwordx4 v9, s[4:7], s28 offen offset:0  lds
  v_mfma_f32_16x16x32_bf16 v[116:119], a[108:111], a[16:19], v[116:119]
  ds_read_b64_tr_b16 a[70:71], v4 offset:44288
  v_mfma_f32_16x16x32_bf16 v[120:123], a[112:115], a[16:19], v[120:123]
  buffer_load_dwordx4 v10, s[4:7], s28 offen offset:1024  lds
  v_mfma_f32_16x16x32_bf16 v[124:127], a[116:119], a[16:19], v[124:127]
  ds_read_b64_tr_b16 a[72:73], v5 offset:40960
  v_mfma_f32_16x16x32_bf16 v[128:131], a[104:107], a[20:23], v[128:131]
  buffer_load_dwordx4 v11, s[4:7], s28 offen offset:2048  lds
  v_mfma_f32_16x16x32_bf16 v[132:135], a[108:111], a[20:23], v[132:135]
  ds_read_b64_tr_b16 a[74:75], v5 offset:44288
  v_mfma_f32_16x16x32_bf16 v[136:139], a[112:115], a[20:23], v[136:139]
  ds_read_b64_tr_b16 a[76:77], v6 offset:40960
  v_mfma_f32_16x16x32_bf16 v[140:143], a[116:119], a[20:23], v[140:143]
  buffer_load_dwordx4 v12, s[4:7], s28 offen offset:3072  lds
  v_mfma_f32_16x16x32_bf16 v[144:147], a[104:107], a[24:27], v[144:147]
  ds_read_b64_tr_b16 a[78:79], v6 offset:44288
  v_mfma_f32_16x16x32_bf16 v[148:151], a[108:111], a[24:27], v[148:151]
  s_add_u32 s27, s27, 128
  v_mfma_f32_16x16x32_bf16 v[152:155], a[112:115], a[24:27], v[152:155]
  ds_read_b64_tr_b16 a[80:81], v7 offset:40960
  v_mfma_f32_16x16x32_bf16 v[156:159], a[116:119], a[24:27], v[156:159]
  ds_read_b64_tr_b16 a[82:83], v7 offset:44288
  v_mfma_f32_16x16x32_bf16 v[160:163], a[104:107], a[28:31], v[160:163]
  s_add_u32 s28, s28, 128
  v_mfma_f32_16x16x32_bf16 v[164:167], a[108:111], a[28:31], v[164:167]
  ds_read_b64_tr_b16 a[84:85], v8 offset:39936
  v_mfma_f32_16x16x32_bf16 v[168:171], a[112:115], a[28:31], v[168:171]
  s_add_u32 m0, s31, 26624
  v_mfma_f32_16x16x32_bf16 v[172:175], a[116:119], a[28:31], v[172:175]
  v_mfma_f32_16x16x32_bf16 v[176:179], a[32:35], a[104:107], v[176:179]
  ds_read_b64_tr_b16 a[86:87], v8 offset:43264
  v_mfma_f32_16x16x32_bf16 v[180:183], a[32:35], a[108:111], v[180:183]
  buffer_load_dwordx4 v13, s[8:11], s29 offen offset:0  lds
  v_mfma_f32_16x16x32_bf16 v[184:187], a[32:35], a[112:115], v[184:187]
  ds_read_b64_tr_b16 a[88:89], v8 offset:39968
  v_mfma_f32_16x16x32_bf16 v[188:191], a[32:35], a[116:119], v[188:191]
  ds_read_b64_tr_b16 a[90:91], v8 offset:43296
  v_mfma_f32_16x16x32_bf16 v[192:195], a[36:39], a[104:107], v[192:195]
  buffer_load_dwordx4 v14, s[8:11], s29 offen offset:1024  lds
  v_mfma_f32_16x16x32_bf16 v[196:199], a[36:39], a[108:111], v[196:199]
  ds_read_b64_tr_b16 a[92:93], v8 offset:40000
  v_mfma_f32_16x16x32_bf16 v[200:203], a[36:39], a[112:115], v[200:203]
  buffer_load_dwordx4 v15, s[12:15], s30 offen offset:2048  lds
  v_mfma_f32_16x16x32_bf16 v[204:207], a[36:39], a[116:119], v[204:207]
  ds_read_b64_tr_b16 a[94:95], v8 offset:43328
  v_mfma_f32_16x16x32_bf16 v[208:211], a[40:43], a[104:107], v[208:211]
  s_mov_b64 exec, s[34:35]
  buffer_load_dwordx4 v16, s[12:15], s30 offen offset:3072  lds
  s_mov_b64 exec, -1
  v_mfma_f32_16x16x32_bf16 v[212:215], a[40:43], a[108:111], v[212:215]
  ds_read_b64_tr_b16 a[96:97], v8 offset:40032
  v_mfma_f32_16x16x32_bf16 v[216:219], a[40:43], a[112:115], v[216:219]
  ds_read_b64_tr_b16 a[98:99], v8 offset:43360
  v_mfma_f32_16x16x32_bf16 v[220:223], a[40:43], a[116:119], v[220:223]
  s_add_u32 s29, s29, 196608
  v_mfma_f32_16x16x32_bf16 v[224:227], a[44:47], a[104:107], v[224:227]
  ds_read_b64_tr_b16 a[100:101], v8 offset:40064
  v_mfma_f32_16x16x32_bf16 v[228:231], a[44:47], a[108:111], v[228:231]
  s_add_u32 s30, s30, 229376
  v_mfma_f32_16x16x32_bf16 v[232:235], a[44:47], a[112:115], v[232:235]
  ds_read_b64_tr_b16 a[102:103], v8 offset:43392
  v_mfma_f32_16x16x32_bf16 v[236:239], a[44:47], a[116:119], v[236:239]
  v_mfma_f32_16x16x32_bf16 v[240:243], a[48:51], a[104:107], v[240:243]
  v_mfma_f32_16x16x32_bf16 v[244:247], a[48:51], a[108:111], v[244:247]
  v_mfma_f32_16x16x32_bf16 v[248:251], a[48:51], a[112:115], v[248:251]
  v_mfma_f32_16x16x32_bf16 v[252:255], a[48:51], a[116:119], v[252:255]
  s_waitcnt vmcnt(16) lgkmcnt(0)
  s_barrier
  v_mfma_f32_16x16x32_bf16 v[48:51], a[136:139], a[52:55], v[48:51]
  s_add_u32 m0, s31, 39936
  v_mfma_f32_16x16x32_bf16 v[52:55], a[140:143], a[52:55], v[52:55]
  ds_read_b128 a[104:107], v2 offset:0
  v_mfma_f32_16x16x32_bf16 v[56:59], a[144:147], a[52:55], v[56:59]
  ds_read_b128 a[108:111], v2 offset:2048
  v_mfma_f32_16x16x32_bf16 v[60:63], a[148:151], a[52:55], v[60:63]
  ds_read_b128 a[112:115], v2 offset:4096
  v_mfma_f32_16x16x32_bf16 v[64:67], a[136:139], a[56:59], v[64:67]
  ds_read_b128 a[116:119], v2 offset:6144
  v_mfma_f32_16x16x32_bf16 v[68:71], a[140:143], a[56:59], v[68:71]
  ds_read_b128 a[120:123], v3 offset:0
  v_mfma_f32_16x16x32_bf16 v[72:75], a[144:147], a[56:59], v[72:75]
  v_mfma_f32_16x16x32_bf16 v[76:79], a[148:151], a[56:59], v[76:79]
  buffer_load_dwordx4 v13, s[8:11], s29 offen offset:0  lds
  v_mfma_f32_16x16x32_bf16 v[80:83], a[136:139], a[60:63], v[80:83]
  ds_read_b128 a[124:127], v3 offset:2048
  v_mfma_f32_16x16x32_bf16 v[84:87], a[140:143], a[60:63], v[84:87]
  ds_read_b128 a[128:131], v3 offset:4096
  v_mfma_f32_16x16x32_bf16 v[88:91], a[144:147], a[60:63], v[88:91]
  ds_read_b128 a[132:135], v3 offset:6144
  v_mfma_f32_16x16x32_bf16 v[92:95], a[148:151], a[60:63], v[92:95]
  ds_read_b64_tr_b16 a[0:1], v4 offset:0
  v_mfma_f32_16x16x32_bf16 v[96:99], a[136:139], a[64:67], v[96:99]
  ds_read_b64_tr_b16 a[2:3], v4 offset:3328
  v_mfma_f32_16x16x32_bf16 v[100:103], a[140:143], a[64:67], v[100:103]
  v_mfma_f32_16x16x32_bf16 v[104:107], a[144:147], a[64:67], v[104:107]
  buffer_load_dwordx4 v14, s[8:11], s29 offen offset:1024  lds
  v_mfma_f32_16x16x32_bf16 v[108:111], a[148:151], a[64:67], v[108:111]
  ds_read_b64_tr_b16 a[4:5], v5 offset:0
  v_mfma_f32_16x16x32_bf16 v[112:115], a[136:139], a[68:71], v[112:115]
  ds_read_b64_tr_b16 a[6:7], v5 offset:3328
  v_mfma_f32_16x16x32_bf16 v[116:119], a[140:143], a[68:71], v[116:119]
  ds_read_b64_tr_b16 a[8:9], v6 offset:0
  v_mfma_f32_16x16x32_bf16 v[120:123], a[144:147], a[68:71], v[120:123]
  ds_read_b64_tr_b16 a[10:11], v6 offset:3328
  v_mfma_f32_16x16x32_bf16 v[124:127], a[148:151], a[68:71], v[124:127]
  ds_read_b64_tr_b16 a[12:13], v7 offset:0
  v_mfma_f32_16x16x32_bf16 v[128:131], a[136:139], a[72:75], v[128:131]
  v_mfma_f32_16x16x32_bf16 v[132:135], a[140:143], a[72:75], v[132:135]
  buffer_load_dwordx4 v15, s[12:15], s30 offen offset:2048  lds
  v_mfma_f32_16x16x32_bf16 v[136:139], a[144:147], a[72:75], v[136:139]
  ds_read_b64_tr_b16 a[14:15], v7 offset:3328
  v_mfma_f32_16x16x32_bf16 v[140:143], a[148:151], a[72:75], v[140:143]
  ds_read_b64_tr_b16 a[16:17], v4 offset:1024
  v_mfma_f32_16x16x32_bf16 v[144:147], a[136:139], a[76:79], v[144:147]
  ds_read_b64_tr_b16 a[18:19], v4 offset:4352
  v_mfma_f32_16x16x32_bf16 v[148:151], a[140:143], a[76:79], v[148:151]
  ds_read_b64_tr_b16 a[20:21], v5 offset:1024
  v_mfma_f32_16x16x32_bf16 v[152:155], a[144:147], a[76:79], v[152:155]
  ds_read_b64_tr_b16 a[22:23], v5 offset:4352
  v_mfma_f32_16x16x32_bf16 v[156:159], a[148:151], a[76:79], v[156:159]
  v_mfma_f32_16x16x32_bf16 v[160:163], a[136:139], a[80:83], v[160:163]
  s_mov_b64 exec, s[34:35]
  buffer_load_dwordx4 v16, s[12:15], s30 offen offset:3072  lds
  s_mov_b64 exec, -1
  v_mfma_f32_16x16x32_bf16 v[164:167], a[140:143], a[80:83], v[164:167]
  ds_read_b64_tr_b16 a[24:25], v6 offset:1024
  v_mfma_f32_16x16x32_bf16 v[168:171], a[144:147], a[80:83], v[168:171]
  ds_read_b64_tr_b16 a[26:27], v6 offset:4352
  v_mfma_f32_16x16x32_bf16 v[172:175], a[148:151], a[80:83], v[172:175]
  ds_read_b64_tr_b16 a[28:29], v7 offset:1024
  v_mfma_f32_16x16x32_bf16 v[176:179], a[84:87], a[136:139], v[176:179]
  ds_read_b64_tr_b16 a[30:31], v7 offset:4352
  v_mfma_f32_16x16x32_bf16 v[180:183], a[84:87], a[140:143], v[180:183]
  ds_read_b64_tr_b16 a[32:33], v8 offset:0
  v_mfma_f32_16x16x32_bf16 v[184:187], a[84:87], a[144:147], v[184:187]
  v_mfma_f32_16x16x32_bf16 v[188:191], a[84:87], a[148:151], v[188:191]
  s_add_u32 s29, s29, 196608
  v_mfma_f32_16x16x32_bf16 v[192:195], a[88:91], a[136:139], v[192:195]
  ds_read_b64_tr_b16 a[34:35], v8 offset:3328
  v_mfma_f32_16x16x32_bf16 v[196:199], a[88:91], a[140:143], v[196:199]
  ds_read_b64_tr_b16 a[36:37], v8 offset:32
  v_mfma_f32_16x16x32_bf16 v[200:203], a[88:91], a[144:147], v[200:203]
  ds_read_b64_tr_b16 a[38:39], v8 offset:3360
  v_mfma_f32_16x16x32_bf16 v[204:207], a[88:91], a[148:151], v[204:207]
  ds_read_b64_tr_b16 a[40:41], v8 offset:64
  v_mfma_f32_16x16x32_bf16 v[208:211], a[92:95], a[136:139], v[208:211]
  ds_read_b64_tr_b16 a[42:43], v8 offset:3392
  v_mfma_f32_16x16x32_bf16 v[212:215], a[92:95], a[140:143], v[212:215]
  v_mfma_f32_16x16x32_bf16 v[216:219], a[92:95], a[144:147], v[216:219]
  s_add_u32 s30, s30, 229376
  v_mfma_f32_16x16x32_bf16 v[220:223], a[92:95], a[148:151], v[220:223]
  ds_read_b64_tr_b16 a[44:45], v8 offset:96
  v_mfma_f32_16x16x32_bf16 v[224:227], a[96:99], a[136:139], v[224:227]
  ds_read_b64_tr_b16 a[46:47], v8 offset:3424
  v_mfma_f32_16x16x32_bf16 v[228:231], a[96:99], a[140:143], v[228:231]
  ds_read_b64_tr_b16 a[48:49], v8 offset:128
  v_mfma_f32_16x16x32_bf16 v[232:235], a[96:99], a[144:147], v[232:235]
  ds_read_b64_tr_b16 a[50:51], v8 offset:3456
  v_mfma_f32_16x16x32_bf16 v[236:239], a[96:99], a[148:151], v[236:239]
  v_mfma_f32_16x16x32_bf16 v[240:243], a[100:103], a[136:139], v[240:243]
  v_mfma_f32_16x16x32_bf16 v[244:247], a[100:103], a[140:143], v[244:247]
  v_mfma_f32_16x16x32_bf16 v[248:251], a[100:103], a[144:147], v[248:251]
  v_mfma_f32_16x16x32_bf16 v[252:255], a[100:103], a[148:151], v[252:255]
  s_waitcnt vmcnt(16) lgkmcnt(0)
  s_barrier
  s_sub_u32 s33, s33, 1
  s_cmp_lg_u32 s33, 0
  s_cbranch_scc1 L_k1A_loop
  v_mfma_f32_16x16x32_bf16 v[48:51], a[104:107], a[0:3], v[48:51]
  buffer_load_dword v46, v44, s[96:99], s74 offen
  v_mfma_f32_16x16x32_bf16 v[52:55], a[108:111], a[0:3], v[52:55]
  ds_read_b64_tr_b16 a[52:53], v4 offset:13312
  v_mfma_f32_16x16x32_bf16 v[56:59], a[112:115], a[0:3], v[56:59]
  v_mfma_f32_16x16x32_bf16 v[60:63], a[116:119], a[0:3], v[60:63]
  ds_read_b64_tr_b16 a[54:55], v4 offset:16640
  v_mfma_f32_16x16x32_bf16 v[64:67], a[104:107], a[4:7], v[64:67]
  ds_read_b64_tr_b16 a[56:57], v5 offset:13312
  v_mfma_f32_16x16x32_bf16 v[68:71], a[108:111], a[4:7], v[68:71]
  v_mfma_f32_16x16x32_bf16 v[72:75], a[112:115], a[4:7], v[72:75]
  ds_read_b64_tr_b16 a[58:59], v5 offset:16640
  v_mfma_f32_16x16x32_bf16 v[76:79], a[116:119], a[4:7], v[76:79]
  v_mfma_f32_16x16x32_bf16 v[80:83], a[104:107], a[8:11], v[80:83]
  ds_read_b64_tr_b16 a[60:61], v6 offset:13312
  v_mfma_f32_16x16x32_bf16 v[84:87], a[108:111], a[8:11], v[84:87]
  ds_read_b64_tr_b16 a[62:63], v6 offset:16640
  v_mfma_f32_16x16x32_bf16 v[88:91], a[112:115], a[8:11], v[88:91]
  v_mfma_f32_16x16x32_bf16 v[92:95], a[116:119], a[8:11], v[92:95]
  ds_read_b64_tr_b16 a[64:65], v7 offset:13312
  v_mfma_f32_16x16x32_bf16 v[96:99], a[104:107], a[12:15], v[96:99]
  buffer_load_dword v46, v45, s[20:23], s3 offen
  v_mfma_f32_16x16x32_bf16 v[100:103], a[108:111], a[12:15], v[100:103]
  v_mfma_f32_16x16x32_bf16 v[104:107], a[112:115], a[12:15], v[104:107]
  ds_read_b64_tr_b16 a[66:67], v7 offset:16640
  v_mfma_f32_16x16x32_bf16 v[108:111], a[116:119], a[12:15], v[108:111]
  v_mfma_f32_16x16x32_bf16 v[112:115], a[104:107], a[16:19], v[112:115]
  ds_read_b64_tr_b16 a[68:69], v4 offset:14336
  v_mfma_f32_16x16x32_bf16 v[116:119], a[108:111], a[16:19], v[116:119]
  ds_read_b64_tr_b16 a[70:71], v4 offset:17664
  v_mfma_f32_16x16x32_bf16 v[120:123], a[112:115], a[16:19], v[120:123]
  v_mfma_f32_16x16x32_bf16 v[124:127], a[116:119], a[16:19], v[124:127]
  ds_read_b64_tr_b16 a[72:73], v5 offset:14336
  v_mfma_f32_16x16x32_bf16 v[128:131], a[104:107], a[20:23], v[128:131]
  ds_read_b64_tr_b16 a[74:75], v5 offset:17664
  v_mfma_f32_16x16x32_bf16 v[132:135], a[108:111], a[20:23], v[132:135]
  v_mfma_f32_16x16x32_bf16 v[136:139], a[112:115], a[20:23], v[136:139]
  ds_read_b64_tr_b16 a[76:77], v6 offset:14336
  v_mfma_f32_16x16x32_bf16 v[140:143], a[116:119], a[20:23], v[140:143]
  v_mfma_f32_16x16x32_bf16 v[144:147], a[104:107], a[24:27], v[144:147]
  s_add_u32 s74, s74, 7168
  v_mfma_f32_16x16x32_bf16 v[148:151], a[108:111], a[24:27], v[148:151]
  ds_read_b64_tr_b16 a[78:79], v6 offset:17664
  v_mfma_f32_16x16x32_bf16 v[152:155], a[112:115], a[24:27], v[152:155]
  v_mfma_f32_16x16x32_bf16 v[156:159], a[116:119], a[24:27], v[156:159]
  ds_read_b64_tr_b16 a[80:81], v7 offset:14336
  v_mfma_f32_16x16x32_bf16 v[160:163], a[104:107], a[28:31], v[160:163]
  ds_read_b64_tr_b16 a[82:83], v7 offset:17664
  v_mfma_f32_16x16x32_bf16 v[164:167], a[108:111], a[28:31], v[164:167]
  v_mfma_f32_16x16x32_bf16 v[168:171], a[112:115], a[28:31], v[168:171]
  ds_read_b64_tr_b16 a[84:85], v8 offset:13312
  v_mfma_f32_16x16x32_bf16 v[172:175], a[116:119], a[28:31], v[172:175]
  v_mfma_f32_16x16x32_bf16 v[176:179], a[32:35], a[104:107], v[176:179]
  ds_read_b64_tr_b16 a[86:87], v8 offset:16640
  v_mfma_f32_16x16x32_bf16 v[180:183], a[32:35], a[108:111], v[180:183]
  ds_read_b64_tr_b16 a[88:89], v8 offset:13344
  v_mfma_f32_16x16x32_bf16 v[184:187], a[32:35], a[112:115], v[184:187]
  v_mfma_f32_16x16x32_bf16 v[188:191], a[32:35], a[116:119], v[188:191]
  ds_read_b64_tr_b16 a[90:91], v8 offset:16672
  v_mfma_f32_16x16x32_bf16 v[192:195], a[36:39], a[104:107], v[192:195]
  s_add_u32 s3, s3, 2048
  v_mfma_f32_16x16x32_bf16 v[196:199], a[36:39], a[108:111], v[196:199]
  v_mfma_f32_16x16x32_bf16 v[200:203], a[36:39], a[112:115], v[200:203]
  ds_read_b64_tr_b16 a[92:93], v8 offset:13376
  v_mfma_f32_16x16x32_bf16 v[204:207], a[36:39], a[116:119], v[204:207]
  v_mfma_f32_16x16x32_bf16 v[208:211], a[40:43], a[104:107], v[208:211]
  ds_read_b64_tr_b16 a[94:95], v8 offset:16704
  v_mfma_f32_16x16x32_bf16 v[212:215], a[40:43], a[108:111], v[212:215]
  ds_read_b64_tr_b16 a[96:97], v8 offset:13408
  v_mfma_f32_16x16x32_bf16 v[216:219], a[40:43], a[112:115], v[216:219]
  v_mfma_f32_16x16x32_bf16 v[220:223], a[40:43], a[116:119], v[220:223]
  ds_read_b64_tr_b16 a[98:99], v8 offset:16736
  v_mfma_f32_16x16x32_bf16 v[224:227], a[44:47], a[104:107], v[224:227]
  ds_read_b64_tr_b16 a[100:101], v8 offset:13440
  v_mfma_f32_16x16x32_bf16 v[228:231], a[44:47], a[108:111], v[228:231]
  v_mfma_f32_16x16x32_bf16 v[232:235], a[44:47], a[112:115], v[232:235]
  ds_read_b64_tr_b16 a[102:103], v8 offset:16768
  v_mfma_f32_16x16x32_bf16 v[236:239], a[44:47], a[116:119], v[236:239]
  v_mfma_f32_16x16x32_bf16 v[240:243], a[48:51], a[104:107], v[240:243]
  v_mfma_f32_16x16x32_bf16 v[244:247], a[48:51], a[108:111], v[244:247]
  v_mfma_f32_16x16x32_bf16 v[248:251], a[48:51], a[112:115], v[248:251]
  v_mfma_f32_16x16x32_bf16 v[252:255], a[48:51], a[116:119], v[252:255]
  s_waitcnt vmcnt(6) lgkmcnt(0)
  s_barrier
  v_mfma_f32_16x16x32_bf16 v[48:51], a[120:123], a[52:55], v[48:51]
  ds_read_b128 a[104:107], v2 offset:8192
  v_mfma_f32_16x16x32_bf16 v[52:55], a[124:127], a[52:55], v[52:55]
  ds_read_b128 a[108:111], v2 offset:10240
  v_mfma_f32_16x16x32_bf16 v[56:59], a[128:131], a[52:55], v[56:59]
  ds_read_b128 a[112:115], v2 offset:12288
  v_mfma_f32_16x16x32_bf16 v[60:63], a[132:135], a[52:55], v[60:63]
  v_mfma_f32_16x16x32_bf16 v[64:67], a[120:123], a[56:59], v[64:67]
  ds_read_b128 a[116:119], v2 offset:14336
  v_mfma_f32_16x16x32_bf16 v[68:71], a[124:127], a[56:59], v[68:71]
  ds_read_b128 a[136:139], v3 offset:8192
  v_mfma_f32_16x16x32_bf16 v[72:75], a[128:131], a[56:59], v[72:75]
  v_mfma_f32_16x16x32_bf16 v[76:79], a[132:135], a[56:59], v[76:79]
  ds_read_b128 a[140:143], v3 offset:10240
  v_mfma_f32_16x16x32_bf16 v[80:83], a[120:123], a[60:63], v[80:83]
  ds_read_b128 a[144:147], v3 offset:12288
  v_mfma_f32_16x16x32_bf16 v[84:87], a[124:127], a[60:63], v[84:87]
  ds_read_b128 a[148:151], v3 offset:14336
  v_mfma_f32_16x16x32_bf16 v[88:91], a[128:131], a[60:63], v[88:91]
  v_mfma_f32_16x16x32_bf16 v[92:95], a[132:135], a[60:63], v[92:95]
  ds_read_b64_tr_b16 a[0:1], v4 offset:26624
  v_mfma_f32_16x16x32_bf16 v[96:99], a[120:123], a[64:67], v[96:99]
  ds_read_b64_tr_b16 a[2:3], v4 offset:29952
  v_mfma_f32_16x16x32_bf16 v[100:103], a[124:127], a[64:67], v[100:103]
  v_mfma_f32_16x16x32_bf16 v[104:107], a[128:131], a[64:67], v[104:107]
  ds_read_b64_tr_b16 a[4:5], v5 offset:26624
  v_mfma_f32_16x16x32_bf16 v[108:111], a[132:135], a[64:67], v[108:111]
  ds_read_b64_tr_b16 a[6:7], v5 offset:29952
  v_mfma_f32_16x16x32_bf16 v[112:115], a[120:123], a[68:71], v[112:115]
  ds_read_b64_tr_b16 a[8:9], v6 offset:26624
  v_mfma_f32_16x16x32_bf16 v[116:119], a[124:127], a[68:71], v[116:119]
  v_mfma_f32_16x16x32_bf16 v[120:123], a[128:131], a[68:71], v[120:123]
  ds_read_b64_tr_b16 a[10:11], v6 offset:29952
  v_mfma_f32_16x16x32_bf16 v[124:127], a[132:135], a[68:71], v[124:127]
  ds_read_b64_tr_b16 a[12:13], v7 offset:26624
  v_mfma_f32_16x16x32_bf16 v[128:131], a[120:123], a[72:75], v[128:131]
  v_mfma_f32_16x16x32_bf16 v[132:135], a[124:127], a[72:75], v[132:135]
  ds_read_b64_tr_b16 a[14:15], v7 offset:29952
  v_mfma_f32_16x16x32_bf16 v[136:139], a[128:131], a[72:75], v[136:139]
  ds_read_b64_tr_b16 a[16:17], v4 offset:27648
  v_mfma_f32_16x16x32_bf16 v[140:143], a[132:135], a[72:75], v[140:143]
  v_mfma_f32_16x16x32_bf16 v[144:147], a[120:123], a[76:79], v[144:147]
  ds_read_b64_tr_b16 a[18:19], v4 offset:30976
  v_mfma_f32_16x16x32_bf16 v[148:151], a[124:127], a[76:79], v[148:151]
  ds_read_b64_tr_b16 a[20:21], v5 offset:27648
  v_mfma_f32_16x16x32_bf16 v[152:155], a[128:131], a[76:79], v[152:155]
  ds_read_b64_tr_b16 a[22:23], v5 offset:30976
  v_mfma_f32_16x16x32_bf16 v[156:159], a[132:135], a[76:79], v[156:159]
  v_mfma_f32_16x16x32_bf16 v[160:163], a[120:123], a[80:83], v[160:163]
  ds_read_b64_tr_b16 a[24:25], v6 offset:27648
  v_mfma_f32_16x16x32_bf16 v[164:167], a[124:127], a[80:83], v[164:167]
  ds_read_b64_tr_b16 a[26:27], v6 offset:30976
  v_mfma_f32_16x16x32_bf16 v[168:171], a[128:131], a[80:83], v[168:171]
  v_mfma_f32_16x16x32_bf16 v[172:175], a[132:135], a[80:83], v[172:175]
  ds_read_b64_tr_b16 a[28:29], v7 offset:27648
  v_mfma_f32_16x16x32_bf16 v[176:179], a[84:87], a[120:123], v[176:179]
  ds_read_b64_tr_b16 a[30:31], v7 offset:30976
  v_mfma_f32_16x16x32_bf16 v[180:183], a[84:87], a[124:127], v[180:183]
  ds_read_b64_tr_b16 a[32:33], v8 offset:26624
  v_mfma_f32_16x16x32_bf16 v[184:187], a[84:87], a[128:131], v[184:187]
  v_mfma_f32_16x16x32_bf16 v[188:191], a[84:87], a[132:135], v[188:191]
  ds_read_b64_tr_b16 a[34:35], v8 offset:29952
  v_mfma_f32_16x16x32_bf16 v[192:195], a[88:91], a[120:123], v[192:195]
  ds_read_b64_tr_b16 a[36:37], v8 offset:26656
  v_mfma_f32_16x16x32_bf16 v[196:199], a[88:91], a[124:127], v[196:199]
  v_mfma_f32_16x16x32_bf16 v[200:203], a[88:91], a[128:131], v[200:203]
  ds_read_b64_tr_b16 a[38:39], v8 offset:29984
  v_mfma_f32_16x16x32_bf16 v[204:207], a[88:91], a[132:135], v[204:207]
  ds_read_b64_tr_b16 a[40:41], v8 offset:26688
  v_mfma_f32_16x16x32_bf16 v[208:211], a[92:95], a[120:123], v[208:211]
  ds_read_b64_tr_b16 a[42:43], v8 offset:30016
  v_mfma_f32_16x16x32_bf16 v[212:215], a[92:95], a[124:127], v[212:215]
  v_mfma_f32_16x16x32_bf16 v[216:219], a[92:95], a[128:131], v[216:219]
  ds_read_b64_tr_b16 a[44:45], v8 offset:26720
  v_mfma_f32_16x16x32_bf16 v[220:223], a[92:95], a[132:135], v[220:223]
  ds_read_b64_tr_b16 a[46:47], v8 offset:30048
  v_mfma_f32_16x16x32_bf16 v[224:227], a[96:99], a[120:123], v[224:227]
  v_mfma_f32_16x16x32_bf16 v[228:231], a[96:99], a[124:127], v[228:231]
  ds_read_b64_tr_b16 a[48:49], v8 offset:26752
  v_mfma_f32_16x16x32_bf16 v[232:235], a[96:99], a[128:131], v[232:235]
  ds_read_b64_tr_b16 a[50:51], v8 offset:30080
  v_mfma_f32_16x16x32_bf16 v[236:239], a[96:99], a[132:135], v[236:239]
  v_mfma_f32_16x16x32_bf16 v[240:243], a[100:103], a[120:123], v[240:243]
  v_mfma_f32_16x16x32_bf16 v[244:247], a[100:103], a[124:127], v[244:247]
  v_mfma_f32_16x16x32_bf16 v[248:251], a[100:103], a[128:131], v[248:251]
  v_mfma_f32_16x16x32_bf16 v[252:255], a[100:103], a[132:135], v[252:255]
  s_waitcnt vmcnt(2) lgkmcnt(0)
  s_barrier
  v_mfma_f32_16x16x32_bf16 v[48:51], a[104:107], a[0:3], v[48:51]
  ds_read_b64_tr_b16 a[52:53], v4 offset:39936
  v_mfma_f32_16x16x32_bf16 v[52:55], a[108:111], a[0:3], v[52:55]
  ds_read_b64_tr_b16 a[54:55], v4 offset:43264
  v_mfma_f32_16x16x32_bf16 v[56:59], a[112:115], a[0:3], v[56:59]
  v_mfma_f32_16x16x32_bf16 v[60:63], a[116:119], a[0:3], v[60:63]
  ds_read_b64_tr_b16 a[56:57], v5 offset:39936
  v_mfma_f32_16x16x32_bf16 v[64:67], a[104:107], a[4:7], v[64:67]
  v_mfma_f32_16x16x32_bf16 v[68:71], a[108:111], a[4:7], v[68:71]
  ds_read_b64_tr_b16 a[58:59], v5 offset:43264
  v_mfma_f32_16x16x32_bf16 v[72:75], a[112:115], a[4:7], v[72:75]
  v_mfma_f32_16x16x32_bf16 v[76:79], a[116:119], a[4:7], v[76:79]
  ds_read_b64_tr_b16 a[60:61], v6 offset:39936
  v_mfma_f32_16x16x32_bf16 v[80:83], a[104:107], a[8:11], v[80:83]
  v_mfma_f32_16x16x32_bf16 v[84:87], a[108:111], a[8:11], v[84:87]
  ds_read_b64_tr_b16 a[62:63], v6 offset:43264
  v_mfma_f32_16x16x32_bf16 v[88:91], a[112:115], a[8:11], v[88:91]
  v_mfma_f32_16x16x32_bf16 v[92:95], a[116:119], a[8:11], v[92:95]
  ds_read_b64_tr_b16 a[64:65], v7 offset:39936
  v_mfma_f32_16x16x32_bf16 v[96:99], a[104:107], a[12:15], v[96:99]
  ds_read_b64_tr_b16 a[66:67], v7 offset:43264
  v_mfma_f32_16x16x32_bf16 v[100:103], a[108:111], a[12:15], v[100:103]
  v_mfma_f32_16x16x32_bf16 v[104:107], a[112:115], a[12:15], v[104:107]
  ds_read_b64_tr_b16 a[68:69], v4 offset:40960
  v_mfma_f32_16x16x32_bf16 v[108:111], a[116:119], a[12:15], v[108:111]
  v_mfma_f32_16x16x32_bf16 v[112:115], a[104:107], a[16:19], v[112:115]
  ds_read_b64_tr_b16 a[70:71], v4 offset:44288
  v_mfma_f32_16x16x32_bf16 v[116:119], a[108:111], a[16:19], v[116:119]
  v_mfma_f32_16x16x32_bf16 v[120:123], a[112:115], a[16:19], v[120:123]
  ds_read_b64_tr_b16 a[72:73], v5 offset:40960
  v_mfma_f32_16x16x32_bf16 v[124:127], a[116:119], a[16:19], v[124:127]
  v_mfma_f32_16x16x32_bf16 v[128:131], a[104:107], a[20:23], v[128:131]
  ds_read_b64_tr_b16 a[74:75], v5 offset:44288
  v_mfma_f32_16x16x32_bf16 v[132:135], a[108:111], a[20:23], v[132:135]
  v_mfma_f32_16x16x32_bf16 v[136:139], a[112:115], a[20:23], v[136:139]
  ds_read_b64_tr_b16 a[76:77], v6 offset:40960
  v_mfma_f32_16x16x32_bf16 v[140:143], a[116:119], a[20:23], v[140:143]
  v_mfma_f32_16x16x32_bf16 v[144:147], a[104:107], a[24:27], v[144:147]
  ds_read_b64_tr_b16 a[78:79], v6 offset:44288
  v_mfma_f32_16x16x32_bf16 v[148:151], a[108:111], a[24:27], v[148:151]
  ds_read_b64_tr_b16 a[80:81], v7 offset:40960
  v_mfma_f32_16x16x32_bf16 v[152:155], a[112:115], a[24:27], v[152:155]
  v_mfma_f32_16x16x32_bf16 v[156:159], a[116:119], a[24:27], v[156:159]
  ds_read_b64_tr_b16 a[82:83], v7 offset:44288
  v_mfma_f32_16x16x32_bf16 v[160:163], a[104:107], a[28:31], v[160:163]
  v_mfma_f32_16x16x32_bf16 v[164:167], a[108:111], a[28:31], v[164:167]
  ds_read_b64_tr_b16 a[84:85], v8 offset:39936
  v_mfma_f32_16x16x32_bf16 v[168:171], a[112:115], a[28:31], v[168:171]
  v_mfma_f32_16x16x32_bf16 v[172:175], a[116:119], a[28:31], v[172:175]
  ds_read_b64_tr_b16 a[86:87], v8 offset:43264
  v_mfma_f32_16x16x32_bf16 v[176:179], a[32:35], a[104:107], v[176:179]
  v_mfma_f32_16x16x32_bf16 v[180:183], a[32:35], a[108:111], v[180:183]
  ds_read_b64_tr_b16 a[88:89], v8 offset:39968
  v_mfma_f32_16x16x32_bf16 v[184:187], a[32:35], a[112:115], v[184:187]
  v_mfma_f32_16x16x32_bf16 v[188:191], a[32:35], a[116:119], v[188:191]
  ds_read_b64_tr_b16 a[90:91], v8 offset:43296
  v_mfma_f32_16x16x32_bf16 v[192:195], a[36:39], a[104:107], v[192:195]
  ds_read_b64_tr_b16 a[92:93], v8 offset:40000
  v_mfma_f32_16x16x32_bf16 v[196:199], a[36:39], a[108:111], v[196:199]
  v_mfma_f32_16x16x32_bf16 v[200:203], a[36:39], a[112:115], v[200:203]
  ds_read_b64_tr_b16 a[94:95], v8 offset:43328
  v_mfma_f32_16x16x32_bf16 v[204:207], a[36:39], a[116:119], v[204:207]
  v_mfma_f32_16x16x32_bf16 v[208:211], a[40:43], a[104:107], v[208:211]
  ds_read_b64_tr_b16 a[96:97], v8 offset:40032
  v_mfma_f32_16x16x32_bf16 v[212:215], a[40:43], a[108:111], v[212:215]
  v_mfma_f32_16x16x32_bf16 v[216:219], a[40:43], a[112:115], v[216:219]
  ds_read_b64_tr_b16 a[98:99], v8 offset:43360
  v_mfma_f32_16x16x32_bf16 v[220:223], a[40:43], a[116:119], v[220:223]
  v_mfma_f32_16x16x32_bf16 v[224:227], a[44:47], a[104:107], v[224:227]
  ds_read_b64_tr_b16 a[100:101], v8 offset:40064
  v_mfma_f32_16x16x32_bf16 v[228:231], a[44:47], a[108:111], v[228:231]
  v_mfma_f32_16x16x32_bf16 v[232:235], a[44:47], a[112:115], v[232:235]
  ds_read_b64_tr_b16 a[102:103], v8 offset:43392
  v_mfma_f32_16x16x32_bf16 v[236:239], a[44:47], a[116:119], v[236:239]
  v_mfma_f32_16x16x32_bf16 v[240:243], a[48:51], a[104:107], v[240:243]
  v_mfma_f32_16x16x32_bf16 v[244:247], a[48:51], a[108:111], v[244:247]
  v_mfma_f32_16x16x32_bf16 v[248:251], a[48:51], a[112:115], v[248:251]
  v_mfma_f32_16x16x32_bf16 v[252:255], a[48:51], a[116:119], v[252:255]
  s_waitcnt lgkmcnt(0)
  v_mfma_f32_16x16x32_bf16 v[48:51], a[136:139], a[52:55], v[48:51]
  v_dot2_f32_bf16 v42, v26, v18, 0
  v_mfma_f32_16x16x32_bf16 v[52:55], a[140:143], a[52:55], v[52:55]
  v_dot2_f32_bf16 v43, v34, v18, 0
  v_mfma_f32_16x16x32_bf16 v[56:59], a[144:147], a[52:55], v[56:59]
  v_dot2_f32_bf16 v42, v27, v19, v42
  v_mfma_f32_16x16x32_bf16 v[60:63], a[148:151], a[52:55], v[60:63]
  v_dot2_f32_bf16 v43, v35, v19, v43
  v_mfma_f32_16x16x32_bf16 v[64:67], a[136:139], a[56:59], v[64:67]
  v_dot2_f32_bf16 v42, v28, v20, v42
  v_mfma_f32_16x16x32_bf16 v[68:71], a[140:143], a[56:59], v[68:71]
  v_dot2_f32_bf16 v43, v36, v20, v43
  v_mfma_f32_16x16x32_bf16 v[72:75], a[144:147], a[56:59], v[72:75]
  v_dot2_f32_bf16 v42, v29, v21, v42
  v_mfma_f32_16x16x32_bf16 v[76:79], a[148:151], a[56:59], v[76:79]
  v_mfma_f32_16x16x32_bf16 v[80:83], a[136:139], a[60:63], v[80:83]
  v_dot2_f32_bf16 v43, v37, v21, v43
  v_mfma_f32_16x16x32_bf16 v[84:87], a[140:143], a[60:63], v[84:87]
  v_dot2_f32_bf16 v42, v30, v22, v42
  v_mfma_f32_16x16x32_bf16 v[88:91], a[144:147], a[60:63], v[88:91]
  v_dot2_f32_bf16 v43, v38, v22, v43
  v_mfma_f32_16x16x32_bf16 v[92:95], a[148:151], a[60:63], v[92:95]
  v_dot2_f32_bf16 v42, v31, v23, v42
  v_mfma_f32_16x16x32_bf16 v[96:99], a[136:139], a[64:67], v[96:99]
  v_dot2_f32_bf16 v43, v39, v23, v43
  v_mfma_f32_16x16x32_bf16 v[100:103], a[140:143], a[64:67], v[100:103]
  v_dot2_f32_bf16 v42, v32, v24, v42
  v_mfma_f32_16x16x32_bf16 v[104:107], a[144:147], a[64:67], v[104:107]
  v_dot2_f32_bf16 v43, v40, v24, v43
  v_mfma_f32_16x16x32_bf16 v[108:111], a[148:151], a[64:67], v[108:111]
  v_mfma_f32_16x16x32_bf16 v[112:115], a[136:139], a[68:71], v[112:115]
  v_dot2_f32_bf16 v42, v33, v25, v42
  v_mfma_f32_16x16x32_bf16 v[116:119], a[140:143], a[68:71], v[116:119]
  v_dot2_f32_bf16 v43, v41, v25, v43
  v_mfma_f32_16x16x32_bf16 v[120:123], a[144:147], a[68:71], v[120:123]
  s_nop 3
  v_mfma_f32_16x16x32_bf16 v[124:127], a[148:151], a[68:71], v[124:127]
  s_nop 0
  v_add_f32_dpp v42, v42, v42 row_shr:1 row_mask:0xf bank_mask:0xf bound_ctrl:0
  v_mfma_f32_16x16x32_bf16 v[128:131], a[136:139], a[72:75], v[128:131]
  s_nop 0
  v_add_f32_dpp v43, v43, v43 row_shr:1 row_mask:0xf bank_mask:0xf bound_ctrl:0
  v_mfma_f32_16x16x32_bf16 v[132:135], a[140:143], a[72:75], v[132:135]
  s_nop 0
  v_add_f32_dpp v42, v42, v42 row_shr:2 row_mask:0xf bank_mask:0xf bound_ctrl:0
  v_mfma_f32_16x16x32_bf16 v[136:139], a[144:147], a[72:75], v[136:139]
  s_nop 0
  v_add_f32_dpp v43, v43, v43 row_shr:2 row_mask:0xf bank_mask:0xf bound_ctrl:0
  v_mfma_f32_16x16x32_bf16 v[140:143], a[148:151], a[72:75], v[140:143]
  v_mfma_f32_16x16x32_bf16 v[144:147], a[136:139], a[76:79], v[144:147]
  s_nop 0
  v_add_f32_dpp v42, v42, v42 row_shr:4 row_mask:0xf bank_mask:0xf bound_ctrl:0
  v_mfma_f32_16x16x32_bf16 v[148:151], a[140:143], a[76:79], v[148:151]
  s_nop 0
  v_add_f32_dpp v43, v43, v43 row_shr:4 row_mask:0xf bank_mask:0xf bound_ctrl:0
  v_mfma_f32_16x16x32_bf16 v[152:155], a[144:147], a[76:79], v[152:155]
  s_nop 0
  v_add_f32_dpp v42, v42, v42 row_shr:8 row_mask:0xf bank_mask:0xf bound_ctrl:0
  v_mfma_f32_16x16x32_bf16 v[156:159], a[148:151], a[76:79], v[156:159]
  s_nop 0
  v_add_f32_dpp v43, v43, v43 row_shr:8 row_mask:0xf bank_mask:0xf bound_ctrl:0
  v_mfma_f32_16x16x32_bf16 v[160:163], a[136:139], a[80:83], v[160:163]
  s_nop 0
  v_add_f32_dpp v42, v42, v42 row_bcast:15 row_mask:0xa bank_mask:0xf
  v_mfma_f32_16x16x32_bf16 v[164:167], a[140:143], a[80:83], v[164:167]
  s_nop 0
  v_add_f32_dpp v43, v43, v43 row_bcast:15 row_mask:0xa bank_mask:0xf
  v_mfma_f32_16x16x32_bf16 v[168:171], a[144:147], a[80:83], v[168:171]
  s_nop 0
  v_add_f32_dpp v42, v42, v42 row_bcast:31 row_mask:0xc bank_mask:0xf
  v_mfma_f32_16x16x32_bf16 v[172:175], a[148:151], a[80:83], v[172:175]
  v_mfma_f32_16x16x32_bf16 v[176:179], a[84:87], a[136:139], v[176:179]
  s_nop 0
  v_add_f32_dpp v43, v43, v43 row_bcast:31 row_mask:0xc bank_mask:0xf
  v_mfma_f32_16x16x32_bf16 v[180:183], a[84:87], a[140:143], v[180:183]
  v_mul_f32 v42, 0xbfb8aa3b, v42
  v_mfma_f32_16x16x32_bf16 v[184:187], a[84:87], a[144:147], v[184:187]
  v_mul_f32 v43, 0xbfb8aa3b, v43
  v_mfma_f32_16x16x32_bf16 v[188:191], a[84:87], a[148:151], v[188:191]
  v_exp_f32 v42, v42
  v_mfma_f32_16x16x32_bf16 v[192:195], a[88:91], a[136:139], v[192:195]
  v_exp_f32 v43, v43
  s_nop 0
  v_mfma_f32_16x16x32_bf16 v[196:199], a[88:91], a[140:143], v[196:199]
  v_add_f32 v42, 1.0, v42
  v_mfma_f32_16x16x32_bf16 v[200:203], a[88:91], a[144:147], v[200:203]
  v_add_f32 v43, 1.0, v43
  v_mfma_f32_16x16x32_bf16 v[204:207], a[88:91], a[148:151], v[204:207]
  v_mfma_f32_16x16x32_bf16 v[208:211], a[92:95], a[136:139], v[208:211]
  v_rcp_f32 v42, v42
  v_mfma_f32_16x16x32_bf16 v[212:215], a[92:95], a[140:143], v[212:215]
  v_rcp_f32 v43, v43
  v_mfma_f32_16x16x32_bf16 v[216:219], a[92:95], a[144:147], v[216:219]
  v_mov_b32 v18, 0
  v_mfma_f32_16x16x32_bf16 v[220:223], a[92:95], a[148:151], v[220:223]
  s_lshl_b32 s61, s73, 2
  s_add_u32 s61, s61, 20545536
  v_mfma_f32_16x16x32_bf16 v[224:227], a[96:99], a[136:139], v[224:227]
  s_lshl_b32 s63, s2, 8
  s_add_u32 s63, s63, 33136640
  v_mfma_f32_16x16x32_bf16 v[228:231], a[96:99], a[140:143], v[228:231]
  s_mov_b32 s68, 0
  s_mov_b32 s69, 0x80000000
  v_mfma_f32_16x16x32_bf16 v[232:235], a[96:99], a[144:147], v[232:235]
  s_mov_b64 exec, s[68:69]
  buffer_store_dwordx2 v[42:43], v18, s[16:19], s61 offen sc1
  s_mov_b64 exec, -1
  v_mfma_f32_16x16x32_bf16 v[236:239], a[96:99], a[148:151], v[236:239]
  v_mfma_f32_16x16x32_bf16 v[240:243], a[100:103], a[136:139], v[240:243]
  v_mfma_f32_16x16x32_bf16 v[244:247], a[100:103], a[140:143], v[244:247]
  v_mfma_f32_16x16x32_bf16 v[248:251], a[100:103], a[144:147], v[248:251]
  v_mfma_f32_16x16x32_bf16 v[252:255], a[100:103], a[148:151], v[252:255]
  s_barrier
  s_mov_b32 s3, 0
  s_mov_b32 s58, 0x3fb8aa3b
  s_mov_b32 s59, 0x3fb8aa3b
  s_lshl_b32 s60, s25, 1
  s_lshr_b32 s61, s24, 1
  s_add_u32 s60, s60, s61
  s_mul_i32 s72, s60, 1179648
  s_and_b32 s61, s24, 1
  s_lshl_b32 s61, s61, 12
  s_add_u32 s72, s72, s61
  s_nop 7
  s_mul_i32 s62, s26, 57344
  s_add_u32 s62, s62, 0
  s_add_u32 s62, s62, s72
  v_pk_mul_f32 v[18:19], v[176:177], s[58:59]
  v_pk_mul_f32 v[20:21], v[178:179], s[58:59]
  v_pk_mul_f32 v[22:23], v[192:193], s[58:59]
  v_pk_mul_f32 v[24:25], v[194:195], s[58:59]
  v_exp_f32 v18, v18
  v_exp_f32 v19, v19
  v_exp_f32 v20, v20
  v_exp_f32 v21, v21
  v_exp_f32 v22, v22
  v_exp_f32 v23, v23
  v_exp_f32 v24, v24
  v_exp_f32 v25, v25
  v_pk_fma_f32 v[26:27], v[18:19], 0.5, 1.0 op_sel_hi:[1,0,0]
  v_pk_fma_f32 v[28:29], v[20:21], 0.5, 1.0 op_sel_hi:[1,0,0]
  v_pk_fma_f32 v[30:31], v[22:23], 0.5, 1.0 op_sel_hi:[1,0,0]
  v_pk_fma_f32 v[32:33], v[24:25], 0.5, 1.0 op_sel_hi:[1,0,0]
  v_pk_fma_f32 v[26:27], v[18:19], v[26:27], 1.0 op_sel_hi:[1,1,0]
  v_pk_fma_f32 v[28:29], v[20:21], v[28:29], 1.0 op_sel_hi:[1,1,0]
  v_pk_fma_f32 v[30:31], v[22:23], v[30:31], 1.0 op_sel_hi:[1,1,0]
  v_pk_fma_f32 v[32:33], v[24:25], v[32:33], 1.0 op_sel_hi:[1,1,0]
  v_rcp_f32 v26, v26
  v_rcp_f32 v27, v27
  v_rcp_f32 v28, v28
  v_rcp_f32 v29, v29
  v_rcp_f32 v30, v30
  v_rcp_f32 v31, v31
  v_rcp_f32 v32, v32
  v_rcp_f32 v33, v33
  v_pk_fma_f32 v[176:177], v[26:27], v[176:177], v[176:177] neg_lo:[1,0,0] neg_hi:[1,0,0]
  v_pk_fma_f32 v[178:179], v[28:29], v[178:179], v[178:179] neg_lo:[1,0,0] neg_hi:[1,0,0]
  v_pk_fma_f32 v[192:193], v[30:31], v[192:193], v[192:193] neg_lo:[1,0,0] neg_hi:[1,0,0]
  v_pk_fma_f32 v[194:195], v[32:33], v[194:195], v[194:195] neg_lo:[1,0,0] neg_hi:[1,0,0]
  v_cvt_pk_bf16_f32 v176, v176, v177
  v_cvt_pk_bf16_f32 v177, v178, v179
  v_cvt_pk_bf16_f32 v178, v192, v193
  v_cvt_pk_bf16_f32 v179, v194, v195
  buffer_store_dwordx4 v[176:179], v17, s[16:19], s62 offen offset:0 sc1
  v_pk_mul_f32 v[18:19], v[180:181], s[58:59]
  v_pk_mul_f32 v[20:21], v[182:183], s[58:59]
  v_pk_mul_f32 v[22:23], v[196:197], s[58:59]
  v_pk_mul_f32 v[24:25], v[198:199], s[58:59]
  v_exp_f32 v18, v18
  v_exp_f32 v19, v19
  v_exp_f32 v20, v20
  v_exp_f32 v21, v21
  v_exp_f32 v22, v22
  v_exp_f32 v23, v23
  v_exp_f32 v24, v24
  v_exp_f32 v25, v25
  v_pk_fma_f32 v[26:27], v[18:19], 0.5, 1.0 op_sel_hi:[1,0,0]
  v_pk_fma_f32 v[28:29], v[20:21], 0.5, 1.0 op_sel_hi:[1,0,0]
  v_pk_fma_f32 v[30:31], v[22:23], 0.5, 1.0 op_sel_hi:[1,0,0]
  v_pk_fma_f32 v[32:33], v[24:25], 0.5, 1.0 op_sel_hi:[1,0,0]
  v_pk_fma_f32 v[26:27], v[18:19], v[26:27], 1.0 op_sel_hi:[1,1,0]
  v_pk_fma_f32 v[28:29], v[20:21], v[28:29], 1.0 op_sel_hi:[1,1,0]
  v_pk_fma_f32 v[30:31], v[22:23], v[30:31], 1.0 op_sel_hi:[1,1,0]
  v_pk_fma_f32 v[32:33], v[24:25], v[32:33], 1.0 op_sel_hi:[1,1,0]
  v_rcp_f32 v26, v26
  v_rcp_f32 v27, v27
  v_rcp_f32 v28, v28
  v_rcp_f32 v29, v29
  v_rcp_f32 v30, v30
  v_rcp_f32 v31, v31
  v_rcp_f32 v32, v32
  v_rcp_f32 v33, v33
  v_pk_fma_f32 v[180:181], v[26:27], v[180:181], v[180:181] neg_lo:[1,0,0] neg_hi:[1,0,0]
  v_pk_fma_f32 v[182:183], v[28:29], v[182:183], v[182:183] neg_lo:[1,0,0] neg_hi:[1,0,0]
  v_pk_fma_f32 v[196:197], v[30:31], v[196:197], v[196:197] neg_lo:[1,0,0] neg_hi:[1,0,0]
  v_pk_fma_f32 v[198:199], v[32:33], v[198:199], v[198:199] neg_lo:[1,0,0] neg_hi:[1,0,0]
  v_cvt_pk_bf16_f32 v180, v180, v181
  v_cvt_pk_bf16_f32 v181, v182, v183
  v_cvt_pk_bf16_f32 v182, v196, v197
  v_cvt_pk_bf16_f32 v183, v198, v199
  buffer_store_dwordx4 v[180:183], v17, s[16:19], s62 offen offset:1024 sc1
  v_pk_mul_f32 v[18:19], v[184:185], s[58:59]
  v_pk_mul_f32 v[20:21], v[186:187], s[58:59]
  v_pk_mul_f32 v[22:23], v[200:201], s[58:59]
  v_pk_mul_f32 v[24:25], v[202:203], s[58:59]
  v_exp_f32 v18, v18
  v_exp_f32 v19, v19
  v_exp_f32 v20, v20
  v_exp_f32 v21, v21
  v_exp_f32 v22, v22
  v_exp_f32 v23, v23
  v_exp_f32 v24, v24
  v_exp_f32 v25, v25
  v_pk_fma_f32 v[26:27], v[18:19], 0.5, 1.0 op_sel_hi:[1,0,0]
  v_pk_fma_f32 v[28:29], v[20:21], 0.5, 1.0 op_sel_hi:[1,0,0]
  v_pk_fma_f32 v[30:31], v[22:23], 0.5, 1.0 op_sel_hi:[1,0,0]
  v_pk_fma_f32 v[32:33], v[24:25], 0.5, 1.0 op_sel_hi:[1,0,0]
  v_pk_fma_f32 v[26:27], v[18:19], v[26:27], 1.0 op_sel_hi:[1,1,0]
  v_pk_fma_f32 v[28:29], v[20:21], v[28:29], 1.0 op_sel_hi:[1,1,0]
  v_pk_fma_f32 v[30:31], v[22:23], v[30:31], 1.0 op_sel_hi:[1,1,0]
  v_pk_fma_f32 v[32:33], v[24:25], v[32:33], 1.0 op_sel_hi:[1,1,0]
  v_rcp_f32 v26, v26
  v_rcp_f32 v27, v27
  v_rcp_f32 v28, v28
  v_rcp_f32 v29, v29
  v_rcp_f32 v30, v30
  v_rcp_f32 v31, v31
  v_rcp_f32 v32, v32
  v_rcp_f32 v33, v33
  v_pk_fma_f32 v[184:185], v[26:27], v[184:185], v[184:185] neg_lo:[1,0,0] neg_hi:[1,0,0]
  v_pk_fma_f32 v[186:187], v[28:29], v[186:187], v[186:187] neg_lo:[1,0,0] neg_hi:[1,0,0]
  v_pk_fma_f32 v[200:201], v[30:31], v[200:201], v[200:201] neg_lo:[1,0,0] neg_hi:[1,0,0]
  v_pk_fma_f32 v[202:203], v[32:33], v[202:203], v[202:203] neg_lo:[1,0,0] neg_hi:[1,0,0]
  v_cvt_pk_bf16_f32 v184, v184, v185
  v_cvt_pk_bf16_f32 v185, v186, v187
  v_cvt_pk_bf16_f32 v186, v200, v201
  v_cvt_pk_bf16_f32 v187, v202, v203
  buffer_store_dwordx4 v[184:187], v17, s[16:19], s62 offen offset:2048 sc1
  v_pk_mul_f32 v[18:19], v[188:189], s[58:59]
  v_pk_mul_f32 v[20:21], v[190:191], s[58:59]
  v_pk_mul_f32 v[22:23], v[204:205], s[58:59]
  v_pk_mul_f32 v[24:25], v[206:207], s[58:59]
  v_exp_f32 v18, v18
  v_exp_f32 v19, v19
  v_exp_f32 v20, v20
  v_exp_f32 v21, v21
  v_exp_f32 v22, v22
  v_exp_f32 v23, v23
  v_exp_f32 v24, v24
  v_exp_f32 v25, v25
  v_pk_fma_f32 v[26:27], v[18:19], 0.5, 1.0 op_sel_hi:[1,0,0]
  v_pk_fma_f32 v[28:29], v[20:21], 0.5, 1.0 op_sel_hi:[1,0,0]
  v_pk_fma_f32 v[30:31], v[22:23], 0.5, 1.0 op_sel_hi:[1,0,0]
  v_pk_fma_f32 v[32:33], v[24:25], 0.5, 1.0 op_sel_hi:[1,0,0]
  v_pk_fma_f32 v[26:27], v[18:19], v[26:27], 1.0 op_sel_hi:[1,1,0]
  v_pk_fma_f32 v[28:29], v[20:21], v[28:29], 1.0 op_sel_hi:[1,1,0]
  v_pk_fma_f32 v[30:31], v[22:23], v[30:31], 1.0 op_sel_hi:[1,1,0]
  v_pk_fma_f32 v[32:33], v[24:25], v[32:33], 1.0 op_sel_hi:[1,1,0]
  v_rcp_f32 v26, v26
  v_rcp_f32 v27, v27
  v_rcp_f32 v28, v28
  v_rcp_f32 v29, v29
  v_rcp_f32 v30, v30
  v_rcp_f32 v31, v31
  v_rcp_f32 v32, v32
  v_rcp_f32 v33, v33
  v_pk_fma_f32 v[188:189], v[26:27], v[188:189], v[188:189] neg_lo:[1,0,0] neg_hi:[1,0,0]
  v_pk_fma_f32 v[190:191], v[28:29], v[190:191], v[190:191] neg_lo:[1,0,0] neg_hi:[1,0,0]
  v_pk_fma_f32 v[204:205], v[30:31], v[204:205], v[204:205] neg_lo:[1,0,0] neg_hi:[1,0,0]
  v_pk_fma_f32 v[206:207], v[32:33], v[206:207], v[206:207] neg_lo:[1,0,0] neg_hi:[1,0,0]
  v_cvt_pk_bf16_f32 v188, v188, v189
  v_cvt_pk_bf16_f32 v189, v190, v191
  v_cvt_pk_bf16_f32 v190, v204, v205
  v_cvt_pk_bf16_f32 v191, v206, v207
  buffer_store_dwordx4 v[188:191], v17, s[16:19], s62 offen offset:3072 sc1
  s_mul_i32 s62, s26, 57344
  s_add_u32 s62, s62, 8192
  s_add_u32 s62, s62, s72
  v_pk_mul_f32 v[18:19], v[208:209], s[58:59]
  v_pk_mul_f32 v[20:21], v[210:211], s[58:59]
  v_pk_mul_f32 v[22:23], v[224:225], s[58:59]
  v_pk_mul_f32 v[24:25], v[226:227], s[58:59]
  v_exp_f32 v18, v18
  v_exp_f32 v19, v19
  v_exp_f32 v20, v20
  v_exp_f32 v21, v21
  v_exp_f32 v22, v22
  v_exp_f32 v23, v23
  v_exp_f32 v24, v24
  v_exp_f32 v25, v25
  v_pk_fma_f32 v[26:27], v[18:19], 0.5, 1.0 op_sel_hi:[1,0,0]
  v_pk_fma_f32 v[28:29], v[20:21], 0.5, 1.0 op_sel_hi:[1,0,0]
  v_pk_fma_f32 v[30:31], v[22:23], 0.5, 1.0 op_sel_hi:[1,0,0]
  v_pk_fma_f32 v[32:33], v[24:25], 0.5, 1.0 op_sel_hi:[1,0,0]
  v_pk_fma_f32 v[26:27], v[18:19], v[26:27], 1.0 op_sel_hi:[1,1,0]
  v_pk_fma_f32 v[28:29], v[20:21], v[28:29], 1.0 op_sel_hi:[1,1,0]
  v_pk_fma_f32 v[30:31], v[22:23], v[30:31], 1.0 op_sel_hi:[1,1,0]
  v_pk_fma_f32 v[32:33], v[24:25], v[32:33], 1.0 op_sel_hi:[1,1,0]
  v_rcp_f32 v26, v26
  v_rcp_f32 v27, v27
  v_rcp_f32 v28, v28
  v_rcp_f32 v29, v29
  v_rcp_f32 v30, v30
  v_rcp_f32 v31, v31
  v_rcp_f32 v32, v32
  v_rcp_f32 v33, v33
  v_pk_fma_f32 v[208:209], v[26:27], v[208:209], v[208:209] neg_lo:[1,0,0] neg_hi:[1,0,0]
  v_pk_fma_f32 v[210:211], v[28:29], v[210:211], v[210:211] neg_lo:[1,0,0] neg_hi:[1,0,0]
  v_pk_fma_f32 v[224:225], v[30:31], v[224:225], v[224:225] neg_lo:[1,0,0] neg_hi:[1,0,0]
  v_pk_fma_f32 v[226:227], v[32:33], v[226:227], v[226:227] neg_lo:[1,0,0] neg_hi:[1,0,0]
  v_cvt_pk_bf16_f32 v208, v208, v209
  v_cvt_pk_bf16_f32 v209, v210, v211
  v_cvt_pk_bf16_f32 v210, v224, v225
  v_cvt_pk_bf16_f32 v211, v226, v227
  buffer_store_dwordx4 v[208:211], v17, s[16:19], s62 offen offset:0 sc1
  v_pk_mul_f32 v[18:19], v[212:213], s[58:59]
  v_pk_mul_f32 v[20:21], v[214:215], s[58:59]
  v_pk_mul_f32 v[22:23], v[228:229], s[58:59]
  v_pk_mul_f32 v[24:25], v[230:231], s[58:59]
  v_exp_f32 v18, v18
  v_exp_f32 v19, v19
  v_exp_f32 v20, v20
  v_exp_f32 v21, v21
  v_exp_f32 v22, v22
  v_exp_f32 v23, v23
  v_exp_f32 v24, v24
  v_exp_f32 v25, v25
  v_pk_fma_f32 v[26:27], v[18:19], 0.5, 1.0 op_sel_hi:[1,0,0]
  v_pk_fma_f32 v[28:29], v[20:21], 0.5, 1.0 op_sel_hi:[1,0,0]
  v_pk_fma_f32 v[30:31], v[22:23], 0.5, 1.0 op_sel_hi:[1,0,0]
  v_pk_fma_f32 v[32:33], v[24:25], 0.5, 1.0 op_sel_hi:[1,0,0]
  v_pk_fma_f32 v[26:27], v[18:19], v[26:27], 1.0 op_sel_hi:[1,1,0]
  v_pk_fma_f32 v[28:29], v[20:21], v[28:29], 1.0 op_sel_hi:[1,1,0]
  v_pk_fma_f32 v[30:31], v[22:23], v[30:31], 1.0 op_sel_hi:[1,1,0]
  v_pk_fma_f32 v[32:33], v[24:25], v[32:33], 1.0 op_sel_hi:[1,1,0]
  v_rcp_f32 v26, v26
  v_rcp_f32 v27, v27
  v_rcp_f32 v28, v28
  v_rcp_f32 v29, v29
  v_rcp_f32 v30, v30
  v_rcp_f32 v31, v31
  v_rcp_f32 v32, v32
  v_rcp_f32 v33, v33
  v_pk_fma_f32 v[212:213], v[26:27], v[212:213], v[212:213] neg_lo:[1,0,0] neg_hi:[1,0,0]
  v_pk_fma_f32 v[214:215], v[28:29], v[214:215], v[214:215] neg_lo:[1,0,0] neg_hi:[1,0,0]
  v_pk_fma_f32 v[228:229], v[30:31], v[228:229], v[228:229] neg_lo:[1,0,0] neg_hi:[1,0,0]
  v_pk_fma_f32 v[230:231], v[32:33], v[230:231], v[230:231] neg_lo:[1,0,0] neg_hi:[1,0,0]
  v_cvt_pk_bf16_f32 v212, v212, v213
  v_cvt_pk_bf16_f32 v213, v214, v215
  v_cvt_pk_bf16_f32 v214, v228, v229
  v_cvt_pk_bf16_f32 v215, v230, v231
  buffer_store_dwordx4 v[212:215], v17, s[16:19], s62 offen offset:1024 sc1
  v_pk_mul_f32 v[18:19], v[216:217], s[58:59]
  v_pk_mul_f32 v[20:21], v[218:219], s[58:59]
  v_pk_mul_f32 v[22:23], v[232:233], s[58:59]
  v_pk_mul_f32 v[24:25], v[234:235], s[58:59]
  v_exp_f32 v18, v18
  v_exp_f32 v19, v19
  v_exp_f32 v20, v20
  v_exp_f32 v21, v21
  v_exp_f32 v22, v22
  v_exp_f32 v23, v23
  v_exp_f32 v24, v24
  v_exp_f32 v25, v25
  v_pk_fma_f32 v[26:27], v[18:19], 0.5, 1.0 op_sel_hi:[1,0,0]
  v_pk_fma_f32 v[28:29], v[20:21], 0.5, 1.0 op_sel_hi:[1,0,0]
  v_pk_fma_f32 v[30:31], v[22:23], 0.5, 1.0 op_sel_hi:[1,0,0]
  v_pk_fma_f32 v[32:33], v[24:25], 0.5, 1.0 op_sel_hi:[1,0,0]
  v_pk_fma_f32 v[26:27], v[18:19], v[26:27], 1.0 op_sel_hi:[1,1,0]
  v_pk_fma_f32 v[28:29], v[20:21], v[28:29], 1.0 op_sel_hi:[1,1,0]
  v_pk_fma_f32 v[30:31], v[22:23], v[30:31], 1.0 op_sel_hi:[1,1,0]
  v_pk_fma_f32 v[32:33], v[24:25], v[32:33], 1.0 op_sel_hi:[1,1,0]
  v_rcp_f32 v26, v26
  v_rcp_f32 v27, v27
  v_rcp_f32 v28, v28
  v_rcp_f32 v29, v29
  v_rcp_f32 v30, v30
  v_rcp_f32 v31, v31
  v_rcp_f32 v32, v32
  v_rcp_f32 v33, v33
  v_pk_fma_f32 v[216:217], v[26:27], v[216:217], v[216:217] neg_lo:[1,0,0] neg_hi:[1,0,0]
  v_pk_fma_f32 v[218:219], v[28:29], v[218:219], v[218:219] neg_lo:[1,0,0] neg_hi:[1,0,0]
  v_pk_fma_f32 v[232:233], v[30:31], v[232:233], v[232:233] neg_lo:[1,0,0] neg_hi:[1,0,0]
  v_pk_fma_f32 v[234:235], v[32:33], v[234:235], v[234:235] neg_lo:[1,0,0] neg_hi:[1,0,0]
  v_cvt_pk_bf16_f32 v216, v216, v217
  v_cvt_pk_bf16_f32 v217, v218, v219
  v_cvt_pk_bf16_f32 v218, v232, v233
  v_cvt_pk_bf16_f32 v219, v234, v235
  buffer_store_dwordx4 v[216:219], v17, s[16:19], s62 offen offset:2048 sc1
  v_pk_mul_f32 v[18:19], v[220:221], s[58:59]
  v_pk_mul_f32 v[20:21], v[222:223], s[58:59]
  v_pk_mul_f32 v[22:23], v[236:237], s[58:59]
  v_pk_mul_f32 v[24:25], v[238:239], s[58:59]
  v_exp_f32 v18, v18
  v_exp_f32 v19, v19
  v_exp_f32 v20, v20
  v_exp_f32 v21, v21
  v_exp_f32 v22, v22
  v_exp_f32 v23, v23
  v_exp_f32 v24, v24
  v_exp_f32 v25, v25
  v_pk_fma_f32 v[26:27], v[18:19], 0.5, 1.0 op_sel_hi:[1,0,0]
  v_pk_fma_f32 v[28:29], v[20:21], 0.5, 1.0 op_sel_hi:[1,0,0]
  v_pk_fma_f32 v[30:31], v[22:23], 0.5, 1.0 op_sel_hi:[1,0,0]
  v_pk_fma_f32 v[32:33], v[24:25], 0.5, 1.0 op_sel_hi:[1,0,0]
  v_pk_fma_f32 v[26:27], v[18:19], v[26:27], 1.0 op_sel_hi:[1,1,0]
  v_pk_fma_f32 v[28:29], v[20:21], v[28:29], 1.0 op_sel_hi:[1,1,0]
  v_pk_fma_f32 v[30:31], v[22:23], v[30:31], 1.0 op_sel_hi:[1,1,0]
  v_pk_fma_f32 v[32:33], v[24:25], v[32:33], 1.0 op_sel_hi:[1,1,0]
  v_rcp_f32 v26, v26
  v_rcp_f32 v27, v27
  v_rcp_f32 v28, v28
  v_rcp_f32 v29, v29
  v_rcp_f32 v30, v30
  v_rcp_f32 v31, v31
  v_rcp_f32 v32, v32
  v_rcp_f32 v33, v33
  v_pk_fma_f32 v[220:221], v[26:27], v[220:221], v[220:221] neg_lo:[1,0,0] neg_hi:[1,0,0]
  v_pk_fma_f32 v[222:223], v[28:29], v[222:223], v[222:223] neg_lo:[1,0,0] neg_hi:[1,0,0]
  v_pk_fma_f32 v[236:237], v[30:31], v[236:237], v[236:237] neg_lo:[1,0,0] neg_hi:[1,0,0]
  v_pk_fma_f32 v[238:239], v[32:33], v[238:239], v[238:239] neg_lo:[1,0,0] neg_hi:[1,0,0]
  v_cvt_pk_bf16_f32 v220, v220, v221
  v_cvt_pk_bf16_f32 v221, v222, v223
  v_cvt_pk_bf16_f32 v222, v236, v237
  v_cvt_pk_bf16_f32 v223, v238, v239
  buffer_store_dwordx4 v[220:223], v17, s[16:19], s62 offen offset:3072 sc1
  s_and_b32 s60, s2, 7
  s_lshr_b32 s61, s2, 3
  s_and_b32 s10, s60, 1
  s_lshr_b32 s60, s60, 1
  s_and_b32 s8, s60, 1
  s_lshl_b32 s8, s8, 3
  s_and_b32 s11, s61, 7
  s_add_u32 s8, s8, s11
  s_lshr_b32 s9, s60, 1
  s_lshl_b32 s9, s9, 2
  s_lshr_b32 s61, s61, 3
  s_add_u32 s9, s9, s61
  s_lshl_b32 s11, s8, 3
  s_add_u32 s11, s11, s9
  v_and_b32 v6, 15, v1
  v_lshrrev_b32 v7, 4, v1
  s_lshl_b32 s15, s24, 12
  s_add_u32 s27, s15, 16384
  s_lshl_b32 s60, s9, 8
  s_and_b32 s63, s24, 1
  s_lshl_b32 s61, s63, 15
  s_add_u32 s60, s60, s61
  v_lshlrev_b32 v8, 11, v7
  v_add_u32 v8, s60, v8
  v_lshlrev_b32 v9, 1, v7
  v_xor_b32 v9, v9, v6
  v_lshlrev_b32 v10, 4, v9
  v_add_u32 v10, v10, v8
  v_add_u32 v2, 0, v10
  v_xor_b32 v10, 8, v9
  v_lshlrev_b32 v10, 4, v10
  v_add_u32 v10, v10, v8
  v_add_u32 v3, 7168, v10
  v_lshlrev_b32 v10, 4, v9
  v_add_u32 v10, v10, v8
  v_add_u32 v4, 14336, v10
  v_xor_b32 v10, 8, v9
  v_lshlrev_b32 v10, 4, v10
  v_add_u32 v10, v10, v8
  v_add_u32 v5, 21504, v10
  s_mul_i32 s60, s10, 3
  s_lshr_b32 s61, s24, 1
  s_add_u32 s60, s60, s61
  s_lshl_b32 s13, s60, 16
  s_mul_i32 s12, s8, 144
  s_add_u32 s12, s12, s60
  s_lshl_b32 s12, s12, 13
  s_mov_b32 s31, 57344
  s_mov_b32 s32, 458752
  s_lshl_b32 s63, s63, 12
  v_add_u32 v8, s63, v17
  s_lshl_b32 s60, s8, 1
  s_add_u32 s60, s60, s10
  s_lshl_b32 s60, s60, 8
  s_add_u32 s60, s60, 33202176
  v_and_b32 v9, 31, v1
  v_lshlrev_b32 v9, 3, v9
  v_add_u32 v9, s60, v9
  s_mov_b32 s64, s54
  s_and_b32 s65, s55, 0xffff
  s_mov_b32 s66, 256
  s_mov_b32 s67, 0x20000
  v_mov_b32 v12, 0
  buffer_load_dwordx2 v[14:15], v12, s[64:67], 0 offen sc1
  s_add_u32 m0, s27, 0
  s_nop 0
  buffer_load_dwordx4 v2, s[96:99], s13 offen offset:0 lds
  buffer_load_dwordx4 v3, s[96:99], s13 offen offset:1024 lds
  buffer_load_dwordx4 v4, s[96:99], s13 offen offset:2048 lds
  buffer_load_dwordx4 v5, s[96:99], s13 offen offset:3072 lds
  s_add_u32 s13, s13, s32
  s_add_u32 m0, s27, 32768
  s_nop 0
  buffer_load_dwordx4 v2, s[96:99], s13 offen offset:0 lds
  buffer_load_dwordx4 v3, s[96:99], s13 offen offset:1024 lds
  buffer_load_dwordx4 v4, s[96:99], s13 offen offset:2048 lds
  buffer_load_dwordx4 v5, s[96:99], s13 offen offset:3072 lds
  s_add_u32 s13, s13, s32
  s_add_u32 m0, s27, 65536
  s_nop 0
  buffer_load_dwordx4 v2, s[96:99], s13 offen offset:0 lds
  buffer_load_dwordx4 v3, s[96:99], s13 offen offset:1024 lds
  buffer_load_dwordx4 v4, s[96:99], s13 offen offset:2048 lds
  buffer_load_dwordx4 v5, s[96:99], s13 offen offset:3072 lds
  s_add_u32 s13, s13, s32
  v_mov_b32 v34, 0x3f803f80
  v_mov_b32 v35, 0x3f803f80
  v_mov_b32 v36, 0x3f803f80
  v_mov_b32 v37, 0x3f803f80
  v_pk_mul_f32 v[18:19], v[48:49], s[58:59]
  v_pk_mul_f32 v[20:21], v[50:51], s[58:59]
  v_pk_mul_f32 v[22:23], v[52:53], s[58:59]
  v_pk_mul_f32 v[24:25], v[54:55], s[58:59]
  v_exp_f32_e64 v18, v18 clamp
  v_exp_f32_e64 v19, v19 clamp
  v_exp_f32_e64 v20, v20 clamp
  v_exp_f32_e64 v21, v21 clamp
  v_exp_f32_e64 v22, v22 clamp
  v_exp_f32_e64 v23, v23 clamp
  v_exp_f32_e64 v24, v24 clamp
  v_exp_f32_e64 v25, v25 clamp
  v_max_f32 v48, 0x358637bd, v48
  v_max_f32 v49, 0x358637bd, v49
  v_max_f32 v50, 0x358637bd, v50
  v_max_f32 v51, 0x358637bd, v51
  v_max_f32 v52, 0x358637bd, v52
  v_max_f32 v53, 0x358637bd, v53
  v_max_f32 v54, 0x358637bd, v54
  v_max_f32 v55, 0x358637bd, v55
  v_pk_add_f32 v[48:49], v[48:49], v[18:19]
  v_pk_add_f32 v[50:51], v[50:51], v[20:21]
  v_pk_add_f32 v[52:53], v[52:53], v[22:23]
  v_pk_add_f32 v[54:55], v[54:55], v[24:25]
  v_cvt_pk_bf16_f32 v48, v48, v49
  v_cvt_pk_bf16_f32 v49, v50, v51
  v_cvt_pk_bf16_f32 v50, v52, v53
  v_cvt_pk_bf16_f32 v51, v54, v55
  v_pk_mul_f32 v[18:19], v[56:57], s[58:59]
  v_pk_mul_f32 v[20:21], v[58:59], s[58:59]
  v_pk_mul_f32 v[22:23], v[60:61], s[58:59]
  v_pk_mul_f32 v[24:25], v[62:63], s[58:59]
  v_exp_f32_e64 v18, v18 clamp
  v_exp_f32_e64 v19, v19 clamp
  v_exp_f32_e64 v20, v20 clamp
  v_exp_f32_e64 v21, v21 clamp
  v_exp_f32_e64 v22, v22 clamp
  v_exp_f32_e64 v23, v23 clamp
  v_exp_f32_e64 v24, v24 clamp
  v_exp_f32_e64 v25, v25 clamp
  v_max_f32 v56, 0x358637bd, v56
  v_max_f32 v57, 0x358637bd, v57
  v_max_f32 v58, 0x358637bd, v58
  v_max_f32 v59, 0x358637bd, v59
  v_max_f32 v60, 0x358637bd, v60
  v_max_f32 v61, 0x358637bd, v61
  v_max_f32 v62, 0x358637bd, v62
  v_max_f32 v63, 0x358637bd, v63
  v_pk_add_f32 v[56:57], v[56:57], v[18:19]
  v_pk_add_f32 v[58:59], v[58:59], v[20:21]
  v_pk_add_f32 v[60:61], v[60:61], v[22:23]
  v_pk_add_f32 v[62:63], v[62:63], v[24:25]
  v_cvt_pk_bf16_f32 v56, v56, v57
  v_cvt_pk_bf16_f32 v57, v58, v59
  v_cvt_pk_bf16_f32 v58, v60, v61
  v_cvt_pk_bf16_f32 v59, v62, v63
  s_waitcnt vmcnt(12)
L_k1A_tw:
  v_readfirstlane_b32 s60, v15
  v_readfirstlane_b32 s61, v14
  s_nop 3
  s_min_u32 s60, s60, s61
  s_cmp_lg_u32 s60, 0
  s_cbranch_scc1 L_k1A_tok
  s_add_u32 s3, s3, 1
  s_cmp_gt_u32 s3, 0x40000
  s_cbranch_scc1 L_k1A_tok
  s_sleep 4
  buffer_load_dwordx2 v[14:15], v12, s[64:67], 0 offen sc1
  s_waitcnt vmcnt(0)
  s_branch L_k1A_tw
L_k1A_tok:
  s_mov_b64 exec, 1
  buffer_store_dwordx2 v[14:15], v0, s[16:19], 0 offen sc1
  s_mov_b64 exec, -1
  v_pk_mul_f32 v[18:19], v[64:65], s[58:59]
  v_pk_mul_f32 v[20:21], v[66:67], s[58:59]
  v_pk_mul_f32 v[22:23], v[68:69], s[58:59]
  v_pk_mul_f32 v[24:25], v[70:71], s[58:59]
  v_exp_f32_e64 v18, v18 clamp
  v_exp_f32_e64 v19, v19 clamp
  v_exp_f32_e64 v20, v20 clamp
  v_exp_f32_e64 v21, v21 clamp
  v_exp_f32_e64 v22, v22 clamp
  v_exp_f32_e64 v23, v23 clamp
  v_exp_f32_e64 v24, v24 clamp
  v_exp_f32_e64 v25, v25 clamp
  v_max_f32 v64, 0x358637bd, v64
  v_max_f32 v65, 0x358637bd, v65
  v_max_f32 v66, 0x358637bd, v66
  v_max_f32 v67, 0x358637bd, v67
  v_max_f32 v68, 0x358637bd, v68
  v_max_f32 v69, 0x358637bd, v69
  v_max_f32 v70, 0x358637bd, v70
  v_max_f32 v71, 0x358637bd, v71
  v_pk_add_f32 v[64:65], v[64:65], v[18:19]
  v_pk_add_f32 v[66:67], v[66:67], v[20:21]
  v_pk_add_f32 v[68:69], v[68:69], v[22:23]
  v_pk_add_f32 v[70:71], v[70:71], v[24:25]
  v_cvt_pk_bf16_f32 v64, v64, v65
  v_cvt_pk_bf16_f32 v65, v66, v67
  v_cvt_pk_bf16_f32 v66, v68, v69
  v_cvt_pk_bf16_f32 v67, v70, v71
  v_pk_mul_f32 v[18:19], v[72:73], s[58:59]
  v_pk_mul_f32 v[20:21], v[74:75], s[58:59]
  v_pk_mul_f32 v[22:23], v[76:77], s[58:59]
  v_pk_mul_f32 v[24:25], v[78:79], s[58:59]
  v_exp_f32_e64 v18, v18 clamp
  v_exp_f32_e64 v19, v19 clamp
  v_exp_f32_e64 v20, v20 clamp
  v_exp_f32_e64 v21, v21 clamp
  v_exp_f32_e64 v22, v22 clamp
  v_exp_f32_e64 v23, v23 clamp
  v_exp_f32_e64 v24, v24 clamp
  v_exp_f32_e64 v25, v25 clamp
  v_max_f32 v72, 0x358637bd, v72
  v_max_f32 v73, 0x358637bd, v73
  v_max_f32 v74, 0x358637bd, v74
  v_max_f32 v75, 0x358637bd, v75
  v_max_f32 v76, 0x358637bd, v76
  v_max_f32 v77, 0x358637bd, v77
  v_max_f32 v78, 0x358637bd, v78
  v_max_f32 v79, 0x358637bd, v79
  v_pk_add_f32 v[72:73], v[72:73], v[18:19]
  v_pk_add_f32 v[74:75], v[74:75], v[20:21]
  v_pk_add_f32 v[76:77], v[76:77], v[22:23]
  v_pk_add_f32 v[78:79], v[78:79], v[24:25]
  v_cvt_pk_bf16_f32 v72, v72, v73
  v_cvt_pk_bf16_f32 v73, v74, v75
  v_cvt_pk_bf16_f32 v74, v76, v77
  v_cvt_pk_bf16_f32 v75, v78, v79
  v_pk_mul_f32 v[18:19], v[80:81], s[58:59]
  v_pk_mul_f32 v[20:21], v[82:83], s[58:59]
  v_pk_mul_f32 v[22:23], v[84:85], s[58:59]
  v_pk_mul_f32 v[24:25], v[86:87], s[58:59]
  v_exp_f32_e64 v18, v18 clamp
  v_exp_f32_e64 v19, v19 clamp
  v_exp_f32_e64 v20, v20 clamp
  v_exp_f32_e64 v21, v21 clamp
  v_exp_f32_e64 v22, v22 clamp
  v_exp_f32_e64 v23, v23 clamp
  v_exp_f32_e64 v24, v24 clamp
  v_exp_f32_e64 v25, v25 clamp
  v_max_f32 v80, 0x358637bd, v80
  v_max_f32 v81, 0x358637bd, v81
  v_max_f32 v82, 0x358637bd, v82
  v_max_f32 v83, 0x358637bd, v83
  v_max_f32 v84, 0x358637bd, v84
  v_max_f32 v85, 0x358637bd, v85
  v_max_f32 v86, 0x358637bd, v86
  v_max_f32 v87, 0x358637bd, v87
  v_pk_add_f32 v[80:81], v[80:81], v[18:19]
  v_pk_add_f32 v[82:83], v[82:83], v[20:21]
  v_pk_add_f32 v[84:85], v[84:85], v[22:23]
  v_pk_add_f32 v[86:87], v[86:87], v[24:25]
  v_cvt_pk_bf16_f32 v80, v80, v81
  v_cvt_pk_bf16_f32 v81, v82, v83
  v_cvt_pk_bf16_f32 v82, v84, v85
  v_cvt_pk_bf16_f32 v83, v86, v87
  v_pk_mul_f32 v[18:19], v[88:89], s[58:59]
  v_pk_mul_f32 v[20:21], v[90:91], s[58:59]
  v_pk_mul_f32 v[22:23], v[92:93], s[58:59]
  v_pk_mul_f32 v[24:25], v[94:95], s[58:59]
  v_exp_f32_e64 v18, v18 clamp
  v_exp_f32_e64 v19, v19 clamp
  v_exp_f32_e64 v20, v20 clamp
  v_exp_f32_e64 v21, v21 clamp
  v_exp_f32_e64 v22, v22 clamp
  v_exp_f32_e64 v23, v23 clamp
  v_exp_f32_e64 v24, v24 clamp
  v_exp_f32_e64 v25, v25 clamp
  v_max_f32 v88, 0x358637bd, v88
  v_max_f32 v89, 0x358637bd, v89
  v_max_f32 v90, 0x358637bd, v90
  v_max_f32 v91, 0x358637bd, v91
  v_max_f32 v92, 0x358637bd, v92
  v_max_f32 v93, 0x358637bd, v93
  v_max_f32 v94, 0x358637bd, v94
  v_max_f32 v95, 0x358637bd, v95
  v_pk_add_f32 v[88:89], v[88:89], v[18:19]
  v_pk_add_f32 v[90:91], v[90:91], v[20:21]
  v_pk_add_f32 v[92:93], v[92:93], v[22:23]
  v_pk_add_f32 v[94:95], v[94:95], v[24:25]
  v_cvt_pk_bf16_f32 v88, v88, v89
  v_cvt_pk_bf16_f32 v89, v90, v91
  v_cvt_pk_bf16_f32 v90, v92, v93
  v_cvt_pk_bf16_f32 v91, v94, v95
  v_pk_mul_f32 v[18:19], v[96:97], s[58:59]
  v_pk_mul_f32 v[20:21], v[98:99], s[58:59]
  v_pk_mul_f32 v[22:23], v[100:101], s[58:59]
  v_pk_mul_f32 v[24:25], v[102:103], s[58:59]
  v_exp_f32_e64 v18, v18 clamp
  v_exp_f32_e64 v19, v19 clamp
  v_exp_f32_e64 v20, v20 clamp
  v_exp_f32_e64 v21, v21 clamp
  v_exp_f32_e64 v22, v22 clamp
  v_exp_f32_e64 v23, v23 clamp
  v_exp_f32_e64 v24, v24 clamp
  v_exp_f32_e64 v25, v25 clamp
  v_max_f32 v96, 0x358637bd, v96
  v_max_f32 v97, 0x358637bd, v97
  v_max_f32 v98, 0x358637bd, v98
  v_max_f32 v99, 0x358637bd, v99
  v_max_f32 v100, 0x358637bd, v100
  v_max_f32 v101, 0x358637bd, v101
  v_max_f32 v102, 0x358637bd, v102
  v_max_f32 v103, 0x358637bd, v103
  v_pk_add_f32 v[96:97], v[96:97], v[18:19]
  v_pk_add_f32 v[98:99], v[98:99], v[20:21]
  v_pk_add_f32 v[100:101], v[100:101], v[22:23]
  v_pk_add_f32 v[102:103], v[102:103], v[24:25]
  v_cvt_pk_bf16_f32 v96, v96, v97
  v_cvt_pk_bf16_f32 v97, v98, v99
  v_cvt_pk_bf16_f32 v98, v100, v101
  v_cvt_pk_bf16_f32 v99, v102, v103
  v_pk_mul_f32 v[18:19], v[104:105], s[58:59]
  v_pk_mul_f32 v[20:21], v[106:107], s[58:59]
  v_pk_mul_f32 v[22:23], v[108:109], s[58:59]
  v_pk_mul_f32 v[24:25], v[110:111], s[58:59]
  v_exp_f32_e64 v18, v18 clamp
  v_exp_f32_e64 v19, v19 clamp
  v_exp_f32_e64 v20, v20 clamp
  v_exp_f32_e64 v21, v21 clamp
  v_exp_f32_e64 v22, v22 clamp
  v_exp_f32_e64 v23, v23 clamp
  v_exp_f32_e64 v24, v24 clamp
  v_exp_f32_e64 v25, v25 clamp
  v_max_f32 v104, 0x358637bd, v104
  v_max_f32 v105, 0x358637bd, v105
  v_max_f32 v106, 0x358637bd, v106
  v_max_f32 v107, 0x358637bd, v107
  v_max_f32 v108, 0x358637bd, v108
  v_max_f32 v109, 0x358637bd, v109
  v_max_f32 v110, 0x358637bd, v110
  v_max_f32 v111, 0x358637bd, v111
  v_pk_add_f32 v[104:105], v[104:105], v[18:19]
  v_pk_add_f32 v[106:107], v[106:107], v[20:21]
  v_pk_add_f32 v[108:109], v[108:109], v[22:23]
  v_pk_add_f32 v[110:111], v[110:111], v[24:25]
  v_cvt_pk_bf16_f32 v104, v104, v105
  v_cvt_pk_bf16_f32 v105, v106, v107
  v_cvt_pk_bf16_f32 v106, v108, v109
  v_cvt_pk_bf16_f32 v107, v110, v111
  v_cvt_pk_bf16_f32 v112, v112, v113
  v_cvt_pk_bf16_f32 v113, v114, v115
  v_cvt_pk_bf16_f32 v114, v116, v117
  v_cvt_pk_bf16_f32 v115, v118, v119
  v_cvt_pk_bf16_f32 v120, v120, v121
  v_cvt_pk_bf16_f32 v121, v122, v123
  v_cvt_pk_bf16_f32 v122, v124, v125
  v_cvt_pk_bf16_f32 v123, v126, v127
  v_cvt_pk_bf16_f32 v128, v128, v129
  v_cvt_pk_bf16_f32 v129, v130, v131
  v_cvt_pk_bf16_f32 v130, v132, v133
  v_cvt_pk_bf16_f32 v131, v134, v135
  v_cvt_pk_bf16_f32 v136, v136, v137
  v_cvt_pk_bf16_f32 v137, v138, v139
  v_cvt_pk_bf16_f32 v138, v140, v141
  v_cvt_pk_bf16_f32 v139, v142, v143
  v_cvt_pk_bf16_f32 v144, v144, v145
  v_cvt_pk_bf16_f32 v145, v146, v147
  v_cvt_pk_bf16_f32 v146, v148, v149
  v_cvt_pk_bf16_f32 v147, v150, v151
  v_cvt_pk_bf16_f32 v152, v152, v153
  v_cvt_pk_bf16_f32 v153, v154, v155
  v_cvt_pk_bf16_f32 v154, v156, v157
  v_cvt_pk_bf16_f32 v155, v158, v159
  v_cvt_pk_bf16_f32 v160, v160, v161
  v_cvt_pk_bf16_f32 v161, v162, v163
  v_cvt_pk_bf16_f32 v162, v164, v165
  v_cvt_pk_bf16_f32 v163, v166, v167
  v_cvt_pk_bf16_f32 v168, v168, v169
  v_cvt_pk_bf16_f32 v169, v170, v171
  v_cvt_pk_bf16_f32 v170, v172, v173
  v_cvt_pk_bf16_f32 v171, v174, v175
  s_nop 1
  v_mfma_f32_16x16x32_bf16 v[52:55], v[48:51], v[112:115], 0
  v_mfma_f32_16x16x32_bf16 v[60:63], v[48:51], v[128:131], 0
  v_mfma_f32_16x16x32_bf16 v[68:71], v[48:51], v[34:37], 0
  v_mfma_f32_16x16x32_bf16 v[76:79], v[64:67], v[112:115], 0
  v_mfma_f32_16x16x32_bf16 v[84:87], v[64:67], v[128:131], 0
  v_mfma_f32_16x16x32_bf16 v[92:95], v[64:67], v[34:37], 0
  v_mfma_f32_16x16x32_bf16 v[100:103], v[80:83], v[144:147], 0
  v_mfma_f32_16x16x32_bf16 v[108:111], v[80:83], v[160:163], 0
  v_mfma_f32_16x16x32_bf16 v[116:119], v[80:83], v[34:37], 0
  v_mfma_f32_16x16x32_bf16 v[124:127], v[96:99], v[144:147], 0
  v_mfma_f32_16x16x32_bf16 v[132:135], v[96:99], v[160:163], 0
  v_mfma_f32_16x16x32_bf16 v[140:143], v[96:99], v[34:37], 0
  v_mfma_f32_16x16x32_bf16 v[52:55], v[56:59], v[120:123], v[52:55]
  v_mfma_f32_16x16x32_bf16 v[60:63], v[56:59], v[136:139], v[60:63]
  v_mfma_f32_16x16x32_bf16 v[68:71], v[56:59], v[34:37], v[68:71]
  v_mfma_f32_16x16x32_bf16 v[76:79], v[72:75], v[120:123], v[76:79]
  v_mfma_f32_16x16x32_bf16 v[84:87], v[72:75], v[136:139], v[84:87]
  v_mfma_f32_16x16x32_bf16 v[92:95], v[72:75], v[34:37], v[92:95]
  v_mfma_f32_16x16x32_bf16 v[100:103], v[88:91], v[152:155], v[100:103]
  v_mfma_f32_16x16x32_bf16 v[108:111], v[88:91], v[168:171], v[108:111]
  v_mfma_f32_16x16x32_bf16 v[116:119], v[88:91], v[34:37], v[116:119]
  v_mfma_f32_16x16x32_bf16 v[124:127], v[104:107], v[152:155], v[124:127]
  v_mfma_f32_16x16x32_bf16 v[132:135], v[104:107], v[168:171], v[132:135]
  v_mfma_f32_16x16x32_bf16 v[140:143], v[104:107], v[34:37], v[140:143]
  s_mul_i32 s60, s24, 12288
  s_add_u32 s60, s60, 98304
  v_add_u32 v38, s60, v17
  s_mul_i32 s60, s24, 3072
  s_add_u32 s60, s60, 98304
  v_add_u32 v39, s60, v17
  buffer_load_dwordx2 v[10:11], v9, s[16:19], 0 offen sc1
  s_nop 7
  ds_write_b128 v38, v[52:55] offset:0
  ds_write_b128 v38, v[60:63] offset:1024
  ds_write_b128 v38, v[68:71] offset:2048
  ds_write_b128 v38, v[76:79] offset:3072
  ds_write_b128 v38, v[84:87] offset:4096
  ds_write_b128 v38, v[92:95] offset:5120
  ds_write_b128 v38, v[100:103] offset:6144
  ds_write_b128 v38, v[108:111] offset:7168
  ds_write_b128 v38, v[116:119] offset:8192
  ds_write_b128 v38, v[124:127] offset:9216
  ds_write_b128 v38, v[132:135] offset:10240
  ds_write_b128 v38, v[140:143] offset:11264
  s_lshl_b32 s60, s26, 3
  s_add_u32 s60, s60, s25
  s_mul_i32 s60, s60, 12288
  s_mul_i32 s61, s24, 3072
  s_add_u32 s60, s60, s61
  s_add_u32 s70, s60, 18874368
  s_mul_i32 s6, s26, 57344
  s_add_u32 s6, s6, 16384
  s_add_u32 s6, s6, s72
  v_pk_mul_f32 v[18:19], v[240:241], s[58:59]
  v_pk_mul_f32 v[20:21], v[242:243], s[58:59]
  v_pk_mul_f32 v[22:23], v[244:245], s[58:59]
  v_pk_mul_f32 v[24:25], v[246:247], s[58:59]
  v_exp_f32 v18, v18
  v_exp_f32 v19, v19
  v_exp_f32 v20, v20
  v_exp_f32 v21, v21
  v_exp_f32 v22, v22
  v_exp_f32 v23, v23
  v_exp_f32 v24, v24
  v_exp_f32 v25, v25
  v_pk_fma_f32 v[26:27], v[18:19], 0.5, 1.0 op_sel_hi:[1,0,0]
  v_pk_fma_f32 v[28:29], v[20:21], 0.5, 1.0 op_sel_hi:[1,0,0]
  v_pk_fma_f32 v[30:31], v[22:23], 0.5, 1.0 op_sel_hi:[1,0,0]
  v_pk_fma_f32 v[32:33], v[24:25], 0.5, 1.0 op_sel_hi:[1,0,0]
  v_pk_fma_f32 v[26:27], v[18:19], v[26:27], 1.0 op_sel_hi:[1,1,0]
  v_pk_fma_f32 v[28:29], v[20:21], v[28:29], 1.0 op_sel_hi:[1,1,0]
  v_pk_fma_f32 v[30:31], v[22:23], v[30:31], 1.0 op_sel_hi:[1,1,0]
  v_pk_fma_f32 v[32:33], v[24:25], v[32:33], 1.0 op_sel_hi:[1,1,0]
  v_rcp_f32 v26, v26
  v_rcp_f32 v27, v27
  v_rcp_f32 v28, v28
  v_rcp_f32 v29, v29
  v_rcp_f32 v30, v30
  v_rcp_f32 v31, v31
  v_rcp_f32 v32, v32
  v_rcp_f32 v33, v33
  v_pk_fma_f32 v[240:241], v[26:27], v[240:241], v[240:241] neg_lo:[1,0,0] neg_hi:[1,0,0]
  v_pk_fma_f32 v[242:243], v[28:29], v[242:243], v[242:243] neg_lo:[1,0,0] neg_hi:[1,0,0]
  v_pk_fma_f32 v[244:245], v[30:31], v[244:245], v[244:245] neg_lo:[1,0,0] neg_hi:[1,0,0]
  v_pk_fma_f32 v[246:247], v[32:33], v[246:247], v[246:247] neg_lo:[1,0,0] neg_hi:[1,0,0]
  v_cvt_pk_bf16_f32 v240, v240, v241
  v_cvt_pk_bf16_f32 v241, v242, v243
  v_cvt_pk_bf16_f32 v242, v244, v245
  v_cvt_pk_bf16_f32 v243, v246, v247
  v_pk_mul_f32 v[18:19], v[248:249], s[58:59]
  v_pk_mul_f32 v[20:21], v[250:251], s[58:59]
  v_pk_mul_f32 v[22:23], v[252:253], s[58:59]
  v_pk_mul_f32 v[24:25], v[254:255], s[58:59]
  v_exp_f32 v18, v18
  v_exp_f32 v19, v19
  v_exp_f32 v20, v20
  v_exp_f32 v21, v21
  v_exp_f32 v22, v22
  v_exp_f32 v23, v23
  v_exp_f32 v24, v24
  v_exp_f32 v25, v25
  v_pk_fma_f32 v[26:27], v[18:19], 0.5, 1.0 op_sel_hi:[1,0,0]
  v_pk_fma_f32 v[28:29], v[20:21], 0.5, 1.0 op_sel_hi:[1,0,0]
  v_pk_fma_f32 v[30:31], v[22:23], 0.5, 1.0 op_sel_hi:[1,0,0]
  v_pk_fma_f32 v[32:33], v[24:25], 0.5, 1.0 op_sel_hi:[1,0,0]
  v_pk_fma_f32 v[26:27], v[18:19], v[26:27], 1.0 op_sel_hi:[1,1,0]
  v_pk_fma_f32 v[28:29], v[20:21], v[28:29], 1.0 op_sel_hi:[1,1,0]
  v_pk_fma_f32 v[30:31], v[22:23], v[30:31], 1.0 op_sel_hi:[1,1,0]
  v_pk_fma_f32 v[32:33], v[24:25], v[32:33], 1.0 op_sel_hi:[1,1,0]
  v_rcp_f32 v26, v26
  v_rcp_f32 v27, v27
  v_rcp_f32 v28, v28
  v_rcp_f32 v29, v29
  v_rcp_f32 v30, v30
  v_rcp_f32 v31, v31
  v_rcp_f32 v32, v32
  v_rcp_f32 v33, v33
  v_pk_fma_f32 v[248:249], v[26:27], v[248:249], v[248:249] neg_lo:[1,0,0] neg_hi:[1,0,0]
  v_pk_fma_f32 v[250:251], v[28:29], v[250:251], v[250:251] neg_lo:[1,0,0] neg_hi:[1,0,0]
  v_pk_fma_f32 v[252:253], v[30:31], v[252:253], v[252:253] neg_lo:[1,0,0] neg_hi:[1,0,0]
  v_pk_fma_f32 v[254:255], v[32:33], v[254:255], v[254:255] neg_lo:[1,0,0] neg_hi:[1,0,0]
  v_cvt_pk_bf16_f32 v244, v248, v249
  v_cvt_pk_bf16_f32 v245, v250, v251
  v_cvt_pk_bf16_f32 v246, v252, v253
  v_cvt_pk_bf16_f32 v247, v254, v255
  s_nop 1
  v_permlane16_swap_b32 v240, v242
  v_permlane16_swap_b32 v241, v243
  v_permlane16_swap_b32 v244, v246
  v_permlane16_swap_b32 v245, v247
  s_mov_b32 s4, 0x7ff00000
  s_mov_b32 s5, 0x7ff00000
  s_waitcnt lgkmcnt(0)
  s_barrier
  ds_read_b128 v[48:51], v39 offset:0
  ds_read_b128 v[56:59], v39 offset:1024
  ds_read_b128 v[64:67], v39 offset:2048
  ds_read_b128 v[72:75], v39 offset:12288
  ds_read_b128 v[80:83], v39 offset:13312
  ds_read_b128 v[88:91], v39 offset:14336
  ds_read_b128 v[96:99], v39 offset:24576
  ds_read_b128 v[104:107], v39 offset:25600
  ds_read_b128 v[112:115], v39 offset:26624
  ds_read_b128 v[120:123], v39 offset:36864
  ds_read_b128 v[128:131], v39 offset:37888
  ds_read_b128 v[136:139], v39 offset:38912
  s_waitcnt vmcnt(0)
  v_cmp_eq_u64 vcc, v[10:11], v[14:15]
  s_mov_b32 s30, 0
  s_nop 0
  s_cmp_eq_u64 vcc, -1
  s_cbranch_scc0 L_k1A_noearly
  s_add_u32 m0, s15, 0
  s_nop 0
  buffer_load_dwordx4 v8, s[16:19], s12 offen offset:0  lds
  buffer_load_dwordx4 v8, s[16:19], s12 offen offset:1024  lds
  buffer_load_dwordx4 v8, s[16:19], s12 offen offset:2048  lds
  buffer_load_dwordx4 v8, s[16:19], s12 offen offset:3072  lds
  s_add_u32 s12, s12, s31
  s_add_u32 m0, s15, 32768
  s_nop 0
  buffer_load_dwordx4 v8, s[16:19], s12 offen offset:0  lds
  buffer_load_dwordx4 v8, s[16:19], s12 offen offset:1024  lds
  buffer_load_dwordx4 v8, s[16:19], s12 offen offset:2048  lds
  buffer_load_dwordx4 v8, s[16:19], s12 offen offset:3072  lds
  s_add_u32 s12, s12, s31
  s_add_u32 m0, s15, 65536
  s_nop 0
  buffer_load_dwordx4 v8, s[16:19], s12 offen offset:0  lds
  buffer_load_dwordx4 v8, s[16:19], s12 offen offset:1024  lds
  buffer_load_dwordx4 v8, s[16:19], s12 offen offset:2048  lds
  buffer_load_dwordx4 v8, s[16:19], s12 offen offset:3072  lds
  s_add_u32 s12, s12, s31
  s_mov_b32 s30, 1
L_k1A_noearly:
  s_waitcnt lgkmcnt(0)
  v_pk_add_f32 v[48:49], v[48:49], v[72:73]
  v_pk_add_f32 v[96:97], v[96:97], v[120:121]
  v_pk_add_f32 v[50:51], v[50:51], v[74:75]
  v_pk_add_f32 v[98:99], v[98:99], v[122:123]
  v_pk_add_f32 v[48:49], v[48:49], v[96:97]
  v_pk_add_f32 v[50:51], v[50:51], v[98:99]
  buffer_store_dwordx4 v[48:51], v17, s[16:19], s70 offen offset:0 sc1
  v_pk_add_f32 v[56:57], v[56:57], v[80:81]
  v_pk_add_f32 v[104:105], v[104:105], v[128:129]
  v_pk_add_f32 v[58:59], v[58:59], v[82:83]
  v_pk_add_f32 v[106:107], v[106:107], v[130:131]
  v_pk_add_f32 v[56:57], v[56:57], v[104:105]
  v_pk_add_f32 v[58:59], v[58:59], v[106:107]
  buffer_store_dwordx4 v[56:59], v17, s[16:19], s70 offen offset:1024 sc1
  v_pk_add_f32 v[64:65], v[64:65], v[88:89]
  v_pk_add_f32 v[112:113], v[112:113], v[136:137]
  v_pk_add_f32 v[66:67], v[66:67], v[90:91]
  v_pk_add_f32 v[114:115], v[114:115], v[138:139]
  v_pk_add_f32 v[64:65], v[64:65], v[112:113]
  v_pk_add_f32 v[66:67], v[66:67], v[114:115]
  buffer_store_dwordx4 v[64:67], v17, s[16:19], s70 offen offset:2048 sc1
  s_cmp_eq_u32 s30, 0
  s_cbranch_scc1 L_p2_late
  s_waitcnt vmcnt(3)
  s_branch L_p2_go
L_k1_typeB:
  v_and_b32 v18, 15, v1
  v_lshrrev_b32 v19, 4, v1
  s_mul_i32 s62, s26, 448
  s_add_u32 s62, s62, 160
  s_lshr_b32 s68, s24, 1
  s_lshl_b32 s68, s68, 4
  s_and_b32 s69, s24, 1
  s_lshl_b32 s69, s69, 2
  s_add_u32 s68, s68, s69
  v_lshrrev_b32 v20, 3, v1
  v_lshrrev_b32 v22, 2, v20
  v_lshlrev_b32 v22, 3, v22
  v_and_b32 v21, 3, v20
  v_add3_u32 v21, v21, v22, s68
  v_mul_u32_u24 v21, 6144, v21
  v_lshrrev_b32 v22, 1, v20
  v_and_b32 v22, 3, v22
  v_lshlrev_b32 v22, 1, v22
  v_and_b32 v23, 7, v1
  v_xor_b32 v23, v23, v22
  v_lshlrev_b32 v23, 4, v23
  v_add_u32 v21, v21, v23
  s_lshl_b32 s69, s26, 7
  s_add_u32 s69, s69, 4096
  v_add_u32 v13, s69, v21
  v_add_u32 v20, 0, v1
  v_mul_u32_u24 v21, 57, v20
  v_lshrrev_b32 v21, 10, v21
  v_mul_u32_u24 v22, 18, v21
  v_sub_u32 v20, v20, v22
  v_and_b32 v21, 7, v21
  v_lshrrev_b32 v23, 2, v21
  v_lshlrev_b32 v23, 3, v23
  v_and_b32 v22, 3, v21
  v_add3_u32 v22, v22, v23, s68
  v_mul_u32_u24 v22, 7168, v22
  v_lshlrev_b32 v20, 4, v20
  v_add3_u32 v20, v20, v22, s62
  v_add_u32 v14, 3072, v20
  v_add_u32 v20, 64, v1
  v_mul_u32_u24 v21, 57, v20
  v_lshrrev_b32 v21, 10, v21
  v_mul_u32_u24 v22, 18, v21
  v_sub_u32 v20, v20, v22
  v_and_b32 v21, 7, v21
  v_lshrrev_b32 v23, 2, v21
  v_lshlrev_b32 v23, 3, v23
  v_and_b32 v22, 3, v21
  v_add3_u32 v22, v22, v23, s68
  v_mul_u32_u24 v22, 7168, v22
  v_lshlrev_b32 v20, 4, v20
  v_add3_u32 v20, v20, v22, s62
  v_add_u32 v15, 2048, v20
  v_add_u32 v20, 128, v1
  v_mul_u32_u24 v21, 57, v20
  v_lshrrev_b32 v21, 10, v21
  v_mul_u32_u24 v22, 18, v21
  v_sub_u32 v20, v20, v22
  v_and_b32 v21, 7, v21
  v_lshrrev_b32 v23, 2, v21
  v_lshlrev_b32 v23, 3, v23
  v_and_b32 v22, 3, v21
  v_add3_u32 v22, v22, v23, s68
  v_mul_u32_u24 v22, 7168, v22
  v_lshlrev_b32 v20, 4, v20
  v_add3_u32 v20, v20, v22, s62
  v_add_u32 v16, 1024, v20
  s_lshl_b32 s69, s25, 8
  s_lshl_b32 s70, s24, 6
  s_add_u32 s69, s69, s70
  s_lshl_b32 s69, s69, 11
  v_lshrrev_b32 v20, 3, v1
  v_lshrrev_b32 v21, 1, v20
  v_and_b32 v22, 7, v1
  v_xor_b32 v22, v22, v21
  v_lshlrev_b32 v20, 11, v20
  v_add_u32 v20, s69, v20
  v_lshlrev_b32 v23, 4, v22
  v_add_u32 v23, v23, v20
  v_add_u32 v9, 0, v23
  v_xor_b32 v23, 4, v22
  v_lshlrev_b32 v23, 4, v23
  v_add_u32 v23, v23, v20
  v_add_u32 v10, 15360, v23
  v_lshlrev_b32 v23, 4, v22
  v_add_u32 v23, v23, v20
  v_add_u32 v11, 30720, v23
  v_xor_b32 v23, 4, v22
  v_lshlrev_b32 v23, 4, v23
  v_add_u32 v23, v23, v20
  v_add_u32 v12, 46080, v23
  s_mul_i32 s31, s24, 3328
  s_lshl_b32 s32, s24, 14
  s_add_u32 s32, s32, 53248
  s_mov_b32 s27, 0
  s_mov_b32 s28, 65536
  s_mov_b32 s29, 0
  s_mov_b32 s30, 0
  s_mov_b32 s34, 0xffff
  s_mov_b32 s35, 0
  s_waitcnt lgkmcnt(0)
  s_sub_u32 s8, s38, 4096
  s_subb_u32 s9, s39, 0
  s_and_b32 s9, s9, 0xffff
  s_mov_b32 s10, 6295552
  s_mov_b32 s11, 0x20000
  s_sub_u32 s12, s44, 4096
  s_subb_u32 s13, s45, 0
  s_and_b32 s13, s13, 0xffff
  s_mov_b32 s14, 7344128
  s_mov_b32 s15, 0x20000
  s_mov_b32 s4, s36
  s_and_b32 s5, s37, 0xffff
  s_mov_b32 s6, 4194304
  s_mov_b32 s7, 0x20000
  s_add_u32 m0, s31, 0
  s_nop 0
  buffer_load_dwordx4 v13, s[8:11], s29 offen offset:0  lds
  buffer_load_dwordx4 v14, s[12:15], s30 offen offset:1024  lds
  buffer_load_dwordx4 v15, s[12:15], s30 offen offset:2048  lds
  s_mov_b64 exec, s[34:35]
  buffer_load_dwordx4 v16, s[12:15], s30 offen offset:3072  lds
  s_mov_b64 exec, -1
  s_add_u32 s29, s29, 196608
  s_add_u32 s30, s30, 229376
  s_add_u32 m0, s32, 0
  s_nop 0
  buffer_load_dwordx4 v9, s[4:7], s27 offen offset:0  lds
  buffer_load_dwordx4 v10, s[4:7], s27 offen offset:1024  lds
  buffer_load_dwordx4 v11, s[4:7], s27 offen offset:2048  lds
  buffer_load_dwordx4 v12, s[4:7], s27 offen offset:3072  lds
  s_add_u32 m0, s32, 4096
  s_nop 0
  buffer_load_dwordx4 v9, s[4:7], s28 offen offset:0  lds
  buffer_load_dwordx4 v10, s[4:7], s28 offen offset:1024  lds
  buffer_load_dwordx4 v11, s[4:7], s28 offen offset:2048  lds
  buffer_load_dwordx4 v12, s[4:7], s28 offen offset:3072  lds
  s_add_u32 s27, s27, 128
  s_add_u32 s28, s28, 128
  s_mov_b32 s64, s46
  s_and_b32 s65, s47, 0xffff
  s_mov_b32 s66, 7168
  s_mov_b32 s67, 0x20000
  v_lshlrev_b32 v21, 3, v19
  buffer_load_dwordx2 v[124:125], v21, s[64:67], s62 offen offset:0
  buffer_load_dwordx2 v[140:141], v21, s[64:67], s62 offen offset:32
  buffer_load_dwordx2 v[156:157], v21, s[64:67], s62 offen offset:64
  buffer_load_dwordx2 v[172:173], v21, s[64:67], s62 offen offset:96
  buffer_load_dwordx2 v[188:189], v21, s[64:67], s62 offen offset:128
  buffer_load_dwordx2 v[204:205], v21, s[64:67], s62 offen offset:160
  buffer_load_dwordx2 v[220:221], v21, s[64:67], s62 offen offset:192
  buffer_load_dwordx2 v[236:237], v21, s[64:67], s62 offen offset:224
  buffer_load_dwordx2 v[252:253], v21, s[64:67], s62 offen offset:256
  s_add_u32 m0, s31, 13312
  s_nop 0
  buffer_load_dwordx4 v13, s[8:11], s29 offen offset:0  lds
  buffer_load_dwordx4 v14, s[12:15], s30 offen offset:1024  lds
  buffer_load_dwordx4 v15, s[12:15], s30 offen offset:2048  lds
  s_mov_b64 exec, s[34:35]
  buffer_load_dwordx4 v16, s[12:15], s30 offen offset:3072  lds
  s_mov_b64 exec, -1
  s_add_u32 s29, s29, 196608
  s_add_u32 s30, s30, 229376
  s_add_u32 m0, s31, 26624
  s_nop 0
  buffer_load_dwordx4 v13, s[8:11], s29 offen offset:0  lds
  buffer_load_dwordx4 v14, s[12:15], s30 offen offset:1024  lds
  buffer_load_dwordx4 v15, s[12:15], s30 offen offset:2048  lds
  s_mov_b64 exec, s[34:35]
  buffer_load_dwordx4 v16, s[12:15], s30 offen offset:3072  lds
  s_mov_b64 exec, -1
  s_add_u32 s29, s29, 196608
  s_add_u32 s30, s30, 229376
  s_add_u32 m0, s32, 8192
  s_nop 0
  buffer_load_dwordx4 v9, s[4:7], s27 offen offset:0  lds
  buffer_load_dwordx4 v10, s[4:7], s27 offen offset:1024  lds
  buffer_load_dwordx4 v11, s[4:7], s27 offen offset:2048  lds
  buffer_load_dwordx4 v12, s[4:7], s27 offen offset:3072  lds
  s_add_u32 m0, s32, 12288
  s_nop 0
  buffer_load_dwordx4 v9, s[4:7], s28 offen offset:0  lds
  buffer_load_dwordx4 v10, s[4:7], s28 offen offset:1024  lds
  buffer_load_dwordx4 v11, s[4:7], s28 offen offset:2048  lds
  buffer_load_dwordx4 v12, s[4:7], s28 offen offset:3072  lds
  s_add_u32 s27, s27, 128
  s_add_u32 s28, s28, 128
  s_add_u32 m0, s31, 39936
  s_nop 0
  buffer_load_dwordx4 v13, s[8:11], s29 offen offset:0  lds
  buffer_load_dwordx4 v14, s[12:15], s30 offen offset:1024  lds
  buffer_load_dwordx4 v15, s[12:15], s30 offen offset:2048  lds
  s_mov_b64 exec, s[34:35]
  buffer_load_dwordx4 v16, s[12:15], s30 offen offset:3072  lds
  s_mov_b64 exec, -1
  s_add_u32 s29, s29, 196608
  s_add_u32 s30, s30, 229376
  v_lshrrev_b32 v20, 3, v18
  v_lshlrev_b32 v20, 6, v20
  v_and_b32 v21, 7, v18
  v_lshlrev_b32 v21, 3, v21
  v_add_u32 v20, v20, v21
  v_lshrrev_b32 v21, 1, v18
  v_xor_b32 v21, v21, v19
  v_add_u32 v22, v20, v21
  v_lshlrev_b32 v22, 4, v22
  v_add_u32 v2, s32, v22
  v_xor_b32 v21, 4, v21
  v_add_u32 v22, v20, v21
  v_lshlrev_b32 v22, 4, v22
  v_add_u32 v3, s32, v22
  v_and_b32 v20, 1, v19
  v_lshlrev_b32 v20, 2, v20
  v_lshrrev_b32 v21, 2, v18
  v_add_u32 v20, v20, v21
  v_lshrrev_b32 v21, 1, v19
  v_mul_u32_u24 v21, 6656, v21
  v_and_b32 v22, 3, v18
  v_lshlrev_b32 v22, 3, v22
  v_add_u32 v21, v21, v22
  v_mul_u32_u24 v23, 288, v20
  v_add3_u32 v8, v21, v23, 0
  v_add_u32 v8, 1024, v8
  v_lshlrev_b32 v23, 7, v20
  v_add_u32 v21, v21, v23
  v_lshrrev_b32 v22, 1, v20
  v_and_b32 v22, 3, v22
  v_xor_b32 v23, 0, v22
  v_lshlrev_b32 v23, 5, v23
  v_add_u32 v4, v21, v23
  v_xor_b32 v23, 1, v22
  v_lshlrev_b32 v23, 5, v23
  v_add_u32 v5, v21, v23
  v_xor_b32 v23, 2, v22
  v_lshlrev_b32 v23, 5, v23
  v_add_u32 v6, v21, v23
  v_xor_b32 v23, 3, v22
  v_lshlrev_b32 v23, 5, v23
  v_add_u32 v7, v21, v23
  v_lshlrev_b32 v17, 4, v1
  v_lshlrev_b32 v42, 5, v1
  s_lshl_b32 s73, s25, 8
  s_lshl_b32 s61, s24, 6
  s_add_u32 s73, s73, s61
  s_lshl_b32 s61, s26, 2
  s_add_u32 s73, s73, s61
  s_add_u32 s73, s73, 2
  s_lshl_b32 s61, s73, 11
  s_mov_b32 s20, s50
  s_and_b32 s21, s51, 0xffff
  s_mov_b32 s22, 2048
  s_mov_b32 s23, 0x20000
  buffer_load_dwordx4 v[18:21], v42, s[20:23], 0 offen
  buffer_load_dwordx4 v[22:25], v42, s[20:23], 0 offen offset:16
  buffer_load_dwordx4 v[26:29], v42, s[4:7], s61 offen
  buffer_load_dwordx4 v[30:33], v42, s[4:7], s61 offen offset:16
  buffer_load_dwordx4 v[34:37], v42, s[4:7], s61 offen offset:2048
  buffer_load_dwordx4 v[38:41], v42, s[4:7], s61 offen offset:2064
  s_mov_b32 s96, s48
  s_and_b32 s97, s49, 0xffff
  s_mov_b32 s98, 7340032
  s_mov_b32 s99, 0x20000
  s_mov_b32 s20, s40
  s_and_b32 s21, s41, 0xffff
  s_mov_b32 s22, 2097152
  s_mov_b32 s23, 0x20000
  v_min_u32 v44, 55, v1
  v_lshlrev_b32 v44, 7, v44
  v_min_u32 v45, 15, v1
  v_lshlrev_b32 v45, 7, v45
  s_lshl_b32 s60, s2, 2
  s_add_u32 s60, s60, s24
  s_mul_i32 s74, s60, 7168
  s_lshl_b32 s3, s60, 11
  s_waitcnt vmcnt(26)
  v_lshlrev_b32 v112, 16, v124
  v_and_b32 v113, 0xffff0000, v124
  v_lshlrev_b32 v114, 16, v125
  v_and_b32 v115, 0xffff0000, v125
  v_lshlrev_b32 v128, 16, v140
  v_and_b32 v129, 0xffff0000, v140
  v_lshlrev_b32 v130, 16, v141
  v_and_b32 v131, 0xffff0000, v141
  v_lshlrev_b32 v144, 16, v156
  v_and_b32 v145, 0xffff0000, v156
  v_lshlrev_b32 v146, 16, v157
  v_and_b32 v147, 0xffff0000, v157
  v_lshlrev_b32 v160, 16, v172
  v_and_b32 v161, 0xffff0000, v172
  v_lshlrev_b32 v162, 16, v173
  v_and_b32 v163, 0xffff0000, v173
  v_lshlrev_b32 v176, 16, v188
  v_and_b32 v177, 0xffff0000, v188
  v_lshlrev_b32 v178, 16, v189
  v_and_b32 v179, 0xffff0000, v189
  v_lshlrev_b32 v192, 16, v204
  v_and_b32 v193, 0xffff0000, v204
  v_lshlrev_b32 v194, 16, v205
  v_and_b32 v195, 0xffff0000, v205
  v_lshlrev_b32 v208, 16, v220
  v_and_b32 v209, 0xffff0000, v220
  v_lshlrev_b32 v210, 16, v221
  v_and_b32 v211, 0xffff0000, v221
  v_lshlrev_b32 v224, 16, v236
  v_and_b32 v225, 0xffff0000, v236
  v_lshlrev_b32 v226, 16, v237
  v_and_b32 v227, 0xffff0000, v237
  v_lshlrev_b32 v240, 16, v252
  v_and_b32 v241, 0xffff0000, v252
  v_lshlrev_b32 v242, 16, v253
  v_and_b32 v243, 0xffff0000, v253
  v_mov_b32 v48, 0x358637bd
  v_mov_b32 v49, 0x358637bd
  v_mov_b32 v50, 0x358637bd
  v_mov_b32 v51, 0x358637bd
  v_mov_b32 v64, 0x358637bd
  v_mov_b32 v65, 0x358637bd
  v_mov_b32 v66, 0x358637bd
  v_mov_b32 v67, 0x358637bd
  v_mov_b32 v80, 0x358637bd
  v_mov_b32 v81, 0x358637bd
  v_mov_b32 v82, 0x358637bd
  v_mov_b32 v83, 0x358637bd
  v_mov_b32 v96, 0x358637bd
  v_mov_b32 v97, 0x358637bd
  v_mov_b32 v98, 0x358637bd
  v_mov_b32 v99, 0x358637bd
  s_barrier
  ds_read_b128 a[104:107], v2 offset:0
  ds_read_b128 a[108:111], v2 offset:2048
  ds_read_b128 a[112:115], v2 offset:4096
  ds_read_b128 a[116:119], v2 offset:6144
  ds_read_b128 a[120:123], v3 offset:0
  ds_read_b128 a[124:127], v3 offset:2048
  ds_read_b128 a[128:131], v3 offset:4096
  ds_read_b128 a[132:135], v3 offset:6144
  ds_read_b64_tr_b16 a[0:1], v4 offset:0
  ds_read_b64_tr_b16 a[2:3], v4 offset:3328
  ds_read_b64_tr_b16 a[4:5], v5 offset:0
  ds_read_b64_tr_b16 a[6:7], v5 offset:3328
  ds_read_b64_tr_b16 a[8:9], v6 offset:0
  ds_read_b64_tr_b16 a[10:11], v6 offset:3328
  ds_read_b64_tr_b16 a[12:13], v7 offset:0
  ds_read_b64_tr_b16 a[14:15], v7 offset:3328
  ds_read_b64_tr_b16 a[16:17], v8 offset:0
  ds_read_b64_tr_b16 a[18:19], v8 offset:3328
  ds_read_b64_tr_b16 a[20:21], v8 offset:32
  ds_read_b64_tr_b16 a[22:23], v8 offset:3360
  ds_read_b64_tr_b16 a[24:25], v8 offset:64
  ds_read_b64_tr_b16 a[26:27], v8 offset:3392
  ds_read_b64_tr_b16 a[28:29], v8 offset:96
  ds_read_b64_tr_b16 a[30:31], v8 offset:3424
  ds_read_b64_tr_b16 a[32:33], v8 offset:128
  ds_read_b64_tr_b16 a[34:35], v8 offset:3456
  ds_read_b64_tr_b16 a[36:37], v8 offset:160
  ds_read_b64_tr_b16 a[38:39], v8 offset:3488
  ds_read_b64_tr_b16 a[40:41], v8 offset:192
  ds_read_b64_tr_b16 a[42:43], v8 offset:3520
  ds_read_b64_tr_b16 a[44:45], v8 offset:224
  ds_read_b64_tr_b16 a[46:47], v8 offset:3552
  ds_read_b64_tr_b16 a[48:49], v8 offset:256
  ds_read_b64_tr_b16 a[50:51], v8 offset:3584
  s_waitcnt vmcnt(22) lgkmcnt(0)
  s_barrier
  v_mfma_f32_16x16x32_bf16 v[52:55], a[0:3], a[108:111], v[48:51]
  s_add_u32 m0, s32, 0
  v_mfma_f32_16x16x32_bf16 v[56:59], a[0:3], a[112:115], v[48:51]
  ds_read_b64_tr_b16 a[52:53], v4 offset:13312
  v_mfma_f32_16x16x32_bf16 v[60:63], a[0:3], a[116:119], v[48:51]
  ds_read_b64_tr_b16 a[54:55], v4 offset:16640
  v_mfma_f32_16x16x32_bf16 v[48:51], a[0:3], a[104:107], v[48:51]
  buffer_load_dwordx4 v9, s[4:7], s27 offen offset:0  lds
  v_mfma_f32_16x16x32_bf16 v[68:71], a[4:7], a[108:111], v[64:67]
  ds_read_b64_tr_b16 a[56:57], v5 offset:13312
  v_mfma_f32_16x16x32_bf16 v[72:75], a[4:7], a[112:115], v[64:67]
  buffer_load_dwordx4 v10, s[4:7], s27 offen offset:1024  lds
  v_mfma_f32_16x16x32_bf16 v[76:79], a[4:7], a[116:119], v[64:67]
  ds_read_b64_tr_b16 a[58:59], v5 offset:16640
  v_mfma_f32_16x16x32_bf16 v[64:67], a[4:7], a[104:107], v[64:67]
  ds_read_b64_tr_b16 a[60:61], v6 offset:13312
  v_mfma_f32_16x16x32_bf16 v[84:87], a[8:11], a[108:111], v[80:83]
  buffer_load_dwordx4 v11, s[4:7], s27 offen offset:2048  lds
  v_mfma_f32_16x16x32_bf16 v[88:91], a[8:11], a[112:115], v[80:83]
  ds_read_b64_tr_b16 a[62:63], v6 offset:16640
  v_mfma_f32_16x16x32_bf16 v[92:95], a[8:11], a[116:119], v[80:83]
  buffer_load_dwordx4 v12, s[4:7], s27 offen offset:3072  lds
  v_mfma_f32_16x16x32_bf16 v[80:83], a[8:11], a[104:107], v[80:83]
  ds_read_b64_tr_b16 a[64:65], v7 offset:13312
  v_mfma_f32_16x16x32_bf16 v[100:103], a[12:15], a[108:111], v[96:99]
  s_add_u32 m0, s32, 4096
  v_mfma_f32_16x16x32_bf16 v[104:107], a[12:15], a[112:115], v[96:99]
  ds_read_b64_tr_b16 a[66:67], v7 offset:16640
  v_mfma_f32_16x16x32_bf16 v[108:111], a[12:15], a[116:119], v[96:99]
  ds_read_b64_tr_b16 a[68:69], v8 offset:13312
  v_mfma_f32_16x16x32_bf16 v[96:99], a[12:15], a[104:107], v[96:99]
  v_mfma_f32_16x16x32_bf16 v[116:119], a[16:19], a[108:111], v[112:115]
  buffer_load_dwordx4 v9, s[4:7], s28 offen offset:0  lds
  v_mfma_f32_16x16x32_bf16 v[120:123], a[16:19], a[112:115], v[112:115]
  ds_read_b64_tr_b16 a[70:71], v8 offset:16640
  v_mfma_f32_16x16x32_bf16 v[124:127], a[16:19], a[116:119], v[112:115]
  buffer_load_dwordx4 v10, s[4:7], s28 offen offset:1024  lds
  v_mfma_f32_16x16x32_bf16 v[112:115], a[16:19], a[104:107], v[112:115]
  ds_read_b64_tr_b16 a[72:73], v8 offset:13344
  v_mfma_f32_16x16x32_bf16 v[132:135], a[20:23], a[108:111], v[128:131]
  buffer_load_dwordx4 v11, s[4:7], s28 offen offset:2048  lds
  v_mfma_f32_16x16x32_bf16 v[136:139], a[20:23], a[112:115], v[128:131]
  ds_read_b64_tr_b16 a[74:75], v8 offset:16672
  v_mfma_f32_16x16x32_bf16 v[140:143], a[20:23], a[116:119], v[128:131]
  ds_read_b64_tr_b16 a[76:77], v8 offset:13376
  v_mfma_f32_16x16x32_bf16 v[128:131], a[20:23], a[104:107], v[128:131]
  buffer_load_dwordx4 v12, s[4:7], s28 offen offset:3072  lds
  v_mfma_f32_16x16x32_bf16 v[148:151], a[24:27], a[108:111], v[144:147]
  ds_read_b64_tr_b16 a[78:79], v8 offset:16704
  v_mfma_f32_16x16x32_bf16 v[152:155], a[24:27], a[112:115], v[144:147]
  s_add_u32 s27, s27, 128
  v_mfma_f32_16x16x32_bf16 v[156:159], a[24:27], a[116:119], v[144:147]
  ds_read_b64_tr_b16 a[80:81], v8 offset:13408
  v_mfma_f32_16x16x32_bf16 v[144:147], a[24:27], a[104:107], v[144:147]
  ds_read_b64_tr_b16 a[82:83], v8 offset:16736
  v_mfma_f32_16x16x32_bf16 v[164:167], a[28:31], a[108:111], v[160:163]
  s_add_u32 s28, s28, 128
  v_mfma_f32_16x16x32_bf16 v[168:171], a[28:31], a[112:115], v[160:163]
  ds_read_b64_tr_b16 a[84:85], v8 offset:13440
  v_mfma_f32_16x16x32_bf16 v[172:175], a[28:31], a[116:119], v[160:163]
  s_add_u32 m0, s31, 0
  v_mfma_f32_16x16x32_bf16 v[160:163], a[28:31], a[104:107], v[160:163]
  v_mfma_f32_16x16x32_bf16 v[180:183], a[32:35], a[108:111], v[176:179]
  ds_read_b64_tr_b16 a[86:87], v8 offset:16768
  v_mfma_f32_16x16x32_bf16 v[184:187], a[32:35], a[112:115], v[176:179]
  buffer_load_dwordx4 v13, s[8:11], s29 offen offset:0  lds
  v_mfma_f32_16x16x32_bf16 v[188:191], a[32:35], a[116:119], v[176:179]
  ds_read_b64_tr_b16 a[88:89], v8 offset:13472
  v_mfma_f32_16x16x32_bf16 v[176:179], a[32:35], a[104:107], v[176:179]
  ds_read_b64_tr_b16 a[90:91], v8 offset:16800
  v_mfma_f32_16x16x32_bf16 v[196:199], a[36:39], a[108:111], v[192:195]
  buffer_load_dwordx4 v14, s[12:15], s30 offen offset:1024  lds
  v_mfma_f32_16x16x32_bf16 v[200:203], a[36:39], a[112:115], v[192:195]
  ds_read_b64_tr_b16 a[92:93], v8 offset:13504
  v_mfma_f32_16x16x32_bf16 v[204:207], a[36:39], a[116:119], v[192:195]
  buffer_load_dwordx4 v15, s[12:15], s30 offen offset:2048  lds
  v_mfma_f32_16x16x32_bf16 v[192:195], a[36:39], a[104:107], v[192:195]
  ds_read_b64_tr_b16 a[94:95], v8 offset:16832
  v_mfma_f32_16x16x32_bf16 v[212:215], a[40:43], a[108:111], v[208:211]
  s_mov_b64 exec, s[34:35]
  buffer_load_dwordx4 v16, s[12:15], s30 offen offset:3072  lds
  s_mov_b64 exec, -1
  v_mfma_f32_16x16x32_bf16 v[216:219], a[40:43], a[112:115], v[208:211]
  ds_read_b64_tr_b16 a[96:97], v8 offset:13536
  v_mfma_f32_16x16x32_bf16 v[220:223], a[40:43], a[116:119], v[208:211]
  ds_read_b64_tr_b16 a[98:99], v8 offset:16864
  v_mfma_f32_16x16x32_bf16 v[208:211], a[40:43], a[104:107], v[208:211]
  s_add_u32 s29, s29, 196608
  v_mfma_f32_16x16x32_bf16 v[228:231], a[44:47], a[108:111], v[224:227]
  ds_read_b64_tr_b16 a[100:101], v8 offset:13568
  v_mfma_f32_16x16x32_bf16 v[232:235], a[44:47], a[112:115], v[224:227]
  s_add_u32 s30, s30, 229376
  v_mfma_f32_16x16x32_bf16 v[236:239], a[44:47], a[116:119], v[224:227]
  ds_read_b64_tr_b16 a[102:103], v8 offset:16896
  v_mfma_f32_16x16x32_bf16 v[224:227], a[44:47], a[104:107], v[224:227]
  v_mfma_f32_16x16x32_bf16 v[244:247], a[48:51], a[108:111], v[240:243]
  v_mfma_f32_16x16x32_bf16 v[248:251], a[48:51], a[112:115], v[240:243]
  v_mfma_f32_16x16x32_bf16 v[252:255], a[48:51], a[116:119], v[240:243]
  v_mfma_f32_16x16x32_bf16 v[240:243], a[48:51], a[104:107], v[240:243]
  s_waitcnt vmcnt(22) lgkmcnt(0)
  s_barrier
  v_mfma_f32_16x16x32_bf16 v[48:51], a[52:55], a[120:123], v[48:51]
  s_add_u32 m0, s31, 13312
  v_mfma_f32_16x16x32_bf16 v[52:55], a[52:55], a[124:127], v[52:55]
  ds_read_b128 a[104:107], v2 offset:8192
  v_mfma_f32_16x16x32_bf16 v[56:59], a[52:55], a[128:131], v[56:59]
  ds_read_b128 a[108:111], v2 offset:10240
  v_mfma_f32_16x16x32_bf16 v[60:63], a[52:55], a[132:135], v[60:63]
  ds_read_b128 a[112:115], v2 offset:12288
  v_mfma_f32_16x16x32_bf16 v[64:67], a[56:59], a[120:123], v[64:67]
  ds_read_b128 a[116:119], v2 offset:14336
  v_mfma_f32_16x16x32_bf16 v[68:71], a[56:59], a[124:127], v[68:71]
  ds_read_b128 a[136:139], v3 offset:8192
  v_mfma_f32_16x16x32_bf16 v[72:75], a[56:59], a[128:131], v[72:75]
  v_mfma_f32_16x16x32_bf16 v[76:79], a[56:59], a[132:135], v[76:79]
  buffer_load_dwordx4 v13, s[8:11], s29 offen offset:0  lds
  v_mfma_f32_16x16x32_bf16 v[80:83], a[60:63], a[120:123], v[80:83]
  ds_read_b128 a[140:143], v3 offset:10240
  v_mfma_f32_16x16x32_bf16 v[84:87], a[60:63], a[124:127], v[84:87]
  ds_read_b128 a[144:147], v3 offset:12288
  v_mfma_f32_16x16x32_bf16 v[88:91], a[60:63], a[128:131], v[88:91]
  ds_read_b128 a[148:151], v3 offset:14336
  v_mfma_f32_16x16x32_bf16 v[92:95], a[60:63], a[132:135], v[92:95]
  ds_read_b64_tr_b16 a[0:1], v4 offset:26624
  v_mfma_f32_16x16x32_bf16 v[96:99], a[64:67], a[120:123], v[96:99]
  ds_read_b64_tr_b16 a[2:3], v4 offset:29952
  v_mfma_f32_16x16x32_bf16 v[100:103], a[64:67], a[124:127], v[100:103]
  v_mfma_f32_16x16x32_bf16 v[104:107], a[64:67], a[128:131], v[104:107]
  buffer_load_dwordx4 v14, s[12:15], s30 offen offset:1024  lds
  v_mfma_f32_16x16x32_bf16 v[108:111], a[64:67], a[132:135], v[108:111]
  ds_read_b64_tr_b16 a[4:5], v5 offset:26624
  v_mfma_f32_16x16x32_bf16 v[112:115], a[68:71], a[120:123], v[112:115]
  ds_read_b64_tr_b16 a[6:7], v5 offset:29952
  v_mfma_f32_16x16x32_bf16 v[116:119], a[68:71], a[124:127], v[116:119]
  ds_read_b64_tr_b16 a[8:9], v6 offset:26624
  v_mfma_f32_16x16x32_bf16 v[120:123], a[68:71], a[128:131], v[120:123]
  ds_read_b64_tr_b16 a[10:11], v6 offset:29952
  v_mfma_f32_16x16x32_bf16 v[124:127], a[68:71], a[132:135], v[124:127]
  ds_read_b64_tr_b16 a[12:13], v7 offset:26624
  v_mfma_f32_16x16x32_bf16 v[128:131], a[72:75], a[120:123], v[128:131]
  v_mfma_f32_16x16x32_bf16 v[132:135], a[72:75], a[124:127], v[132:135]
  buffer_load_dwordx4 v15, s[12:15], s30 offen offset:2048  lds
  v_mfma_f32_16x16x32_bf16 v[136:139], a[72:75], a[128:131], v[136:139]
  ds_read_b64_tr_b16 a[14:15], v7 offset:29952
  v_mfma_f32_16x16x32_bf16 v[140:143], a[72:75], a[132:135], v[140:143]
  ds_read_b64_tr_b16 a[16:17], v8 offset:26624
  v_mfma_f32_16x16x32_bf16 v[144:147], a[76:79], a[120:123], v[144:147]
  ds_read_b64_tr_b16 a[18:19], v8 offset:29952
  v_mfma_f32_16x16x32_bf16 v[148:151], a[76:79], a[124:127], v[148:151]
  ds_read_b64_tr_b16 a[20:21], v8 offset:26656
  v_mfma_f32_16x16x32_bf16 v[152:155], a[76:79], a[128:131], v[152:155]
  ds_read_b64_tr_b16 a[22:23], v8 offset:29984
  v_mfma_f32_16x16x32_bf16 v[156:159], a[76:79], a[132:135], v[156:159]
  v_mfma_f32_16x16x32_bf16 v[160:163], a[80:83], a[120:123], v[160:163]
  s_mov_b64 exec, s[34:35]
  buffer_load_dwordx4 v16, s[12:15], s30 offen offset:3072  lds
  s_mov_b64 exec, -1
  v_mfma_f32_16x16x32_bf16 v[164:167], a[80:83], a[124:127], v[164:167]
  ds_read_b64_tr_b16 a[24:25], v8 offset:26688
  v_mfma_f32_16x16x32_bf16 v[168:171], a[80:83], a[128:131], v[168:171]
  ds_read_b64_tr_b16 a[26:27], v8 offset:30016
  v_mfma_f32_16x16x32_bf16 v[172:175], a[80:83], a[132:135], v[172:175]
  ds_read_b64_tr_b16 a[28:29], v8 offset:26720
  v_mfma_f32_16x16x32_bf16 v[176:179], a[84:87], a[120:123], v[176:179]
  ds_read_b64_tr_b16 a[30:31], v8 offset:30048
  v_mfma_f32_16x16x32_bf16 v[180:183], a[84:87], a[124:127], v[180:183]
  ds_read_b64_tr_b16 a[32:33], v8 offset:26752
  v_mfma_f32_16x16x32_bf16 v[184:187], a[84:87], a[128:131], v[184:187]
  v_mfma_f32_16x16x32_bf16 v[188:191], a[84:87], a[132:135], v[188:191]
  s_add_u32 s29, s29, 196608
  v_mfma_f32_16x16x32_bf16 v[192:195], a[88:91], a[120:123], v[192:195]
  ds_read_b64_tr_b16 a[34:35], v8 offset:30080
  v_mfma_f32_16x16x32_bf16 v[196:199], a[88:91], a[124:127], v[196:199]
  ds_read_b64_tr_b16 a[36:37], v8 offset:26784
  v_mfma_f32_16x16x32_bf16 v[200:203], a[88:91], a[128:131], v[200:203]
  ds_read_b64_tr_b16 a[38:39], v8 offset:30112
  v_mfma_f32_16x16x32_bf16 v[204:207], a[88:91], a[132:135], v[204:207]
  ds_read_b64_tr_b16 a[40:41], v8 offset:26816
  v_mfma_f32_16x16x32_bf16 v[208:211], a[92:95], a[120:123], v[208:211]
  ds_read_b64_tr_b16 a[42:43], v8 offset:30144
  v_mfma_f32_16x16x32_bf16 v[212:215], a[92:95], a[124:127], v[212:215]
  v_mfma_f32_16x16x32_bf16 v[216:219], a[92:95], a[128:131], v[216:219]
  s_add_u32 s30, s30, 229376
  v_mfma_f32_16x16x32_bf16 v[220:223], a[92:95], a[132:135], v[220:223]
  ds_read_b64_tr_b16 a[44:45], v8 offset:26848
  v_mfma_f32_16x16x32_bf16 v[224:227], a[96:99], a[120:123], v[224:227]
  ds_read_b64_tr_b16 a[46:47], v8 offset:30176
  v_mfma_f32_16x16x32_bf16 v[228:231], a[96:99], a[124:127], v[228:231]
  ds_read_b64_tr_b16 a[48:49], v8 offset:26880
  v_mfma_f32_16x16x32_bf16 v[232:235], a[96:99], a[128:131], v[232:235]
  ds_read_b64_tr_b16 a[50:51], v8 offset:30208
  v_mfma_f32_16x16x32_bf16 v[236:239], a[96:99], a[132:135], v[236:239]
  v_mfma_f32_16x16x32_bf16 v[240:243], a[100:103], a[120:123], v[240:243]
  v_mfma_f32_16x16x32_bf16 v[244:247], a[100:103], a[124:127], v[244:247]
  v_mfma_f32_16x16x32_bf16 v[248:251], a[100:103], a[128:131], v[248:251]
  v_mfma_f32_16x16x32_bf16 v[252:255], a[100:103], a[132:135], v[252:255]
  s_waitcnt vmcnt(22) lgkmcnt(0)
  s_barrier
  v_mfma_f32_16x16x32_bf16 v[48:51], a[0:3], a[104:107], v[48:51]
  s_add_u32 m0, s32, 8192
  v_mfma_f32_16x16x32_bf16 v[52:55], a[0:3], a[108:111], v[52:55]
  ds_read_b64_tr_b16 a[52:53], v4 offset:39936
  v_mfma_f32_16x16x32_bf16 v[56:59], a[0:3], a[112:115], v[56:59]
  ds_read_b64_tr_b16 a[54:55], v4 offset:43264
  v_mfma_f32_16x16x32_bf16 v[60:63], a[0:3], a[116:119], v[60:63]
  buffer_load_dwordx4 v9, s[4:7], s27 offen offset:0  lds
  v_mfma_f32_16x16x32_bf16 v[64:67], a[4:7], a[104:107], v[64:67]
  ds_read_b64_tr_b16 a[56:57], v5 offset:39936
  v_mfma_f32_16x16x32_bf16 v[68:71], a[4:7], a[108:111], v[68:71]
  buffer_load_dwordx4 v10, s[4:7], s27 offen offset:1024  lds
  v_mfma_f32_16x16x32_bf16 v[72:75], a[4:7], a[112:115], v[72:75]
  ds_read_b64_tr_b16 a[58:59], v5 offset:43264
  v_mfma_f32_16x16x32_bf16 v[76:79], a[4:7], a[116:119], v[76:79]
  ds_read_b64_tr_b16 a[60:61], v6 offset:39936
  v_mfma_f32_16x16x32_bf16 v[80:83], a[8:11], a[104:107], v[80:83]
  buffer_load_dwordx4 v11, s[4:7], s27 offen offset:2048  lds
  v_mfma_f32_16x16x32_bf16 v[84:87], a[8:11], a[108:111], v[84:87]
  ds_read_b64_tr_b16 a[62:63], v6 offset:43264
  v_mfma_f32_16x16x32_bf16 v[88:91], a[8:11], a[112:115], v[88:91]
  buffer_load_dwordx4 v12, s[4:7], s27 offen offset:3072  lds
  v_mfma_f32_16x16x32_bf16 v[92:95], a[8:11], a[116:119], v[92:95]
  ds_read_b64_tr_b16 a[64:65], v7 offset:39936
  v_mfma_f32_16x16x32_bf16 v[96:99], a[12:15], a[104:107], v[96:99]
  s_add_u32 m0, s32, 12288
  v_mfma_f32_16x16x32_bf16 v[100:103], a[12:15], a[108:111], v[100:103]
  ds_read_b64_tr_b16 a[66:67], v7 offset:43264
  v_mfma_f32_16x16x32_bf16 v[104:107], a[12:15], a[112:115], v[104:107]
  ds_read_b64_tr_b16 a[68:69], v8 offset:39936
  v_mfma_f32_16x16x32_bf16 v[108:111], a[12:15], a[116:119], v[108:111]
  v_mfma_f32_16x16x32_bf16 v[112:115], a[16:19], a[104:107], v[112:115]
  buffer_load_dwordx4 v9, s[4:7], s28 offen offset:0  lds
  v_mfma_f32_16x16x32_bf16 v[116:119], a[16:19], a[108:111], v[116:119]
  ds_read_b64_tr_b16 a[70:71], v8 offset:43264
  v_mfma_f32_16x16x32_bf16 v[120:123], a[16:19], a[112:115], v[120:123]
  buffer_load_dwordx4 v10, s[4:7], s28 offen offset:1024  lds
  v_mfma_f32_16x16x32_bf16 v[124:127], a[16:19], a[116:119], v[124:127]
  ds_read_b64_tr_b16 a[72:73], v8 offset:39968
  v_mfma_f32_16x16x32_bf16 v[128:131], a[20:23], a[104:107], v[128:131]
  buffer_load_dwordx4 v11, s[4:7], s28 offen offset:2048  lds
  v_mfma_f32_16x16x32_bf16 v[132:135], a[20:23], a[108:111], v[132:135]
  ds_read_b64_tr_b16 a[74:75], v8 offset:43296
  v_mfma_f32_16x16x32_bf16 v[136:139], a[20:23], a[112:115], v[136:139]
  ds_read_b64_tr_b16 a[76:77], v8 offset:40000
  v_mfma_f32_16x16x32_bf16 v[140:143], a[20:23], a[116:119], v[140:143]
  buffer_load_dwordx4 v12, s[4:7], s28 offen offset:3072  lds
  v_mfma_f32_16x16x32_bf16 v[144:147], a[24:27], a[104:107], v[144:147]
  ds_read_b64_tr_b16 a[78:79], v8 offset:43328
  v_mfma_f32_16x16x32_bf16 v[148:151], a[24:27], a[108:111], v[148:151]
  s_add_u32 s27, s27, 128
  v_mfma_f32_16x16x32_bf16 v[152:155], a[24:27], a[112:115], v[152:155]
  ds_read_b64_tr_b16 a[80:81], v8 offset:40032
  v_mfma_f32_16x16x32_bf16 v[156:159], a[24:27], a[116:119], v[156:159]
  ds_read_b64_tr_b16 a[82:83], v8 offset:43360
  v_mfma_f32_16x16x32_bf16 v[160:163], a[28:31], a[104:107], v[160:163]
  s_add_u32 s28, s28, 128
  v_mfma_f32_16x16x32_bf16 v[164:167], a[28:31], a[108:111], v[164:167]
  ds_read_b64_tr_b16 a[84:85], v8 offset:40064
  v_mfma_f32_16x16x32_bf16 v[168:171], a[28:31], a[112:115], v[168:171]
  s_add_u32 m0, s31, 26624
  v_mfma_f32_16x16x32_bf16 v[172:175], a[28:31], a[116:119], v[172:175]
  v_mfma_f32_16x16x32_bf16 v[176:179], a[32:35], a[104:107], v[176:179]
  ds_read_b64_tr_b16 a[86:87], v8 offset:43392
  v_mfma_f32_16x16x32_bf16 v[180:183], a[32:35], a[108:111], v[180:183]
  buffer_load_dwordx4 v13, s[8:11], s29 offen offset:0  lds
  v_mfma_f32_16x16x32_bf16 v[184:187], a[32:35], a[112:115], v[184:187]
  ds_read_b64_tr_b16 a[88:89], v8 offset:40096
  v_mfma_f32_16x16x32_bf16 v[188:191], a[32:35], a[116:119], v[188:191]
  ds_read_b64_tr_b16 a[90:91], v8 offset:43424
  v_mfma_f32_16x16x32_bf16 v[192:195], a[36:39], a[104:107], v[192:195]
  buffer_load_dwordx4 v14, s[12:15], s30 offen offset:1024  lds
  v_mfma_f32_16x16x32_bf16 v[196:199], a[36:39], a[108:111], v[196:199]
  ds_read_b64_tr_b16 a[92:93], v8 offset:40128
  v_mfma_f32_16x16x32_bf16 v[200:203], a[36:39], a[112:115], v[200:203]
  buffer_load_dwordx4 v15, s[12:15], s30 offen offset:2048  lds
  v_mfma_f32_16x16x32_bf16 v[204:207], a[36:39], a[116:119], v[204:207]
  ds_read_b64_tr_b16 a[94:95], v8 offset:43456
  v_mfma_f32_16x16x32_bf16 v[208:211], a[40:43], a[104:107], v[208:211]
  s_mov_b64 exec, s[34:35]
  buffer_load_dwordx4 v16, s[12:15], s30 offen offset:3072  lds
  s_mov_b64 exec, -1
  v_mfma_f32_16x16x32_bf16 v[212:215], a[40:43], a[108:111], v[212:215]
  ds_read_b64_tr_b16 a[96:97], v8 offset:40160
  v_mfma_f32_16x16x32_bf16 v[216:219], a[40:43], a[112:115], v[216:219]
  ds_read_b64_tr_b16 a[98:99], v8 offset:43488
  v_mfma_f32_16x16x32_bf16 v[220:223], a[40:43], a[116:119], v[220:223]
  s_add_u32 s29, s29, 196608
  v_mfma_f32_16x16x32_bf16 v[224:227], a[44:47], a[104:107], v[224:227]
  ds_read_b64_tr_b16 a[100:101], v8 offset:40192
  v_mfma_f32_16x16x32_bf16 v[228:231], a[44:47], a[108:111], v[228:231]
  s_add_u32 s30, s30, 229376
  v_mfma_f32_16x16x32_bf16 v[232:235], a[44:47], a[112:115], v[232:235]
  ds_read_b64_tr_b16 a[102:103], v8 offset:43520
  v_mfma_f32_16x16x32_bf16 v[236:239], a[44:47], a[116:119], v[236:239]
  v_mfma_f32_16x16x32_bf16 v[240:243], a[48:51], a[104:107], v[240:243]
  v_mfma_f32_16x16x32_bf16 v[244:247], a[48:51], a[108:111], v[244:247]
  v_mfma_f32_16x16x32_bf16 v[248:251], a[48:51], a[112:115], v[248:251]
  v_mfma_f32_16x16x32_bf16 v[252:255], a[48:51], a[116:119], v[252:255]
  s_waitcnt vmcnt(16) lgkmcnt(0)
  s_barrier
  v_mfma_f32_16x16x32_bf16 v[48:51], a[52:55], a[136:139], v[48:51]
  s_add_u32 m0, s31, 39936
  ds_read_b128 a[104:107], v2 offset:0
  v_mfma_f32_16x16x32_bf16 v[52:55], a[52:55], a[140:143], v[52:55]
  buffer_load_dwordx4 v13, s[8:11], s29 offen offset:0  lds
  ds_read_b128 a[108:111], v2 offset:2048
  v_mfma_f32_16x16x32_bf16 v[56:59], a[52:55], a[144:147], v[56:59]
  buffer_load_dwordx4 v14, s[12:15], s30 offen offset:1024  lds
  v_mfma_f32_16x16x32_bf16 v[60:63], a[52:55], a[148:151], v[60:63]
  ds_read_b128 a[112:115], v2 offset:4096
  buffer_load_dwordx4 v15, s[12:15], s30 offen offset:2048  lds
  v_mfma_f32_16x16x32_bf16 v[64:67], a[56:59], a[136:139], v[64:67]
  ds_read_b128 a[116:119], v2 offset:6144
  s_mov_b64 exec, s[34:35]
  buffer_load_dwordx4 v16, s[12:15], s30 offen offset:3072  lds
  s_mov_b64 exec, -1
  v_mfma_f32_16x16x32_bf16 v[68:71], a[56:59], a[140:143], v[68:71]
  s_add_u32 s29, s29, 196608
  v_mfma_f32_16x16x32_bf16 v[72:75], a[56:59], a[144:147], v[72:75]
  ds_read_b128 a[120:123], v3 offset:0
  s_add_u32 s30, s30, 229376
  v_mfma_f32_16x16x32_bf16 v[76:79], a[56:59], a[148:151], v[76:79]
  ds_read_b128 a[124:127], v3 offset:2048
  s_mov_b32 s16, s56
  s_and_b32 s17, s57, 0xffff
  v_mfma_f32_16x16x32_bf16 v[80:83], a[60:63], a[136:139], v[80:83]
  ds_read_b128 a[128:131], v3 offset:4096
  v_mfma_f32_16x16x32_bf16 v[84:87], a[60:63], a[140:143], v[84:87]
  s_mov_b32 s18, 33212416
  s_mov_b32 s19, 0x20000
  s_and_b32 s60, s2, 7
  s_lshr_b32 s61, s2, 3
  v_mfma_f32_16x16x32_bf16 v[88:91], a[60:63], a[144:147], v[88:91]
  ds_read_b128 a[132:135], v3 offset:6144
  s_and_b32 s66, s60, 1
  s_lshr_b32 s60, s60, 1
  v_mfma_f32_16x16x32_bf16 v[92:95], a[60:63], a[148:151], v[92:95]
  ds_read_b64_tr_b16 a[0:1], v4 offset:0
  v_mfma_f32_16x16x32_bf16 v[96:99], a[64:67], a[136:139], v[96:99]
  s_and_b32 s64, s60, 1
  s_lshl_b32 s64, s64, 3
  ds_read_b64_tr_b16 a[2:3], v4 offset:3328
  v_mfma_f32_16x16x32_bf16 v[100:103], a[64:67], a[140:143], v[100:103]
  s_and_b32 s67, s61, 7
  s_add_u32 s64, s64, s67
  s_lshr_b32 s65, s60, 1
  s_lshl_b32 s65, s65, 2
  v_mfma_f32_16x16x32_bf16 v[104:107], a[64:67], a[144:147], v[104:107]
  ds_read_b64_tr_b16 a[4:5], v5 offset:0
  v_mfma_f32_16x16x32_bf16 v[108:111], a[64:67], a[148:151], v[108:111]
  s_lshr_b32 s61, s61, 3
  s_add_u32 s65, s65, s61
  ds_read_b64_tr_b16 a[6:7], v5 offset:3328
  v_mfma_f32_16x16x32_bf16 v[112:115], a[68:71], a[136:139], v[112:115]
  s_lshl_b32 s67, s64, 3
  s_add_u32 s67, s67, s65
  v_mfma_f32_16x16x32_bf16 v[116:119], a[68:71], a[140:143], v[116:119]
  ds_read_b64_tr_b16 a[8:9], v6 offset:0
  s_lshl_b32 s60, s25, 1
  s_lshr_b32 s61, s24, 1
  v_mfma_f32_16x16x32_bf16 v[120:123], a[68:71], a[144:147], v[120:123]
  s_add_u32 s60, s60, s61
  s_lshl_b32 s60, s60, 5
  ds_read_b64_tr_b16 a[10:11], v6 offset:3328
  v_mfma_f32_16x16x32_bf16 v[124:127], a[68:71], a[148:151], v[124:127]
  s_lshl_b32 s61, s26, 1
  s_add_u32 s60, s60, s61
  v_mfma_f32_16x16x32_bf16 v[128:131], a[72:75], a[136:139], v[128:131]
  ds_read_b64_tr_b16 a[12:13], v7 offset:0
  s_add_u32 s60, s60, 1
  s_lshl_b32 s60, s60, 1
  v_mfma_f32_16x16x32_bf16 v[132:135], a[72:75], a[140:143], v[132:135]
  ds_read_b64_tr_b16 a[14:15], v7 offset:3328
  s_and_b32 s61, s24, 1
  s_add_u32 s60, s60, s61
  v_mfma_f32_16x16x32_bf16 v[136:139], a[72:75], a[144:147], v[136:139]
  s_lshl_b32 s60, s60, 3
  s_add_u32 s60, s60, 33136640
  v_mfma_f32_16x16x32_bf16 v[140:143], a[72:75], a[148:151], v[140:143]
  ds_read_b64_tr_b16 a[16:17], v8 offset:0
  v_writelane_b32 v0, s60, 4
  s_lshl_b32 s60, s25, 1
  v_mfma_f32_16x16x32_bf16 v[144:147], a[76:79], a[136:139], v[144:147]
  ds_read_b64_tr_b16 a[18:19], v8 offset:3328
  s_lshr_b32 s63, s24, 1
  s_add_u32 s60, s60, s63
  v_mfma_f32_16x16x32_bf16 v[148:151], a[76:79], a[140:143], v[148:151]
  ds_read_b64_tr_b16 a[20:21], v8 offset:32
  v_mfma_f32_16x16x32_bf16 v[152:155], a[76:79], a[144:147], v[152:155]
  s_lshl_b32 s60, s60, 5
  s_add_u32 s60, s60, s26
  s_lshl_b32 s60, s60, 1
  s_add_u32 s60, s60, s61
  v_mfma_f32_16x16x32_bf16 v[156:159], a[76:79], a[148:151], v[156:159]
  ds_read_b64_tr_b16 a[22:23], v8 offset:3360
  s_lshl_b32 s60, s60, 3
  s_add_u32 s60, s60, 33202432
  v_mfma_f32_16x16x32_bf16 v[160:163], a[80:83], a[136:139], v[160:163]
  ds_read_b64_tr_b16 a[24:25], v8 offset:64
  v_mfma_f32_16x16x32_bf16 v[164:167], a[80:83], a[140:143], v[164:167]
  v_writelane_b32 v0, s60, 0
  s_lshl_b32 s60, s26, 4
  ds_read_b64_tr_b16 a[26:27], v8 offset:3392
  v_mfma_f32_16x16x32_bf16 v[168:171], a[80:83], a[144:147], v[168:171]
  s_add_u32 s60, s60, s25
  s_lshl_b32 s60, s60, 2
  s_add_u32 s60, s60, s24
  s_lshl_b32 s60, s60, 3
  v_mfma_f32_16x16x32_bf16 v[172:175], a[80:83], a[148:151], v[172:175]
  ds_read_b64_tr_b16 a[28:29], v8 offset:96
  v_mfma_f32_16x16x32_bf16 v[176:179], a[84:87], a[136:139], v[176:179]
  s_add_u32 s60, s60, 33145088
  v_writelane_b32 v0, s60, 1
  ds_read_b64_tr_b16 a[30:31], v8 offset:3424
  v_mfma_f32_16x16x32_bf16 v[180:183], a[84:87], a[140:143], v[180:183]
  s_lshr_b32 s60, s2, 5
  s_lshl_b32 s60, s60, 1
  v_mfma_f32_16x16x32_bf16 v[184:187], a[84:87], a[144:147], v[184:187]
  ds_read_b64_tr_b16 a[32:33], v8 offset:128
  s_lshr_b32 s61, s24, 1
  s_add_u32 s60, s60, s61
  v_mfma_f32_16x16x32_bf16 v[188:191], a[84:87], a[148:151], v[188:191]
  s_lshl_b32 s60, s60, 9
  s_and_b32 s61, s2, 31
  ds_read_b64_tr_b16 a[34:35], v8 offset:3456
  v_mfma_f32_16x16x32_bf16 v[192:195], a[88:91], a[136:139], v[192:195]
  s_lshl_b32 s61, s61, 4
  s_add_u32 s60, s60, s61
  v_mfma_f32_16x16x32_bf16 v[196:199], a[88:91], a[140:143], v[196:199]
  ds_read_b64_tr_b16 a[36:37], v8 offset:160
  s_and_b32 s61, s24, 1
  s_lshl_b32 s61, s61, 3
  v_mfma_f32_16x16x32_bf16 v[200:203], a[88:91], a[144:147], v[200:203]
  ds_read_b64_tr_b16 a[38:39], v8 offset:3488
  s_add_u32 s60, s60, s61
  s_add_u32 s60, s60, 33153024
  v_mfma_f32_16x16x32_bf16 v[204:207], a[88:91], a[148:151], v[204:207]
  s_lshl_b32 s61, s67, 8
  s_lshl_b32 s63, s24, 3
  v_mfma_f32_16x16x32_bf16 v[208:211], a[92:95], a[136:139], v[208:211]
  ds_read_b64_tr_b16 a[40:41], v8 offset:192
  s_add_u32 s61, s61, s63
  s_add_u32 s61, s61, 33161216
  v_mfma_f32_16x16x32_bf16 v[212:215], a[92:95], a[140:143], v[212:215]
  ds_read_b64_tr_b16 a[42:43], v8 offset:3520
  s_cmp_eq_u32 s66, 0
  s_cselect_b32 s61, s61, 0x7ffffff0
  v_mfma_f32_16x16x32_bf16 v[216:219], a[92:95], a[144:147], v[216:219]
  ds_read_b64_tr_b16 a[44:45], v8 offset:224
  v_mfma_f32_16x16x32_bf16 v[220:223], a[92:95], a[148:151], v[220:223]
  v_writelane_b32 v0, s60, 2
  v_writelane_b32 v0, s61, 3
  s_mul_i32 s60, s2, 171
  s_lshr_b32 s60, s60, 10
  v_mfma_f32_16x16x32_bf16 v[224:227], a[96:99], a[136:139], v[224:227]
  ds_read_b64_tr_b16 a[46:47], v8 offset:3552
  s_lshl_b32 s60, s60, 1
  s_add_u32 s60, s60, s2
  v_mfma_f32_16x16x32_bf16 v[228:231], a[96:99], a[140:143], v[228:231]
  ds_read_b64_tr_b16 a[48:49], v8 offset:256
  v_mfma_f32_16x16x32_bf16 v[232:235], a[96:99], a[144:147], v[232:235]
  s_lshl_b32 s60, s60, 3
  s_add_u32 s60, s60, 33210368
  ds_read_b64_tr_b16 a[50:51], v8 offset:3584
  v_mfma_f32_16x16x32_bf16 v[236:239], a[96:99], a[148:151], v[236:239]
  v_writelane_b32 v0, s60, 5
  v_mfma_f32_16x16x32_bf16 v[240:243], a[100:103], a[136:139], v[240:243]
  v_mfma_f32_16x16x32_bf16 v[244:247], a[100:103], a[140:143], v[244:247]
  v_mfma_f32_16x16x32_bf16 v[248:251], a[100:103], a[144:147], v[248:251]
  v_mfma_f32_16x16x32_bf16 v[252:255], a[100:103], a[148:151], v[252:255]
  s_waitcnt vmcnt(16) lgkmcnt(0)
  s_barrier
  s_mov_b32 s33, 6
L_k1B_loop:
  v_mfma_f32_16x16x32_bf16 v[48:51], a[0:3], a[104:107], v[48:51]
  s_add_u32 m0, s32, 0
  v_mfma_f32_16x16x32_bf16 v[52:55], a[0:3], a[108:111], v[52:55]
  ds_read_b64_tr_b16 a[52:53], v4 offset:13312
  v_mfma_f32_16x16x32_bf16 v[56:59], a[0:3], a[112:115], v[56:59]
  ds_read_b64_tr_b16 a[54:55], v4 offset:16640
  v_mfma_f32_16x16x32_bf16 v[60:63], a[0:3], a[116:119], v[60:63]
  buffer_load_dwordx4 v9, s[4:7], s27 offen offset:0  lds
  v_mfma_f32_16x16x32_bf16 v[64:67], a[4:7], a[104:107], v[64:67]
  ds_read_b64_tr_b16 a[56:57], v5 offset:13312
  v_mfma_f32_16x16x32_bf16 v[68:71], a[4:7], a[108:111], v[68:71]
  buffer_load_dwordx4 v10, s[4:7], s27 offen offset:1024  lds
  v_mfma_f32_16x16x32_bf16 v[72:75], a[4:7], a[112:115], v[72:75]
  ds_read_b64_tr_b16 a[58:59], v5 offset:16640
  v_mfma_f32_16x16x32_bf16 v[76:79], a[4:7], a[116:119], v[76:79]
  ds_read_b64_tr_b16 a[60:61], v6 offset:13312
  v_mfma_f32_16x16x32_bf16 v[80:83], a[8:11], a[104:107], v[80:83]
  buffer_load_dwordx4 v11, s[4:7], s27 offen offset:2048  lds
  v_mfma_f32_16x16x32_bf16 v[84:87], a[8:11], a[108:111], v[84:87]
  ds_read_b64_tr_b16 a[62:63], v6 offset:16640
  v_mfma_f32_16x16x32_bf16 v[88:91], a[8:11], a[112:115], v[88:91]
  buffer_load_dwordx4 v12, s[4:7], s27 offen offset:3072  lds
  v_mfma_f32_16x16x32_bf16 v[92:95], a[8:11], a[116:119], v[92:95]
  ds_read_b64_tr_b16 a[64:65], v7 offset:13312
  v_mfma_f32_16x16x32_bf16 v[96:99], a[12:15], a[104:107], v[96:99]
  s_add_u32 m0, s32, 4096
  v_mfma_f32_16x16x32_bf16 v[100:103], a[12:15], a[108:111], v[100:103]
  ds_read_b64_tr_b16 a[66:67], v7 offset:16640
  v_mfma_f32_16x16x32_bf16 v[104:107], a[12:15], a[112:115], v[104:107]
  ds_read_b64_tr_b16 a[68:69], v8 offset:13312
  v_mfma_f32_16x16x32_bf16 v[108:111], a[12:15], a[116:119], v[108:111]
  v_mfma_f32_16x16x32_bf16 v[112:115], a[16:19], a[104:107], v[112:115]
  buffer_load_dwordx4 v9, s[4:7], s28 offen offset:0  lds
  v_mfma_f32_16x16x32_bf16 v[116:119], a[16:19], a[108:111], v[116:119]
  ds_read_b64_tr_b16 a[70:71], v8 offset:16640
  v_mfma_f32_16x16x32_bf16 v[120:123], a[16:19], a[112:115], v[120:123]
  buffer_load_dwordx4 v10, s[4:7], s28 offen offset:1024  lds
  v_mfma_f32_16x16x32_bf16 v[124:127], a[16:19], a[116:119], v[124:127]
  ds_read_b64_tr_b16 a[72:73], v8 offset:13344
  v_mfma_f32_16x16x32_bf16 v[128:131], a[20:23], a[104:107], v[128:131]
  buffer_load_dwordx4 v11, s[4:7], s28 offen offset:2048  lds
  v_mfma_f32_16x16x32_bf16 v[132:135], a[20:23], a[108:111], v[132:135]
  ds_read_b64_tr_b16 a[74:75], v8 offset:16672
  v_mfma_f32_16x16x32_bf16 v[136:139], a[20:23], a[112:115], v[136:139]
  ds_read_b64_tr_b16 a[76:77], v8 offset:13376
  v_mfma_f32_16x16x32_bf16 v[140:143], a[20:23], a[116:119], v[140:143]
  buffer_load_dwordx4 v12, s[4:7], s28 offen offset:3072  lds
  v_mfma_f32_16x16x32_bf16 v[144:147], a[24:27], a[104:107], v[144:147]
  ds_read_b64_tr_b16 a[78:79], v8 offset:16704
  v_mfma_f32_16x16x32_bf16 v[148:151], a[24:27], a[108:111], v[148:151]
  s_add_u32 s27, s27, 128
  v_mfma_f32_16x16x32_bf16 v[152:155], a[24:27], a[112:115], v[152:155]
  ds_read_b64_tr_b16 a[80:81], v8 offset:13408
  v_mfma_f32_16x16x32_bf16 v[156:159], a[24:27], a[116:119], v[156:159]
  ds_read_b64_tr_b16 a[82:83], v8 offset:16736
  v_mfma_f32_16x16x32_bf16 v[160:163], a[28:31], a[104:107], v[160:163]
  s_add_u32 s28, s28, 128
  v_mfma_f32_16x16x32_bf16 v[164:167], a[28:31], a[108:111], v[164:167]
  ds_read_b64_tr_b16 a[84:85], v8 offset:13440
  v_mfma_f32_16x16x32_bf16 v[168:171], a[28:31], a[112:115], v[168:171]
  s_add_u32 m0, s31, 0
  v_mfma_f32_16x16x32_bf16 v[172:175], a[28:31], a[116:119], v[172:175]
  v_mfma_f32_16x16x32_bf16 v[176:179], a[32:35], a[104:107], v[176:179]
  ds_read_b64_tr_b16 a[86:87], v8 offset:16768
  v_mfma_f32_16x16x32_bf16 v[180:183], a[32:35], a[108:111], v[180:183]
  buffer_load_dwordx4 v13, s[8:11], s29 offen offset:0  lds
  v_mfma_f32_16x16x32_bf16 v[184:187], a[32:35], a[112:115], v[184:187]
  ds_read_b64_tr_b16 a[88:89], v8 offset:13472
  v_mfma_f32_16x16x32_bf16 v[188:191], a[32:35], a[116:119], v[188:191]
  ds_read_b64_tr_b16 a[90:91], v8 offset:16800
  v_mfma_f32_16x16x32_bf16 v[192:195], a[36:39], a[104:107], v[192:195]
  buffer_load_dwordx4 v14, s[12:15], s30 offen offset:1024  lds
  v_mfma_f32_16x16x32_bf16 v[196:199], a[36:39], a[108:111], v[196:199]
  ds_read_b64_tr_b16 a[92:93], v8 offset:13504
  v_mfma_f32_16x16x32_bf16 v[200:203], a[36:39], a[112:115], v[200:203]
  buffer_load_dwordx4 v15, s[12:15], s30 offen offset:2048  lds
  v_mfma_f32_16x16x32_bf16 v[204:207], a[36:39], a[116:119], v[204:207]
  ds_read_b64_tr_b16 a[94:95], v8 offset:16832
  v_mfma_f32_16x16x32_bf16 v[208:211], a[40:43], a[104:107], v[208:211]
  s_mov_b64 exec, s[34:35]
  buffer_load_dwordx4 v16, s[12:15], s30 offen offset:3072  lds
  s_mov_b64 exec, -1
  v_mfma_f32_16x16x32_bf16 v[212:215], a[40:43], a[108:111], v[212:215]
  ds_read_b64_tr_b16 a[96:97], v8 offset:13536
  v_mfma_f32_16x16x32_bf16 v[216:219], a[40:43], a[112:115], v[216:219]
  ds_read_b64_tr_b16 a[98:99], v8 offset:16864
  v_mfma_f32_16x16x32_bf16 v[220:223], a[40:43], a[116:119], v[220:223]
  s_add_u32 s29, s29, 196608
  v_mfma_f32_16x16x32_bf16 v[224:227], a[44:47], a[104:107], v[224:227]
  ds_read_b64_tr_b16 a[100:101], v8 offset:13568
  v_mfma_f32_16x16x32_bf16 v[228:231], a[44:47], a[108:111], v[228:231]
  s_add_u32 s30, s30, 229376
  v_mfma_f32_16x16x32_bf16 v[232:235], a[44:47], a[112:115], v[232:235]
  ds_read_b64_tr_b16 a[102:103], v8 offset:16896
  v_mfma_f32_16x16x32_bf16 v[236:239], a[44:47], a[116:119], v[236:239]
  v_mfma_f32_16x16x32_bf16 v[240:243], a[48:51], a[104:107], v[240:243]
  v_mfma_f32_16x16x32_bf16 v[244:247], a[48:51], a[108:111], v[244:247]
  v_mfma_f32_16x16x32_bf16 v[248:251], a[48:51], a[112:115], v[248:251]
  v_mfma_f32_16x16x32_bf16 v[252:255], a[48:51], a[116:119], v[252:255]
  s_waitcnt vmcnt(16) lgkmcnt(0)
  s_barrier
  v_mfma_f32_16x16x32_bf16 v[48:51], a[52:55], a[120:123], v[48:51]
  s_add_u32 m0, s31, 13312
  v_mfma_f32_16x16x32_bf16 v[52:55], a[52:55], a[124:127], v[52:55]
  ds_read_b128 a[104:107], v2 offset:8192
  v_mfma_f32_16x16x32_bf16 v[56:59], a[52:55], a[128:131], v[56:59]
  ds_read_b128 a[108:111], v2 offset:10240
  v_mfma_f32_16x16x32_bf16 v[60:63], a[52:55], a[132:135], v[60:63]
  ds_read_b128 a[112:115], v2 offset:12288
  v_mfma_f32_16x16x32_bf16 v[64:67], a[56:59], a[120:123], v[64:67]
  ds_read_b128 a[116:119], v2 offset:14336
  v_mfma_f32_16x16x32_bf16 v[68:71], a[56:59], a[124:127], v[68:71]
  ds_read_b128 a[136:139], v3 offset:8192
  v_mfma_f32_16x16x32_bf16 v[72:75], a[56:59], a[128:131], v[72:75]
  v_mfma_f32_16x16x32_bf16 v[76:79], a[56:59], a[132:135], v[76:79]
  buffer_load_dwordx4 v13, s[8:11], s29 offen offset:0  lds
  v_mfma_f32_16x16x32_bf16 v[80:83], a[60:63], a[120:123], v[80:83]
  ds_read_b128 a[140:143], v3 offset:10240
  v_mfma_f32_16x16x32_bf16 v[84:87], a[60:63], a[124:127], v[84:87]
  ds_read_b128 a[144:147], v3 offset:12288
  v_mfma_f32_16x16x32_bf16 v[88:91], a[60:63], a[128:131], v[88:91]
  ds_read_b128 a[148:151], v3 offset:14336
  v_mfma_f32_16x16x32_bf16 v[92:95], a[60:63], a[132:135], v[92:95]
  ds_read_b64_tr_b16 a[0:1], v4 offset:26624
  v_mfma_f32_16x16x32_bf16 v[96:99], a[64:67], a[120:123], v[96:99]
  ds_read_b64_tr_b16 a[2:3], v4 offset:29952
  v_mfma_f32_16x16x32_bf16 v[100:103], a[64:67], a[124:127], v[100:103]
  v_mfma_f32_16x16x32_bf16 v[104:107], a[64:67], a[128:131], v[104:107]
  buffer_load_dwordx4 v14, s[12:15], s30 offen offset:1024  lds
  v_mfma_f32_16x16x32_bf16 v[108:111], a[64:67], a[132:135], v[108:111]
  ds_read_b64_tr_b16 a[4:5], v5 offset:26624
  v_mfma_f32_16x16x32_bf16 v[112:115], a[68:71], a[120:123], v[112:115]
  ds_read_b64_tr_b16 a[6:7], v5 offset:29952
  v_mfma_f32_16x16x32_bf16 v[116:119], a[68:71], a[124:127], v[116:119]
  ds_read_b64_tr_b16 a[8:9], v6 offset:26624
  v_mfma_f32_16x16x32_bf16 v[120:123], a[68:71], a[128:131], v[120:123]
  ds_read_b64_tr_b16 a[10:11], v6 offset:29952
  v_mfma_f32_16x16x32_bf16 v[124:127], a[68:71], a[132:135], v[124:127]
  ds_read_b64_tr_b16 a[12:13], v7 offset:26624
  v_mfma_f32_16x16x32_bf16 v[128:131], a[72:75], a[120:123], v[128:131]
  v_mfma_f32_16x16x32_bf16 v[132:135], a[72:75], a[124:127], v[132:135]
  buffer_load_dwordx4 v15, s[12:15], s30 offen offset:2048  lds
  v_mfma_f32_16x16x32_bf16 v[136:139], a[72:75], a[128:131], v[136:139]
  ds_read_b64_tr_b16 a[14:15], v7 offset:29952
  v_mfma_f32_16x16x32_bf16 v[140:143], a[72:75], a[132:135], v[140:143]
  ds_read_b64_tr_b16 a[16:17], v8 offset:26624
  v_mfma_f32_16x16x32_bf16 v[144:147], a[76:79], a[120:123], v[144:147]
  ds_read_b64_tr_b16 a[18:19], v8 offset:29952
  v_mfma_f32_16x16x32_bf16 v[148:151], a[76:79], a[124:127], v[148:151]
  ds_read_b64_tr_b16 a[20:21], v8 offset:26656
  v_mfma_f32_16x16x32_bf16 v[152:155], a[76:79], a[128:131], v[152:155]
  ds_read_b64_tr_b16 a[22:23], v8 offset:29984
  v_mfma_f32_16x16x32_bf16 v[156:159], a[76:79], a[132:135], v[156:159]
  v_mfma_f32_16x16x32_bf16 v[160:163], a[80:83], a[120:123], v[160:163]
  s_mov_b64 exec, s[34:35]
  buffer_load_dwordx4 v16, s[12:15], s30 offen offset:3072  lds
  s_mov_b64 exec, -1
  v_mfma_f32_16x16x32_bf16 v[164:167], a[80:83], a[124:127], v[164:167]
  ds_read_b64_tr_b16 a[24:25], v8 offset:26688
  v_mfma_f32_16x16x32_bf16 v[168:171], a[80:83], a[128:131], v[168:171]
  ds_read_b64_tr_b16 a[26:27], v8 offset:30016
  v_mfma_f32_16x16x32_bf16 v[172:175], a[80:83], a[132:135], v[172:175]
  ds_read_b64_tr_b16 a[28:29], v8 offset:26720
  v_mfma_f32_16x16x32_bf16 v[176:179], a[84:87], a[120:123], v[176:179]
  ds_read_b64_tr_b16 a[30:31], v8 offset:30048
  v_mfma_f32_16x16x32_bf16 v[180:183], a[84:87], a[124:127], v[180:183]
  ds_read_b64_tr_b16 a[32:33], v8 offset:26752
  v_mfma_f32_16x16x32_bf16 v[184:187], a[84:87], a[128:131], v[184:187]
  v_mfma_f32_16x16x32_bf16 v[188:191], a[84:87], a[132:135], v[188:191]
  s_add_u32 s29, s29, 196608
  v_mfma_f32_16x16x32_bf16 v[192:195], a[88:91], a[120:123], v[192:195]
  ds_read_b64_tr_b16 a[34:35], v8 offset:30080
  v_mfma_f32_16x16x32_bf16 v[196:199], a[88:91], a[124:127], v[196:199]
  ds_read_b64_tr_b16 a[36:37], v8 offset:26784
  v_mfma_f32_16x16x32_bf16 v[200:203], a[88:91], a[128:131], v[200:203]
  ds_read_b64_tr_b16 a[38:39], v8 offset:30112
  v_mfma_f32_16x16x32_bf16 v[204:207], a[88:91], a[132:135], v[204:207]
  ds_read_b64_tr_b16 a[40:41], v8 offset:26816
  v_mfma_f32_16x16x32_bf16 v[208:211], a[92:95], a[120:123], v[208:211]
  ds_read_b64_tr_b16 a[42:43], v8 offset:30144
  v_mfma_f32_16x16x32_bf16 v[212:215], a[92:95], a[124:127], v[212:215]
  v_mfma_f32_16x16x32_bf16 v[216:219], a[92:95], a[128:131], v[216:219]
  s_add_u32 s30, s30, 229376
  v_mfma_f32_16x16x32_bf16 v[220:223], a[92:95], a[132:135], v[220:223]
  ds_read_b64_tr_b16 a[44:45], v8 offset:26848
  v_mfma_f32_16x16x32_bf16 v[224:227], a[96:99], a[120:123], v[224:227]
  ds_read_b64_tr_b16 a[46:47], v8 offset:30176
  v_mfma_f32_16x16x32_bf16 v[228:231], a[96:99], a[124:127], v[228:231]
  ds_read_b64_tr_b16 a[48:49], v8 offset:26880
  v_mfma_f32_16x16x32_bf16 v[232:235], a[96:99], a[128:131], v[232:235]
  ds_read_b64_tr_b16 a[50:51], v8 offset:30208
  v_mfma_f32_16x16x32_bf16 v[236:239], a[96:99], a[132:135], v[236:239]
  v_mfma_f32_16x16x32_bf16 v[240:243], a[100:103], a[120:123], v[240:243]
  v_mfma_f32_16x16x32_bf16 v[244:247], a[100:103], a[124:127], v[244:247]
  v_mfma_f32_16x16x32_bf16 v[248:251], a[100:103], a[128:131], v[248:251]
  v_mfma_f32_16x16x32_bf16 v[252:255], a[100:103], a[132:135], v[252:255]
  s_waitcnt vmcnt(16) lgkmcnt(0)
  s_barrier
  v_mfma_f32_16x16x32_bf16 v[48:51], a[0:3], a[104:107], v[48:51]
  s_add_u32 m0, s32, 8192
  v_mfma_f32_16x16x32_bf16 v[52:55], a[0:3], a[108:111], v[52:55]
  ds_read_b64_tr_b16 a[52:53], v4 offset:39936
  v_mfma_f32_16x16x32_bf16 v[56:59], a[0:3], a[112:115], v[56:59]
  ds_read_b64_tr_b16 a[54:55], v4 offset:43264
  v_mfma_f32_16x16x32_bf16 v[60:63], a[0:3], a[116:119], v[60:63]
  buffer_load_dwordx4 v9, s[4:7], s27 offen offset:0  lds
  v_mfma_f32_16x16x32_bf16 v[64:67], a[4:7], a[104:107], v[64:67]
  ds_read_b64_tr_b16 a[56:57], v5 offset:39936
  v_mfma_f32_16x16x32_bf16 v[68:71], a[4:7], a[108:111], v[68:71]
  buffer_load_dwordx4 v10, s[4:7], s27 offen offset:1024  lds
  v_mfma_f32_16x16x32_bf16 v[72:75], a[4:7], a[112:115], v[72:75]
  ds_read_b64_tr_b16 a[58:59], v5 offset:43264
  v_mfma_f32_16x16x32_bf16 v[76:79], a[4:7], a[116:119], v[76:79]
  ds_read_b64_tr_b16 a[60:61], v6 offset:39936
  v_mfma_f32_16x16x32_bf16 v[80:83], a[8:11], a[104:107], v[80:83]
  buffer_load_dwordx4 v11, s[4:7], s27 offen offset:2048  lds
  v_mfma_f32_16x16x32_bf16 v[84:87], a[8:11], a[108:111], v[84:87]
  ds_read_b64_tr_b16 a[62:63], v6 offset:43264
  v_mfma_f32_16x16x32_bf16 v[88:91], a[8:11], a[112:115], v[88:91]
  buffer_load_dwordx4 v12, s[4:7], s27 offen offset:3072  lds
  v_mfma_f32_16x16x32_bf16 v[92:95], a[8:11], a[116:119], v[92:95]
  ds_read_b64_tr_b16 a[64:65], v7 offset:39936
  v_mfma_f32_16x16x32_bf16 v[96:99], a[12:15], a[104:107], v[96:99]
  s_add_u32 m0, s32, 12288
  v_mfma_f32_16x16x32_bf16 v[100:103], a[12:15], a[108:111], v[100:103]
  ds_read_b64_tr_b16 a[66:67], v7 offset:43264
  v_mfma_f32_16x16x32_bf16 v[104:107], a[12:15], a[112:115], v[104:107]
  ds_read_b64_tr_b16 a[68:69], v8 offset:39936
  v_mfma_f32_16x16x32_bf16 v[108:111], a[12:15], a[116:119], v[108:111]
  v_mfma_f32_16x16x32_bf16 v[112:115], a[16:19], a[104:107], v[112:115]
  buffer_load_dwordx4 v9, s[4:7], s28 offen offset:0  lds
  v_mfma_f32_16x16x32_bf16 v[116:119], a[16:19], a[108:111], v[116:119]
  ds_read_b64_tr_b16 a[70:71], v8 offset:43264
  v_mfma_f32_16x16x32_bf16 v[120:123], a[16:19], a[112:115], v[120:123]
  buffer_load_dwordx4 v10, s[4:7], s28 offen offset:1024  lds
  v_mfma_f32_16x16x32_bf16 v[124:127], a[16:19], a[116:119], v[124:127]
  ds_read_b64_tr_b16 a[72:73], v8 offset:39968
  v_mfma_f32_16x16x32_bf16 v[128:131], a[20:23], a[104:107], v[128:131]
  buffer_load_dwordx4 v11, s[4:7], s28 offen offset:2048  lds
  v_mfma_f32_16x16x32_bf16 v[132:135], a[20:23], a[108:111], v[132:135]
  ds_read_b64_tr_b16 a[74:75], v8 offset:43296
  v_mfma_f32_16x16x32_bf16 v[136:139], a[20:23], a[112:115], v[136:139]
  ds_read_b64_tr_b16 a[76:77], v8 offset:40000
  v_mfma_f32_16x16x32_bf16 v[140:143], a[20:23], a[116:119], v[140:143]
  buffer_load_dwordx4 v12, s[4:7], s28 offen offset:3072  lds
  v_mfma_f32_16x16x32_bf16 v[144:147], a[24:27], a[104:107], v[144:147]
  ds_read_b64_tr_b16 a[78:79], v8 offset:43328
  v_mfma_f32_16x16x32_bf16 v[148:151], a[24:27], a[108:111], v[148:151]
  s_add_u32 s27, s27, 128
  v_mfma_f32_16x16x32_bf16 v[152:155], a[24:27], a[112:115], v[152:155]
  ds_read_b64_tr_b16 a[80:81], v8 offset:40032
  v_mfma_f32_16x16x32_bf16 v[156:159], a[24:27], a[116:119], v[156:159]
  ds_read_b64_tr_b16 a[82:83], v8 offset:43360
  v_mfma_f32_16x16x32_bf16 v[160:163], a[28:31], a[104:107], v[160:163]
  s_add_u32 s28, s28, 128
  v_mfma_f32_16x16x32_bf16 v[164:167], a[28:31], a[108:111], v[164:167]
  ds_read_b64_tr_b16 a[84:85], v8 offset:40064
  v_mfma_f32_16x16x32_bf16 v[168:171], a[28:31], a[112:115], v[168:171]
  s_add_u32 m0, s31, 26624
  v_mfma_f32_16x16x32_bf16 v[172:175], a[28:31], a[116:119], v[172:175]
  v_mfma_f32_16x16x32_bf16 v[176:179], a[32:35], a[104:107], v[176:179]
  ds_read_b64_tr_b16 a[86:87], v8 offset:43392
  v_mfma_f32_16x16x32_bf16 v[180:183], a[32:35], a[108:111], v[180:183]
  buffer_load_dwordx4 v13, s[8:11], s29 offen offset:0  lds
  v_mfma_f32_16x16x32_bf16 v[184:187], a[32:35], a[112:115], v[184:187]
  ds_read_b64_tr_b16 a[88:89], v8 offset:40096
  v_mfma_f32_16x16x32_bf16 v[188:191], a[32:35], a[116:119], v[188:191]
  ds_read_b64_tr_b16 a[90:91], v8 offset:43424
  v_mfma_f32_16x16x32_bf16 v[192:195], a[36:39], a[104:107], v[192:195]
  buffer_load_dwordx4 v14, s[12:15], s30 offen offset:1024  lds
  v_mfma_f32_16x16x32_bf16 v[196:199], a[36:39], a[108:111], v[196:199]
  ds_read_b64_tr_b16 a[92:93], v8 offset:40128
  v_mfma_f32_16x16x32_bf16 v[200:203], a[36:39], a[112:115], v[200:203]
  buffer_load_dwordx4 v15, s[12:15], s30 offen offset:2048  lds
  v_mfma_f32_16x16x32_bf16 v[204:207], a[36:39], a[116:119], v[204:207]
  ds_read_b64_tr_b16 a[94:95], v8 offset:43456
  v_mfma_f32_16x16x32_bf16 v[208:211], a[40:43], a[104:107], v[208:211]
  s_mov_b64 exec, s[34:35]
  buffer_load_dwordx4 v16, s[12:15], s30 offen offset:3072  lds
  s_mov_b64 exec, -1
  v_mfma_f32_16x16x32_bf16 v[212:215], a[40:43], a[108:111], v[212:215]
  ds_read_b64_tr_b16 a[96:97], v8 offset:40160
  v_mfma_f32_16x16x32_bf16 v[216:219], a[40:43], a[112:115], v[216:219]
  ds_read_b64_tr_b16 a[98:99], v8 offset:43488
  v_mfma_f32_16x16x32_bf16 v[220:223], a[40:43], a[116:119], v[220:223]
  s_add_u32 s29, s29, 196608
  v_mfma_f32_16x16x32_bf16 v[224:227], a[44:47], a[104:107], v[224:227]
  ds_read_b64_tr_b16 a[100:101], v8 offset:40192
  v_mfma_f32_16x16x32_bf16 v[228:231], a[44:47], a[108:111], v[228:231]
  s_add_u32 s30, s30, 229376
  v_mfma_f32_16x16x32_bf16 v[232:235], a[44:47], a[112:115], v[232:235]
  ds_read_b64_tr_b16 a[102:103], v8 offset:43520
  v_mfma_f32_16x16x32_bf16 v[236:239], a[44:47], a[116:119], v[236:239]
  v_mfma_f32_16x16x32_bf16 v[240:243], a[48:51], a[104:107], v[240:243]
  v_mfma_f32_16x16x32_bf16 v[244:247], a[48:51], a[108:111], v[244:247]
  v_mfma_f32_16x16x32_bf16 v[248:251], a[48:51], a[112:115], v[248:251]
  v_mfma_f32_16x16x32_bf16 v[252:255], a[48:51], a[116:119], v[252:255]
  s_waitcnt vmcnt(16) lgkmcnt(0)
  s_barrier
  v_mfma_f32_16x16x32_bf16 v[48:51], a[52:55], a[136:139], v[48:51]
  s_add_u32 m0, s31, 39936
  v_mfma_f32_16x16x32_bf16 v[52:55], a[52:55], a[140:143], v[52:55]
  ds_read_b128 a[104:107], v2 offset:0
  v_mfma_f32_16x16x32_bf16 v[56:59], a[52:55], a[144:147], v[56:59]
  ds_read_b128 a[108:111], v2 offset:2048
  v_mfma_f32_16x16x32_bf16 v[60:63], a[52:55], a[148:151], v[60:63]
  ds_read_b128 a[112:115], v2 offset:4096
  v_mfma_f32_16x16x32_bf16 v[64:67], a[56:59], a[136:139], v[64:67]
  ds_read_b128 a[116:119], v2 offset:6144
  v_mfma_f32_16x16x32_bf16 v[68:71], a[56:59], a[140:143], v[68:71]
  ds_read_b128 a[120:123], v3 offset:0
  v_mfma_f32_16x16x32_bf16 v[72:75], a[56:59], a[144:147], v[72:75]
  v_mfma_f32_16x16x32_bf16 v[76:79], a[56:59], a[148:151], v[76:79]
  buffer_load_dwordx4 v13, s[8:11], s29 offen offset:0  lds
  v_mfma_f32_16x16x32_bf16 v[80:83], a[60:63], a[136:139], v[80:83]
  ds_read_b128 a[124:127], v3 offset:2048
  v_mfma_f32_16x16x32_bf16 v[84:87], a[60:63], a[140:143], v[84:87]
  ds_read_b128 a[128:131], v3 offset:4096
  v_mfma_f32_16x16x32_bf16 v[88:91], a[60:63], a[144:147], v[88:91]
  ds_read_b128 a[132:135], v3 offset:6144
  v_mfma_f32_16x16x32_bf16 v[92:95], a[60:63], a[148:151], v[92:95]
  ds_read_b64_tr_b16 a[0:1], v4 offset:0
  v_mfma_f32_16x16x32_bf16 v[96:99], a[64:67], a[136:139], v[96:99]
  ds_read_b64_tr_b16 a[2:3], v4 offset:3328
  v_mfma_f32_16x16x32_bf16 v[100:103], a[64:67], a[140:143], v[100:103]
  v_mfma_f32_16x16x32_bf16 v[104:107], a[64:67], a[144:147], v[104:107]
  buffer_load_dwordx4 v14, s[12:15], s30 offen offset:1024  lds
  v_mfma_f32_16x16x32_bf16 v[108:111], a[64:67], a[148:151], v[108:111]
  ds_read_b64_tr_b16 a[4:5], v5 offset:0
  v_mfma_f32_16x16x32_bf16 v[112:115], a[68:71], a[136:139], v[112:115]
  ds_read_b64_tr_b16 a[6:7], v5 offset:3328
  v_mfma_f32_16x16x32_bf16 v[116:119], a[68:71], a[140:143], v[116:119]
  ds_read_b64_tr_b16 a[8:9], v6 offset:0
  v_mfma_f32_16x16x32_bf16 v[120:123], a[68:71], a[144:147], v[120:123]
  ds_read_b64_tr_b16 a[10:11], v6 offset:3328
  v_mfma_f32_16x16x32_bf16 v[124:127], a[68:71], a[148:151], v[124:127]
  ds_read_b64_tr_b16 a[12:13], v7 offset:0
  v_mfma_f32_16x16x32_bf16 v[128:131], a[72:75], a[136:139], v[128:131]
  v_mfma_f32_16x16x32_bf16 v[132:135], a[72:75], a[140:143], v[132:135]
  buffer_load_dwordx4 v15, s[12:15], s30 offen offset:2048  lds
  v_mfma_f32_16x16x32_bf16 v[136:139], a[72:75], a[144:147], v[136:139]
  ds_read_b64_tr_b16 a[14:15], v7 offset:3328
  v_mfma_f32_16x16x32_bf16 v[140:143], a[72:75], a[148:151], v[140:143]
  ds_read_b64_tr_b16 a[16:17], v8 offset:0
  v_mfma_f32_16x16x32_bf16 v[144:147], a[76:79], a[136:139], v[144:147]
  ds_read_b64_tr_b16 a[18:19], v8 offset:3328
  v_mfma_f32_16x16x32_bf16 v[148:151], a[76:79], a[140:143], v[148:151]
  ds_read_b64_tr_b16 a[20:21], v8 offset:32
  v_mfma_f32_16x16x32_bf16 v[152:155], a[76:79], a[144:147], v[152:155]
  ds_read_b64_tr_b16 a[22:23], v8 offset:3360
  v_mfma_f32_16x16x32_bf16 v[156:159], a[76:79], a[148:151], v[156:159]
  v_mfma_f32_16x16x32_bf16 v[160:163], a[80:83], a[136:139], v[160:163]
  s_mov_b64 exec, s[34:35]
  buffer_load_dwordx4 v16, s[12:15], s30 offen offset:3072  lds
  s_mov_b64 exec, -1
  v_mfma_f32_16x16x32_bf16 v[164:167], a[80:83], a[140:143], v[164:167]
  ds_read_b64_tr_b16 a[24:25], v8 offset:64
  v_mfma_f32_16x16x32_bf16 v[168:171], a[80:83], a[144:147], v[168:171]
  ds_read_b64_tr_b16 a[26:27], v8 offset:3392
  v_mfma_f32_16x16x32_bf16 v[172:175], a[80:83], a[148:151], v[172:175]
  ds_read_b64_tr_b16 a[28:29], v8 offset:96
  v_mfma_f32_16x16x32_bf16 v[176:179], a[84:87], a[136:139], v[176:179]
  ds_read_b64_tr_b16 a[30:31], v8 offset:3424
  v_mfma_f32_16x16x32_bf16 v[180:183], a[84:87], a[140:143], v[180:183]
  ds_read_b64_tr_b16 a[32:33], v8 offset:128
  v_mfma_f32_16x16x32_bf16 v[184:187], a[84:87], a[144:147], v[184:187]
  v_mfma_f32_16x16x32_bf16 v[188:191], a[84:87], a[148:151], v[188:191]
  s_add_u32 s29, s29, 196608
  v_mfma_f32_16x16x32_bf16 v[192:195], a[88:91], a[136:139], v[192:195]
  ds_read_b64_tr_b16 a[34:35], v8 offset:3456
  v_mfma_f32_16x16x32_bf16 v[196:199], a[88:91], a[140:143], v[196:199]
  ds_read_b64_tr_b16 a[36:37], v8 offset:160
  v_mfma_f32_16x16x32_bf16 v[200:203], a[88:91], a[144:147], v[200:203]
  ds_read_b64_tr_b16 a[38:39], v8 offset:3488
  v_mfma_f32_16x16x32_bf16 v[204:207], a[88:91], a[148:151], v[204:207]
  ds_read_b64_tr_b16 a[40:41], v8 offset:192
  v_mfma_f32_16x16x32_bf16 v[208:211], a[92:95], a[136:139], v[208:211]
  ds_read_b64_tr_b16 a[42:43], v8 offset:3520
  v_mfma_f32_16x16x32_bf16 v[212:215], a[92:95], a[140:143], v[212:215]
  v_mfma_f32_16x16x32_bf16 v[216:219], a[92:95], a[144:147], v[216:219]
  s_add_u32 s30, s30, 229376
  v_mfma_f32_16x16x32_bf16 v[220:223], a[92:95], a[148:151], v[220:223]
  ds_read_b64_tr_b16 a[44:45], v8 offset:224
  v_mfma_f32_16x16x32_bf16 v[224:227], a[96:99], a[136:139], v[224:227]
  ds_read_b64_tr_b16 a[46:47], v8 offset:3552
  v_mfma_f32_16x16x32_bf16 v[228:231], a[96:99], a[140:143], v[228:231]
  ds_read_b64_tr_b16 a[48:49], v8 offset:256
  v_mfma_f32_16x16x32_bf16 v[232:235], a[96:99], a[144:147], v[232:235]
  ds_read_b64_tr_b16 a[50:51], v8 offset:3584
  v_mfma_f32_16x16x32_bf16 v[236:239], a[96:99], a[148:151], v[236:239]
  v_mfma_f32_16x16x32_bf16 v[240:243], a[100:103], a[136:139], v[240:243]
  v_mfma_f32_16x16x32_bf16 v[244:247], a[100:103], a[140:143], v[244:247]
  v_mfma_f32_16x16x32_bf16 v[248:251], a[100:103], a[144:147], v[248:251]
  v_mfma_f32_16x16x32_bf16 v[252:255], a[100:103], a[148:151], v[252:255]
  s_waitcnt vmcnt(16) lgkmcnt(0)
  s_barrier
  s_sub_u32 s33, s33, 1
  s_cmp_lg_u32 s33, 0
  s_cbranch_scc1 L_k1B_loop
  v_mfma_f32_16x16x32_bf16 v[48:51], a[0:3], a[104:107], v[48:51]
  buffer_load_dword v46, v44, s[96:99], s74 offen
  v_mfma_f32_16x16x32_bf16 v[52:55], a[0:3], a[108:111], v[52:55]
  ds_read_b64_tr_b16 a[52:53], v4 offset:13312
  v_mfma_f32_16x16x32_bf16 v[56:59], a[0:3], a[112:115], v[56:59]
  v_mfma_f32_16x16x32_bf16 v[60:63], a[0:3], a[116:119], v[60:63]
  ds_read_b64_tr_b16 a[54:55], v4 offset:16640
  v_mfma_f32_16x16x32_bf16 v[64:67], a[4:7], a[104:107], v[64:67]
  ds_read_b64_tr_b16 a[56:57], v5 offset:13312
  v_mfma_f32_16x16x32_bf16 v[68:71], a[4:7], a[108:111], v[68:71]
  v_mfma_f32_16x16x32_bf16 v[72:75], a[4:7], a[112:115], v[72:75]
  ds_read_b64_tr_b16 a[58:59], v5 offset:16640
  v_mfma_f32_16x16x32_bf16 v[76:79], a[4:7], a[116:119], v[76:79]
  v_mfma_f32_16x16x32_bf16 v[80:83], a[8:11], a[104:107], v[80:83]
  ds_read_b64_tr_b16 a[60:61], v6 offset:13312
  v_mfma_f32_16x16x32_bf16 v[84:87], a[8:11], a[108:111], v[84:87]
  ds_read_b64_tr_b16 a[62:63], v6 offset:16640
  v_mfma_f32_16x16x32_bf16 v[88:91], a[8:11], a[112:115], v[88:91]
  v_mfma_f32_16x16x32_bf16 v[92:95], a[8:11], a[116:119], v[92:95]
  ds_read_b64_tr_b16 a[64:65], v7 offset:13312
  v_mfma_f32_16x16x32_bf16 v[96:99], a[12:15], a[104:107], v[96:99]
  buffer_load_dword v46, v45, s[20:23], s3 offen
  v_mfma_f32_16x16x32_bf16 v[100:103], a[12:15], a[108:111], v[100:103]
  v_mfma_f32_16x16x32_bf16 v[104:107], a[12:15], a[112:115], v[104:107]
  ds_read_b64_tr_b16 a[66:67], v7 offset:16640
  v_mfma_f32_16x16x32_bf16 v[108:111], a[12:15], a[116:119], v[108:111]
  v_mfma_f32_16x16x32_bf16 v[112:115], a[16:19], a[104:107], v[112:115]
  ds_read_b64_tr_b16 a[68:69], v8 offset:13312
  v_mfma_f32_16x16x32_bf16 v[116:119], a[16:19], a[108:111], v[116:119]
  ds_read_b64_tr_b16 a[70:71], v8 offset:16640
  v_mfma_f32_16x16x32_bf16 v[120:123], a[16:19], a[112:115], v[120:123]
  v_mfma_f32_16x16x32_bf16 v[124:127], a[16:19], a[116:119], v[124:127]
  ds_read_b64_tr_b16 a[72:73], v8 offset:13344
  v_mfma_f32_16x16x32_bf16 v[128:131], a[20:23], a[104:107], v[128:131]
  ds_read_b64_tr_b16 a[74:75], v8 offset:16672
  v_mfma_f32_16x16x32_bf16 v[132:135], a[20:23], a[108:111], v[132:135]
  v_mfma_f32_16x16x32_bf16 v[136:139], a[20:23], a[112:115], v[136:139]
  ds_read_b64_tr_b16 a[76:77], v8 offset:13376
  v_mfma_f32_16x16x32_bf16 v[140:143], a[20:23], a[116:119], v[140:143]
  v_mfma_f32_16x16x32_bf16 v[144:147], a[24:27], a[104:107], v[144:147]
  s_add_u32 s74, s74, 7168
  v_mfma_f32_16x16x32_bf16 v[148:151], a[24:27], a[108:111], v[148:151]
  ds_read_b64_tr_b16 a[78:79], v8 offset:16704
  v_mfma_f32_16x16x32_bf16 v[152:155], a[24:27], a[112:115], v[152:155]
  v_mfma_f32_16x16x32_bf16 v[156:159], a[24:27], a[116:119], v[156:159]
  ds_read_b64_tr_b16 a[80:81], v8 offset:13408
  v_mfma_f32_16x16x32_bf16 v[160:163], a[28:31], a[104:107], v[160:163]
  ds_read_b64_tr_b16 a[82:83], v8 offset:16736
  v_mfma_f32_16x16x32_bf16 v[164:167], a[28:31], a[108:111], v[164:167]
  v_mfma_f32_16x16x32_bf16 v[168:171], a[28:31], a[112:115], v[168:171]
  ds_read_b64_tr_b16 a[84:85], v8 offset:13440
  v_mfma_f32_16x16x32_bf16 v[172:175], a[28:31], a[116:119], v[172:175]
  v_mfma_f32_16x16x32_bf16 v[176:179], a[32:35], a[104:107], v[176:179]
  ds_read_b64_tr_b16 a[86:87], v8 offset:16768
  v_mfma_f32_16x16x32_bf16 v[180:183], a[32:35], a[108:111], v[180:183]
  ds_read_b64_tr_b16 a[88:89], v8 offset:13472
  v_mfma_f32_16x16x32_bf16 v[184:187], a[32:35], a[112:115], v[184:187]
  v_mfma_f32_16x16x32_bf16 v[188:191], a[32:35], a[116:119], v[188:191]
  ds_read_b64_tr_b16 a[90:91], v8 offset:16800
  v_mfma_f32_16x16x32_bf16 v[192:195], a[36:39], a[104:107], v[192:195]
  s_add_u32 s3, s3, 2048
  v_mfma_f32_16x16x32_bf16 v[196:199], a[36:39], a[108:111], v[196:199]
  v_mfma_f32_16x16x32_bf16 v[200:203], a[36:39], a[112:115], v[200:203]
  ds_read_b64_tr_b16 a[92:93], v8 offset:13504
  v_mfma_f32_16x16x32_bf16 v[204:207], a[36:39], a[116:119], v[204:207]
  v_mfma_f32_16x16x32_bf16 v[208:211], a[40:43], a[104:107], v[208:211]
  ds_read_b64_tr_b16 a[94:95], v8 offset:16832
  v_mfma_f32_16x16x32_bf16 v[212:215], a[40:43], a[108:111], v[212:215]
  ds_read_b64_tr_b16 a[96:97], v8 offset:13536
  v_mfma_f32_16x16x32_bf16 v[216:219], a[40:43], a[112:115], v[216:219]
  v_mfma_f32_16x16x32_bf16 v[220:223], a[40:43], a[116:119], v[220:223]
  ds_read_b64_tr_b16 a[98:99], v8 offset:16864
  v_mfma_f32_16x16x32_bf16 v[224:227], a[44:47], a[104:107], v[224:227]
  ds_read_b64_tr_b16 a[100:101], v8 offset:13568
  v_mfma_f32_16x16x32_bf16 v[228:231], a[44:47], a[108:111], v[228:231]
  v_mfma_f32_16x16x32_bf16 v[232:235], a[44:47], a[112:115], v[232:235]
  ds_read_b64_tr_b16 a[102:103], v8 offset:16896
  v_mfma_f32_16x16x32_bf16 v[236:239], a[44:47], a[116:119], v[236:239]
  v_mfma_f32_16x16x32_bf16 v[240:243], a[48:51], a[104:107], v[240:243]
  v_mfma_f32_16x16x32_bf16 v[244:247], a[48:51], a[108:111], v[244:247]
  v_mfma_f32_16x16x32_bf16 v[248:251], a[48:51], a[112:115], v[248:251]
  v_mfma_f32_16x16x32_bf16 v[252:255], a[48:51], a[116:119], v[252:255]
  s_waitcnt vmcnt(6) lgkmcnt(0)
  s_barrier
  v_mfma_f32_16x16x32_bf16 v[48:51], a[52:55], a[120:123], v[48:51]
  ds_read_b128 a[104:107], v2 offset:8192
  v_mfma_f32_16x16x32_bf16 v[52:55], a[52:55], a[124:127], v[52:55]
  ds_read_b128 a[108:111], v2 offset:10240
  v_mfma_f32_16x16x32_bf16 v[56:59], a[52:55], a[128:131], v[56:59]
  ds_read_b128 a[112:115], v2 offset:12288
  v_mfma_f32_16x16x32_bf16 v[60:63], a[52:55], a[132:135], v[60:63]
  v_mfma_f32_16x16x32_bf16 v[64:67], a[56:59], a[120:123], v[64:67]
  ds_read_b128 a[116:119], v2 offset:14336
  v_mfma_f32_16x16x32_bf16 v[68:71], a[56:59], a[124:127], v[68:71]
  ds_read_b128 a[136:139], v3 offset:8192
  v_mfma_f32_16x16x32_bf16 v[72:75], a[56:59], a[128:131], v[72:75]
  v_mfma_f32_16x16x32_bf16 v[76:79], a[56:59], a[132:135], v[76:79]
  ds_read_b128 a[140:143], v3 offset:10240
  v_mfma_f32_16x16x32_bf16 v[80:83], a[60:63], a[120:123], v[80:83]
  ds_read_b128 a[144:147], v3 offset:12288
  v_mfma_f32_16x16x32_bf16 v[84:87], a[60:63], a[124:127], v[84:87]
  ds_read_b128 a[148:151], v3 offset:14336
  v_mfma_f32_16x16x32_bf16 v[88:91], a[60:63], a[128:131], v[88:91]
  v_mfma_f32_16x16x32_bf16 v[92:95], a[60:63], a[132:135], v[92:95]
  ds_read_b64_tr_b16 a[0:1], v4 offset:26624
  v_mfma_f32_16x16x32_bf16 v[96:99], a[64:67], a[120:123], v[96:99]
  ds_read_b64_tr_b16 a[2:3], v4 offset:29952
  v_mfma_f32_16x16x32_bf16 v[100:103], a[64:67], a[124:127], v[100:103]
  v_mfma_f32_16x16x32_bf16 v[104:107], a[64:67], a[128:131], v[104:107]
  ds_read_b64_tr_b16 a[4:5], v5 offset:26624
  v_mfma_f32_16x16x32_bf16 v[108:111], a[64:67], a[132:135], v[108:111]
  ds_read_b64_tr_b16 a[6:7], v5 offset:29952
  v_mfma_f32_16x16x32_bf16 v[112:115], a[68:71], a[120:123], v[112:115]
  ds_read_b64_tr_b16 a[8:9], v6 offset:26624
  v_mfma_f32_16x16x32_bf16 v[116:119], a[68:71], a[124:127], v[116:119]
  v_mfma_f32_16x16x32_bf16 v[120:123], a[68:71], a[128:131], v[120:123]
  ds_read_b64_tr_b16 a[10:11], v6 offset:29952
  v_mfma_f32_16x16x32_bf16 v[124:127], a[68:71], a[132:135], v[124:127]
  ds_read_b64_tr_b16 a[12:13], v7 offset:26624
  v_mfma_f32_16x16x32_bf16 v[128:131], a[72:75], a[120:123], v[128:131]
  v_mfma_f32_16x16x32_bf16 v[132:135], a[72:75], a[124:127], v[132:135]
  ds_read_b64_tr_b16 a[14:15], v7 offset:29952
  v_mfma_f32_16x16x32_bf16 v[136:139], a[72:75], a[128:131], v[136:139]
  ds_read_b64_tr_b16 a[16:17], v8 offset:26624
  v_mfma_f32_16x16x32_bf16 v[140:143], a[72:75], a[132:135], v[140:143]
  v_mfma_f32_16x16x32_bf16 v[144:147], a[76:79], a[120:123], v[144:147]
  ds_read_b64_tr_b16 a[18:19], v8 offset:29952
  v_mfma_f32_16x16x32_bf16 v[148:151], a[76:79], a[124:127], v[148:151]
  ds_read_b64_tr_b16 a[20:21], v8 offset:26656
  v_mfma_f32_16x16x32_bf16 v[152:155], a[76:79], a[128:131], v[152:155]
  ds_read_b64_tr_b16 a[22:23], v8 offset:29984
  v_mfma_f32_16x16x32_bf16 v[156:159], a[76:79], a[132:135], v[156:159]
  v_mfma_f32_16x16x32_bf16 v[160:163], a[80:83], a[120:123], v[160:163]
  ds_read_b64_tr_b16 a[24:25], v8 offset:26688
  v_mfma_f32_16x16x32_bf16 v[164:167], a[80:83], a[124:127], v[164:167]
  ds_read_b64_tr_b16 a[26:27], v8 offset:30016
  v_mfma_f32_16x16x32_bf16 v[168:171], a[80:83], a[128:131], v[168:171]
  v_mfma_f32_16x16x32_bf16 v[172:175], a[80:83], a[132:135], v[172:175]
  ds_read_b64_tr_b16 a[28:29], v8 offset:26720
  v_mfma_f32_16x16x32_bf16 v[176:179], a[84:87], a[120:123], v[176:179]
  ds_read_b64_tr_b16 a[30:31], v8 offset:30048
  v_mfma_f32_16x16x32_bf16 v[180:183], a[84:87], a[124:127], v[180:183]
  ds_read_b64_tr_b16 a[32:33], v8 offset:26752
  v_mfma_f32_16x16x32_bf16 v[184:187], a[84:87], a[128:131], v[184:187]
  v_mfma_f32_16x16x32_bf16 v[188:191], a[84:87], a[132:135], v[188:191]
  ds_read_b64_tr_b16 a[34:35], v8 offset:30080
  v_mfma_f32_16x16x32_bf16 v[192:195], a[88:91], a[120:123], v[192:195]
  ds_read_b64_tr_b16 a[36:37], v8 offset:26784
  v_mfma_f32_16x16x32_bf16 v[196:199], a[88:91], a[124:127], v[196:199]
  v_mfma_f32_16x16x32_bf16 v[200:203], a[88:91], a[128:131], v[200:203]
  ds_read_b64_tr_b16 a[38:39], v8 offset:30112
  v_mfma_f32_16x16x32_bf16 v[204:207], a[88:91], a[132:135], v[204:207]
  ds_read_b64_tr_b16 a[40:41], v8 offset:26816
  v_mfma_f32_16x16x32_bf16 v[208:211], a[92:95], a[120:123], v[208:211]
  ds_read_b64_tr_b16 a[42:43], v8 offset:30144
  v_mfma_f32_16x16x32_bf16 v[212:215], a[92:95], a[124:127], v[212:215]
  v_mfma_f32_16x16x32_bf16 v[216:219], a[92:95], a[128:131], v[216:219]
  ds_read_b64_tr_b16 a[44:45], v8 offset:26848
  v_mfma_f32_16x16x32_bf16 v[220:223], a[92:95], a[132:135], v[220:223]
  ds_read_b64_tr_b16 a[46:47], v8 offset:30176
  v_mfma_f32_16x16x32_bf16 v[224:227], a[96:99], a[120:123], v[224:227]
  v_mfma_f32_16x16x32_bf16 v[228:231], a[96:99], a[124:127], v[228:231]
  ds_read_b64_tr_b16 a[48:49], v8 offset:26880
  v_mfma_f32_16x16x32_bf16 v[232:235], a[96:99], a[128:131], v[232:235]
  ds_read_b64_tr_b16 a[50:51], v8 offset:30208
  v_mfma_f32_16x16x32_bf16 v[236:239], a[96:99], a[132:135], v[236:239]
  v_mfma_f32_16x16x32_bf16 v[240:243], a[100:103], a[120:123], v[240:243]
  v_mfma_f32_16x16x32_bf16 v[244:247], a[100:103], a[124:127], v[244:247]
  v_mfma_f32_16x16x32_bf16 v[248:251], a[100:103], a[128:131], v[248:251]
  v_mfma_f32_16x16x32_bf16 v[252:255], a[100:103], a[132:135], v[252:255]
  s_waitcnt vmcnt(2) lgkmcnt(0)
  s_barrier
  v_mfma_f32_16x16x32_bf16 v[48:51], a[0:3], a[104:107], v[48:51]
  ds_read_b64_tr_b16 a[52:53], v4 offset:39936
  v_mfma_f32_16x16x32_bf16 v[52:55], a[0:3], a[108:111], v[52:55]
  ds_read_b64_tr_b16 a[54:55], v4 offset:43264
  v_mfma_f32_16x16x32_bf16 v[56:59], a[0:3], a[112:115], v[56:59]
  v_mfma_f32_16x16x32_bf16 v[60:63], a[0:3], a[116:119], v[60:63]
  ds_read_b64_tr_b16 a[56:57], v5 offset:39936
  v_mfma_f32_16x16x32_bf16 v[64:67], a[4:7], a[104:107], v[64:67]
  v_mfma_f32_16x16x32_bf16 v[68:71], a[4:7], a[108:111], v[68:71]
  ds_read_b64_tr_b16 a[58:59], v5 offset:43264
  v_mfma_f32_16x16x32_bf16 v[72:75], a[4:7], a[112:115], v[72:75]
  v_mfma_f32_16x16x32_bf16 v[76:79], a[4:7], a[116:119], v[76:79]
  ds_read_b64_tr_b16 a[60:61], v6 offset:39936
  v_mfma_f32_16x16x32_bf16 v[80:83], a[8:11], a[104:107], v[80:83]
  v_mfma_f32_16x16x32_bf16 v[84:87], a[8:11], a[108:111], v[84:87]
  ds_read_b64_tr_b16 a[62:63], v6 offset:43264
  v_mfma_f32_16x16x32_bf16 v[88:91], a[8:11], a[112:115], v[88:91]
  v_mfma_f32_16x16x32_bf16 v[92:95], a[8:11], a[116:119], v[92:95]
  ds_read_b64_tr_b16 a[64:65], v7 offset:39936
  v_mfma_f32_16x16x32_bf16 v[96:99], a[12:15], a[104:107], v[96:99]
  ds_read_b64_tr_b16 a[66:67], v7 offset:43264
  v_mfma_f32_16x16x32_bf16 v[100:103], a[12:15], a[108:111], v[100:103]
  v_mfma_f32_16x16x32_bf16 v[104:107], a[12:15], a[112:115], v[104:107]
  ds_read_b64_tr_b16 a[68:69], v8 offset:39936
  v_mfma_f32_16x16x32_bf16 v[108:111], a[12:15], a[116:119], v[108:111]
  v_mfma_f32_16x16x32_bf16 v[112:115], a[16:19], a[104:107], v[112:115]
  ds_read_b64_tr_b16 a[70:71], v8 offset:43264
  v_mfma_f32_16x16x32_bf16 v[116:119], a[16:19], a[108:111], v[116:119]
  v_mfma_f32_16x16x32_bf16 v[120:123], a[16:19], a[112:115], v[120:123]
  ds_read_b64_tr_b16 a[72:73], v8 offset:39968
  v_mfma_f32_16x16x32_bf16 v[124:127], a[16:19], a[116:119], v[124:127]
  v_mfma_f32_16x16x32_bf16 v[128:131], a[20:23], a[104:107], v[128:131]
  ds_read_b64_tr_b16 a[74:75], v8 offset:43296
  v_mfma_f32_16x16x32_bf16 v[132:135], a[20:23], a[108:111], v[132:135]
  v_mfma_f32_16x16x32_bf16 v[136:139], a[20:23], a[112:115], v[136:139]
  ds_read_b64_tr_b16 a[76:77], v8 offset:40000
  v_mfma_f32_16x16x32_bf16 v[140:143], a[20:23], a[116:119], v[140:143]
  v_mfma_f32_16x16x32_bf16 v[144:147], a[24:27], a[104:107], v[144:147]
  ds_read_b64_tr_b16 a[78:79], v8 offset:43328
  v_mfma_f32_16x16x32_bf16 v[148:151], a[24:27], a[108:111], v[148:151]
  ds_read_b64_tr_b16 a[80:81], v8 offset:40032
  v_mfma_f32_16x16x32_bf16 v[152:155], a[24:27], a[112:115], v[152:155]
  v_mfma_f32_16x16x32_bf16 v[156:159], a[24:27], a[116:119], v[156:159]
  ds_read_b64_tr_b16 a[82:83], v8 offset:43360
  v_mfma_f32_16x16x32_bf16 v[160:163], a[28:31], a[104:107], v[160:163]
  v_mfma_f32_16x16x32_bf16 v[164:167], a[28:31], a[108:111], v[164:167]
  ds_read_b64_tr_b16 a[84:85], v8 offset:40064
  v_mfma_f32_16x16x32_bf16 v[168:171], a[28:31], a[112:115], v[168:171]
  v_mfma_f32_16x16x32_bf16 v[172:175], a[28:31], a[116:119], v[172:175]
  ds_read_b64_tr_b16 a[86:87], v8 offset:43392
  v_mfma_f32_16x16x32_bf16 v[176:179], a[32:35], a[104:107], v[176:179]
  v_mfma_f32_16x16x32_bf16 v[180:183], a[32:35], a[108:111], v[180:183]
  ds_read_b64_tr_b16 a[88:89], v8 offset:40096
  v_mfma_f32_16x16x32_bf16 v[184:187], a[32:35], a[112:115], v[184:187]
  v_mfma_f32_16x16x32_bf16 v[188:191], a[32:35], a[116:119], v[188:191]
  ds_read_b64_tr_b16 a[90:91], v8 offset:43424
  v_mfma_f32_16x16x32_bf16 v[192:195], a[36:39], a[104:107], v[192:195]
  ds_read_b64_tr_b16 a[92:93], v8 offset:40128
  v_mfma_f32_16x16x32_bf16 v[196:199], a[36:39], a[108:111], v[196:199]
  v_mfma_f32_16x16x32_bf16 v[200:203], a[36:39], a[112:115], v[200:203]
  ds_read_b64_tr_b16 a[94:95], v8 offset:43456
  v_mfma_f32_16x16x32_bf16 v[204:207], a[36:39], a[116:119], v[204:207]
  v_mfma_f32_16x16x32_bf16 v[208:211], a[40:43], a[104:107], v[208:211]
  ds_read_b64_tr_b16 a[96:97], v8 offset:40160
  v_mfma_f32_16x16x32_bf16 v[212:215], a[40:43], a[108:111], v[212:215]
  v_mfma_f32_16x16x32_bf16 v[216:219], a[40:43], a[112:115], v[216:219]
  ds_read_b64_tr_b16 a[98:99], v8 offset:43488
  v_mfma_f32_16x16x32_bf16 v[220:223], a[40:43], a[116:119], v[220:223]
  v_mfma_f32_16x16x32_bf16 v[224:227], a[44:47], a[104:107], v[224:227]
  ds_read_b64_tr_b16 a[100:101], v8 offset:40192
  v_mfma_f32_16x16x32_bf16 v[228:231], a[44:47], a[108:111], v[228:231]
  v_mfma_f32_16x16x32_bf16 v[232:235], a[44:47], a[112:115], v[232:235]
  ds_read_b64_tr_b16 a[102:103], v8 offset:43520
  v_mfma_f32_16x16x32_bf16 v[236:239], a[44:47], a[116:119], v[236:239]
  v_mfma_f32_16x16x32_bf16 v[240:243], a[48:51], a[104:107], v[240:243]
  v_mfma_f32_16x16x32_bf16 v[244:247], a[48:51], a[108:111], v[244:247]
  v_mfma_f32_16x16x32_bf16 v[248:251], a[48:51], a[112:115], v[248:251]
  v_mfma_f32_16x16x32_bf16 v[252:255], a[48:51], a[116:119], v[252:255]
  s_waitcnt lgkmcnt(0)
  v_mfma_f32_16x16x32_bf16 v[48:51], a[52:55], a[136:139], v[48:51]
  v_dot2_f32_bf16 v42, v26, v18, 0
  v_mfma_f32_16x16x32_bf16 v[52:55], a[52:55], a[140:143], v[52:55]
  v_dot2_f32_bf16 v43, v34, v18, 0
  v_mfma_f32_16x16x32_bf16 v[56:59], a[52:55], a[144:147], v[56:59]
  v_dot2_f32_bf16 v42, v27, v19, v42
  v_mfma_f32_16x16x32_bf16 v[60:63], a[52:55], a[148:151], v[60:63]
  v_dot2_f32_bf16 v43, v35, v19, v43
  v_mfma_f32_16x16x32_bf16 v[64:67], a[56:59], a[136:139], v[64:67]
  v_dot2_f32_bf16 v42, v28, v20, v42
  v_mfma_f32_16x16x32_bf16 v[68:71], a[56:59], a[140:143], v[68:71]
  v_dot2_f32_bf16 v43, v36, v20, v43
  v_mfma_f32_16x16x32_bf16 v[72:75], a[56:59], a[144:147], v[72:75]
  v_dot2_f32_bf16 v42, v29, v21, v42
  v_mfma_f32_16x16x32_bf16 v[76:79], a[56:59], a[148:151], v[76:79]
  v_mfma_f32_16x16x32_bf16 v[80:83], a[60:63], a[136:139], v[80:83]
  v_dot2_f32_bf16 v43, v37, v21, v43
  v_mfma_f32_16x16x32_bf16 v[84:87], a[60:63], a[140:143], v[84:87]
  v_dot2_f32_bf16 v42, v30, v22, v42
  v_mfma_f32_16x16x32_bf16 v[88:91], a[60:63], a[144:147], v[88:91]
  v_dot2_f32_bf16 v43, v38, v22, v43
  v_mfma_f32_16x16x32_bf16 v[92:95], a[60:63], a[148:151], v[92:95]
  v_dot2_f32_bf16 v42, v31, v23, v42
  v_mfma_f32_16x16x32_bf16 v[96:99], a[64:67], a[136:139], v[96:99]
  v_dot2_f32_bf16 v43, v39, v23, v43
  v_mfma_f32_16x16x32_bf16 v[100:103], a[64:67], a[140:143], v[100:103]
  v_dot2_f32_bf16 v42, v32, v24, v42
  v_mfma_f32_16x16x32_bf16 v[104:107], a[64:67], a[144:147], v[104:107]
  v_dot2_f32_bf16 v43, v40, v24, v43
  v_mfma_f32_16x16x32_bf16 v[108:111], a[64:67], a[148:151], v[108:111]
  v_mfma_f32_16x16x32_bf16 v[112:115], a[68:71], a[136:139], v[112:115]
  v_dot2_f32_bf16 v42, v33, v25, v42
  v_mfma_f32_16x16x32_bf16 v[116:119], a[68:71], a[140:143], v[116:119]
  v_dot2_f32_bf16 v43, v41, v25, v43
  v_mfma_f32_16x16x32_bf16 v[120:123], a[68:71], a[144:147], v[120:123]
  s_nop 3
  v_mfma_f32_16x16x32_bf16 v[124:127], a[68:71], a[148:151], v[124:127]
  s_nop 0
  v_add_f32_dpp v42, v42, v42 row_shr:1 row_mask:0xf bank_mask:0xf bound_ctrl:0
  v_mfma_f32_16x16x32_bf16 v[128:131], a[72:75], a[136:139], v[128:131]
  s_nop 0
  v_add_f32_dpp v43, v43, v43 row_shr:1 row_mask:0xf bank_mask:0xf bound_ctrl:0
  v_mfma_f32_16x16x32_bf16 v[132:135], a[72:75], a[140:143], v[132:135]
  s_nop 0
  v_add_f32_dpp v42, v42, v42 row_shr:2 row_mask:0xf bank_mask:0xf bound_ctrl:0
  v_mfma_f32_16x16x32_bf16 v[136:139], a[72:75], a[144:147], v[136:139]
  s_nop 0
  v_add_f32_dpp v43, v43, v43 row_shr:2 row_mask:0xf bank_mask:0xf bound_ctrl:0
  v_mfma_f32_16x16x32_bf16 v[140:143], a[72:75], a[148:151], v[140:143]
  v_mfma_f32_16x16x32_bf16 v[144:147], a[76:79], a[136:139], v[144:147]
  s_nop 0
  v_add_f32_dpp v42, v42, v42 row_shr:4 row_mask:0xf bank_mask:0xf bound_ctrl:0
  v_mfma_f32_16x16x32_bf16 v[148:151], a[76:79], a[140:143], v[148:151]
  s_nop 0
  v_add_f32_dpp v43, v43, v43 row_shr:4 row_mask:0xf bank_mask:0xf bound_ctrl:0
  v_mfma_f32_16x16x32_bf16 v[152:155], a[76:79], a[144:147], v[152:155]
  s_nop 0
  v_add_f32_dpp v42, v42, v42 row_shr:8 row_mask:0xf bank_mask:0xf bound_ctrl:0
  v_mfma_f32_16x16x32_bf16 v[156:159], a[76:79], a[148:151], v[156:159]
  s_nop 0
  v_add_f32_dpp v43, v43, v43 row_shr:8 row_mask:0xf bank_mask:0xf bound_ctrl:0
  v_mfma_f32_16x16x32_bf16 v[160:163], a[80:83], a[136:139], v[160:163]
  s_nop 0
  v_add_f32_dpp v42, v42, v42 row_bcast:15 row_mask:0xa bank_mask:0xf
  v_mfma_f32_16x16x32_bf16 v[164:167], a[80:83], a[140:143], v[164:167]
  s_nop 0
  v_add_f32_dpp v43, v43, v43 row_bcast:15 row_mask:0xa bank_mask:0xf
  v_mfma_f32_16x16x32_bf16 v[168:171], a[80:83], a[144:147], v[168:171]
  s_nop 0
  v_add_f32_dpp v42, v42, v42 row_bcast:31 row_mask:0xc bank_mask:0xf
  v_mfma_f32_16x16x32_bf16 v[172:175], a[80:83], a[148:151], v[172:175]
  v_mfma_f32_16x16x32_bf16 v[176:179], a[84:87], a[136:139], v[176:179]
  s_nop 0
  v_add_f32_dpp v43, v43, v43 row_bcast:31 row_mask:0xc bank_mask:0xf
  v_mfma_f32_16x16x32_bf16 v[180:183], a[84:87], a[140:143], v[180:183]
  v_mul_f32 v42, 0xbfb8aa3b, v42
  v_mfma_f32_16x16x32_bf16 v[184:187], a[84:87], a[144:147], v[184:187]
  v_mul_f32 v43, 0xbfb8aa3b, v43
  v_mfma_f32_16x16x32_bf16 v[188:191], a[84:87], a[148:151], v[188:191]
  v_exp_f32 v42, v42
  v_mfma_f32_16x16x32_bf16 v[192:195], a[88:91], a[136:139], v[192:195]
  v_exp_f32 v43, v43
  s_nop 0
  v_mfma_f32_16x16x32_bf16 v[196:199], a[88:91], a[140:143], v[196:199]
  v_add_f32 v42, 1.0, v42
  v_mfma_f32_16x16x32_bf16 v[200:203], a[88:91], a[144:147], v[200:203]
  v_add_f32 v43, 1.0, v43
  v_mfma_f32_16x16x32_bf16 v[204:207], a[88:91], a[148:151], v[204:207]
  v_mfma_f32_16x16x32_bf16 v[208:211], a[92:95], a[136:139], v[208:211]
  v_rcp_f32 v42, v42
  v_mfma_f32_16x16x32_bf16 v[212:215], a[92:95], a[140:143], v[212:215]
  v_rcp_f32 v43, v43
  v_mfma_f32_16x16x32_bf16 v[216:219], a[92:95], a[144:147], v[216:219]
  v_mov_b32 v18, 0
  v_mfma_f32_16x16x32_bf16 v[220:223], a[92:95], a[148:151], v[220:223]
  s_lshl_b32 s61, s73, 2
  s_add_u32 s61, s61, 20545536
  v_mfma_f32_16x16x32_bf16 v[224:227], a[96:99], a[136:139], v[224:227]
  s_lshl_b32 s63, s2, 8
  s_add_u32 s63, s63, 33136640
  v_mfma_f32_16x16x32_bf16 v[228:231], a[96:99], a[140:143], v[228:231]
  s_mov_b32 s68, 0
  s_mov_b32 s69, 0x80000000
  v_mfma_f32_16x16x32_bf16 v[232:235], a[96:99], a[144:147], v[232:235]
  s_mov_b64 exec, s[68:69]
  buffer_store_dwordx2 v[42:43], v18, s[16:19], s61 offen sc1
  s_mov_b64 exec, -1
  v_mfma_f32_16x16x32_bf16 v[236:239], a[96:99], a[148:151], v[236:239]
  v_mfma_f32_16x16x32_bf16 v[240:243], a[100:103], a[136:139], v[240:243]
  v_mfma_f32_16x16x32_bf16 v[244:247], a[100:103], a[140:143], v[244:247]
  v_mfma_f32_16x16x32_bf16 v[248:251], a[100:103], a[144:147], v[248:251]
  v_mfma_f32_16x16x32_bf16 v[252:255], a[100:103], a[148:151], v[252:255]
  s_barrier
  s_mov_b32 s3, 0
  s_mov_b32 s58, 0x3fb8aa3b
  s_mov_b32 s59, 0x3fb8aa3b
  s_lshl_b32 s60, s25, 1
  s_lshr_b32 s61, s24, 1
  s_add_u32 s60, s60, s61
  s_mul_i32 s72, s60, 1179648
  s_and_b32 s61, s24, 1
  s_lshl_b32 s61, s61, 12
  s_add_u32 s72, s72, s61
  s_nop 7
  s_mul_i32 s62, s26, 57344
  s_add_u32 s62, s62, 24576
  s_add_u32 s62, s62, s72
  v_pk_mul_f32 v[18:19], v[128:129], s[58:59]
  v_pk_mul_f32 v[20:21], v[130:131], s[58:59]
  v_pk_mul_f32 v[22:23], v[144:145], s[58:59]
  v_pk_mul_f32 v[24:25], v[146:147], s[58:59]
  v_exp_f32 v18, v18
  v_exp_f32 v19, v19
  v_exp_f32 v20, v20
  v_exp_f32 v21, v21
  v_exp_f32 v22, v22
  v_exp_f32 v23, v23
  v_exp_f32 v24, v24
  v_exp_f32 v25, v25
  v_pk_fma_f32 v[26:27], v[18:19], 0.5, 1.0 op_sel_hi:[1,0,0]
  v_pk_fma_f32 v[28:29], v[20:21], 0.5, 1.0 op_sel_hi:[1,0,0]
  v_pk_fma_f32 v[30:31], v[22:23], 0.5, 1.0 op_sel_hi:[1,0,0]
  v_pk_fma_f32 v[32:33], v[24:25], 0.5, 1.0 op_sel_hi:[1,0,0]
  v_pk_fma_f32 v[26:27], v[18:19], v[26:27], 1.0 op_sel_hi:[1,1,0]
  v_pk_fma_f32 v[28:29], v[20:21], v[28:29], 1.0 op_sel_hi:[1,1,0]
  v_pk_fma_f32 v[30:31], v[22:23], v[30:31], 1.0 op_sel_hi:[1,1,0]
  v_pk_fma_f32 v[32:33], v[24:25], v[32:33], 1.0 op_sel_hi:[1,1,0]
  v_rcp_f32 v26, v26
  v_rcp_f32 v27, v27
  v_rcp_f32 v28, v28
  v_rcp_f32 v29, v29
  v_rcp_f32 v30, v30
  v_rcp_f32 v31, v31
  v_rcp_f32 v32, v32
  v_rcp_f32 v33, v33
  v_pk_fma_f32 v[128:129], v[26:27], v[128:129], v[128:129] neg_lo:[1,0,0] neg_hi:[1,0,0]
  v_pk_fma_f32 v[130:131], v[28:29], v[130:131], v[130:131] neg_lo:[1,0,0] neg_hi:[1,0,0]
  v_pk_fma_f32 v[144:145], v[30:31], v[144:145], v[144:145] neg_lo:[1,0,0] neg_hi:[1,0,0]
  v_pk_fma_f32 v[146:147], v[32:33], v[146:147], v[146:147] neg_lo:[1,0,0] neg_hi:[1,0,0]
  v_cvt_pk_bf16_f32 v128, v128, v129
  v_cvt_pk_bf16_f32 v129, v130, v131
  v_cvt_pk_bf16_f32 v130, v144, v145
  v_cvt_pk_bf16_f32 v131, v146, v147
  buffer_store_dwordx4 v[128:131], v17, s[16:19], s62 offen offset:0 sc1
  v_pk_mul_f32 v[18:19], v[132:133], s[58:59]
  v_pk_mul_f32 v[20:21], v[134:135], s[58:59]
  v_pk_mul_f32 v[22:23], v[148:149], s[58:59]
  v_pk_mul_f32 v[24:25], v[150:151], s[58:59]
  v_exp_f32 v18, v18
  v_exp_f32 v19, v19
  v_exp_f32 v20, v20
  v_exp_f32 v21, v21
  v_exp_f32 v22, v22
  v_exp_f32 v23, v23
  v_exp_f32 v24, v24
  v_exp_f32 v25, v25
  v_pk_fma_f32 v[26:27], v[18:19], 0.5, 1.0 op_sel_hi:[1,0,0]
  v_pk_fma_f32 v[28:29], v[20:21], 0.5, 1.0 op_sel_hi:[1,0,0]
  v_pk_fma_f32 v[30:31], v[22:23], 0.5, 1.0 op_sel_hi:[1,0,0]
  v_pk_fma_f32 v[32:33], v[24:25], 0.5, 1.0 op_sel_hi:[1,0,0]
  v_pk_fma_f32 v[26:27], v[18:19], v[26:27], 1.0 op_sel_hi:[1,1,0]
  v_pk_fma_f32 v[28:29], v[20:21], v[28:29], 1.0 op_sel_hi:[1,1,0]
  v_pk_fma_f32 v[30:31], v[22:23], v[30:31], 1.0 op_sel_hi:[1,1,0]
  v_pk_fma_f32 v[32:33], v[24:25], v[32:33], 1.0 op_sel_hi:[1,1,0]
  v_rcp_f32 v26, v26
  v_rcp_f32 v27, v27
  v_rcp_f32 v28, v28
  v_rcp_f32 v29, v29
  v_rcp_f32 v30, v30
  v_rcp_f32 v31, v31
  v_rcp_f32 v32, v32
  v_rcp_f32 v33, v33
  v_pk_fma_f32 v[132:133], v[26:27], v[132:133], v[132:133] neg_lo:[1,0,0] neg_hi:[1,0,0]
  v_pk_fma_f32 v[134:135], v[28:29], v[134:135], v[134:135] neg_lo:[1,0,0] neg_hi:[1,0,0]
  v_pk_fma_f32 v[148:149], v[30:31], v[148:149], v[148:149] neg_lo:[1,0,0] neg_hi:[1,0,0]
  v_pk_fma_f32 v[150:151], v[32:33], v[150:151], v[150:151] neg_lo:[1,0,0] neg_hi:[1,0,0]
  v_cvt_pk_bf16_f32 v132, v132, v133
  v_cvt_pk_bf16_f32 v133, v134, v135
  v_cvt_pk_bf16_f32 v134, v148, v149
  v_cvt_pk_bf16_f32 v135, v150, v151
  buffer_store_dwordx4 v[132:135], v17, s[16:19], s62 offen offset:1024 sc1
  v_pk_mul_f32 v[18:19], v[136:137], s[58:59]
  v_pk_mul_f32 v[20:21], v[138:139], s[58:59]
  v_pk_mul_f32 v[22:23], v[152:153], s[58:59]
  v_pk_mul_f32 v[24:25], v[154:155], s[58:59]
  v_exp_f32 v18, v18
  v_exp_f32 v19, v19
  v_exp_f32 v20, v20
  v_exp_f32 v21, v21
  v_exp_f32 v22, v22
  v_exp_f32 v23, v23
  v_exp_f32 v24, v24
  v_exp_f32 v25, v25
  v_pk_fma_f32 v[26:27], v[18:19], 0.5, 1.0 op_sel_hi:[1,0,0]
  v_pk_fma_f32 v[28:29], v[20:21], 0.5, 1.0 op_sel_hi:[1,0,0]
  v_pk_fma_f32 v[30:31], v[22:23], 0.5, 1.0 op_sel_hi:[1,0,0]
  v_pk_fma_f32 v[32:33], v[24:25], 0.5, 1.0 op_sel_hi:[1,0,0]
  v_pk_fma_f32 v[26:27], v[18:19], v[26:27], 1.0 op_sel_hi:[1,1,0]
  v_pk_fma_f32 v[28:29], v[20:21], v[28:29], 1.0 op_sel_hi:[1,1,0]
  v_pk_fma_f32 v[30:31], v[22:23], v[30:31], 1.0 op_sel_hi:[1,1,0]
  v_pk_fma_f32 v[32:33], v[24:25], v[32:33], 1.0 op_sel_hi:[1,1,0]
  v_rcp_f32 v26, v26
  v_rcp_f32 v27, v27
  v_rcp_f32 v28, v28
  v_rcp_f32 v29, v29
  v_rcp_f32 v30, v30
  v_rcp_f32 v31, v31
  v_rcp_f32 v32, v32
  v_rcp_f32 v33, v33
  v_pk_fma_f32 v[136:137], v[26:27], v[136:137], v[136:137] neg_lo:[1,0,0] neg_hi:[1,0,0]
  v_pk_fma_f32 v[138:139], v[28:29], v[138:139], v[138:139] neg_lo:[1,0,0] neg_hi:[1,0,0]
  v_pk_fma_f32 v[152:153], v[30:31], v[152:153], v[152:153] neg_lo:[1,0,0] neg_hi:[1,0,0]
  v_pk_fma_f32 v[154:155], v[32:33], v[154:155], v[154:155] neg_lo:[1,0,0] neg_hi:[1,0,0]
  v_cvt_pk_bf16_f32 v136, v136, v137
  v_cvt_pk_bf16_f32 v137, v138, v139
  v_cvt_pk_bf16_f32 v138, v152, v153
  v_cvt_pk_bf16_f32 v139, v154, v155
  buffer_store_dwordx4 v[136:139], v17, s[16:19], s62 offen offset:2048 sc1
  v_pk_mul_f32 v[18:19], v[140:141], s[58:59]
  v_pk_mul_f32 v[20:21], v[142:143], s[58:59]
  v_pk_mul_f32 v[22:23], v[156:157], s[58:59]
  v_pk_mul_f32 v[24:25], v[158:159], s[58:59]
  v_exp_f32 v18, v18
  v_exp_f32 v19, v19
  v_exp_f32 v20, v20
  v_exp_f32 v21, v21
  v_exp_f32 v22, v22
  v_exp_f32 v23, v23
  v_exp_f32 v24, v24
  v_exp_f32 v25, v25
  v_pk_fma_f32 v[26:27], v[18:19], 0.5, 1.0 op_sel_hi:[1,0,0]
  v_pk_fma_f32 v[28:29], v[20:21], 0.5, 1.0 op_sel_hi:[1,0,0]
  v_pk_fma_f32 v[30:31], v[22:23], 0.5, 1.0 op_sel_hi:[1,0,0]
  v_pk_fma_f32 v[32:33], v[24:25], 0.5, 1.0 op_sel_hi:[1,0,0]
  v_pk_fma_f32 v[26:27], v[18:19], v[26:27], 1.0 op_sel_hi:[1,1,0]
  v_pk_fma_f32 v[28:29], v[20:21], v[28:29], 1.0 op_sel_hi:[1,1,0]
  v_pk_fma_f32 v[30:31], v[22:23], v[30:31], 1.0 op_sel_hi:[1,1,0]
  v_pk_fma_f32 v[32:33], v[24:25], v[32:33], 1.0 op_sel_hi:[1,1,0]
  v_rcp_f32 v26, v26
  v_rcp_f32 v27, v27
  v_rcp_f32 v28, v28
  v_rcp_f32 v29, v29
  v_rcp_f32 v30, v30
  v_rcp_f32 v31, v31
  v_rcp_f32 v32, v32
  v_rcp_f32 v33, v33
  v_pk_fma_f32 v[140:141], v[26:27], v[140:141], v[140:141] neg_lo:[1,0,0] neg_hi:[1,0,0]
  v_pk_fma_f32 v[142:143], v[28:29], v[142:143], v[142:143] neg_lo:[1,0,0] neg_hi:[1,0,0]
  v_pk_fma_f32 v[156:157], v[30:31], v[156:157], v[156:157] neg_lo:[1,0,0] neg_hi:[1,0,0]
  v_pk_fma_f32 v[158:159], v[32:33], v[158:159], v[158:159] neg_lo:[1,0,0] neg_hi:[1,0,0]
  v_cvt_pk_bf16_f32 v140, v140, v141
  v_cvt_pk_bf16_f32 v141, v142, v143
  v_cvt_pk_bf16_f32 v142, v156, v157
  v_cvt_pk_bf16_f32 v143, v158, v159
  buffer_store_dwordx4 v[140:143], v17, s[16:19], s62 offen offset:3072 sc1
  s_mul_i32 s62, s26, 57344
  s_add_u32 s62, s62, 32768
  s_add_u32 s62, s62, s72
  v_pk_mul_f32 v[18:19], v[160:161], s[58:59]
  v_pk_mul_f32 v[20:21], v[162:163], s[58:59]
  v_pk_mul_f32 v[22:23], v[176:177], s[58:59]
  v_pk_mul_f32 v[24:25], v[178:179], s[58:59]
  v_exp_f32 v18, v18
  v_exp_f32 v19, v19
  v_exp_f32 v20, v20
  v_exp_f32 v21, v21
  v_exp_f32 v22, v22
  v_exp_f32 v23, v23
  v_exp_f32 v24, v24
  v_exp_f32 v25, v25
  v_pk_fma_f32 v[26:27], v[18:19], 0.5, 1.0 op_sel_hi:[1,0,0]
  v_pk_fma_f32 v[28:29], v[20:21], 0.5, 1.0 op_sel_hi:[1,0,0]
  v_pk_fma_f32 v[30:31], v[22:23], 0.5, 1.0 op_sel_hi:[1,0,0]
  v_pk_fma_f32 v[32:33], v[24:25], 0.5, 1.0 op_sel_hi:[1,0,0]
  v_pk_fma_f32 v[26:27], v[18:19], v[26:27], 1.0 op_sel_hi:[1,1,0]
  v_pk_fma_f32 v[28:29], v[20:21], v[28:29], 1.0 op_sel_hi:[1,1,0]
  v_pk_fma_f32 v[30:31], v[22:23], v[30:31], 1.0 op_sel_hi:[1,1,0]
  v_pk_fma_f32 v[32:33], v[24:25], v[32:33], 1.0 op_sel_hi:[1,1,0]
  v_rcp_f32 v26, v26
  v_rcp_f32 v27, v27
  v_rcp_f32 v28, v28
  v_rcp_f32 v29, v29
  v_rcp_f32 v30, v30
  v_rcp_f32 v31, v31
  v_rcp_f32 v32, v32
  v_rcp_f32 v33, v33
  v_pk_fma_f32 v[160:161], v[26:27], v[160:161], v[160:161] neg_lo:[1,0,0] neg_hi:[1,0,0]
  v_pk_fma_f32 v[162:163], v[28:29], v[162:163], v[162:163] neg_lo:[1,0,0] neg_hi:[1,0,0]
  v_pk_fma_f32 v[176:177], v[30:31], v[176:177], v[176:177] neg_lo:[1,0,0] neg_hi:[1,0,0]
  v_pk_fma_f32 v[178:179], v[32:33], v[178:179], v[178:179] neg_lo:[1,0,0] neg_hi:[1,0,0]
  v_cvt_pk_bf16_f32 v160, v160, v161
  v_cvt_pk_bf16_f32 v161, v162, v163
  v_cvt_pk_bf16_f32 v162, v176, v177
  v_cvt_pk_bf16_f32 v163, v178, v179
  buffer_store_dwordx4 v[160:163], v17, s[16:19], s62 offen offset:0 sc1
  v_pk_mul_f32 v[18:19], v[164:165], s[58:59]
  v_pk_mul_f32 v[20:21], v[166:167], s[58:59]
  v_pk_mul_f32 v[22:23], v[180:181], s[58:59]
  v_pk_mul_f32 v[24:25], v[182:183], s[58:59]
  v_exp_f32 v18, v18
  v_exp_f32 v19, v19
  v_exp_f32 v20, v20
  v_exp_f32 v21, v21
  v_exp_f32 v22, v22
  v_exp_f32 v23, v23
  v_exp_f32 v24, v24
  v_exp_f32 v25, v25
  v_pk_fma_f32 v[26:27], v[18:19], 0.5, 1.0 op_sel_hi:[1,0,0]
  v_pk_fma_f32 v[28:29], v[20:21], 0.5, 1.0 op_sel_hi:[1,0,0]
  v_pk_fma_f32 v[30:31], v[22:23], 0.5, 1.0 op_sel_hi:[1,0,0]
  v_pk_fma_f32 v[32:33], v[24:25], 0.5, 1.0 op_sel_hi:[1,0,0]
  v_pk_fma_f32 v[26:27], v[18:19], v[26:27], 1.0 op_sel_hi:[1,1,0]
  v_pk_fma_f32 v[28:29], v[20:21], v[28:29], 1.0 op_sel_hi:[1,1,0]
  v_pk_fma_f32 v[30:31], v[22:23], v[30:31], 1.0 op_sel_hi:[1,1,0]
  v_pk_fma_f32 v[32:33], v[24:25], v[32:33], 1.0 op_sel_hi:[1,1,0]
  v_rcp_f32 v26, v26
  v_rcp_f32 v27, v27
  v_rcp_f32 v28, v28
  v_rcp_f32 v29, v29
  v_rcp_f32 v30, v30
  v_rcp_f32 v31, v31
  v_rcp_f32 v32, v32
  v_rcp_f32 v33, v33
  v_pk_fma_f32 v[164:165], v[26:27], v[164:165], v[164:165] neg_lo:[1,0,0] neg_hi:[1,0,0]
  v_pk_fma_f32 v[166:167], v[28:29], v[166:167], v[166:167] neg_lo:[1,0,0] neg_hi:[1,0,0]
  v_pk_fma_f32 v[180:181], v[30:31], v[180:181], v[180:181] neg_lo:[1,0,0] neg_hi:[1,0,0]
  v_pk_fma_f32 v[182:183], v[32:33], v[182:183], v[182:183] neg_lo:[1,0,0] neg_hi:[1,0,0]
  v_cvt_pk_bf16_f32 v164, v164, v165
  v_cvt_pk_bf16_f32 v165, v166, v167
  v_cvt_pk_bf16_f32 v166, v180, v181
  v_cvt_pk_bf16_f32 v167, v182, v183
  buffer_store_dwordx4 v[164:167], v17, s[16:19], s62 offen offset:1024 sc1
  v_pk_mul_f32 v[18:19], v[168:169], s[58:59]
  v_pk_mul_f32 v[20:21], v[170:171], s[58:59]
  v_pk_mul_f32 v[22:23], v[184:185], s[58:59]
  v_pk_mul_f32 v[24:25], v[186:187], s[58:59]
  v_exp_f32 v18, v18
  v_exp_f32 v19, v19
  v_exp_f32 v20, v20
  v_exp_f32 v21, v21
  v_exp_f32 v22, v22
  v_exp_f32 v23, v23
  v_exp_f32 v24, v24
  v_exp_f32 v25, v25
  v_pk_fma_f32 v[26:27], v[18:19], 0.5, 1.0 op_sel_hi:[1,0,0]
  v_pk_fma_f32 v[28:29], v[20:21], 0.5, 1.0 op_sel_hi:[1,0,0]
  v_pk_fma_f32 v[30:31], v[22:23], 0.5, 1.0 op_sel_hi:[1,0,0]
  v_pk_fma_f32 v[32:33], v[24:25], 0.5, 1.0 op_sel_hi:[1,0,0]
  v_pk_fma_f32 v[26:27], v[18:19], v[26:27], 1.0 op_sel_hi:[1,1,0]
  v_pk_fma_f32 v[28:29], v[20:21], v[28:29], 1.0 op_sel_hi:[1,1,0]
  v_pk_fma_f32 v[30:31], v[22:23], v[30:31], 1.0 op_sel_hi:[1,1,0]
  v_pk_fma_f32 v[32:33], v[24:25], v[32:33], 1.0 op_sel_hi:[1,1,0]
  v_rcp_f32 v26, v26
  v_rcp_f32 v27, v27
  v_rcp_f32 v28, v28
  v_rcp_f32 v29, v29
  v_rcp_f32 v30, v30
  v_rcp_f32 v31, v31
  v_rcp_f32 v32, v32
  v_rcp_f32 v33, v33
  v_pk_fma_f32 v[168:169], v[26:27], v[168:169], v[168:169] neg_lo:[1,0,0] neg_hi:[1,0,0]
  v_pk_fma_f32 v[170:171], v[28:29], v[170:171], v[170:171] neg_lo:[1,0,0] neg_hi:[1,0,0]
  v_pk_fma_f32 v[184:185], v[30:31], v[184:185], v[184:185] neg_lo:[1,0,0] neg_hi:[1,0,0]
  v_pk_fma_f32 v[186:187], v[32:33], v[186:187], v[186:187] neg_lo:[1,0,0] neg_hi:[1,0,0]
  v_cvt_pk_bf16_f32 v168, v168, v169
  v_cvt_pk_bf16_f32 v169, v170, v171
  v_cvt_pk_bf16_f32 v170, v184, v185
  v_cvt_pk_bf16_f32 v171, v186, v187
  buffer_store_dwordx4 v[168:171], v17, s[16:19], s62 offen offset:2048 sc1
  v_pk_mul_f32 v[18:19], v[172:173], s[58:59]
  v_pk_mul_f32 v[20:21], v[174:175], s[58:59]
  v_pk_mul_f32 v[22:23], v[188:189], s[58:59]
  v_pk_mul_f32 v[24:25], v[190:191], s[58:59]
  v_exp_f32 v18, v18
  v_exp_f32 v19, v19
  v_exp_f32 v20, v20
  v_exp_f32 v21, v21
  v_exp_f32 v22, v22
  v_exp_f32 v23, v23
  v_exp_f32 v24, v24
  v_exp_f32 v25, v25
  v_pk_fma_f32 v[26:27], v[18:19], 0.5, 1.0 op_sel_hi:[1,0,0]
  v_pk_fma_f32 v[28:29], v[20:21], 0.5, 1.0 op_sel_hi:[1,0,0]
  v_pk_fma_f32 v[30:31], v[22:23], 0.5, 1.0 op_sel_hi:[1,0,0]
  v_pk_fma_f32 v[32:33], v[24:25], 0.5, 1.0 op_sel_hi:[1,0,0]
  v_pk_fma_f32 v[26:27], v[18:19], v[26:27], 1.0 op_sel_hi:[1,1,0]
  v_pk_fma_f32 v[28:29], v[20:21], v[28:29], 1.0 op_sel_hi:[1,1,0]
  v_pk_fma_f32 v[30:31], v[22:23], v[30:31], 1.0 op_sel_hi:[1,1,0]
  v_pk_fma_f32 v[32:33], v[24:25], v[32:33], 1.0 op_sel_hi:[1,1,0]
  v_rcp_f32 v26, v26
  v_rcp_f32 v27, v27
  v_rcp_f32 v28, v28
  v_rcp_f32 v29, v29
  v_rcp_f32 v30, v30
  v_rcp_f32 v31, v31
  v_rcp_f32 v32, v32
  v_rcp_f32 v33, v33
  v_pk_fma_f32 v[172:173], v[26:27], v[172:173], v[172:173] neg_lo:[1,0,0] neg_hi:[1,0,0]
  v_pk_fma_f32 v[174:175], v[28:29], v[174:175], v[174:175] neg_lo:[1,0,0] neg_hi:[1,0,0]
  v_pk_fma_f32 v[188:189], v[30:31], v[188:189], v[188:189] neg_lo:[1,0,0] neg_hi:[1,0,0]
  v_pk_fma_f32 v[190:191], v[32:33], v[190:191], v[190:191] neg_lo:[1,0,0] neg_hi:[1,0,0]
  v_cvt_pk_bf16_f32 v172, v172, v173
  v_cvt_pk_bf16_f32 v173, v174, v175
  v_cvt_pk_bf16_f32 v174, v188, v189
  v_cvt_pk_bf16_f32 v175, v190, v191
  buffer_store_dwordx4 v[172:175], v17, s[16:19], s62 offen offset:3072 sc1
  s_and_b32 s60, s2, 7
  s_lshr_b32 s61, s2, 3
  s_and_b32 s10, s60, 1
  s_lshr_b32 s60, s60, 1
  s_and_b32 s8, s60, 1
  s_lshl_b32 s8, s8, 3
  s_and_b32 s11, s61, 7
  s_add_u32 s8, s8, s11
  s_lshr_b32 s9, s60, 1
  s_lshl_b32 s9, s9, 2
  s_lshr_b32 s61, s61, 3
  s_add_u32 s9, s9, s61
  s_lshl_b32 s11, s8, 3
  s_add_u32 s11, s11, s9
  v_and_b32 v6, 15, v1
  v_lshrrev_b32 v7, 4, v1
  s_lshl_b32 s15, s24, 12
  s_add_u32 s27, s15, 16384
  s_lshl_b32 s60, s9, 8
  s_and_b32 s63, s24, 1
  s_lshl_b32 s61, s63, 15
  s_add_u32 s60, s60, s61
  v_lshlrev_b32 v8, 11, v7
  v_add_u32 v8, s60, v8
  v_lshlrev_b32 v9, 1, v7
  v_xor_b32 v9, v9, v6
  v_lshlrev_b32 v10, 4, v9
  v_add_u32 v10, v10, v8
  v_add_u32 v2, 0, v10
  v_xor_b32 v10, 8, v9
  v_lshlrev_b32 v10, 4, v10
  v_add_u32 v10, v10, v8
  v_add_u32 v3, 7168, v10
  v_lshlrev_b32 v10, 4, v9
  v_add_u32 v10, v10, v8
  v_add_u32 v4, 14336, v10
  v_xor_b32 v10, 8, v9
  v_lshlrev_b32 v10, 4, v10
  v_add_u32 v10, v10, v8
  v_add_u32 v5, 21504, v10
  s_mul_i32 s60, s10, 3
  s_lshr_b32 s61, s24, 1
  s_add_u32 s60, s60, s61
  s_lshl_b32 s13, s60, 16
  s_mul_i32 s12, s8, 144
  s_add_u32 s12, s12, s60
  s_lshl_b32 s12, s12, 13
  s_mov_b32 s31, 57344
  s_mov_b32 s32, 458752
  s_lshl_b32 s63, s63, 12
  v_add_u32 v8, s63, v17
  s_lshl_b32 s60, s8, 1
  s_add_u32 s60, s60, s10
  s_lshl_b32 s60, s60, 8
  s_add_u32 s60, s60, 33202176
  v_and_b32 v9, 31, v1
  v_lshlrev_b32 v9, 3, v9
  v_add_u32 v9, s60, v9
  s_mov_b32 s64, s54
  s_and_b32 s65, s55, 0xffff
  s_mov_b32 s66, 256
  s_mov_b32 s67, 0x20000
  v_mov_b32 v12, 0
  buffer_load_dwordx2 v[14:15], v12, s[64:67], 0 offen sc1
  s_add_u32 m0, s27, 0
  s_nop 0
  buffer_load_dwordx4 v2, s[96:99], s13 offen offset:0 lds
  buffer_load_dwordx4 v3, s[96:99], s13 offen offset:1024 lds
  buffer_load_dwordx4 v4, s[96:99], s13 offen offset:2048 lds
  buffer_load_dwordx4 v5, s[96:99], s13 offen offset:3072 lds
  s_add_u32 s13, s13, s32
  s_add_u32 m0, s27, 32768
  s_nop 0
  buffer_load_dwordx4 v2, s[96:99], s13 offen offset:0 lds
  buffer_load_dwordx4 v3, s[96:99], s13 offen offset:1024 lds
  buffer_load_dwordx4 v4, s[96:99], s13 offen offset:2048 lds
  buffer_load_dwordx4 v5, s[96:99], s13 offen offset:3072 lds
  s_add_u32 s13, s13, s32
  s_add_u32 m0, s27, 65536
  s_nop 0
  buffer_load_dwordx4 v2, s[96:99], s13 offen offset:0 lds
  buffer_load_dwordx4 v3, s[96:99], s13 offen offset:1024 lds
  buffer_load_dwordx4 v4, s[96:99], s13 offen offset:2048 lds
  buffer_load_dwordx4 v5, s[96:99], s13 offen offset:3072 lds
  s_add_u32 s13, s13, s32
  s_mul_i32 s62, s26, 16384
  s_add_u32 s62, s62, 917504
  s_add_u32 s62, s62, s72
  v_pk_mul_f32 v[18:19], v[48:49], s[58:59]
  v_pk_mul_f32 v[20:21], v[50:51], s[58:59]
  v_pk_mul_f32 v[22:23], v[64:65], s[58:59]
  v_pk_mul_f32 v[24:25], v[66:67], s[58:59]
  v_exp_f32_e64 v18, v18 clamp
  v_exp_f32_e64 v19, v19 clamp
  v_exp_f32_e64 v20, v20 clamp
  v_exp_f32_e64 v21, v21 clamp
  v_exp_f32_e64 v22, v22 clamp
  v_exp_f32_e64 v23, v23 clamp
  v_exp_f32_e64 v24, v24 clamp
  v_exp_f32_e64 v25, v25 clamp
  v_max_f32 v48, 0x358637bd, v48
  v_max_f32 v49, 0x358637bd, v49
  v_max_f32 v50, 0x358637bd, v50
  v_max_f32 v51, 0x358637bd, v51
  v_max_f32 v64, 0x358637bd, v64
  v_max_f32 v65, 0x358637bd, v65
  v_max_f32 v66, 0x358637bd, v66
  v_max_f32 v67, 0x358637bd, v67
  v_pk_add_f32 v[48:49], v[48:49], v[18:19]
  v_pk_add_f32 v[50:51], v[50:51], v[20:21]
  v_pk_add_f32 v[64:65], v[64:65], v[22:23]
  v_pk_add_f32 v[66:67], v[66:67], v[24:25]
  v_cvt_pk_bf16_f32 v48, v48, v49
  v_cvt_pk_bf16_f32 v49, v50, v51
  v_cvt_pk_bf16_f32 v50, v64, v65
  v_cvt_pk_bf16_f32 v51, v66, v67
  buffer_store_dwordx4 v[48:51], v17, s[16:19], s62 offen offset:0 sc1
  v_pk_mul_f32 v[18:19], v[52:53], s[58:59]
  v_pk_mul_f32 v[20:21], v[54:55], s[58:59]
  v_pk_mul_f32 v[22:23], v[68:69], s[58:59]
  v_pk_mul_f32 v[24:25], v[70:71], s[58:59]
  v_exp_f32_e64 v18, v18 clamp
  v_exp_f32_e64 v19, v19 clamp
  v_exp_f32_e64 v20, v20 clamp
  v_exp_f32_e64 v21, v21 clamp
  v_exp_f32_e64 v22, v22 clamp
  v_exp_f32_e64 v23, v23 clamp
  v_exp_f32_e64 v24, v24 clamp
  v_exp_f32_e64 v25, v25 clamp
  v_max_f32 v52, 0x358637bd, v52
  v_max_f32 v53, 0x358637bd, v53
  v_max_f32 v54, 0x358637bd, v54
  v_max_f32 v55, 0x358637bd, v55
  v_max_f32 v68, 0x358637bd, v68
  v_max_f32 v69, 0x358637bd, v69
  v_max_f32 v70, 0x358637bd, v70
  v_max_f32 v71, 0x358637bd, v71
  v_pk_add_f32 v[52:53], v[52:53], v[18:19]
  v_pk_add_f32 v[54:55], v[54:55], v[20:21]
  v_pk_add_f32 v[68:69], v[68:69], v[22:23]
  v_pk_add_f32 v[70:71], v[70:71], v[24:25]
  v_cvt_pk_bf16_f32 v52, v52, v53
  v_cvt_pk_bf16_f32 v53, v54, v55
  v_cvt_pk_bf16_f32 v54, v68, v69
  v_cvt_pk_bf16_f32 v55, v70, v71
  buffer_store_dwordx4 v[52:55], v17, s[16:19], s62 offen offset:1024 sc1
  s_waitcnt vmcnt(14)
L_k1B_tw:
  v_readfirstlane_b32 s60, v15
  v_readfirstlane_b32 s61, v14
  s_nop 3
  s_min_u32 s60, s60, s61
  s_cmp_lg_u32 s60, 0
  s_cbranch_scc1 L_k1B_tok
  s_add_u32 s3, s3, 1
  s_cmp_gt_u32 s3, 0x40000
  s_cbranch_scc1 L_k1B_tok
  s_sleep 4
  buffer_load_dwordx2 v[14:15], v12, s[64:67], 0 offen sc1
  s_waitcnt vmcnt(0)
  s_branch L_k1B_tw
L_k1B_tok:
  s_mov_b64 exec, 1
  buffer_store_dwordx2 v[14:15], v0, s[16:19], 0 offen sc1
  s_mov_b64 exec, -1
  v_pk_mul_f32 v[18:19], v[56:57], s[58:59]
  v_pk_mul_f32 v[20:21], v[58:59], s[58:59]
  v_pk_mul_f32 v[22:23], v[72:73], s[58:59]
  v_pk_mul_f32 v[24:25], v[74:75], s[58:59]
  v_exp_f32_e64 v18, v18 clamp
  v_exp_f32_e64 v19, v19 clamp
  v_exp_f32_e64 v20, v20 clamp
  v_exp_f32_e64 v21, v21 clamp
  v_exp_f32_e64 v22, v22 clamp
  v_exp_f32_e64 v23, v23 clamp
  v_exp_f32_e64 v24, v24 clamp
  v_exp_f32_e64 v25, v25 clamp
  v_max_f32 v56, 0x358637bd, v56
  v_max_f32 v57, 0x358637bd, v57
  v_max_f32 v58, 0x358637bd, v58
  v_max_f32 v59, 0x358637bd, v59
  v_max_f32 v72, 0x358637bd, v72
  v_max_f32 v73, 0x358637bd, v73
  v_max_f32 v74, 0x358637bd, v74
  v_max_f32 v75, 0x358637bd, v75
  v_pk_add_f32 v[56:57], v[56:57], v[18:19]
  v_pk_add_f32 v[58:59], v[58:59], v[20:21]
  v_pk_add_f32 v[72:73], v[72:73], v[22:23]
  v_pk_add_f32 v[74:75], v[74:75], v[24:25]
  v_cvt_pk_bf16_f32 v56, v56, v57
  v_cvt_pk_bf16_f32 v57, v58, v59
  v_cvt_pk_bf16_f32 v58, v72, v73
  v_cvt_pk_bf16_f32 v59, v74, v75
  buffer_store_dwordx4 v[56:59], v17, s[16:19], s62 offen offset:2048 sc1
  v_pk_mul_f32 v[18:19], v[60:61], s[58:59]
  v_pk_mul_f32 v[20:21], v[62:63], s[58:59]
  v_pk_mul_f32 v[22:23], v[76:77], s[58:59]
  v_pk_mul_f32 v[24:25], v[78:79], s[58:59]
  v_exp_f32_e64 v18, v18 clamp
  v_exp_f32_e64 v19, v19 clamp
  v_exp_f32_e64 v20, v20 clamp
  v_exp_f32_e64 v21, v21 clamp
  v_exp_f32_e64 v22, v22 clamp
  v_exp_f32_e64 v23, v23 clamp
  v_exp_f32_e64 v24, v24 clamp
  v_exp_f32_e64 v25, v25 clamp
  v_max_f32 v60, 0x358637bd, v60
  v_max_f32 v61, 0x358637bd, v61
  v_max_f32 v62, 0x358637bd, v62
  v_max_f32 v63, 0x358637bd, v63
  v_max_f32 v76, 0x358637bd, v76
  v_max_f32 v77, 0x358637bd, v77
  v_max_f32 v78, 0x358637bd, v78
  v_max_f32 v79, 0x358637bd, v79
  v_pk_add_f32 v[60:61], v[60:61], v[18:19]
  v_pk_add_f32 v[62:63], v[62:63], v[20:21]
  v_pk_add_f32 v[76:77], v[76:77], v[22:23]
  v_pk_add_f32 v[78:79], v[78:79], v[24:25]
  v_cvt_pk_bf16_f32 v60, v60, v61
  v_cvt_pk_bf16_f32 v61, v62, v63
  v_cvt_pk_bf16_f32 v62, v76, v77
  v_cvt_pk_bf16_f32 v63, v78, v79
  buffer_store_dwordx4 v[60:63], v17, s[16:19], s62 offen offset:3072 sc1
  s_mul_i32 s62, s26, 16384
  s_add_u32 s62, s62, 925696
  s_add_u32 s62, s62, s72
  v_pk_mul_f32 v[18:19], v[80:81], s[58:59]
  v_pk_mul_f32 v[20:21], v[82:83], s[58:59]
  v_pk_mul_f32 v[22:23], v[96:97], s[58:59]
  v_pk_mul_f32 v[24:25], v[98:99], s[58:59]
  v_exp_f32_e64 v18, v18 clamp
  v_exp_f32_e64 v19, v19 clamp
  v_exp_f32_e64 v20, v20 clamp
  v_exp_f32_e64 v21, v21 clamp
  v_exp_f32_e64 v22, v22 clamp
  v_exp_f32_e64 v23, v23 clamp
  v_exp_f32_e64 v24, v24 clamp
  v_exp_f32_e64 v25, v25 clamp
  v_max_f32 v80, 0x358637bd, v80
  v_max_f32 v81, 0x358637bd, v81
  v_max_f32 v82, 0x358637bd, v82
  v_max_f32 v83, 0x358637bd, v83
  v_max_f32 v96, 0x358637bd, v96
  v_max_f32 v97, 0x358637bd, v97
  v_max_f32 v98, 0x358637bd, v98
  v_max_f32 v99, 0x358637bd, v99
  v_pk_add_f32 v[80:81], v[80:81], v[18:19]
  v_pk_add_f32 v[82:83], v[82:83], v[20:21]
  v_pk_add_f32 v[96:97], v[96:97], v[22:23]
  v_pk_add_f32 v[98:99], v[98:99], v[24:25]
  v_cvt_pk_bf16_f32 v80, v80, v81
  v_cvt_pk_bf16_f32 v81, v82, v83
  v_cvt_pk_bf16_f32 v82, v96, v97
  v_cvt_pk_bf16_f32 v83, v98, v99
  buffer_store_dwordx4 v[80:83], v17, s[16:19], s62 offen offset:0 sc1
  v_pk_mul_f32 v[18:19], v[84:85], s[58:59]
  v_pk_mul_f32 v[20:21], v[86:87], s[58:59]
  v_pk_mul_f32 v[22:23], v[100:101], s[58:59]
  v_pk_mul_f32 v[24:25], v[102:103], s[58:59]
  v_exp_f32_e64 v18, v18 clamp
  v_exp_f32_e64 v19, v19 clamp
  v_exp_f32_e64 v20, v20 clamp
  v_exp_f32_e64 v21, v21 clamp
  v_exp_f32_e64 v22, v22 clamp
  v_exp_f32_e64 v23, v23 clamp
  v_exp_f32_e64 v24, v24 clamp
  v_exp_f32_e64 v25, v25 clamp
  v_max_f32 v84, 0x358637bd, v84
  v_max_f32 v85, 0x358637bd, v85
  v_max_f32 v86, 0x358637bd, v86
  v_max_f32 v87, 0x358637bd, v87
  v_max_f32 v100, 0x358637bd, v100
  v_max_f32 v101, 0x358637bd, v101
  v_max_f32 v102, 0x358637bd, v102
  v_max_f32 v103, 0x358637bd, v103
  v_pk_add_f32 v[84:85], v[84:85], v[18:19]
  v_pk_add_f32 v[86:87], v[86:87], v[20:21]
  v_pk_add_f32 v[100:101], v[100:101], v[22:23]
  v_pk_add_f32 v[102:103], v[102:103], v[24:25]
  v_cvt_pk_bf16_f32 v84, v84, v85
  v_cvt_pk_bf16_f32 v85, v86, v87
  v_cvt_pk_bf16_f32 v86, v100, v101
  v_cvt_pk_bf16_f32 v87, v102, v103
  buffer_store_dwordx4 v[84:87], v17, s[16:19], s62 offen offset:1024 sc1
  v_pk_mul_f32 v[18:19], v[88:89], s[58:59]
  v_pk_mul_f32 v[20:21], v[90:91], s[58:59]
  v_pk_mul_f32 v[22:23], v[104:105], s[58:59]
  v_pk_mul_f32 v[24:25], v[106:107], s[58:59]
  v_exp_f32_e64 v18, v18 clamp
  v_exp_f32_e64 v19, v19 clamp
  v_exp_f32_e64 v20, v20 clamp
  v_exp_f32_e64 v21, v21 clamp
  v_exp_f32_e64 v22, v22 clamp
  v_exp_f32_e64 v23, v23 clamp
  v_exp_f32_e64 v24, v24 clamp
  v_exp_f32_e64 v25, v25 clamp
  v_max_f32 v88, 0x358637bd, v88
  v_max_f32 v89, 0x358637bd, v89
  v_max_f32 v90, 0x358637bd, v90
  v_max_f32 v91, 0x358637bd, v91
  v_max_f32 v104, 0x358637bd, v104
  v_max_f32 v105, 0x358637bd, v105
  v_max_f32 v106, 0x358637bd, v106
  v_max_f32 v107, 0x358637bd, v107
  v_pk_add_f32 v[88:89], v[88:89], v[18:19]
  v_pk_add_f32 v[90:91], v[90:91], v[20:21]
  v_pk_add_f32 v[104:105], v[104:105], v[22:23]
  v_pk_add_f32 v[106:107], v[106:107], v[24:25]
  v_cvt_pk_bf16_f32 v88, v88, v89
  v_cvt_pk_bf16_f32 v89, v90, v91
  v_cvt_pk_bf16_f32 v90, v104, v105
  v_cvt_pk_bf16_f32 v91, v106, v107
  buffer_store_dwordx4 v[88:91], v17, s[16:19], s62 offen offset:2048 sc1
  v_pk_mul_f32 v[18:19], v[92:93], s[58:59]
  v_pk_mul_f32 v[20:21], v[94:95], s[58:59]
  v_pk_mul_f32 v[22:23], v[108:109], s[58:59]
  v_pk_mul_f32 v[24:25], v[110:111], s[58:59]
  v_exp_f32_e64 v18, v18 clamp
  v_exp_f32_e64 v19, v19 clamp
  v_exp_f32_e64 v20, v20 clamp
  v_exp_f32_e64 v21, v21 clamp
  v_exp_f32_e64 v22, v22 clamp
  v_exp_f32_e64 v23, v23 clamp
  v_exp_f32_e64 v24, v24 clamp
  v_exp_f32_e64 v25, v25 clamp
  v_max_f32 v92, 0x358637bd, v92
  v_max_f32 v93, 0x358637bd, v93
  v_max_f32 v94, 0x358637bd, v94
  v_max_f32 v95, 0x358637bd, v95
  v_max_f32 v108, 0x358637bd, v108
  v_max_f32 v109, 0x358637bd, v109
  v_max_f32 v110, 0x358637bd, v110
  v_max_f32 v111, 0x358637bd, v111
  v_pk_add_f32 v[92:93], v[92:93], v[18:19]
  v_pk_add_f32 v[94:95], v[94:95], v[20:21]
  v_pk_add_f32 v[108:109], v[108:109], v[22:23]
  v_pk_add_f32 v[110:111], v[110:111], v[24:25]
  v_cvt_pk_bf16_f32 v92, v92, v93
  v_cvt_pk_bf16_f32 v93, v94, v95
  v_cvt_pk_bf16_f32 v94, v108, v109
  v_cvt_pk_bf16_f32 v95, v110, v111
  buffer_store_dwordx4 v[92:95], v17, s[16:19], s62 offen offset:3072 sc1
  s_mul_i32 s4, s26, 57344
  s_add_u32 s4, s4, 40960
  s_add_u32 s4, s4, s72
  v_pk_mul_f32 v[18:19], v[192:193], s[58:59]
  v_pk_mul_f32 v[20:21], v[194:195], s[58:59]
  v_pk_mul_f32 v[22:23], v[208:209], s[58:59]
  v_pk_mul_f32 v[24:25], v[210:211], s[58:59]
  v_exp_f32 v18, v18
  v_exp_f32 v19, v19
  v_exp_f32 v20, v20
  v_exp_f32 v21, v21
  v_exp_f32 v22, v22
  v_exp_f32 v23, v23
  v_exp_f32 v24, v24
  v_exp_f32 v25, v25
  v_pk_fma_f32 v[26:27], v[18:19], 0.5, 1.0 op_sel_hi:[1,0,0]
  v_pk_fma_f32 v[28:29], v[20:21], 0.5, 1.0 op_sel_hi:[1,0,0]
  v_pk_fma_f32 v[30:31], v[22:23], 0.5, 1.0 op_sel_hi:[1,0,0]
  v_pk_fma_f32 v[32:33], v[24:25], 0.5, 1.0 op_sel_hi:[1,0,0]
  v_pk_fma_f32 v[26:27], v[18:19], v[26:27], 1.0 op_sel_hi:[1,1,0]
  v_pk_fma_f32 v[28:29], v[20:21], v[28:29], 1.0 op_sel_hi:[1,1,0]
  v_pk_fma_f32 v[30:31], v[22:23], v[30:31], 1.0 op_sel_hi:[1,1,0]
  v_pk_fma_f32 v[32:33], v[24:25], v[32:33], 1.0 op_sel_hi:[1,1,0]
  v_rcp_f32 v26, v26
  v_rcp_f32 v27, v27
  v_rcp_f32 v28, v28
  v_rcp_f32 v29, v29
  v_rcp_f32 v30, v30
  v_rcp_f32 v31, v31
  v_rcp_f32 v32, v32
  v_rcp_f32 v33, v33
  v_pk_fma_f32 v[192:193], v[26:27], v[192:193], v[192:193] neg_lo:[1,0,0] neg_hi:[1,0,0]
  v_pk_fma_f32 v[194:195], v[28:29], v[194:195], v[194:195] neg_lo:[1,0,0] neg_hi:[1,0,0]
  v_pk_fma_f32 v[208:209], v[30:31], v[208:209], v[208:209] neg_lo:[1,0,0] neg_hi:[1,0,0]
  v_pk_fma_f32 v[210:211], v[32:33], v[210:211], v[210:211] neg_lo:[1,0,0] neg_hi:[1,0,0]
  v_cvt_pk_bf16_f32 v192, v192, v193
  v_cvt_pk_bf16_f32 v193, v194, v195
  v_cvt_pk_bf16_f32 v194, v208, v209
  v_cvt_pk_bf16_f32 v195, v210, v211
  v_pk_mul_f32 v[18:19], v[196:197], s[58:59]
  v_pk_mul_f32 v[20:21], v[198:199], s[58:59]
  v_pk_mul_f32 v[22:23], v[212:213], s[58:59]
  v_pk_mul_f32 v[24:25], v[214:215], s[58:59]
  v_exp_f32 v18, v18
  v_exp_f32 v19, v19
  v_exp_f32 v20, v20
  v_exp_f32 v21, v21
  v_exp_f32 v22, v22
  v_exp_f32 v23, v23
  v_exp_f32 v24, v24
  v_exp_f32 v25, v25
  v_pk_fma_f32 v[26:27], v[18:19], 0.5, 1.0 op_sel_hi:[1,0,0]
  v_pk_fma_f32 v[28:29], v[20:21], 0.5, 1.0 op_sel_hi:[1,0,0]
  v_pk_fma_f32 v[30:31], v[22:23], 0.5, 1.0 op_sel_hi:[1,0,0]
  v_pk_fma_f32 v[32:33], v[24:25], 0.5, 1.0 op_sel_hi:[1,0,0]
  v_pk_fma_f32 v[26:27], v[18:19], v[26:27], 1.0 op_sel_hi:[1,1,0]
  v_pk_fma_f32 v[28:29], v[20:21], v[28:29], 1.0 op_sel_hi:[1,1,0]
  v_pk_fma_f32 v[30:31], v[22:23], v[30:31], 1.0 op_sel_hi:[1,1,0]
  v_pk_fma_f32 v[32:33], v[24:25], v[32:33], 1.0 op_sel_hi:[1,1,0]
  v_rcp_f32 v26, v26
  v_rcp_f32 v27, v27
  v_rcp_f32 v28, v28
  v_rcp_f32 v29, v29
  v_rcp_f32 v30, v30
  v_rcp_f32 v31, v31
  v_rcp_f32 v32, v32
  v_rcp_f32 v33, v33
  v_pk_fma_f32 v[196:197], v[26:27], v[196:197], v[196:197] neg_lo:[1,0,0] neg_hi:[1,0,0]
  v_pk_fma_f32 v[198:199], v[28:29], v[198:199], v[198:199] neg_lo:[1,0,0] neg_hi:[1,0,0]
  v_pk_fma_f32 v[212:213], v[30:31], v[212:213], v[212:213] neg_lo:[1,0,0] neg_hi:[1,0,0]
  v_pk_fma_f32 v[214:215], v[32:33], v[214:215], v[214:215] neg_lo:[1,0,0] neg_hi:[1,0,0]
  v_cvt_pk_bf16_f32 v196, v196, v197
  v_cvt_pk_bf16_f32 v197, v198, v199
  v_cvt_pk_bf16_f32 v198, v212, v213
  v_cvt_pk_bf16_f32 v199, v214, v215
  buffer_load_dwordx2 v[10:11], v9, s[16:19], 0 offen sc1
  v_pk_mul_f32 v[18:19], v[200:201], s[58:59]
  v_pk_mul_f32 v[20:21], v[202:203], s[58:59]
  v_pk_mul_f32 v[22:23], v[216:217], s[58:59]
  v_pk_mul_f32 v[24:25], v[218:219], s[58:59]
  v_exp_f32 v18, v18
  v_exp_f32 v19, v19
  v_exp_f32 v20, v20
  v_exp_f32 v21, v21
  v_exp_f32 v22, v22
  v_exp_f32 v23, v23
  v_exp_f32 v24, v24
  v_exp_f32 v25, v25
  v_pk_fma_f32 v[26:27], v[18:19], 0.5, 1.0 op_sel_hi:[1,0,0]
  v_pk_fma_f32 v[28:29], v[20:21], 0.5, 1.0 op_sel_hi:[1,0,0]
  v_pk_fma_f32 v[30:31], v[22:23], 0.5, 1.0 op_sel_hi:[1,0,0]
  v_pk_fma_f32 v[32:33], v[24:25], 0.5, 1.0 op_sel_hi:[1,0,0]
  v_pk_fma_f32 v[26:27], v[18:19], v[26:27], 1.0 op_sel_hi:[1,1,0]
  v_pk_fma_f32 v[28:29], v[20:21], v[28:29], 1.0 op_sel_hi:[1,1,0]
  v_pk_fma_f32 v[30:31], v[22:23], v[30:31], 1.0 op_sel_hi:[1,1,0]
  v_pk_fma_f32 v[32:33], v[24:25], v[32:33], 1.0 op_sel_hi:[1,1,0]
  v_rcp_f32 v26, v26
  v_rcp_f32 v27, v27
  v_rcp_f32 v28, v28
  v_rcp_f32 v29, v29
  v_rcp_f32 v30, v30
  v_rcp_f32 v31, v31
  v_rcp_f32 v32, v32
  v_rcp_f32 v33, v33
  v_pk_fma_f32 v[200:201], v[26:27], v[200:201], v[200:201] neg_lo:[1,0,0] neg_hi:[1,0,0]
  v_pk_fma_f32 v[202:203], v[28:29], v[202:203], v[202:203] neg_lo:[1,0,0] neg_hi:[1,0,0]
  v_pk_fma_f32 v[216:217], v[30:31], v[216:217], v[216:217] neg_lo:[1,0,0] neg_hi:[1,0,0]
  v_pk_fma_f32 v[218:219], v[32:33], v[218:219], v[218:219] neg_lo:[1,0,0] neg_hi:[1,0,0]
  v_cvt_pk_bf16_f32 v200, v200, v201
  v_cvt_pk_bf16_f32 v201, v202, v203
  v_cvt_pk_bf16_f32 v202, v216, v217
  v_cvt_pk_bf16_f32 v203, v218, v219
  v_pk_mul_f32 v[18:19], v[204:205], s[58:59]
  v_pk_mul_f32 v[20:21], v[206:207], s[58:59]
  v_pk_mul_f32 v[22:23], v[220:221], s[58:59]
  v_pk_mul_f32 v[24:25], v[222:223], s[58:59]
  v_exp_f32 v18, v18
  v_exp_f32 v19, v19
  v_exp_f32 v20, v20
  v_exp_f32 v21, v21
  v_exp_f32 v22, v22
  v_exp_f32 v23, v23
  v_exp_f32 v24, v24
  v_exp_f32 v25, v25
  v_pk_fma_f32 v[26:27], v[18:19], 0.5, 1.0 op_sel_hi:[1,0,0]
  v_pk_fma_f32 v[28:29], v[20:21], 0.5, 1.0 op_sel_hi:[1,0,0]
  v_pk_fma_f32 v[30:31], v[22:23], 0.5, 1.0 op_sel_hi:[1,0,0]
  v_pk_fma_f32 v[32:33], v[24:25], 0.5, 1.0 op_sel_hi:[1,0,0]
  v_pk_fma_f32 v[26:27], v[18:19], v[26:27], 1.0 op_sel_hi:[1,1,0]
  v_pk_fma_f32 v[28:29], v[20:21], v[28:29], 1.0 op_sel_hi:[1,1,0]
  v_pk_fma_f32 v[30:31], v[22:23], v[30:31], 1.0 op_sel_hi:[1,1,0]
  v_pk_fma_f32 v[32:33], v[24:25], v[32:33], 1.0 op_sel_hi:[1,1,0]
  v_rcp_f32 v26, v26
  v_rcp_f32 v27, v27
  v_rcp_f32 v28, v28
  v_rcp_f32 v29, v29
  v_rcp_f32 v30, v30
  v_rcp_f32 v31, v31
  v_rcp_f32 v32, v32
  v_rcp_f32 v33, v33
  v_pk_fma_f32 v[204:205], v[26:27], v[204:205], v[204:205] neg_lo:[1,0,0] neg_hi:[1,0,0]
  v_pk_fma_f32 v[206:207], v[28:29], v[206:207], v[206:207] neg_lo:[1,0,0] neg_hi:[1,0,0]
  v_pk_fma_f32 v[220:221], v[30:31], v[220:221], v[220:221] neg_lo:[1,0,0] neg_hi:[1,0,0]
  v_pk_fma_f32 v[222:223], v[32:33], v[222:223], v[222:223] neg_lo:[1,0,0] neg_hi:[1,0,0]
  v_cvt_pk_bf16_f32 v204, v204, v205
  v_cvt_pk_bf16_f32 v205, v206, v207
  v_cvt_pk_bf16_f32 v206, v220, v221
  v_cvt_pk_bf16_f32 v207, v222, v223
  s_mul_i32 s5, s26, 57344
  s_add_u32 s5, s5, 49152
  s_add_u32 s5, s5, s72
  v_pk_mul_f32 v[18:19], v[224:225], s[58:59]
  v_pk_mul_f32 v[20:21], v[226:227], s[58:59]
  v_pk_mul_f32 v[22:23], v[240:241], s[58:59]
  v_pk_mul_f32 v[24:25], v[242:243], s[58:59]
  v_exp_f32 v18, v18
  v_exp_f32 v19, v19
  v_exp_f32 v20, v20
  v_exp_f32 v21, v21
  v_exp_f32 v22, v22
  v_exp_f32 v23, v23
  v_exp_f32 v24, v24
  v_exp_f32 v25, v25
  v_pk_fma_f32 v[26:27], v[18:19], 0.5, 1.0 op_sel_hi:[1,0,0]
  v_pk_fma_f32 v[28:29], v[20:21], 0.5, 1.0 op_sel_hi:[1,0,0]
  v_pk_fma_f32 v[30:31], v[22:23], 0.5, 1.0 op_sel_hi:[1,0,0]
  v_pk_fma_f32 v[32:33], v[24:25], 0.5, 1.0 op_sel_hi:[1,0,0]
  v_pk_fma_f32 v[26:27], v[18:19], v[26:27], 1.0 op_sel_hi:[1,1,0]
  v_pk_fma_f32 v[28:29], v[20:21], v[28:29], 1.0 op_sel_hi:[1,1,0]
  v_pk_fma_f32 v[30:31], v[22:23], v[30:31], 1.0 op_sel_hi:[1,1,0]
  v_pk_fma_f32 v[32:33], v[24:25], v[32:33], 1.0 op_sel_hi:[1,1,0]
  v_rcp_f32 v26, v26
  v_rcp_f32 v27, v27
  v_rcp_f32 v28, v28
  v_rcp_f32 v29, v29
  v_rcp_f32 v30, v30
  v_rcp_f32 v31, v31
  v_rcp_f32 v32, v32
  v_rcp_f32 v33, v33
  v_pk_fma_f32 v[224:225], v[26:27], v[224:225], v[224:225] neg_lo:[1,0,0] neg_hi:[1,0,0]
  v_pk_fma_f32 v[226:227], v[28:29], v[226:227], v[226:227] neg_lo:[1,0,0] neg_hi:[1,0,0]
  v_pk_fma_f32 v[240:241], v[30:31], v[240:241], v[240:241] neg_lo:[1,0,0] neg_hi:[1,0,0]
  v_pk_fma_f32 v[242:243], v[32:33], v[242:243], v[242:243] neg_lo:[1,0,0] neg_hi:[1,0,0]
  v_cvt_pk_bf16_f32 v224, v224, v225
  v_cvt_pk_bf16_f32 v225, v226, v227
  v_cvt_pk_bf16_f32 v226, v240, v241
  v_cvt_pk_bf16_f32 v227, v242, v243
  v_pk_mul_f32 v[18:19], v[228:229], s[58:59]
  v_pk_mul_f32 v[20:21], v[230:231], s[58:59]
  v_pk_mul_f32 v[22:23], v[244:245], s[58:59]
  v_pk_mul_f32 v[24:25], v[246:247], s[58:59]
  v_exp_f32 v18, v18
  v_exp_f32 v19, v19
  v_exp_f32 v20, v20
  v_exp_f32 v21, v21
  v_exp_f32 v22, v22
  v_exp_f32 v23, v23
  v_exp_f32 v24, v24
  v_exp_f32 v25, v25
  v_pk_fma_f32 v[26:27], v[18:19], 0.5, 1.0 op_sel_hi:[1,0,0]
  v_pk_fma_f32 v[28:29], v[20:21], 0.5, 1.0 op_sel_hi:[1,0,0]
  v_pk_fma_f32 v[30:31], v[22:23], 0.5, 1.0 op_sel_hi:[1,0,0]
  v_pk_fma_f32 v[32:33], v[24:25], 0.5, 1.0 op_sel_hi:[1,0,0]
  v_pk_fma_f32 v[26:27], v[18:19], v[26:27], 1.0 op_sel_hi:[1,1,0]
  v_pk_fma_f32 v[28:29], v[20:21], v[28:29], 1.0 op_sel_hi:[1,1,0]
  v_pk_fma_f32 v[30:31], v[22:23], v[30:31], 1.0 op_sel_hi:[1,1,0]
  v_pk_fma_f32 v[32:33], v[24:25], v[32:33], 1.0 op_sel_hi:[1,1,0]
  v_rcp_f32 v26, v26
  v_rcp_f32 v27, v27
  v_rcp_f32 v28, v28
  v_rcp_f32 v29, v29
  v_rcp_f32 v30, v30
  v_rcp_f32 v31, v31
  v_rcp_f32 v32, v32
  v_rcp_f32 v33, v33
  v_pk_fma_f32 v[228:229], v[26:27], v[228:229], v[228:229] neg_lo:[1,0,0] neg_hi:[1,0,0]
  v_pk_fma_f32 v[230:231], v[28:29], v[230:231], v[230:231] neg_lo:[1,0,0] neg_hi:[1,0,0]
  v_pk_fma_f32 v[244:245], v[30:31], v[244:245], v[244:245] neg_lo:[1,0,0] neg_hi:[1,0,0]
  v_pk_fma_f32 v[246:247], v[32:33], v[246:247], v[246:247] neg_lo:[1,0,0] neg_hi:[1,0,0]
  v_cvt_pk_bf16_f32 v228, v228, v229
  v_cvt_pk_bf16_f32 v229, v230, v231
  v_cvt_pk_bf16_f32 v230, v244, v245
  v_cvt_pk_bf16_f32 v231, v246, v247
  s_waitcnt vmcnt(0)
  v_cmp_eq_u64 vcc, v[10:11], v[14:15]
  s_mov_b32 s30, 0
  s_nop 0
  s_cmp_eq_u64 vcc, -1
  s_cbranch_scc0 L_k1B_noearly
  s_add_u32 m0, s15, 0
  s_nop 0
  buffer_load_dwordx4 v8, s[16:19], s12 offen offset:0  lds
  buffer_load_dwordx4 v8, s[16:19], s12 offen offset:1024  lds
  buffer_load_dwordx4 v8, s[16:19], s12 offen offset:2048  lds
  buffer_load_dwordx4 v8, s[16:19], s12 offen offset:3072  lds
  s_add_u32 s12, s12, s31
  s_add_u32 m0, s15, 32768
  s_nop 0
  buffer_load_dwordx4 v8, s[16:19], s12 offen offset:0  lds
  buffer_load_dwordx4 v8, s[16:19], s12 offen offset:1024  lds
  buffer_load_dwordx4 v8, s[16:19], s12 offen offset:2048  lds
  buffer_load_dwordx4 v8, s[16:19], s12 offen offset:3072  lds
  s_add_u32 s12, s12, s31
  s_add_u32 m0, s15, 65536
  s_nop 0
  buffer_load_dwordx4 v8, s[16:19], s12 offen offset:0  lds
  buffer_load_dwordx4 v8, s[16:19], s12 offen offset:1024  lds
  buffer_load_dwordx4 v8, s[16:19], s12 offen offset:2048  lds
  buffer_load_dwordx4 v8, s[16:19], s12 offen offset:3072  lds
  s_add_u32 s12, s12, s31
  s_mov_b32 s30, 1
L_k1B_noearly:
  v_pk_mul_f32 v[18:19], v[232:233], s[58:59]
  v_pk_mul_f32 v[20:21], v[234:235], s[58:59]
  v_pk_mul_f32 v[22:23], v[248:249], s[58:59]
  v_pk_mul_f32 v[24:25], v[250:251], s[58:59]
  v_exp_f32 v18, v18
  v_exp_f32 v19, v19
  v_exp_f32 v20, v20
  v_exp_f32 v21, v21
  v_exp_f32 v22, v22
  v_exp_f32 v23, v23
  v_exp_f32 v24, v24
  v_exp_f32 v25, v25
  v_pk_fma_f32 v[26:27], v[18:19], 0.5, 1.0 op_sel_hi:[1,0,0]
  v_pk_fma_f32 v[28:29], v[20:21], 0.5, 1.0 op_sel_hi:[1,0,0]
  v_pk_fma_f32 v[30:31], v[22:23], 0.5, 1.0 op_sel_hi:[1,0,0]
  v_pk_fma_f32 v[32:33], v[24:25], 0.5, 1.0 op_sel_hi:[1,0,0]
  v_pk_fma_f32 v[26:27], v[18:19], v[26:27], 1.0 op_sel_hi:[1,1,0]
  v_pk_fma_f32 v[28:29], v[20:21], v[28:29], 1.0 op_sel_hi:[1,1,0]
  v_pk_fma_f32 v[30:31], v[22:23], v[30:31], 1.0 op_sel_hi:[1,1,0]
  v_pk_fma_f32 v[32:33], v[24:25], v[32:33], 1.0 op_sel_hi:[1,1,0]
  v_rcp_f32 v26, v26
  v_rcp_f32 v27, v27
  v_rcp_f32 v28, v28
  v_rcp_f32 v29, v29
  v_rcp_f32 v30, v30
  v_rcp_f32 v31, v31
  v_rcp_f32 v32, v32
  v_rcp_f32 v33, v33
  v_pk_fma_f32 v[232:233], v[26:27], v[232:233], v[232:233] neg_lo:[1,0,0] neg_hi:[1,0,0]
  v_pk_fma_f32 v[234:235], v[28:29], v[234:235], v[234:235] neg_lo:[1,0,0] neg_hi:[1,0,0]
  v_pk_fma_f32 v[248:249], v[30:31], v[248:249], v[248:249] neg_lo:[1,0,0] neg_hi:[1,0,0]
  v_pk_fma_f32 v[250:251], v[32:33], v[250:251], v[250:251] neg_lo:[1,0,0] neg_hi:[1,0,0]
  v_cvt_pk_bf16_f32 v232, v232, v233
  v_cvt_pk_bf16_f32 v233, v234, v235
  v_cvt_pk_bf16_f32 v234, v248, v249
  v_cvt_pk_bf16_f32 v235, v250, v251
  v_pk_mul_f32 v[18:19], v[236:237], s[58:59]
  v_pk_mul_f32 v[20:21], v[238:239], s[58:59]
  v_pk_mul_f32 v[22:23], v[252:253], s[58:59]
  v_pk_mul_f32 v[24:25], v[254:255], s[58:59]
  v_exp_f32 v18, v18
  v_exp_f32 v19, v19
  v_exp_f32 v20, v20
  v_exp_f32 v21, v21
  v_exp_f32 v22, v22
  v_exp_f32 v23, v23
  v_exp_f32 v24, v24
  v_exp_f32 v25, v25
  v_pk_fma_f32 v[26:27], v[18:19], 0.5, 1.0 op_sel_hi:[1,0,0]
  v_pk_fma_f32 v[28:29], v[20:21], 0.5, 1.0 op_sel_hi:[1,0,0]
  v_pk_fma_f32 v[30:31], v[22:23], 0.5, 1.0 op_sel_hi:[1,0,0]
  v_pk_fma_f32 v[32:33], v[24:25], 0.5, 1.0 op_sel_hi:[1,0,0]
  v_pk_fma_f32 v[26:27], v[18:19], v[26:27], 1.0 op_sel_hi:[1,1,0]
  v_pk_fma_f32 v[28:29], v[20:21], v[28:29], 1.0 op_sel_hi:[1,1,0]
  v_pk_fma_f32 v[30:31], v[22:23], v[30:31], 1.0 op_sel_hi:[1,1,0]
  v_pk_fma_f32 v[32:33], v[24:25], v[32:33], 1.0 op_sel_hi:[1,1,0]
  v_rcp_f32 v26, v26
  v_rcp_f32 v27, v27
  v_rcp_f32 v28, v28
  v_rcp_f32 v29, v29
  v_rcp_f32 v30, v30
  v_rcp_f32 v31, v31
  v_rcp_f32 v32, v32
  v_rcp_f32 v33, v33
  v_pk_fma_f32 v[236:237], v[26:27], v[236:237], v[236:237] neg_lo:[1,0,0] neg_hi:[1,0,0]
  v_pk_fma_f32 v[238:239], v[28:29], v[238:239], v[238:239] neg_lo:[1,0,0] neg_hi:[1,0,0]
  v_pk_fma_f32 v[252:253], v[30:31], v[252:253], v[252:253] neg_lo:[1,0,0] neg_hi:[1,0,0]
  v_pk_fma_f32 v[254:255], v[32:33], v[254:255], v[254:255] neg_lo:[1,0,0] neg_hi:[1,0,0]
  v_cvt_pk_bf16_f32 v236, v236, v237
  v_cvt_pk_bf16_f32 v237, v238, v239
  v_cvt_pk_bf16_f32 v238, v252, v253
  v_cvt_pk_bf16_f32 v239, v254, v255
  s_mul_i32 s6, s26, 57344
  s_add_u32 s6, s6, 16384
  s_add_u32 s6, s6, s72
  s_add_u32 s6, s6, 512
  v_pk_mul_f32 v[18:19], v[112:113], s[58:59]
  v_pk_mul_f32 v[20:21], v[114:115], s[58:59]
  v_pk_mul_f32 v[22:23], v[116:117], s[58:59]
  v_pk_mul_f32 v[24:25], v[118:119], s[58:59]
  v_exp_f32 v18, v18
  v_exp_f32 v19, v19
  v_exp_f32 v20, v20
  v_exp_f32 v21, v21
  v_exp_f32 v22, v22
  v_exp_f32 v23, v23
  v_exp_f32 v24, v24
  v_exp_f32 v25, v25
  v_pk_fma_f32 v[26:27], v[18:19], 0.5, 1.0 op_sel_hi:[1,0,0]
  v_pk_fma_f32 v[28:29], v[20:21], 0.5, 1.0 op_sel_hi:[1,0,0]
  v_pk_fma_f32 v[30:31], v[22:23], 0.5, 1.0 op_sel_hi:[1,0,0]
  v_pk_fma_f32 v[32:33], v[24:25], 0.5, 1.0 op_sel_hi:[1,0,0]
  v_pk_fma_f32 v[26:27], v[18:19], v[26:27], 1.0 op_sel_hi:[1,1,0]
  v_pk_fma_f32 v[28:29], v[20:21], v[28:29], 1.0 op_sel_hi:[1,1,0]
  v_pk_fma_f32 v[30:31], v[22:23], v[30:31], 1.0 op_sel_hi:[1,1,0]
  v_pk_fma_f32 v[32:33], v[24:25], v[32:33], 1.0 op_sel_hi:[1,1,0]
  v_rcp_f32 v26, v26
  v_rcp_f32 v27, v27
  v_rcp_f32 v28, v28
  v_rcp_f32 v29, v29
  v_rcp_f32 v30, v30
  v_rcp_f32 v31, v31
  v_rcp_f32 v32, v32
  v_rcp_f32 v33, v33
  v_pk_fma_f32 v[112:113], v[26:27], v[112:113], v[112:113] neg_lo:[1,0,0] neg_hi:[1,0,0]
  v_pk_fma_f32 v[114:115], v[28:29], v[114:115], v[114:115] neg_lo:[1,0,0] neg_hi:[1,0,0]
  v_pk_fma_f32 v[116:117], v[30:31], v[116:117], v[116:117] neg_lo:[1,0,0] neg_hi:[1,0,0]
  v_pk_fma_f32 v[118:119], v[32:33], v[118:119], v[118:119] neg_lo:[1,0,0] neg_hi:[1,0,0]
  v_cvt_pk_bf16_f32 v240, v112, v113
  v_cvt_pk_bf16_f32 v241, v114, v115
  v_cvt_pk_bf16_f32 v242, v116, v117
  v_cvt_pk_bf16_f32 v243, v118, v119
  v_pk_mul_f32 v[18:19], v[120:121], s[58:59]
  v_pk_mul_f32 v[20:21], v[122:123], s[58:59]
  v_pk_mul_f32 v[22:23], v[124:125], s[58:59]
  v_pk_mul_f32 v[24:25], v[126:127], s[58:59]
  v_exp_f32 v18, v18
  v_exp_f32 v19, v19
  v_exp_f32 v20, v20
  v_exp_f32 v21, v21
  v_exp_f32 v22, v22
  v_exp_f32 v23, v23
  v_exp_f32 v24, v24
  v_exp_f32 v25, v25
  v_pk_fma_f32 v[26:27], v[18:19], 0.5, 1.0 op_sel_hi:[1,0,0]
  v_pk_fma_f32 v[28:29], v[20:21], 0.5, 1.0 op_sel_hi:[1,0,0]
  v_pk_fma_f32 v[30:31], v[22:23], 0.5, 1.0 op_sel_hi:[1,0,0]
  v_pk_fma_f32 v[32:33], v[24:25], 0.5, 1.0 op_sel_hi:[1,0,0]
  v_pk_fma_f32 v[26:27], v[18:19], v[26:27], 1.0 op_sel_hi:[1,1,0]
  v_pk_fma_f32 v[28:29], v[20:21], v[28:29], 1.0 op_sel_hi:[1,1,0]
  v_pk_fma_f32 v[30:31], v[22:23], v[30:31], 1.0 op_sel_hi:[1,1,0]
  v_pk_fma_f32 v[32:33], v[24:25], v[32:33], 1.0 op_sel_hi:[1,1,0]
  v_rcp_f32 v26, v26
  v_rcp_f32 v27, v27
  v_rcp_f32 v28, v28
  v_rcp_f32 v29, v29
  v_rcp_f32 v30, v30
  v_rcp_f32 v31, v31
  v_rcp_f32 v32, v32
  v_rcp_f32 v33, v33
  v_pk_fma_f32 v[120:121], v[26:27], v[120:121], v[120:121] neg_lo:[1,0,0] neg_hi:[1,0,0]
  v_pk_fma_f32 v[122:123], v[28:29], v[122:123], v[122:123] neg_lo:[1,0,0] neg_hi:[1,0,0]
  v_pk_fma_f32 v[124:125], v[30:31], v[124:125], v[124:125] neg_lo:[1,0,0] neg_hi:[1,0,0]
  v_pk_fma_f32 v[126:127], v[32:33], v[126:127], v[126:127] neg_lo:[1,0,0] neg_hi:[1,0,0]
  v_cvt_pk_bf16_f32 v244, v120, v121
  v_cvt_pk_bf16_f32 v245, v122, v123
  v_cvt_pk_bf16_f32 v246, v124, v125
  v_cvt_pk_bf16_f32 v247, v126, v127
  s_nop 1
  v_permlane16_swap_b32 v240, v242
  v_permlane16_swap_b32 v241, v243
  v_permlane16_swap_b32 v244, v246
  v_permlane16_swap_b32 v245, v247
  s_cmp_eq_u32 s30, 0
  s_cbranch_scc1 L_p2_late
  s_waitcnt vmcnt(0)
  s_branch L_p2_go
L_p2_late:
  buffer_load_dwordx2 v[10:11], v9, s[16:19], 0 offen sc1
  s_waitcnt vmcnt(0)
  v_cmp_eq_u64 vcc, v[10:11], v[14:15]
  s_nop 1
  s_cmp_eq_u64 vcc, -1
  s_cbranch_scc1 L_p2_fok
  s_add_u32 s3, s3, 1
  s_cmp_gt_u32 s3, 0x40000
  s_cbranch_scc1 L_p2_fok
  s_sleep 4
  s_branch L_p2_late
L_p2_fok:
  s_add_u32 m0, s15, 0
  s_nop 0
  buffer_load_dwordx4 v8, s[16:19], s12 offen offset:0  lds
  buffer_load_dwordx4 v8, s[16:19], s12 offen offset:1024  lds
  buffer_load_dwordx4 v8, s[16:19], s12 offen offset:2048  lds
  buffer_load_dwordx4 v8, s[16:19], s12 offen offset:3072  lds
  s_add_u32 s12, s12, s31
  s_add_u32 m0, s15, 32768
  s_nop 0
  buffer_load_dwordx4 v8, s[16:19], s12 offen offset:0  lds
  buffer_load_dwordx4 v8, s[16:19], s12 offen offset:1024  lds
  buffer_load_dwordx4 v8, s[16:19], s12 offen offset:2048  lds
  buffer_load_dwordx4 v8, s[16:19], s12 offen offset:3072  lds
  s_add_u32 s12, s12, s31
  s_add_u32 m0, s15, 65536
  s_nop 0
  buffer_load_dwordx4 v8, s[16:19], s12 offen offset:0  lds
  buffer_load_dwordx4 v8, s[16:19], s12 offen offset:1024  lds
  buffer_load_dwordx4 v8, s[16:19], s12 offen offset:2048  lds
  buffer_load_dwordx4 v8, s[16:19], s12 offen offset:3072  lds
  s_add_u32 s12, s12, s31
  s_waitcnt vmcnt(0)
L_p2_go:
  s_and_b32 s60, s24, 1
  s_lshl_b32 s60, s60, 12
  v_add_u32 v12, s60, v17
  v_add_u32 v13, 65536, v12
  v_lshlrev_b32 v30, 2, v7
  v_lshrrev_b32 v31, 2, v6
  v_add_u32 v30, v30, v31
  v_and_b32 v31, 7, v30
  s_lshr_b32 s60, s24, 1
  s_lshl_b32 s60, s60, 2
  v_xor_b32 v31, s60, v31
  v_lshlrev_b32 v30, 8, v30
  v_and_b32 v32, 3, v6
  v_lshlrev_b32 v32, 3, v32
  v_add_u32 v30, v30, v32
  v_add_u32 v30, 16384, v30
  v_xor_b32 v33, 0, v31
  v_lshlrev_b32 v33, 5, v33
  v_add_u32 v18, v30, v33
  v_add_u32 v22, 65536, v18
  v_xor_b32 v33, 1, v31
  v_lshlrev_b32 v33, 5, v33
  v_add_u32 v19, v30, v33
  v_add_u32 v23, 65536, v19
  v_xor_b32 v33, 2, v31
  v_lshlrev_b32 v33, 5, v33
  v_add_u32 v20, v30, v33
  v_add_u32 v24, 65536, v20
  v_xor_b32 v33, 3, v31
  v_lshlrev_b32 v33, 5, v33
  v_add_u32 v21, v30, v33
  v_add_u32 v25, 65536, v21
  v_add_u32 v26, s27, v17
  v_add_u32 v27, 65536, v26
  v_and_b32 v30, 1, v7
  v_lshlrev_b32 v30, 10, v30
  v_lshrrev_b32 v31, 1, v7
  v_lshlrev_b32 v31, 8, v31
  v_lshlrev_b32 v16, 4, v6
  v_add3_u32 v16, v16, v30, v31
  s_cmp_eq_u32 s10, 0
  s_cbranch_scc1 L_p2_r0
  s_barrier
  ds_read_b128 a[0:3], v12 offset:0
  ds_read_b64_tr_b16 a[16:17], v18 offset:0
  ds_read_b64_tr_b16 a[18:19], v18 offset:4096
  ds_read_b128 a[32:35], v12 offset:8192
  ds_read_b64_tr_b16 a[48:49], v18 offset:8192
  ds_read_b64_tr_b16 a[50:51], v18 offset:12288
  ds_read_b128 a[4:7], v12 offset:1024
  ds_read_b64_tr_b16 a[20:21], v19 offset:0
  ds_read_b64_tr_b16 a[22:23], v19 offset:4096
  ds_read_b128 a[36:39], v12 offset:9216
  ds_read_b64_tr_b16 a[52:53], v19 offset:8192
  ds_read_b64_tr_b16 a[54:55], v19 offset:12288
  ds_read_b128 a[8:11], v12 offset:2048
  ds_read_b64_tr_b16 a[24:25], v20 offset:0
  ds_read_b64_tr_b16 a[26:27], v20 offset:4096
  s_add_u32 m0, s15, 98304
  s_nop 0
  buffer_load_dwordx4 v8, s[16:19], s12 offen offset:0  lds
  ds_read_b128 a[40:43], v12 offset:10240
  buffer_load_dwordx4 v8, s[16:19], s12 offen offset:1024  lds
  ds_read_b64_tr_b16 a[56:57], v20 offset:8192
  buffer_load_dwordx4 v8, s[16:19], s12 offen offset:2048  lds
  ds_read_b64_tr_b16 a[58:59], v20 offset:12288
  buffer_load_dwordx4 v8, s[16:19], s12 offen offset:3072  lds
  s_add_u32 s12, s12, s31
  ds_read_b128 a[12:15], v12 offset:3072
  s_add_u32 m0, s27, 98304
  ds_read_b64_tr_b16 a[28:29], v21 offset:0
  buffer_load_dwordx4 v2, s[96:99], s13 offen offset:0 lds
  ds_read_b64_tr_b16 a[30:31], v21 offset:4096
  buffer_load_dwordx4 v3, s[96:99], s13 offen offset:1024 lds
  buffer_load_dwordx4 v4, s[96:99], s13 offen offset:2048 lds
  ds_read_b128 a[44:47], v12 offset:11264
  buffer_load_dwordx4 v5, s[96:99], s13 offen offset:3072 lds
  ds_read_b64_tr_b16 a[60:61], v21 offset:8192
  s_add_u32 s13, s13, s32
  ds_read_b64_tr_b16 a[62:63], v21 offset:12288
  buffer_store_dwordx4 v[240:243], v16, s[16:19], s6 offen offset:0 sc1
  buffer_store_dwordx4 v[244:247], v16, s[16:19], s6 offen offset:2048 sc1
  buffer_store_dwordx4 v[192:195], v17, s[16:19], s4 offen offset:0 sc1
  buffer_store_dwordx4 v[196:199], v17, s[16:19], s4 offen offset:1024 sc1
  buffer_store_dwordx4 v[200:203], v17, s[16:19], s4 offen offset:2048 sc1
  s_waitcnt lgkmcnt(0)
  s_barrier
  v_mfma_f32_16x16x32_bf16 v[128:131], a[16:19], a[0:3], 0
  ds_read_b128 a[64:67], v12 offset:32768
  s_add_u32 m0, s15, 0
  v_mfma_f32_16x16x32_bf16 v[128:131], a[48:51], a[32:35], v[128:131]
  ds_read_b64_tr_b16 a[80:81], v18 offset:32768
  v_mfma_f32_16x16x32_bf16 v[132:135], a[20:23], a[0:3], 0
  buffer_load_dwordx4 v8, s[16:19], s12 offen offset:0  lds
  ds_read_b64_tr_b16 a[82:83], v18 offset:36864
  v_mfma_f32_16x16x32_bf16 v[132:135], a[52:55], a[32:35], v[132:135]
  ds_read_b128 a[96:99], v12 offset:40960
  v_mfma_f32_16x16x32_bf16 v[136:139], a[24:27], a[0:3], 0
  buffer_load_dwordx4 v8, s[16:19], s12 offen offset:1024  lds
  ds_read_b64_tr_b16 a[112:113], v18 offset:40960
  v_mfma_f32_16x16x32_bf16 v[136:139], a[56:59], a[32:35], v[136:139]
  ds_read_b64_tr_b16 a[114:115], v18 offset:45056
  buffer_load_dwordx4 v8, s[16:19], s12 offen offset:2048  lds
  v_mfma_f32_16x16x32_bf16 v[140:143], a[28:31], a[0:3], 0
  ds_read_b128 a[68:71], v12 offset:33792
  v_mfma_f32_16x16x32_bf16 v[140:143], a[60:63], a[32:35], v[140:143]
  buffer_load_dwordx4 v8, s[16:19], s12 offen offset:3072  lds
  ds_read_b64_tr_b16 a[84:85], v19 offset:32768
  v_mfma_f32_16x16x32_bf16 v[144:147], a[16:19], a[4:7], 0
  v_mfma_f32_16x16x32_bf16 v[144:147], a[48:51], a[36:39], v[144:147]
  ds_read_b64_tr_b16 a[86:87], v19 offset:36864
  s_add_u32 s12, s12, s31
  v_mfma_f32_16x16x32_bf16 v[148:151], a[20:23], a[4:7], 0
  ds_read_b128 a[100:103], v12 offset:41984
  v_mfma_f32_16x16x32_bf16 v[148:151], a[52:55], a[36:39], v[148:151]
  s_add_u32 m0, s27, 0
  ds_read_b64_tr_b16 a[116:117], v19 offset:40960
  v_mfma_f32_16x16x32_bf16 v[152:155], a[24:27], a[4:7], 0
  ds_read_b64_tr_b16 a[118:119], v19 offset:45056
  buffer_load_dwordx4 v2, s[96:99], s13 offen offset:0 lds
  v_mfma_f32_16x16x32_bf16 v[152:155], a[56:59], a[36:39], v[152:155]
  ds_read_b128 a[72:75], v12 offset:34816
  v_mfma_f32_16x16x32_bf16 v[156:159], a[28:31], a[4:7], 0
  buffer_load_dwordx4 v3, s[96:99], s13 offen offset:1024 lds
  ds_read_b64_tr_b16 a[88:89], v20 offset:32768
  v_mfma_f32_16x16x32_bf16 v[156:159], a[60:63], a[36:39], v[156:159]
  ds_read_b64_tr_b16 a[90:91], v20 offset:36864
  v_mfma_f32_16x16x32_bf16 v[160:163], a[16:19], a[8:11], 0
  buffer_load_dwordx4 v4, s[96:99], s13 offen offset:2048 lds
  v_mfma_f32_16x16x32_bf16 v[160:163], a[48:51], a[40:43], v[160:163]
  ds_read_b128 a[104:107], v12 offset:43008
  v_mfma_f32_16x16x32_bf16 v[164:167], a[20:23], a[8:11], 0
  buffer_load_dwordx4 v5, s[96:99], s13 offen offset:3072 lds
  ds_read_b64_tr_b16 a[120:121], v20 offset:40960
  v_mfma_f32_16x16x32_bf16 v[164:167], a[52:55], a[40:43], v[164:167]
  ds_read_b64_tr_b16 a[122:123], v20 offset:45056
  s_add_u32 s13, s13, s32
  v_mfma_f32_16x16x32_bf16 v[168:171], a[24:27], a[8:11], 0
  ds_read_b128 a[76:79], v12 offset:35840
  v_mfma_f32_16x16x32_bf16 v[168:171], a[56:59], a[40:43], v[168:171]
  ds_read_b64_tr_b16 a[92:93], v21 offset:32768
  buffer_store_dwordx4 v[204:207], v17, s[16:19], s4 offen offset:3072 sc1
  v_mfma_f32_16x16x32_bf16 v[172:175], a[28:31], a[8:11], 0
  ds_read_b64_tr_b16 a[94:95], v21 offset:36864
  v_mfma_f32_16x16x32_bf16 v[172:175], a[60:63], a[40:43], v[172:175]
  buffer_store_dwordx4 v[224:227], v17, s[16:19], s5 offen offset:0 sc1
  ds_read_b128 a[108:111], v12 offset:44032
  v_mfma_f32_16x16x32_bf16 v[176:179], a[16:19], a[12:15], 0
  ds_read_b64_tr_b16 a[124:125], v21 offset:40960
  v_mfma_f32_16x16x32_bf16 v[176:179], a[48:51], a[44:47], v[176:179]
  buffer_store_dwordx4 v[228:231], v17, s[16:19], s5 offen offset:1024 sc1
  v_mfma_f32_16x16x32_bf16 v[180:183], a[20:23], a[12:15], 0
  ds_read_b64_tr_b16 a[126:127], v21 offset:45056
  buffer_store_dwordx4 v[232:235], v17, s[16:19], s5 offen offset:2048 sc1
  v_mfma_f32_16x16x32_bf16 v[180:183], a[52:55], a[44:47], v[180:183]
  v_mfma_f32_16x16x32_bf16 v[184:187], a[24:27], a[12:15], 0
  buffer_store_dwordx4 v[236:239], v17, s[16:19], s5 offen offset:3072 sc1
  v_mfma_f32_16x16x32_bf16 v[184:187], a[56:59], a[44:47], v[184:187]
  v_mfma_f32_16x16x32_bf16 v[188:191], a[28:31], a[12:15], 0
  v_mfma_f32_16x16x32_bf16 v[188:191], a[60:63], a[44:47], v[188:191]
  s_waitcnt lgkmcnt(0)
  s_barrier
  s_waitcnt vmcnt(26)
  v_mfma_f32_16x16x32_bf16 v[128:131], a[80:83], a[64:67], v[128:131]
  ds_read_b128 a[0:3], v13 offset:0
  s_add_u32 m0, s15, 32768
  v_mfma_f32_16x16x32_bf16 v[128:131], a[112:115], a[96:99], v[128:131]
  s_mov_b64 exec, 2
  buffer_store_dwordx2 v[14:15], v0, s[16:19], 0 offen sc1
  s_mov_b64 exec, -1
  ds_read_b64_tr_b16 a[16:17], v22 offset:0
  v_mfma_f32_16x16x32_bf16 v[132:135], a[84:87], a[64:67], v[132:135]
  ds_read_b64_tr_b16 a[18:19], v22 offset:4096
  buffer_load_dwordx4 v8, s[16:19], s12 offen offset:0  lds
  v_mfma_f32_16x16x32_bf16 v[132:135], a[116:119], a[96:99], v[132:135]
  ds_read_b128 a[32:35], v13 offset:8192
  v_mfma_f32_16x16x32_bf16 v[136:139], a[88:91], a[64:67], v[136:139]
  ds_read_b64_tr_b16 a[48:49], v22 offset:8192
  v_mfma_f32_16x16x32_bf16 v[136:139], a[120:123], a[96:99], v[136:139]
  buffer_load_dwordx4 v8, s[16:19], s12 offen offset:1024  lds
  ds_read_b64_tr_b16 a[50:51], v22 offset:12288
  v_mfma_f32_16x16x32_bf16 v[140:143], a[92:95], a[64:67], v[140:143]
  ds_read_b128 a[4:7], v13 offset:1024
  v_mfma_f32_16x16x32_bf16 v[140:143], a[124:127], a[96:99], v[140:143]
  ds_read_b64_tr_b16 a[20:21], v23 offset:0
  buffer_load_dwordx4 v8, s[16:19], s12 offen offset:2048  lds
  v_mfma_f32_16x16x32_bf16 v[144:147], a[80:83], a[68:71], v[144:147]
  v_mfma_f32_16x16x32_bf16 v[144:147], a[112:115], a[100:103], v[144:147]
  ds_read_b64_tr_b16 a[22:23], v23 offset:4096
  v_mfma_f32_16x16x32_bf16 v[148:151], a[84:87], a[68:71], v[148:151]
  ds_read_b128 a[36:39], v13 offset:9216
  buffer_load_dwordx4 v8, s[16:19], s12 offen offset:3072  lds
  v_mfma_f32_16x16x32_bf16 v[148:151], a[116:119], a[100:103], v[148:151]
  ds_read_b64_tr_b16 a[52:53], v23 offset:8192
  v_mfma_f32_16x16x32_bf16 v[152:155], a[88:91], a[68:71], v[152:155]
  ds_read_b64_tr_b16 a[54:55], v23 offset:12288
  s_add_u32 s12, s12, s31
  v_mfma_f32_16x16x32_bf16 v[152:155], a[120:123], a[100:103], v[152:155]
  ds_read_b128 a[8:11], v13 offset:2048
  v_mfma_f32_16x16x32_bf16 v[156:159], a[92:95], a[68:71], v[156:159]
  ds_read_b64_tr_b16 a[24:25], v24 offset:0
  v_mfma_f32_16x16x32_bf16 v[156:159], a[124:127], a[100:103], v[156:159]
  s_add_u32 m0, s27, 32768
  ds_read_b64_tr_b16 a[26:27], v24 offset:4096
  v_mfma_f32_16x16x32_bf16 v[160:163], a[80:83], a[72:75], v[160:163]
  v_mfma_f32_16x16x32_bf16 v[160:163], a[112:115], a[104:107], v[160:163]
  ds_read_b128 a[40:43], v13 offset:10240
  buffer_load_dwordx4 v2, s[96:99], s13 offen offset:0 lds
  v_mfma_f32_16x16x32_bf16 v[164:167], a[84:87], a[72:75], v[164:167]
  ds_read_b64_tr_b16 a[56:57], v24 offset:8192
  v_mfma_f32_16x16x32_bf16 v[164:167], a[116:119], a[104:107], v[164:167]
  ds_read_b64_tr_b16 a[58:59], v24 offset:12288
  v_mfma_f32_16x16x32_bf16 v[168:171], a[88:91], a[72:75], v[168:171]
  ds_read_b128 a[12:15], v13 offset:3072
  buffer_load_dwordx4 v3, s[96:99], s13 offen offset:1024 lds
  v_mfma_f32_16x16x32_bf16 v[168:171], a[120:123], a[104:107], v[168:171]
  ds_read_b64_tr_b16 a[28:29], v25 offset:0
  v_mfma_f32_16x16x32_bf16 v[172:175], a[92:95], a[72:75], v[172:175]
  ds_read_b64_tr_b16 a[30:31], v25 offset:4096
  buffer_load_dwordx4 v4, s[96:99], s13 offen offset:2048 lds
  v_mfma_f32_16x16x32_bf16 v[172:175], a[124:127], a[104:107], v[172:175]
  ds_read_b128 a[44:47], v13 offset:11264
  v_mfma_f32_16x16x32_bf16 v[176:179], a[80:83], a[76:79], v[176:179]
  ds_read_b64_tr_b16 a[60:61], v25 offset:8192
  v_mfma_f32_16x16x32_bf16 v[176:179], a[112:115], a[108:111], v[176:179]
  buffer_load_dwordx4 v5, s[96:99], s13 offen offset:3072 lds
  v_mfma_f32_16x16x32_bf16 v[180:183], a[84:87], a[76:79], v[180:183]
  ds_read_b64_tr_b16 a[62:63], v25 offset:12288
  v_mfma_f32_16x16x32_bf16 v[180:183], a[116:119], a[108:111], v[180:183]
  s_add_u32 s13, s13, s32
  v_mfma_f32_16x16x32_bf16 v[184:187], a[88:91], a[76:79], v[184:187]
  v_mfma_f32_16x16x32_bf16 v[184:187], a[120:123], a[108:111], v[184:187]
  v_mfma_f32_16x16x32_bf16 v[188:191], a[92:95], a[76:79], v[188:191]
  v_mfma_f32_16x16x32_bf16 v[188:191], a[124:127], a[108:111], v[188:191]
  s_waitcnt vmcnt(27) lgkmcnt(0)
  s_barrier
  v_mfma_f32_16x16x32_bf16 v[128:131], a[16:19], a[0:3], v[128:131]
  ds_read_b128 a[64:67], v13 offset:32768
  s_add_u32 m0, s15, 65536
  v_mfma_f32_16x16x32_bf16 v[128:131], a[48:51], a[32:35], v[128:131]
  ds_read_b64_tr_b16 a[80:81], v22 offset:32768
  v_mfma_f32_16x16x32_bf16 v[132:135], a[20:23], a[0:3], v[132:135]
  ds_read_b64_tr_b16 a[82:83], v22 offset:36864
  buffer_load_dwordx4 v8, s[16:19], s12 offen offset:0  lds
  v_mfma_f32_16x16x32_bf16 v[132:135], a[52:55], a[32:35], v[132:135]
  ds_read_b128 a[96:99], v13 offset:40960
  v_mfma_f32_16x16x32_bf16 v[136:139], a[24:27], a[0:3], v[136:139]
  ds_read_b64_tr_b16 a[112:113], v22 offset:40960
  v_mfma_f32_16x16x32_bf16 v[136:139], a[56:59], a[32:35], v[136:139]
  buffer_load_dwordx4 v8, s[16:19], s12 offen offset:1024  lds
  ds_read_b64_tr_b16 a[114:115], v22 offset:45056
  v_mfma_f32_16x16x32_bf16 v[140:143], a[28:31], a[0:3], v[140:143]
  ds_read_b128 a[68:71], v13 offset:33792
  v_mfma_f32_16x16x32_bf16 v[140:143], a[60:63], a[32:35], v[140:143]
  ds_read_b64_tr_b16 a[84:85], v23 offset:32768
  buffer_load_dwordx4 v8, s[16:19], s12 offen offset:2048  lds
  v_mfma_f32_16x16x32_bf16 v[144:147], a[16:19], a[4:7], v[144:147]
  v_mfma_f32_16x16x32_bf16 v[144:147], a[48:51], a[36:39], v[144:147]
  ds_read_b64_tr_b16 a[86:87], v23 offset:36864
  v_mfma_f32_16x16x32_bf16 v[148:151], a[20:23], a[4:7], v[148:151]
  ds_read_b128 a[100:103], v13 offset:41984
  buffer_load_dwordx4 v8, s[16:19], s12 offen offset:3072  lds
  v_mfma_f32_16x16x32_bf16 v[148:151], a[52:55], a[36:39], v[148:151]
  ds_read_b64_tr_b16 a[116:117], v23 offset:40960
  v_mfma_f32_16x16x32_bf16 v[152:155], a[24:27], a[4:7], v[152:155]
  ds_read_b64_tr_b16 a[118:119], v23 offset:45056
  s_add_u32 s12, s12, s31
  v_mfma_f32_16x16x32_bf16 v[152:155], a[56:59], a[36:39], v[152:155]
  ds_read_b128 a[72:75], v13 offset:34816
  v_mfma_f32_16x16x32_bf16 v[156:159], a[28:31], a[4:7], v[156:159]
  ds_read_b64_tr_b16 a[88:89], v24 offset:32768
  v_mfma_f32_16x16x32_bf16 v[156:159], a[60:63], a[36:39], v[156:159]
  s_add_u32 m0, s27, 65536
  ds_read_b64_tr_b16 a[90:91], v24 offset:36864
  v_mfma_f32_16x16x32_bf16 v[160:163], a[16:19], a[8:11], v[160:163]
  v_mfma_f32_16x16x32_bf16 v[160:163], a[48:51], a[40:43], v[160:163]
  ds_read_b128 a[104:107], v13 offset:43008
  buffer_load_dwordx4 v2, s[96:99], s13 offen offset:0 lds
  v_mfma_f32_16x16x32_bf16 v[164:167], a[20:23], a[8:11], v[164:167]
  ds_read_b64_tr_b16 a[120:121], v24 offset:40960
  v_mfma_f32_16x16x32_bf16 v[164:167], a[52:55], a[40:43], v[164:167]
  ds_read_b64_tr_b16 a[122:123], v24 offset:45056
  v_mfma_f32_16x16x32_bf16 v[168:171], a[24:27], a[8:11], v[168:171]
  ds_read_b128 a[76:79], v13 offset:35840
  buffer_load_dwordx4 v3, s[96:99], s13 offen offset:1024 lds
  v_mfma_f32_16x16x32_bf16 v[168:171], a[56:59], a[40:43], v[168:171]
  ds_read_b64_tr_b16 a[92:93], v25 offset:32768
  v_mfma_f32_16x16x32_bf16 v[172:175], a[28:31], a[8:11], v[172:175]
  ds_read_b64_tr_b16 a[94:95], v25 offset:36864
  buffer_load_dwordx4 v4, s[96:99], s13 offen offset:2048 lds
  v_mfma_f32_16x16x32_bf16 v[172:175], a[60:63], a[40:43], v[172:175]
  ds_read_b128 a[108:111], v13 offset:44032
  v_mfma_f32_16x16x32_bf16 v[176:179], a[16:19], a[12:15], v[176:179]
  ds_read_b64_tr_b16 a[124:125], v25 offset:40960
  v_mfma_f32_16x16x32_bf16 v[176:179], a[48:51], a[44:47], v[176:179]
  buffer_load_dwordx4 v5, s[96:99], s13 offen offset:3072 lds
  v_mfma_f32_16x16x32_bf16 v[180:183], a[20:23], a[12:15], v[180:183]
  ds_read_b64_tr_b16 a[126:127], v25 offset:45056
  v_mfma_f32_16x16x32_bf16 v[180:183], a[52:55], a[44:47], v[180:183]
  s_add_u32 s13, s13, s32
  v_mfma_f32_16x16x32_bf16 v[184:187], a[24:27], a[12:15], v[184:187]
  v_mfma_f32_16x16x32_bf16 v[184:187], a[56:59], a[44:47], v[184:187]
  v_mfma_f32_16x16x32_bf16 v[188:191], a[28:31], a[12:15], v[188:191]
  v_mfma_f32_16x16x32_bf16 v[188:191], a[60:63], a[44:47], v[188:191]
  s_waitcnt vmcnt(22) lgkmcnt(0)
  s_barrier
  s_waitcnt vmcnt(17)
  v_mfma_f32_16x16x32_bf16 v[128:131], a[80:83], a[64:67], v[128:131]
  ds_read_b128 a[0:3], v12 offset:0
  s_add_u32 m0, s15, 98304
  v_mfma_f32_16x16x32_bf16 v[128:131], a[112:115], a[96:99], v[128:131]
  s_and_b32 s60, s2, 3
  ds_read_b64_tr_b16 a[16:17], v18 offset:0
  v_mfma_f32_16x16x32_bf16 v[132:135], a[84:87], a[64:67], v[132:135]
  s_cmp_eq_u32 s60, s24
  s_cselect_b32 s30, 1, 0
  ds_read_b64_tr_b16 a[18:19], v18 offset:4096
  buffer_load_dwordx4 v8, s[16:19], s12 offen offset:0  lds
  v_mfma_f32_16x16x32_bf16 v[132:135], a[116:119], a[96:99], v[132:135]
  ds_read_b128 a[32:35], v12 offset:8192
  s_cmp_lt_u32 s2, 192
  s_cselect_b32 s30, s30, 0
  v_mfma_f32_16x16x32_bf16 v[136:139], a[88:91], a[64:67], v[136:139]
  ds_read_b64_tr_b16 a[48:49], v18 offset:8192
  s_mul_i32 s28, s2, 171
  v_mfma_f32_16x16x32_bf16 v[136:139], a[120:123], a[96:99], v[136:139]
  buffer_load_dwordx4 v8, s[16:19], s12 offen offset:1024  lds
  ds_read_b64_tr_b16 a[50:51], v18 offset:12288
  s_lshr_b32 s28, s28, 10
  v_mfma_f32_16x16x32_bf16 v[140:143], a[92:95], a[64:67], v[140:143]
  ds_read_b128 a[4:7], v12 offset:1024
  s_min_u32 s28, s28, 31
  v_mfma_f32_16x16x32_bf16 v[140:143], a[124:127], a[96:99], v[140:143]
  ds_read_b64_tr_b16 a[20:21], v19 offset:0
  buffer_load_dwordx4 v8, s[16:19], s12 offen offset:2048  lds
  v_mfma_f32_16x16x32_bf16 v[144:147], a[80:83], a[68:71], v[144:147]
  s_lshr_b32 s60, s28, 1
  v_mfma_f32_16x16x32_bf16 v[144:147], a[112:115], a[100:103], v[144:147]
  ds_read_b64_tr_b16 a[22:23], v19 offset:4096
  s_lshl_b32 s60, s60, 9
  v_mfma_f32_16x16x32_bf16 v[148:151], a[84:87], a[68:71], v[148:151]
  ds_read_b128 a[36:39], v12 offset:9216
  buffer_load_dwordx4 v8, s[16:19], s12 offen offset:3072  lds
  s_add_u32 s60, s60, 33144832
  v_mfma_f32_16x16x32_bf16 v[148:151], a[116:119], a[100:103], v[148:151]
  ds_read_b64_tr_b16 a[52:53], v19 offset:8192
  v_and_b32 v122, 31, v1
  v_mfma_f32_16x16x32_bf16 v[152:155], a[88:91], a[68:71], v[152:155]
  ds_read_b64_tr_b16 a[54:55], v19 offset:12288
  s_add_u32 s12, s12, s31
  v_lshlrev_b32 v122, 3, v122
  v_mfma_f32_16x16x32_bf16 v[152:155], a[120:123], a[100:103], v[152:155]
  ds_read_b128 a[8:11], v12 offset:2048
  v_mfma_f32_16x16x32_bf16 v[156:159], a[92:95], a[68:71], v[156:159]
  v_add_u32 v122, s60, v122
  ds_read_b64_tr_b16 a[24:25], v20 offset:0
  v_mfma_f32_16x16x32_bf16 v[156:159], a[124:127], a[100:103], v[156:159]
  buffer_load_dwordx2 v[120:121], v122, s[16:19], 0 offen sc1
  s_add_u32 m0, s27, 98304
  ds_read_b64_tr_b16 a[26:27], v20 offset:4096
  v_mfma_f32_16x16x32_bf16 v[160:163], a[80:83], a[72:75], v[160:163]
  s_mov_b64 exec, 16
  buffer_store_dwordx2 v[14:15], v0, s[16:19], 0 offen sc1
  s_mov_b64 exec, -1
  v_mfma_f32_16x16x32_bf16 v[160:163], a[112:115], a[104:107], v[160:163]
  ds_read_b128 a[40:43], v12 offset:10240
  s_mov_b32 s4, s52
  buffer_load_dwordx4 v2, s[96:99], s13 offen offset:0 lds
  v_mfma_f32_16x16x32_bf16 v[164:167], a[84:87], a[72:75], v[164:167]
  ds_read_b64_tr_b16 a[56:57], v20 offset:8192
  s_and_b32 s5, s53, 0xffff
  v_mfma_f32_16x16x32_bf16 v[164:167], a[116:119], a[104:107], v[164:167]
  ds_read_b64_tr_b16 a[58:59], v20 offset:12288
  v_mfma_f32_16x16x32_bf16 v[168:171], a[88:91], a[72:75], v[168:171]
  s_mov_b32 s6, 4194304
  ds_read_b128 a[12:15], v12 offset:3072
  buffer_load_dwordx4 v3, s[96:99], s13 offen offset:1024 lds
  v_mfma_f32_16x16x32_bf16 v[168:171], a[120:123], a[104:107], v[168:171]
  s_mov_b32 s7, 0x20000
  ds_read_b64_tr_b16 a[28:29], v21 offset:0
  v_mfma_f32_16x16x32_bf16 v[172:175], a[92:95], a[72:75], v[172:175]
  ds_read_b64_tr_b16 a[30:31], v21 offset:4096
  buffer_load_dwordx4 v4, s[96:99], s13 offen offset:2048 lds
  v_mfma_f32_16x16x32_bf16 v[172:175], a[124:127], a[104:107], v[172:175]
  ds_read_b128 a[44:47], v12 offset:11264
  v_mfma_f32_16x16x32_bf16 v[176:179], a[80:83], a[76:79], v[176:179]
  ds_read_b64_tr_b16 a[60:61], v21 offset:8192
  v_mfma_f32_16x16x32_bf16 v[176:179], a[112:115], a[108:111], v[176:179]
  buffer_load_dwordx4 v5, s[96:99], s13 offen offset:3072 lds
  v_mfma_f32_16x16x32_bf16 v[180:183], a[84:87], a[76:79], v[180:183]
  ds_read_b64_tr_b16 a[62:63], v21 offset:12288
  v_mfma_f32_16x16x32_bf16 v[180:183], a[116:119], a[108:111], v[180:183]
  s_add_u32 s13, s13, s32
  v_mfma_f32_16x16x32_bf16 v[184:187], a[88:91], a[76:79], v[184:187]
  v_mfma_f32_16x16x32_bf16 v[184:187], a[120:123], a[108:111], v[184:187]
  v_mfma_f32_16x16x32_bf16 v[188:191], a[92:95], a[76:79], v[188:191]
  v_mfma_f32_16x16x32_bf16 v[188:191], a[124:127], a[108:111], v[188:191]
  s_waitcnt vmcnt(18) lgkmcnt(0)
  s_barrier
  v_mfma_f32_16x16x32_bf16 v[128:131], a[16:19], a[0:3], v[128:131]
  ds_read_b128 a[64:67], v12 offset:32768
  s_add_u32 m0, s15, 0
  v_mfma_f32_16x16x32_bf16 v[128:131], a[48:51], a[32:35], v[128:131]
  ds_read_b64_tr_b16 a[80:81], v18 offset:32768
  v_mfma_f32_16x16x32_bf16 v[132:135], a[20:23], a[0:3], v[132:135]
  ds_read_b64_tr_b16 a[82:83], v18 offset:36864
  buffer_load_dwordx4 v8, s[16:19], s12 offen offset:0  lds
  v_mfma_f32_16x16x32_bf16 v[132:135], a[52:55], a[32:35], v[132:135]
  ds_read_b128 a[96:99], v12 offset:40960
  v_mfma_f32_16x16x32_bf16 v[136:139], a[24:27], a[0:3], v[136:139]
  ds_read_b64_tr_b16 a[112:113], v18 offset:40960
  v_mfma_f32_16x16x32_bf16 v[136:139], a[56:59], a[32:35], v[136:139]
  buffer_load_dwordx4 v8, s[16:19], s12 offen offset:1024  lds
  ds_read_b64_tr_b16 a[114:115], v18 offset:45056
  v_mfma_f32_16x16x32_bf16 v[140:143], a[28:31], a[0:3], v[140:143]
  ds_read_b128 a[68:71], v12 offset:33792
  v_mfma_f32_16x16x32_bf16 v[140:143], a[60:63], a[32:35], v[140:143]
  ds_read_b64_tr_b16 a[84:85], v19 offset:32768
  buffer_load_dwordx4 v8, s[16:19], s12 offen offset:2048  lds
  v_mfma_f32_16x16x32_bf16 v[144:147], a[16:19], a[4:7], v[144:147]
  v_mfma_f32_16x16x32_bf16 v[144:147], a[48:51], a[36:39], v[144:147]
  ds_read_b64_tr_b16 a[86:87], v19 offset:36864
  v_mfma_f32_16x16x32_bf16 v[148:151], a[20:23], a[4:7], v[148:151]
  ds_read_b128 a[100:103], v12 offset:41984
  buffer_load_dwordx4 v8, s[16:19], s12 offen offset:3072  lds
  v_mfma_f32_16x16x32_bf16 v[148:151], a[52:55], a[36:39], v[148:151]
  ds_read_b64_tr_b16 a[116:117], v19 offset:40960
  v_mfma_f32_16x16x32_bf16 v[152:155], a[24:27], a[4:7], v[152:155]
  ds_read_b64_tr_b16 a[118:119], v19 offset:45056
  s_add_u32 s12, s12, s31
  v_mfma_f32_16x16x32_bf16 v[152:155], a[56:59], a[36:39], v[152:155]
  ds_read_b128 a[72:75], v12 offset:34816
  v_mfma_f32_16x16x32_bf16 v[156:159], a[28:31], a[4:7], v[156:159]
  ds_read_b64_tr_b16 a[88:89], v20 offset:32768
  v_mfma_f32_16x16x32_bf16 v[156:159], a[60:63], a[36:39], v[156:159]
  s_add_u32 m0, s27, 0
  ds_read_b64_tr_b16 a[90:91], v20 offset:36864
  v_mfma_f32_16x16x32_bf16 v[160:163], a[16:19], a[8:11], v[160:163]
  v_mfma_f32_16x16x32_bf16 v[160:163], a[48:51], a[40:43], v[160:163]
  ds_read_b128 a[104:107], v12 offset:43008
  buffer_load_dwordx4 v2, s[96:99], s13 offen offset:0 lds
  v_mfma_f32_16x16x32_bf16 v[164:167], a[20:23], a[8:11], v[164:167]
  ds_read_b64_tr_b16 a[120:121], v20 offset:40960
  v_mfma_f32_16x16x32_bf16 v[164:167], a[52:55], a[40:43], v[164:167]
  ds_read_b64_tr_b16 a[122:123], v20 offset:45056
  v_mfma_f32_16x16x32_bf16 v[168:171], a[24:27], a[8:11], v[168:171]
  ds_read_b128 a[76:79], v12 offset:35840
  buffer_load_dwordx4 v3, s[96:99], s13 offen offset:1024 lds
  v_mfma_f32_16x16x32_bf16 v[168:171], a[56:59], a[40:43], v[168:171]
  ds_read_b64_tr_b16 a[92:93], v21 offset:32768
  v_mfma_f32_16x16x32_bf16 v[172:175], a[28:31], a[8:11], v[172:175]
  ds_read_b64_tr_b16 a[94:95], v21 offset:36864
  buffer_load_dwordx4 v4, s[96:99], s13 offen offset:2048 lds
  v_mfma_f32_16x16x32_bf16 v[172:175], a[60:63], a[40:43], v[172:175]
  ds_read_b128 a[108:111], v12 offset:44032
  v_mfma_f32_16x16x32_bf16 v[176:179], a[16:19], a[12:15], v[176:179]
  ds_read_b64_tr_b16 a[124:125], v21 offset:40960
  v_mfma_f32_16x16x32_bf16 v[176:179], a[48:51], a[44:47], v[176:179]
  buffer_load_dwordx4 v5, s[96:99], s13 offen offset:3072 lds
  v_mfma_f32_16x16x32_bf16 v[180:183], a[20:23], a[12:15], v[180:183]
  ds_read_b64_tr_b16 a[126:127], v21 offset:45056
  v_mfma_f32_16x16x32_bf16 v[180:183], a[52:55], a[44:47], v[180:183]
  s_add_u32 s13, s13, s32
  v_mfma_f32_16x16x32_bf16 v[184:187], a[24:27], a[12:15], v[184:187]
  v_mfma_f32_16x16x32_bf16 v[184:187], a[56:59], a[44:47], v[184:187]
  v_mfma_f32_16x16x32_bf16 v[188:191], a[28:31], a[12:15], v[188:191]
  v_mfma_f32_16x16x32_bf16 v[188:191], a[60:63], a[44:47], v[188:191]
  s_cmp_eq_u32 s30, 0
  s_cbranch_scc1 L_p2r1_nr1
  s_waitcnt vmcnt(13)
L_p2r1_qw:
  v_cmp_eq_u64 vcc, v[120:121], v[14:15]
  s_nop 1
  s_cmp_eq_u64 vcc, -1
  s_cbranch_scc1 L_p2r1_qok
  s_add_u32 s3, s3, 1
  s_cmp_gt_u32 s3, 0x40000
  s_cbranch_scc1 L_p2r1_qok
  s_sleep 4
  buffer_load_dwordx2 v[120:121], v122, s[16:19], 0 offen sc1
  s_waitcnt vmcnt(0)
  s_branch L_p2r1_qw
L_p2r1_qok:
  s_lshr_b32 s60, s28, 1
  s_mul_i32 s60, s60, 84
  s_add_u32 s60, s60, s2
  s_lshl_b32 s60, s60, 10
  s_add_u32 s60, s60, 18874368
  buffer_load_dwordx4 v[48:51], v17, s[16:19], s60 offen
  s_add_u32 s60, s60, 12288
  buffer_load_dwordx4 v[52:55], v17, s[16:19], s60 offen
  s_add_u32 s60, s60, 12288
  buffer_load_dwordx4 v[56:59], v17, s[16:19], s60 offen
  s_add_u32 s60, s60, 12288
  buffer_load_dwordx4 v[60:63], v17, s[16:19], s60 offen
  s_add_u32 s60, s60, 12288
  buffer_load_dwordx4 v[64:67], v17, s[16:19], s60 offen
  s_add_u32 s60, s60, 12288
  buffer_load_dwordx4 v[68:71], v17, s[16:19], s60 offen
  s_add_u32 s60, s60, 12288
  buffer_load_dwordx4 v[72:75], v17, s[16:19], s60 offen
  s_add_u32 s60, s60, 12288
  buffer_load_dwordx4 v[76:79], v17, s[16:19], s60 offen
L_p2r1_nr1:
  s_waitcnt vmcnt(18) lgkmcnt(0)
  s_barrier
  v_mfma_f32_16x16x32_bf16 v[128:131], a[80:83], a[64:67], v[128:131]
  ds_read_b128 a[0:3], v13 offset:0
  s_add_u32 m0, s15, 32768
  v_mfma_f32_16x16x32_bf16 v[128:131], a[112:115], a[96:99], v[128:131]
  ds_read_b64_tr_b16 a[16:17], v22 offset:0
  v_mfma_f32_16x16x32_bf16 v[132:135], a[84:87], a[64:67], v[132:135]
  ds_read_b64_tr_b16 a[18:19], v22 offset:4096
  buffer_load_dwordx4 v8, s[16:19], s12 offen offset:0  lds
  v_mfma_f32_16x16x32_bf16 v[132:135], a[116:119], a[96:99], v[132:135]
  ds_read_b128 a[32:35], v13 offset:8192
  v_mfma_f32_16x16x32_bf16 v[136:139], a[88:91], a[64:67], v[136:139]
  ds_read_b64_tr_b16 a[48:49], v22 offset:8192
  v_mfma_f32_16x16x32_bf16 v[136:139], a[120:123], a[96:99], v[136:139]
  buffer_load_dwordx4 v8, s[16:19], s12 offen offset:1024  lds
  ds_read_b64_tr_b16 a[50:51], v22 offset:12288
  v_mfma_f32_16x16x32_bf16 v[140:143], a[92:95], a[64:67], v[140:143]
  ds_read_b128 a[4:7], v13 offset:1024
  v_mfma_f32_16x16x32_bf16 v[140:143], a[124:127], a[96:99], v[140:143]
  ds_read_b64_tr_b16 a[20:21], v23 offset:0
  buffer_load_dwordx4 v8, s[16:19], s12 offen offset:2048  lds
  v_mfma_f32_16x16x32_bf16 v[144:147], a[80:83], a[68:71], v[144:147]
  v_mfma_f32_16x16x32_bf16 v[144:147], a[112:115], a[100:103], v[144:147]
  ds_read_b64_tr_b16 a[22:23], v23 offset:4096
  v_mfma_f32_16x16x32_bf16 v[148:151], a[84:87], a[68:71], v[148:151]
  ds_read_b128 a[36:39], v13 offset:9216
  buffer_load_dwordx4 v8, s[16:19], s12 offen offset:3072  lds
  v_mfma_f32_16x16x32_bf16 v[148:151], a[116:119], a[100:103], v[148:151]
  ds_read_b64_tr_b16 a[52:53], v23 offset:8192
  v_mfma_f32_16x16x32_bf16 v[152:155], a[88:91], a[68:71], v[152:155]
  ds_read_b64_tr_b16 a[54:55], v23 offset:12288
  s_add_u32 s12, s12, s31
  v_mfma_f32_16x16x32_bf16 v[152:155], a[120:123], a[100:103], v[152:155]
  ds_read_b128 a[8:11], v13 offset:2048
  v_mfma_f32_16x16x32_bf16 v[156:159], a[92:95], a[68:71], v[156:159]
  ds_read_b64_tr_b16 a[24:25], v24 offset:0
  v_mfma_f32_16x16x32_bf16 v[156:159], a[124:127], a[100:103], v[156:159]
  s_add_u32 m0, s27, 32768
  ds_read_b64_tr_b16 a[26:27], v24 offset:4096
  v_mfma_f32_16x16x32_bf16 v[160:163], a[80:83], a[72:75], v[160:163]
  v_mfma_f32_16x16x32_bf16 v[160:163], a[112:115], a[104:107], v[160:163]
  ds_read_b128 a[40:43], v13 offset:10240
  buffer_load_dwordx4 v2, s[96:99], s13 offen offset:0 lds
  v_mfma_f32_16x16x32_bf16 v[164:167], a[84:87], a[72:75], v[164:167]
  ds_read_b64_tr_b16 a[56:57], v24 offset:8192
  v_mfma_f32_16x16x32_bf16 v[164:167], a[116:119], a[104:107], v[164:167]
  ds_read_b64_tr_b16 a[58:59], v24 offset:12288
  v_mfma_f32_16x16x32_bf16 v[168:171], a[88:91], a[72:75], v[168:171]
  ds_read_b128 a[12:15], v13 offset:3072
  buffer_load_dwordx4 v3, s[96:99], s13 offen offset:1024 lds
  v_mfma_f32_16x16x32_bf16 v[168:171], a[120:123], a[104:107], v[168:171]
  ds_read_b64_tr_b16 a[28:29], v25 offset:0
  v_mfma_f32_16x16x32_bf16 v[172:175], a[92:95], a[72:75], v[172:175]
  ds_read_b64_tr_b16 a[30:31], v25 offset:4096
  buffer_load_dwordx4 v4, s[96:99], s13 offen offset:2048 lds
  v_mfma_f32_16x16x32_bf16 v[172:175], a[124:127], a[104:107], v[172:175]
  ds_read_b128 a[44:47], v13 offset:11264
  v_mfma_f32_16x16x32_bf16 v[176:179], a[80:83], a[76:79], v[176:179]
  ds_read_b64_tr_b16 a[60:61], v25 offset:8192
  v_mfma_f32_16x16x32_bf16 v[176:179], a[112:115], a[108:111], v[176:179]
  buffer_load_dwordx4 v5, s[96:99], s13 offen offset:3072 lds
  v_mfma_f32_16x16x32_bf16 v[180:183], a[84:87], a[76:79], v[180:183]
  ds_read_b64_tr_b16 a[62:63], v25 offset:12288
  v_mfma_f32_16x16x32_bf16 v[180:183], a[116:119], a[108:111], v[180:183]
  s_add_u32 s13, s13, s32
  v_mfma_f32_16x16x32_bf16 v[184:187], a[88:91], a[76:79], v[184:187]
  v_mfma_f32_16x16x32_bf16 v[184:187], a[120:123], a[108:111], v[184:187]
  v_mfma_f32_16x16x32_bf16 v[188:191], a[92:95], a[76:79], v[188:191]
  v_mfma_f32_16x16x32_bf16 v[188:191], a[124:127], a[108:111], v[188:191]
  s_waitcnt vmcnt(16) lgkmcnt(0)
  s_barrier
  v_mfma_f32_16x16x32_bf16 v[128:131], a[16:19], a[0:3], v[128:131]
  ds_read_b128 a[64:67], v13 offset:32768
  s_add_u32 m0, s15, 65536
  v_mfma_f32_16x16x32_bf16 v[128:131], a[48:51], a[32:35], v[128:131]
  ds_read_b64_tr_b16 a[80:81], v22 offset:32768
  v_mfma_f32_16x16x32_bf16 v[132:135], a[20:23], a[0:3], v[132:135]
  ds_read_b64_tr_b16 a[82:83], v22 offset:36864
  buffer_load_dwordx4 v8, s[16:19], s12 offen offset:0  lds
  v_mfma_f32_16x16x32_bf16 v[132:135], a[52:55], a[32:35], v[132:135]
  ds_read_b128 a[96:99], v13 offset:40960
  v_mfma_f32_16x16x32_bf16 v[136:139], a[24:27], a[0:3], v[136:139]
  ds_read_b64_tr_b16 a[112:113], v22 offset:40960
  v_mfma_f32_16x16x32_bf16 v[136:139], a[56:59], a[32:35], v[136:139]
  buffer_load_dwordx4 v8, s[16:19], s12 offen offset:1024  lds
  ds_read_b64_tr_b16 a[114:115], v22 offset:45056
  v_mfma_f32_16x16x32_bf16 v[140:143], a[28:31], a[0:3], v[140:143]
  ds_read_b128 a[68:71], v13 offset:33792
  v_mfma_f32_16x16x32_bf16 v[140:143], a[60:63], a[32:35], v[140:143]
  ds_read_b64_tr_b16 a[84:85], v23 offset:32768
  buffer_load_dwordx4 v8, s[16:19], s12 offen offset:2048  lds
  v_mfma_f32_16x16x32_bf16 v[144:147], a[16:19], a[4:7], v[144:147]
  v_mfma_f32_16x16x32_bf16 v[144:147], a[48:51], a[36:39], v[144:147]
  ds_read_b64_tr_b16 a[86:87], v23 offset:36864
  v_mfma_f32_16x16x32_bf16 v[148:151], a[20:23], a[4:7], v[148:151]
  ds_read_b128 a[100:103], v13 offset:41984
  buffer_load_dwordx4 v8, s[16:19], s12 offen offset:3072  lds
  v_mfma_f32_16x16x32_bf16 v[148:151], a[52:55], a[36:39], v[148:151]
  ds_read_b64_tr_b16 a[116:117], v23 offset:40960
  v_mfma_f32_16x16x32_bf16 v[152:155], a[24:27], a[4:7], v[152:155]
  ds_read_b64_tr_b16 a[118:119], v23 offset:45056
  s_add_u32 s12, s12, s31
  v_mfma_f32_16x16x32_bf16 v[152:155], a[56:59], a[36:39], v[152:155]
  ds_read_b128 a[72:75], v13 offset:34816
  v_mfma_f32_16x16x32_bf16 v[156:159], a[28:31], a[4:7], v[156:159]
  ds_read_b64_tr_b16 a[88:89], v24 offset:32768
  v_mfma_f32_16x16x32_bf16 v[156:159], a[60:63], a[36:39], v[156:159]
  s_add_u32 m0, s27, 65536
  ds_read_b64_tr_b16 a[90:91], v24 offset:36864
  v_mfma_f32_16x16x32_bf16 v[160:163], a[16:19], a[8:11], v[160:163]
  v_mfma_f32_16x16x32_bf16 v[160:163], a[48:51], a[40:43], v[160:163]
  ds_read_b128 a[104:107], v13 offset:43008
  buffer_load_dwordx4 v2, s[96:99], s13 offen offset:0 lds
  v_mfma_f32_16x16x32_bf16 v[164:167], a[20:23], a[8:11], v[164:167]
  ds_read_b64_tr_b16 a[120:121], v24 offset:40960
  v_mfma_f32_16x16x32_bf16 v[164:167], a[52:55], a[40:43], v[164:167]
  ds_read_b64_tr_b16 a[122:123], v24 offset:45056
  v_mfma_f32_16x16x32_bf16 v[168:171], a[24:27], a[8:11], v[168:171]
  ds_read_b128 a[76:79], v13 offset:35840
  buffer_load_dwordx4 v3, s[96:99], s13 offen offset:1024 lds
  v_mfma_f32_16x16x32_bf16 v[168:171], a[56:59], a[40:43], v[168:171]
  ds_read_b64_tr_b16 a[92:93], v25 offset:32768
  v_mfma_f32_16x16x32_bf16 v[172:175], a[28:31], a[8:11], v[172:175]
  ds_read_b64_tr_b16 a[94:95], v25 offset:36864
  buffer_load_dwordx4 v4, s[96:99], s13 offen offset:2048 lds
  v_mfma_f32_16x16x32_bf16 v[172:175], a[60:63], a[40:43], v[172:175]
  ds_read_b128 a[108:111], v13 offset:44032
  v_mfma_f32_16x16x32_bf16 v[176:179], a[16:19], a[12:15], v[176:179]
  ds_read_b64_tr_b16 a[124:125], v25 offset:40960
  v_mfma_f32_16x16x32_bf16 v[176:179], a[48:51], a[44:47], v[176:179]
  buffer_load_dwordx4 v5, s[96:99], s13 offen offset:3072 lds
  v_mfma_f32_16x16x32_bf16 v[180:183], a[20:23], a[12:15], v[180:183]
  ds_read_b64_tr_b16 a[126:127], v25 offset:45056
  v_mfma_f32_16x16x32_bf16 v[180:183], a[52:55], a[44:47], v[180:183]
  s_add_u32 s13, s13, s32
  v_mfma_f32_16x16x32_bf16 v[184:187], a[24:27], a[12:15], v[184:187]
  v_mfma_f32_16x16x32_bf16 v[184:187], a[56:59], a[44:47], v[184:187]
  v_mfma_f32_16x16x32_bf16 v[188:191], a[28:31], a[12:15], v[188:191]
  v_mfma_f32_16x16x32_bf16 v[188:191], a[60:63], a[44:47], v[188:191]
  s_cmp_eq_u32 s30, 0
  s_cbranch_scc1 L_p2r1_nr2
  s_waitcnt vmcnt(16)
  v_pk_add_f32 v[48:49], v[48:49], v[52:53]
  v_pk_add_f32 v[50:51], v[50:51], v[54:55]
  v_pk_add_f32 v[56:57], v[56:57], v[60:61]
  v_pk_add_f32 v[58:59], v[58:59], v[62:63]
  v_pk_add_f32 v[64:65], v[64:65], v[68:69]
  v_pk_add_f32 v[66:67], v[66:67], v[70:71]
  v_pk_add_f32 v[72:73], v[72:73], v[76:77]
  v_pk_add_f32 v[74:75], v[74:75], v[78:79]
  v_pk_add_f32 v[48:49], v[48:49], v[56:57]
  v_pk_add_f32 v[50:51], v[50:51], v[58:59]
  v_pk_add_f32 v[64:65], v[64:65], v[72:73]
  v_pk_add_f32 v[66:67], v[66:67], v[74:75]
  v_pk_add_f32 v[48:49], v[48:49], v[64:65]
  v_pk_add_f32 v[50:51], v[50:51], v[66:67]
  v_cvt_pk_bf16_f32 v48, v48, v49
  v_cvt_pk_bf16_f32 v49, v50, v51
  s_mul_i32 s60, s28, 6
  s_sub_u32 s60, s2, s60
  s_cmp_ge_u32 s60, 3
  s_cselect_b32 s61, 1, 0
  s_mul_i32 s62, s61, 3
  s_sub_u32 s60, s60, s62
  s_mul_i32 s62, s28, 3
  s_add_u32 s60, s60, s62
  s_lshl_b32 s60, s60, 10
  s_lshl_b32 s61, s61, 9
  s_add_u32 s60, s60, s61
  s_add_u32 s60, s60, 20447232
  v_lshlrev_b32 v30, 3, v1
  buffer_store_dwordx2 v[48:49], v30, s[16:19], s60 offen sc1
L_p2r1_nr2:
  s_waitcnt vmcnt(16) lgkmcnt(0)
  s_barrier
  v_mfma_f32_16x16x32_bf16 v[128:131], a[80:83], a[64:67], v[128:131]
  ds_read_b128 a[0:3], v12 offset:0
  s_add_u32 m0, s15, 98304
  v_mfma_f32_16x16x32_bf16 v[128:131], a[112:115], a[96:99], v[128:131]
  ds_read_b64_tr_b16 a[16:17], v18 offset:0
  v_mfma_f32_16x16x32_bf16 v[132:135], a[84:87], a[64:67], v[132:135]
  ds_read_b64_tr_b16 a[18:19], v18 offset:4096
  buffer_load_dwordx4 v8, s[16:19], s12 offen offset:0  lds
  v_mfma_f32_16x16x32_bf16 v[132:135], a[116:119], a[96:99], v[132:135]
  ds_read_b128 a[32:35], v12 offset:8192
  v_mfma_f32_16x16x32_bf16 v[136:139], a[88:91], a[64:67], v[136:139]
  ds_read_b64_tr_b16 a[48:49], v18 offset:8192
  v_mfma_f32_16x16x32_bf16 v[136:139], a[120:123], a[96:99], v[136:139]
  buffer_load_dwordx4 v8, s[16:19], s12 offen offset:1024  lds
  ds_read_b64_tr_b16 a[50:51], v18 offset:12288
  v_mfma_f32_16x16x32_bf16 v[140:143], a[92:95], a[64:67], v[140:143]
  ds_read_b128 a[4:7], v12 offset:1024
  v_mfma_f32_16x16x32_bf16 v[140:143], a[124:127], a[96:99], v[140:143]
  ds_read_b64_tr_b16 a[20:21], v19 offset:0
  buffer_load_dwordx4 v8, s[16:19], s12 offen offset:2048  lds
  v_mfma_f32_16x16x32_bf16 v[144:147], a[80:83], a[68:71], v[144:147]
  v_mfma_f32_16x16x32_bf16 v[144:147], a[112:115], a[100:103], v[144:147]
  ds_read_b64_tr_b16 a[22:23], v19 offset:4096
  v_mfma_f32_16x16x32_bf16 v[148:151], a[84:87], a[68:71], v[148:151]
  ds_read_b128 a[36:39], v12 offset:9216
  buffer_load_dwordx4 v8, s[16:19], s12 offen offset:3072  lds
  v_mfma_f32_16x16x32_bf16 v[148:151], a[116:119], a[100:103], v[148:151]
  ds_read_b64_tr_b16 a[52:53], v19 offset:8192
  v_mfma_f32_16x16x32_bf16 v[152:155], a[88:91], a[68:71], v[152:155]
  ds_read_b64_tr_b16 a[54:55], v19 offset:12288
  s_add_u32 s12, s12, s31
  v_mfma_f32_16x16x32_bf16 v[152:155], a[120:123], a[100:103], v[152:155]
  ds_read_b128 a[8:11], v12 offset:2048
  v_mfma_f32_16x16x32_bf16 v[156:159], a[92:95], a[68:71], v[156:159]
  ds_read_b64_tr_b16 a[24:25], v20 offset:0
  v_mfma_f32_16x16x32_bf16 v[156:159], a[124:127], a[100:103], v[156:159]
  s_add_u32 m0, s27, 98304
  ds_read_b64_tr_b16 a[26:27], v20 offset:4096
  v_mfma_f32_16x16x32_bf16 v[160:163], a[80:83], a[72:75], v[160:163]
  v_mfma_f32_16x16x32_bf16 v[160:163], a[112:115], a[104:107], v[160:163]
  ds_read_b128 a[40:43], v12 offset:10240
  buffer_load_dwordx4 v2, s[96:99], s13 offen offset:0 lds
  v_mfma_f32_16x16x32_bf16 v[164:167], a[84:87], a[72:75], v[164:167]
  ds_read_b64_tr_b16 a[56:57], v20 offset:8192
  v_mfma_f32_16x16x32_bf16 v[164:167], a[116:119], a[104:107], v[164:167]
  ds_read_b64_tr_b16 a[58:59], v20 offset:12288
  v_mfma_f32_16x16x32_bf16 v[168:171], a[88:91], a[72:75], v[168:171]
  ds_read_b128 a[12:15], v12 offset:3072
  buffer_load_dwordx4 v3, s[96:99], s13 offen offset:1024 lds
  v_mfma_f32_16x16x32_bf16 v[168:171], a[120:123], a[104:107], v[168:171]
  ds_read_b64_tr_b16 a[28:29], v21 offset:0
  v_mfma_f32_16x16x32_bf16 v[172:175], a[92:95], a[72:75], v[172:175]
  ds_read_b64_tr_b16 a[30:31], v21 offset:4096
  buffer_load_dwordx4 v4, s[96:99], s13 offen offset:2048 lds
  v_mfma_f32_16x16x32_bf16 v[172:175], a[124:127], a[104:107], v[172:175]
  ds_read_b128 a[44:47], v12 offset:11264
  v_mfma_f32_16x16x32_bf16 v[176:179], a[80:83], a[76:79], v[176:179]
  ds_read_b64_tr_b16 a[60:61], v21 offset:8192
  v_mfma_f32_16x16x32_bf16 v[176:179], a[112:115], a[108:111], v[176:179]
  buffer_load_dwordx4 v5, s[96:99], s13 offen offset:3072 lds
  v_mfma_f32_16x16x32_bf16 v[180:183], a[84:87], a[76:79], v[180:183]
  ds_read_b64_tr_b16 a[62:63], v21 offset:12288
  v_mfma_f32_16x16x32_bf16 v[180:183], a[116:119], a[108:111], v[180:183]
  s_add_u32 s13, s13, s32
  v_mfma_f32_16x16x32_bf16 v[184:187], a[88:91], a[76:79], v[184:187]
  v_mfma_f32_16x16x32_bf16 v[184:187], a[120:123], a[108:111], v[184:187]
  v_mfma_f32_16x16x32_bf16 v[188:191], a[92:95], a[76:79], v[188:191]
  v_mfma_f32_16x16x32_bf16 v[188:191], a[124:127], a[108:111], v[188:191]
  s_waitcnt vmcnt(16) lgkmcnt(0)
  s_barrier
  v_mfma_f32_16x16x32_bf16 v[128:131], a[16:19], a[0:3], v[128:131]
  ds_read_b128 a[64:67], v12 offset:32768
  s_add_u32 m0, s15, 0
  v_mfma_f32_16x16x32_bf16 v[128:131], a[48:51], a[32:35], v[128:131]
  ds_read_b64_tr_b16 a[80:81], v18 offset:32768
  v_mfma_f32_16x16x32_bf16 v[132:135], a[20:23], a[0:3], v[132:135]
  ds_read_b64_tr_b16 a[82:83], v18 offset:36864
  buffer_load_dwordx4 v8, s[16:19], s12 offen offset:0  lds
  v_mfma_f32_16x16x32_bf16 v[132:135], a[52:55], a[32:35], v[132:135]
  ds_read_b128 a[96:99], v12 offset:40960
  v_mfma_f32_16x16x32_bf16 v[136:139], a[24:27], a[0:3], v[136:139]
  ds_read_b64_tr_b16 a[112:113], v18 offset:40960
  v_mfma_f32_16x16x32_bf16 v[136:139], a[56:59], a[32:35], v[136:139]
  buffer_load_dwordx4 v8, s[16:19], s12 offen offset:1024  lds
  ds_read_b64_tr_b16 a[114:115], v18 offset:45056
  v_mfma_f32_16x16x32_bf16 v[140:143], a[28:31], a[0:3], v[140:143]
  ds_read_b128 a[68:71], v12 offset:33792
  v_mfma_f32_16x16x32_bf16 v[140:143], a[60:63], a[32:35], v[140:143]
  ds_read_b64_tr_b16 a[84:85], v19 offset:32768
  buffer_load_dwordx4 v8, s[16:19], s12 offen offset:2048  lds
  v_mfma_f32_16x16x32_bf16 v[144:147], a[16:19], a[4:7], v[144:147]
  v_mfma_f32_16x16x32_bf16 v[144:147], a[48:51], a[36:39], v[144:147]
  ds_read_b64_tr_b16 a[86:87], v19 offset:36864
  v_mfma_f32_16x16x32_bf16 v[148:151], a[20:23], a[4:7], v[148:151]
  ds_read_b128 a[100:103], v12 offset:41984
  buffer_load_dwordx4 v8, s[16:19], s12 offen offset:3072  lds
  v_mfma_f32_16x16x32_bf16 v[148:151], a[52:55], a[36:39], v[148:151]
  ds_read_b64_tr_b16 a[116:117], v19 offset:40960
  v_mfma_f32_16x16x32_bf16 v[152:155], a[24:27], a[4:7], v[152:155]
  ds_read_b64_tr_b16 a[118:119], v19 offset:45056
  s_add_u32 s12, s12, s31
  v_mfma_f32_16x16x32_bf16 v[152:155], a[56:59], a[36:39], v[152:155]
  ds_read_b128 a[72:75], v12 offset:34816
  v_mfma_f32_16x16x32_bf16 v[156:159], a[28:31], a[4:7], v[156:159]
  ds_read_b64_tr_b16 a[88:89], v20 offset:32768
  v_mfma_f32_16x16x32_bf16 v[156:159], a[60:63], a[36:39], v[156:159]
  s_add_u32 m0, s27, 0
  ds_read_b64_tr_b16 a[90:91], v20 offset:36864
  v_mfma_f32_16x16x32_bf16 v[160:163], a[16:19], a[8:11], v[160:163]
  v_mfma_f32_16x16x32_bf16 v[160:163], a[48:51], a[40:43], v[160:163]
  ds_read_b128 a[104:107], v12 offset:43008
  buffer_load_dwordx4 v2, s[96:99], s13 offen offset:0 lds
  v_mfma_f32_16x16x32_bf16 v[164:167], a[20:23], a[8:11], v[164:167]
  ds_read_b64_tr_b16 a[120:121], v20 offset:40960
  v_mfma_f32_16x16x32_bf16 v[164:167], a[52:55], a[40:43], v[164:167]
  ds_read_b64_tr_b16 a[122:123], v20 offset:45056
  v_mfma_f32_16x16x32_bf16 v[168:171], a[24:27], a[8:11], v[168:171]
  ds_read_b128 a[76:79], v12 offset:35840
  buffer_load_dwordx4 v3, s[96:99], s13 offen offset:1024 lds
  v_mfma_f32_16x16x32_bf16 v[168:171], a[56:59], a[40:43], v[168:171]
  ds_read_b64_tr_b16 a[92:93], v21 offset:32768
  v_mfma_f32_16x16x32_bf16 v[172:175], a[28:31], a[8:11], v[172:175]
  ds_read_b64_tr_b16 a[94:95], v21 offset:36864
  buffer_load_dwordx4 v4, s[96:99], s13 offen offset:2048 lds
  v_mfma_f32_16x16x32_bf16 v[172:175], a[60:63], a[40:43], v[172:175]
  ds_read_b128 a[108:111], v12 offset:44032
  v_mfma_f32_16x16x32_bf16 v[176:179], a[16:19], a[12:15], v[176:179]
  ds_read_b64_tr_b16 a[124:125], v21 offset:40960
  v_mfma_f32_16x16x32_bf16 v[176:179], a[48:51], a[44:47], v[176:179]
  buffer_load_dwordx4 v5, s[96:99], s13 offen offset:3072 lds
  v_mfma_f32_16x16x32_bf16 v[180:183], a[20:23], a[12:15], v[180:183]
  ds_read_b64_tr_b16 a[126:127], v21 offset:45056
  v_mfma_f32_16x16x32_bf16 v[180:183], a[52:55], a[44:47], v[180:183]
  s_add_u32 s13, s13, s32
  v_mfma_f32_16x16x32_bf16 v[184:187], a[24:27], a[12:15], v[184:187]
  v_mfma_f32_16x16x32_bf16 v[184:187], a[56:59], a[44:47], v[184:187]
  v_mfma_f32_16x16x32_bf16 v[188:191], a[28:31], a[12:15], v[188:191]
  v_mfma_f32_16x16x32_bf16 v[188:191], a[60:63], a[44:47], v[188:191]
  s_cmp_eq_u32 s30, 0
  s_cbranch_scc1 L_p2r1_nr3
  s_waitcnt vmcnt(16)
  s_mov_b64 exec, 32
  buffer_store_dwordx2 v[14:15], v0, s[16:19], 0 offen sc1
  s_mov_b64 exec, -1
L_p2r1_nr3:
  s_waitcnt vmcnt(16) lgkmcnt(0)
  s_barrier
  v_mfma_f32_16x16x32_bf16 v[128:131], a[80:83], a[64:67], v[128:131]
  ds_read_b128 a[0:3], v13 offset:0
  s_add_u32 m0, s15, 32768
  v_mfma_f32_16x16x32_bf16 v[128:131], a[112:115], a[96:99], v[128:131]
  ds_read_b64_tr_b16 a[16:17], v22 offset:0
  v_mfma_f32_16x16x32_bf16 v[132:135], a[84:87], a[64:67], v[132:135]
  ds_read_b64_tr_b16 a[18:19], v22 offset:4096
  buffer_load_dwordx4 v8, s[16:19], s12 offen offset:0  lds
  v_mfma_f32_16x16x32_bf16 v[132:135], a[116:119], a[96:99], v[132:135]
  ds_read_b128 a[32:35], v13 offset:8192
  v_mfma_f32_16x16x32_bf16 v[136:139], a[88:91], a[64:67], v[136:139]
  ds_read_b64_tr_b16 a[48:49], v22 offset:8192
  v_mfma_f32_16x16x32_bf16 v[136:139], a[120:123], a[96:99], v[136:139]
  buffer_load_dwordx4 v8, s[16:19], s12 offen offset:1024  lds
  ds_read_b64_tr_b16 a[50:51], v22 offset:12288
  v_mfma_f32_16x16x32_bf16 v[140:143], a[92:95], a[64:67], v[140:143]
  ds_read_b128 a[4:7], v13 offset:1024
  v_mfma_f32_16x16x32_bf16 v[140:143], a[124:127], a[96:99], v[140:143]
  ds_read_b64_tr_b16 a[20:21], v23 offset:0
  buffer_load_dwordx4 v8, s[16:19], s12 offen offset:2048  lds
  v_mfma_f32_16x16x32_bf16 v[144:147], a[80:83], a[68:71], v[144:147]
  v_mfma_f32_16x16x32_bf16 v[144:147], a[112:115], a[100:103], v[144:147]
  ds_read_b64_tr_b16 a[22:23], v23 offset:4096
  v_mfma_f32_16x16x32_bf16 v[148:151], a[84:87], a[68:71], v[148:151]
  ds_read_b128 a[36:39], v13 offset:9216
  buffer_load_dwordx4 v8, s[16:19], s12 offen offset:3072  lds
  v_mfma_f32_16x16x32_bf16 v[148:151], a[116:119], a[100:103], v[148:151]
  ds_read_b64_tr_b16 a[52:53], v23 offset:8192
  v_mfma_f32_16x16x32_bf16 v[152:155], a[88:91], a[68:71], v[152:155]
  ds_read_b64_tr_b16 a[54:55], v23 offset:12288
  s_add_u32 s12, s12, s31
  v_mfma_f32_16x16x32_bf16 v[152:155], a[120:123], a[100:103], v[152:155]
  ds_read_b128 a[8:11], v13 offset:2048
  v_mfma_f32_16x16x32_bf16 v[156:159], a[92:95], a[68:71], v[156:159]
  ds_read_b64_tr_b16 a[24:25], v24 offset:0
  v_mfma_f32_16x16x32_bf16 v[156:159], a[124:127], a[100:103], v[156:159]
  s_add_u32 m0, s27, 32768
  ds_read_b64_tr_b16 a[26:27], v24 offset:4096
  v_mfma_f32_16x16x32_bf16 v[160:163], a[80:83], a[72:75], v[160:163]
  v_mfma_f32_16x16x32_bf16 v[160:163], a[112:115], a[104:107], v[160:163]
  ds_read_b128 a[40:43], v13 offset:10240
  buffer_load_dwordx4 v2, s[96:99], s13 offen offset:0 lds
  v_mfma_f32_16x16x32_bf16 v[164:167], a[84:87], a[72:75], v[164:167]
  ds_read_b64_tr_b16 a[56:57], v24 offset:8192
  v_mfma_f32_16x16x32_bf16 v[164:167], a[116:119], a[104:107], v[164:167]
  ds_read_b64_tr_b16 a[58:59], v24 offset:12288
  v_mfma_f32_16x16x32_bf16 v[168:171], a[88:91], a[72:75], v[168:171]
  ds_read_b128 a[12:15], v13 offset:3072
  buffer_load_dwordx4 v3, s[96:99], s13 offen offset:1024 lds
  v_mfma_f32_16x16x32_bf16 v[168:171], a[120:123], a[104:107], v[168:171]
  ds_read_b64_tr_b16 a[28:29], v25 offset:0
  v_mfma_f32_16x16x32_bf16 v[172:175], a[92:95], a[72:75], v[172:175]
  ds_read_b64_tr_b16 a[30:31], v25 offset:4096
  buffer_load_dwordx4 v4, s[96:99], s13 offen offset:2048 lds
  v_mfma_f32_16x16x32_bf16 v[172:175], a[124:127], a[104:107], v[172:175]
  ds_read_b128 a[44:47], v13 offset:11264
  v_mfma_f32_16x16x32_bf16 v[176:179], a[80:83], a[76:79], v[176:179]
  ds_read_b64_tr_b16 a[60:61], v25 offset:8192
  v_mfma_f32_16x16x32_bf16 v[176:179], a[112:115], a[108:111], v[176:179]
  buffer_load_dwordx4 v5, s[96:99], s13 offen offset:3072 lds
  v_mfma_f32_16x16x32_bf16 v[180:183], a[84:87], a[76:79], v[180:183]
  ds_read_b64_tr_b16 a[62:63], v25 offset:12288
  v_mfma_f32_16x16x32_bf16 v[180:183], a[116:119], a[108:111], v[180:183]
  s_add_u32 s13, s13, s32
  v_mfma_f32_16x16x32_bf16 v[184:187], a[88:91], a[76:79], v[184:187]
  v_mfma_f32_16x16x32_bf16 v[184:187], a[120:123], a[108:111], v[184:187]
  v_mfma_f32_16x16x32_bf16 v[188:191], a[92:95], a[76:79], v[188:191]
  v_mfma_f32_16x16x32_bf16 v[188:191], a[124:127], a[108:111], v[188:191]
  s_waitcnt vmcnt(16) lgkmcnt(0)
  s_barrier
  v_mfma_f32_16x16x32_bf16 v[128:131], a[16:19], a[0:3], v[128:131]
  ds_read_b128 a[64:67], v13 offset:32768
  s_add_u32 m0, s15, 65536
  v_mfma_f32_16x16x32_bf16 v[128:131], a[48:51], a[32:35], v[128:131]
  s_lshl_b32 s60, s8, 9
  ds_read_b64_tr_b16 a[80:81], v22 offset:32768
  v_mfma_f32_16x16x32_bf16 v[132:135], a[20:23], a[0:3], v[132:135]
  s_add_u32 s60, s60, 33136640
  ds_read_b64_tr_b16 a[82:83], v22 offset:36864
  buffer_load_dwordx4 v8, s[16:19], s12 offen offset:0  lds
  v_mfma_f32_16x16x32_bf16 v[132:135], a[52:55], a[32:35], v[132:135]
  ds_read_b128 a[96:99], v13 offset:40960
  v_lshlrev_b32 v9, 3, v1
  v_mfma_f32_16x16x32_bf16 v[136:139], a[24:27], a[0:3], v[136:139]
  ds_read_b64_tr_b16 a[112:113], v22 offset:40960
  v_add_u32 v9, s60, v9
  v_mfma_f32_16x16x32_bf16 v[136:139], a[56:59], a[32:35], v[136:139]
  buffer_load_dwordx4 v8, s[16:19], s12 offen offset:1024  lds
  ds_read_b64_tr_b16 a[114:115], v22 offset:45056
  buffer_load_dwordx2 v[10:11], v9, s[16:19], 0 offen sc1
  v_mfma_f32_16x16x32_bf16 v[140:143], a[28:31], a[0:3], v[140:143]
  ds_read_b128 a[68:71], v13 offset:33792
  v_mfma_f32_16x16x32_bf16 v[140:143], a[60:63], a[32:35], v[140:143]
  ds_read_b64_tr_b16 a[84:85], v23 offset:32768
  buffer_load_dwordx4 v8, s[16:19], s12 offen offset:2048  lds
  v_mfma_f32_16x16x32_bf16 v[144:147], a[16:19], a[4:7], v[144:147]
  v_mfma_f32_16x16x32_bf16 v[144:147], a[48:51], a[36:39], v[144:147]
  ds_read_b64_tr_b16 a[86:87], v23 offset:36864
  v_mfma_f32_16x16x32_bf16 v[148:151], a[20:23], a[4:7], v[148:151]
  ds_read_b128 a[100:103], v13 offset:41984
  buffer_load_dwordx4 v8, s[16:19], s12 offen offset:3072  lds
  v_mfma_f32_16x16x32_bf16 v[148:151], a[52:55], a[36:39], v[148:151]
  ds_read_b64_tr_b16 a[116:117], v23 offset:40960
  v_mfma_f32_16x16x32_bf16 v[152:155], a[24:27], a[4:7], v[152:155]
  ds_read_b64_tr_b16 a[118:119], v23 offset:45056
  s_add_u32 s12, s12, s31
  v_mfma_f32_16x16x32_bf16 v[152:155], a[56:59], a[36:39], v[152:155]
  ds_read_b128 a[72:75], v13 offset:34816
  v_mfma_f32_16x16x32_bf16 v[156:159], a[28:31], a[4:7], v[156:159]
  ds_read_b64_tr_b16 a[88:89], v24 offset:32768
  v_mfma_f32_16x16x32_bf16 v[156:159], a[60:63], a[36:39], v[156:159]
  s_add_u32 m0, s27, 65536
  ds_read_b64_tr_b16 a[90:91], v24 offset:36864
  v_mfma_f32_16x16x32_bf16 v[160:163], a[16:19], a[8:11], v[160:163]
  v_mfma_f32_16x16x32_bf16 v[160:163], a[48:51], a[40:43], v[160:163]
  ds_read_b128 a[104:107], v13 offset:43008
  buffer_load_dwordx4 v2, s[96:99], s13 offen offset:0 lds
  v_mfma_f32_16x16x32_bf16 v[164:167], a[20:23], a[8:11], v[164:167]
  ds_read_b64_tr_b16 a[120:121], v24 offset:40960
  v_mfma_f32_16x16x32_bf16 v[164:167], a[52:55], a[40:43], v[164:167]
  ds_read_b64_tr_b16 a[122:123], v24 offset:45056
  v_mfma_f32_16x16x32_bf16 v[168:171], a[24:27], a[8:11], v[168:171]
  ds_read_b128 a[76:79], v13 offset:35840
  buffer_load_dwordx4 v3, s[96:99], s13 offen offset:1024 lds
  v_mfma_f32_16x16x32_bf16 v[168:171], a[56:59], a[40:43], v[168:171]
  ds_read_b64_tr_b16 a[92:93], v25 offset:32768
  v_mfma_f32_16x16x32_bf16 v[172:175], a[28:31], a[8:11], v[172:175]
  ds_read_b64_tr_b16 a[94:95], v25 offset:36864
  buffer_load_dwordx4 v4, s[96:99], s13 offen offset:2048 lds
  v_mfma_f32_16x16x32_bf16 v[172:175], a[60:63], a[40:43], v[172:175]
  ds_read_b128 a[108:111], v13 offset:44032
  v_mfma_f32_16x16x32_bf16 v[176:179], a[16:19], a[12:15], v[176:179]
  ds_read_b64_tr_b16 a[124:125], v25 offset:40960
  v_mfma_f32_16x16x32_bf16 v[176:179], a[48:51], a[44:47], v[176:179]
  buffer_load_dwordx4 v5, s[96:99], s13 offen offset:3072 lds
  v_mfma_f32_16x16x32_bf16 v[180:183], a[20:23], a[12:15], v[180:183]
  ds_read_b64_tr_b16 a[126:127], v25 offset:45056
  v_mfma_f32_16x16x32_bf16 v[180:183], a[52:55], a[44:47], v[180:183]
  s_add_u32 s13, s13, s32
  v_mfma_f32_16x16x32_bf16 v[184:187], a[24:27], a[12:15], v[184:187]
  v_mfma_f32_16x16x32_bf16 v[184:187], a[56:59], a[44:47], v[184:187]
  v_mfma_f32_16x16x32_bf16 v[188:191], a[28:31], a[12:15], v[188:191]
  v_mfma_f32_16x16x32_bf16 v[188:191], a[60:63], a[44:47], v[188:191]
  s_waitcnt vmcnt(17) lgkmcnt(0)
  s_barrier
  v_mfma_f32_16x16x32_bf16 v[128:131], a[80:83], a[64:67], v[128:131]
  ds_read_b128 a[0:3], v12 offset:0
  s_add_u32 m0, s15, 98304
  v_mfma_f32_16x16x32_bf16 v[128:131], a[112:115], a[96:99], v[128:131]
  s_and_b32 s28, s2, 31
  ds_read_b64_tr_b16 a[16:17], v18 offset:0
  v_mfma_f32_16x16x32_bf16 v[132:135], a[84:87], a[64:67], v[132:135]
  s_lshr_b32 s29, s2, 5
  ds_read_b64_tr_b16 a[18:19], v18 offset:4096
  buffer_load_dwordx4 v8, s[16:19], s12 offen offset:0  lds
  v_mfma_f32_16x16x32_bf16 v[132:135], a[116:119], a[96:99], v[132:135]
  ds_read_b128 a[32:35], v12 offset:8192
  s_lshr_b32 s60, s28, 1
  v_mfma_f32_16x16x32_bf16 v[136:139], a[88:91], a[64:67], v[136:139]
  ds_read_b64_tr_b16 a[48:49], v18 offset:8192
  s_lshl_b32 s60, s60, 4
  v_mfma_f32_16x16x32_bf16 v[136:139], a[120:123], a[96:99], v[136:139]
  buffer_load_dwordx4 v8, s[16:19], s12 offen offset:1024  lds
  ds_read_b64_tr_b16 a[50:51], v18 offset:12288
  s_add_u32 s60, s60, s29
  v_mfma_f32_16x16x32_bf16 v[140:143], a[92:95], a[64:67], v[140:143]
  ds_read_b128 a[4:7], v12 offset:1024
  v_mfma_f32_16x16x32_bf16 v[140:143], a[124:127], a[96:99], v[140:143]
  s_lshl_b32 s60, s60, 2
  ds_read_b64_tr_b16 a[20:21], v19 offset:0
  buffer_load_dwordx4 v8, s[16:19], s12 offen offset:2048  lds
  v_mfma_f32_16x16x32_bf16 v[144:147], a[80:83], a[68:71], v[144:147]
  s_add_u32 s60, s60, s24
  v_mfma_f32_16x16x32_bf16 v[144:147], a[112:115], a[100:103], v[144:147]
  ds_read_b64_tr_b16 a[22:23], v19 offset:4096
  s_lshl_b32 s60, s60, 3
  v_mfma_f32_16x16x32_bf16 v[148:151], a[84:87], a[68:71], v[148:151]
  ds_read_b128 a[36:39], v12 offset:9216
  buffer_load_dwordx4 v8, s[16:19], s12 offen offset:3072  lds
  s_add_u32 s60, s60, 33145088
  v_mfma_f32_16x16x32_bf16 v[148:151], a[116:119], a[100:103], v[148:151]
  ds_read_b64_tr_b16 a[52:53], v19 offset:8192
  s_lshl_b32 s61, s28, 6
  v_mfma_f32_16x16x32_bf16 v[152:155], a[88:91], a[68:71], v[152:155]
  ds_read_b64_tr_b16 a[54:55], v19 offset:12288
  s_add_u32 s12, s12, s31
  v_mfma_f32_16x16x32_bf16 v[152:155], a[120:123], a[100:103], v[152:155]
  s_add_u32 s61, s61, 33210368
  ds_read_b128 a[8:11], v12 offset:2048
  v_mfma_f32_16x16x32_bf16 v[156:159], a[92:95], a[68:71], v[156:159]
  v_lshlrev_b32 v122, 3, v1
  ds_read_b64_tr_b16 a[24:25], v20 offset:0
  v_mfma_f32_16x16x32_bf16 v[156:159], a[124:127], a[100:103], v[156:159]
  v_add_u32 v122, s61, v122
  s_add_u32 m0, s27, 98304
  ds_read_b64_tr_b16 a[26:27], v20 offset:4096
  v_mfma_f32_16x16x32_bf16 v[160:163], a[80:83], a[72:75], v[160:163]
  v_mov_b32 v30, s60
  v_mfma_f32_16x16x32_bf16 v[160:163], a[112:115], a[104:107], v[160:163]
  ds_read_b128 a[40:43], v12 offset:10240
  v_cmp_gt_u32 s[62:63], 6, v1
  buffer_load_dwordx4 v2, s[96:99], s13 offen offset:0 lds
  v_mfma_f32_16x16x32_bf16 v[164:167], a[84:87], a[72:75], v[164:167]
  ds_read_b64_tr_b16 a[56:57], v20 offset:8192
  v_mfma_f32_16x16x32_bf16 v[164:167], a[116:119], a[104:107], v[164:167]
  s_nop 1
  ds_read_b64_tr_b16 a[58:59], v20 offset:12288
  v_mfma_f32_16x16x32_bf16 v[168:171], a[88:91], a[72:75], v[168:171]
  v_cndmask_b32 v122, v30, v122, s[62:63]
  ds_read_b128 a[12:15], v12 offset:3072
  buffer_load_dwordx4 v3, s[96:99], s13 offen offset:1024 lds
  v_mfma_f32_16x16x32_bf16 v[168:171], a[120:123], a[104:107], v[168:171]
  s_lshl_b32 s29, s29, 1
  ds_read_b64_tr_b16 a[28:29], v21 offset:0
  v_mfma_f32_16x16x32_bf16 v[172:175], a[92:95], a[72:75], v[172:175]
  s_lshr_b32 s60, s24, 1
  ds_read_b64_tr_b16 a[30:31], v21 offset:4096
  buffer_load_dwordx4 v4, s[96:99], s13 offen offset:2048 lds
  v_mfma_f32_16x16x32_bf16 v[172:175], a[124:127], a[104:107], v[172:175]
  ds_read_b128 a[44:47], v12 offset:11264
  s_add_u32 s29, s29, s60
  v_mfma_f32_16x16x32_bf16 v[176:179], a[80:83], a[76:79], v[176:179]
  ds_read_b64_tr_b16 a[60:61], v21 offset:8192
  v_mfma_f32_16x16x32_bf16 v[176:179], a[112:115], a[108:111], v[176:179]
  buffer_load_dwordx2 v[120:121], v122, s[16:19], 0 offen sc1
  buffer_load_dwordx4 v5, s[96:99], s13 offen offset:3072 lds
  v_mfma_f32_16x16x32_bf16 v[180:183], a[84:87], a[76:79], v[180:183]
  ds_read_b64_tr_b16 a[62:63], v21 offset:12288
  v_mfma_f32_16x16x32_bf16 v[180:183], a[116:119], a[108:111], v[180:183]
  s_add_u32 s13, s13, s32
  v_mfma_f32_16x16x32_bf16 v[184:187], a[88:91], a[76:79], v[184:187]
  v_mfma_f32_16x16x32_bf16 v[184:187], a[120:123], a[108:111], v[184:187]
  v_mfma_f32_16x16x32_bf16 v[188:191], a[92:95], a[76:79], v[188:191]
  v_mfma_f32_16x16x32_bf16 v[188:191], a[124:127], a[108:111], v[188:191]
  s_waitcnt vmcnt(18) lgkmcnt(0)
  s_barrier
  s_waitcnt vmcnt(15)
L_p2r1_lw:
  v_cmp_eq_u64 vcc, v[10:11], v[14:15]
  s_nop 1
  s_cmp_eq_u64 vcc, -1
  s_cbranch_scc1 L_p2r1_lok
  s_add_u32 s3, s3, 1
  s_cmp_gt_u32 s3, 0x40000
  s_cbranch_scc1 L_p2r1_lok
  s_sleep 4
  buffer_load_dwordx2 v[10:11], v9, s[16:19], 0 offen sc1
  s_waitcnt vmcnt(0)
  s_branch L_p2r1_lw
L_p2r1_lok:
  v_mfma_f32_16x16x32_bf16 v[128:131], a[16:19], a[0:3], v[128:131]
  ds_read_b128 a[64:67], v12 offset:32768
  s_lshr_b32 s71, s24, 1
  s_mul_i32 s71, s71, 1
  s_add_u32 s71, s71, 89
  s_lshl_b32 s13, s71, 16
  s_mul_i32 s12, s8, 144
  s_add_u32 s12, s12, s71
  s_lshl_b32 s12, s12, 13
  s_mov_b32 s31, 57344
  s_mov_b32 s32, 458752
  v_mfma_f32_16x16x32_bf16 v[128:131], a[48:51], a[32:35], v[128:131]
  ds_read_b64_tr_b16 a[80:81], v18 offset:32768
  v_mfma_f32_16x16x32_bf16 v[132:135], a[20:23], a[0:3], v[132:135]
  ds_read_b64_tr_b16 a[82:83], v18 offset:36864
  s_add_u32 m0, s15, 0
  v_mfma_f32_16x16x32_bf16 v[132:135], a[52:55], a[32:35], v[132:135]
  ds_read_b128 a[96:99], v12 offset:40960
  v_mfma_f32_16x16x32_bf16 v[136:139], a[24:27], a[0:3], v[136:139]
  ds_read_b64_tr_b16 a[112:113], v18 offset:40960
  v_mfma_f32_16x16x32_bf16 v[136:139], a[56:59], a[32:35], v[136:139]
  buffer_load_dwordx4 v8, s[16:19], s12 offen offset:0  lds
  ds_read_b64_tr_b16 a[114:115], v18 offset:45056
  v_mfma_f32_16x16x32_bf16 v[140:143], a[28:31], a[0:3], v[140:143]
  ds_read_b128 a[68:71], v12 offset:33792
  v_mfma_f32_16x16x32_bf16 v[140:143], a[60:63], a[32:35], v[140:143]
  buffer_load_dwordx4 v8, s[16:19], s12 offen offset:1024  lds
  ds_read_b64_tr_b16 a[84:85], v19 offset:32768
  v_mfma_f32_16x16x32_bf16 v[144:147], a[16:19], a[4:7], v[144:147]
  v_mfma_f32_16x16x32_bf16 v[144:147], a[48:51], a[36:39], v[144:147]
  ds_read_b64_tr_b16 a[86:87], v19 offset:36864
  buffer_load_dwordx4 v8, s[16:19], s12 offen offset:2048  lds
  v_mfma_f32_16x16x32_bf16 v[148:151], a[20:23], a[4:7], v[148:151]
  ds_read_b128 a[100:103], v12 offset:41984
  v_mfma_f32_16x16x32_bf16 v[148:151], a[52:55], a[36:39], v[148:151]
  ds_read_b64_tr_b16 a[116:117], v19 offset:40960
  v_mfma_f32_16x16x32_bf16 v[152:155], a[24:27], a[4:7], v[152:155]
  buffer_load_dwordx4 v8, s[16:19], s12 offen offset:3072  lds
  ds_read_b64_tr_b16 a[118:119], v19 offset:45056
  v_mfma_f32_16x16x32_bf16 v[152:155], a[56:59], a[36:39], v[152:155]
  ds_read_b128 a[72:75], v12 offset:34816
  v_mfma_f32_16x16x32_bf16 v[156:159], a[28:31], a[4:7], v[156:159]
  s_add_u32 s12, s12, s31
  ds_read_b64_tr_b16 a[88:89], v20 offset:32768
  v_mfma_f32_16x16x32_bf16 v[156:159], a[60:63], a[36:39], v[156:159]
  ds_read_b64_tr_b16 a[90:91], v20 offset:36864
  v_mfma_f32_16x16x32_bf16 v[160:163], a[16:19], a[8:11], v[160:163]
  s_add_u32 m0, s27, 0
  v_mfma_f32_16x16x32_bf16 v[160:163], a[48:51], a[40:43], v[160:163]
  ds_read_b128 a[104:107], v12 offset:43008
  v_mfma_f32_16x16x32_bf16 v[164:167], a[20:23], a[8:11], v[164:167]
  ds_read_b64_tr_b16 a[120:121], v20 offset:40960
  buffer_load_dwordx4 v2, s[96:99], s13 offen offset:0 lds
  v_mfma_f32_16x16x32_bf16 v[164:167], a[52:55], a[40:43], v[164:167]
  ds_read_b64_tr_b16 a[122:123], v20 offset:45056
  v_mfma_f32_16x16x32_bf16 v[168:171], a[24:27], a[8:11], v[168:171]
  ds_read_b128 a[76:79], v12 offset:35840
  v_mfma_f32_16x16x32_bf16 v[168:171], a[56:59], a[40:43], v[168:171]
  buffer_load_dwordx4 v3, s[96:99], s13 offen offset:1024 lds
  ds_read_b64_tr_b16 a[92:93], v21 offset:32768
  v_mfma_f32_16x16x32_bf16 v[172:175], a[28:31], a[8:11], v[172:175]
  ds_read_b64_tr_b16 a[94:95], v21 offset:36864
  v_mfma_f32_16x16x32_bf16 v[172:175], a[60:63], a[40:43], v[172:175]
  buffer_load_dwordx4 v4, s[96:99], s13 offen offset:2048 lds
  ds_read_b128 a[108:111], v12 offset:44032
  v_mfma_f32_16x16x32_bf16 v[176:179], a[16:19], a[12:15], v[176:179]
  ds_read_b64_tr_b16 a[124:125], v21 offset:40960
  v_mfma_f32_16x16x32_bf16 v[176:179], a[48:51], a[44:47], v[176:179]
  buffer_load_dwordx4 v5, s[96:99], s13 offen offset:3072 lds
  v_mfma_f32_16x16x32_bf16 v[180:183], a[20:23], a[12:15], v[180:183]
  ds_read_b64_tr_b16 a[126:127], v21 offset:45056
  v_mfma_f32_16x16x32_bf16 v[180:183], a[52:55], a[44:47], v[180:183]
  v_mfma_f32_16x16x32_bf16 v[184:187], a[24:27], a[12:15], v[184:187]
  s_add_u32 s13, s13, s32
  v_mfma_f32_16x16x32_bf16 v[184:187], a[56:59], a[44:47], v[184:187]
  v_mfma_f32_16x16x32_bf16 v[188:191], a[28:31], a[12:15], v[188:191]
  v_mfma_f32_16x16x32_bf16 v[188:191], a[60:63], a[44:47], v[188:191]
  s_waitcnt vmcnt(17) lgkmcnt(0)
  s_barrier
  s_waitcnt vmcnt(9)
L_p2r1_kw:
  v_cmp_eq_u64 vcc, v[120:121], v[14:15]
  s_nop 1
  s_cmp_eq_u64 vcc, -1
  s_cbranch_scc1 L_p2r1_kok
  s_add_u32 s3, s3, 1
  s_cmp_gt_u32 s3, 0x40000
  s_cbranch_scc1 L_p2r1_kok
  s_sleep 4
  buffer_load_dwordx2 v[120:121], v122, s[16:19], 0 offen sc1
  s_waitcnt vmcnt(0)
  s_branch L_p2r1_kw
L_p2r1_kok:
  v_mfma_f32_16x16x32_bf16 v[128:131], a[80:83], a[64:67], v[128:131]
  ds_read_b128 a[0:3], v13 offset:0
  s_add_u32 m0, s15, 32768
  v_mfma_f32_16x16x32_bf16 v[128:131], a[112:115], a[96:99], v[128:131]
  v_lshlrev_b32 v31, 2, v6
  ds_read_b64_tr_b16 a[16:17], v22 offset:0
  s_lshl_b32 s60, s8, 9
  v_mfma_f32_16x16x32_bf16 v[132:135], a[84:87], a[64:67], v[132:135]
  ds_read_b64_tr_b16 a[18:19], v22 offset:4096
  s_and_b32 s61, s24, 1
  buffer_load_dwordx4 v8, s[16:19], s12 offen offset:0  lds
  v_mfma_f32_16x16x32_bf16 v[132:135], a[116:119], a[96:99], v[132:135]
  ds_read_b128 a[32:35], v13 offset:8192
  s_lshl_b32 s61, s61, 8
  v_mfma_f32_16x16x32_bf16 v[136:139], a[88:91], a[64:67], v[136:139]
  s_add_u32 s60, s60, s61
  ds_read_b64_tr_b16 a[48:49], v22 offset:8192
  v_mfma_f32_16x16x32_bf16 v[136:139], a[120:123], a[96:99], v[136:139]
  s_add_u32 s60, s60, 20545536
  buffer_load_dwordx4 v8, s[16:19], s12 offen offset:1024  lds
  ds_read_b64_tr_b16 a[50:51], v22 offset:12288
  v_mfma_f32_16x16x32_bf16 v[140:143], a[92:95], a[64:67], v[140:143]
  buffer_load_dword v38, v31, s[16:19], s60 offen offset:0
  ds_read_b128 a[4:7], v13 offset:1024
  v_mfma_f32_16x16x32_bf16 v[140:143], a[124:127], a[96:99], v[140:143]
  buffer_load_dword v39, v31, s[16:19], s60 offen offset:64
  buffer_load_dword v40, v31, s[16:19], s60 offen offset:128
  ds_read_b64_tr_b16 a[20:21], v23 offset:0
  buffer_load_dwordx4 v8, s[16:19], s12 offen offset:2048  lds
  v_mfma_f32_16x16x32_bf16 v[144:147], a[80:83], a[68:71], v[144:147]
  buffer_load_dword v41, v31, s[16:19], s60 offen offset:192
  v_mfma_f32_16x16x32_bf16 v[144:147], a[112:115], a[100:103], v[144:147]
  ds_read_b64_tr_b16 a[22:23], v23 offset:4096
  s_mul_i32 s60, s28, 3072
  v_mfma_f32_16x16x32_bf16 v[148:151], a[84:87], a[68:71], v[148:151]
  ds_read_b128 a[36:39], v13 offset:9216
  s_add_u32 s60, s60, 20447232
  buffer_load_dwordx4 v8, s[16:19], s12 offen offset:3072  lds
  v_mfma_f32_16x16x32_bf16 v[148:151], a[116:119], a[100:103], v[148:151]
  v_lshlrev_b32 v30, 3, v1
  ds_read_b64_tr_b16 a[52:53], v23 offset:8192
  v_mfma_f32_16x16x32_bf16 v[152:155], a[88:91], a[68:71], v[152:155]
  buffer_load_dwordx2 a[144:145], v30, s[16:19], s60 offen offset:0
  ds_read_b64_tr_b16 a[54:55], v23 offset:12288
  s_add_u32 s12, s12, s31
  v_mfma_f32_16x16x32_bf16 v[152:155], a[120:123], a[100:103], v[152:155]
  buffer_load_dwordx2 a[146:147], v30, s[16:19], s60 offen offset:512
  ds_read_b128 a[8:11], v13 offset:2048
  buffer_load_dwordx2 a[148:149], v30, s[16:19], s60 offen offset:1024
  v_mfma_f32_16x16x32_bf16 v[156:159], a[92:95], a[68:71], v[156:159]
  buffer_load_dwordx2 a[150:151], v30, s[16:19], s60 offen offset:1536
  ds_read_b64_tr_b16 a[24:25], v24 offset:0
  v_mfma_f32_16x16x32_bf16 v[156:159], a[124:127], a[100:103], v[156:159]
  s_add_u32 m0, s27, 32768
  buffer_load_dwordx2 a[152:153], v30, s[16:19], s60 offen offset:2048
  ds_read_b64_tr_b16 a[26:27], v24 offset:4096
  v_mfma_f32_16x16x32_bf16 v[160:163], a[80:83], a[72:75], v[160:163]
  buffer_load_dwordx2 a[154:155], v30, s[16:19], s60 offen offset:2560
  v_mfma_f32_16x16x32_bf16 v[160:163], a[112:115], a[104:107], v[160:163]
  ds_read_b128 a[40:43], v13 offset:10240
  s_mul_i32 s60, s29, 144
  buffer_load_dwordx4 v2, s[96:99], s13 offen offset:0 lds
  v_mfma_f32_16x16x32_bf16 v[164:167], a[84:87], a[72:75], v[164:167]
  ds_read_b64_tr_b16 a[56:57], v24 offset:8192
  s_add_u32 s60, s60, s28
  v_mfma_f32_16x16x32_bf16 v[164:167], a[116:119], a[104:107], v[164:167]
  s_add_u32 s60, s60, 112
  ds_read_b64_tr_b16 a[58:59], v24 offset:12288
  s_lshl_b32 s60, s60, 13
  v_mfma_f32_16x16x32_bf16 v[168:171], a[88:91], a[72:75], v[168:171]
  ds_read_b128 a[12:15], v13 offset:3072
  buffer_load_dwordx4 v3, s[96:99], s13 offen offset:1024 lds
  buffer_load_dwordx4 a[128:131], v8, s[16:19], s60 offen offset:0
  v_mfma_f32_16x16x32_bf16 v[168:171], a[120:123], a[104:107], v[168:171]
  ds_read_b64_tr_b16 a[28:29], v25 offset:0
  buffer_load_dwordx4 a[132:135], v8, s[16:19], s60 offen offset:1024
  v_mfma_f32_16x16x32_bf16 v[172:175], a[92:95], a[72:75], v[172:175]
  buffer_load_dwordx4 a[136:139], v8, s[16:19], s60 offen offset:2048
  ds_read_b64_tr_b16 a[30:31], v25 offset:4096
  buffer_load_dwordx4 v4, s[96:99], s13 offen offset:2048 lds
  v_mfma_f32_16x16x32_bf16 v[172:175], a[124:127], a[104:107], v[172:175]
  buffer_load_dwordx4 a[140:143], v8, s[16:19], s60 offen offset:3072
  ds_read_b128 a[44:47], v13 offset:11264
  v_mfma_f32_16x16x32_bf16 v[176:179], a[80:83], a[76:79], v[176:179]
  s_lshl_b32 s14, s29, 5
  ds_read_b64_tr_b16 a[60:61], v25 offset:8192
  v_mfma_f32_16x16x32_bf16 v[176:179], a[112:115], a[108:111], v[176:179]
  s_add_u32 s14, s14, s28
  buffer_load_dwordx4 v5, s[96:99], s13 offen offset:3072 lds
  s_lshl_b32 s14, s14, 13
  v_mfma_f32_16x16x32_bf16 v[180:183], a[84:87], a[76:79], v[180:183]
  ds_read_b64_tr_b16 a[62:63], v25 offset:12288
  s_add_u32 s14, s14, 28942336
  v_mfma_f32_16x16x32_bf16 v[180:183], a[116:119], a[108:111], v[180:183]
  v_mov_b32 v112, 0x358637bd
  s_add_u32 s13, s13, s32
  v_mfma_f32_16x16x32_bf16 v[184:187], a[88:91], a[76:79], v[184:187]
  v_mov_b32 v113, 0x358637bd
  v_mfma_f32_16x16x32_bf16 v[184:187], a[120:123], a[108:111], v[184:187]
  v_mov_b32 v114, 0x358637bd
  v_mfma_f32_16x16x32_bf16 v[188:191], a[92:95], a[76:79], v[188:191]
  v_mov_b32 v115, 0x358637bd
  v_mfma_f32_16x16x32_bf16 v[188:191], a[124:127], a[108:111], v[188:191]
  s_waitcnt vmcnt(30) lgkmcnt(0)
  s_barrier
  v_mfma_f32_16x16x32_bf16 v[128:131], a[16:19], a[0:3], v[128:131]
  ds_read_b128 a[64:67], v13 offset:32768
  s_add_u32 m0, s15, 65536
  v_mfma_f32_16x16x32_bf16 v[128:131], a[48:51], a[32:35], v[128:131]
  ds_read_b64_tr_b16 a[80:81], v22 offset:32768
  v_mfma_f32_16x16x32_bf16 v[132:135], a[20:23], a[0:3], v[132:135]
  ds_read_b64_tr_b16 a[82:83], v22 offset:36864
  buffer_load_dwordx4 v8, s[16:19], s12 offen offset:0  lds
  v_mfma_f32_16x16x32_bf16 v[132:135], a[52:55], a[32:35], v[132:135]
  ds_read_b128 a[96:99], v13 offset:40960
  v_mfma_f32_16x16x32_bf16 v[136:139], a[24:27], a[0:3], v[136:139]
  ds_read_b64_tr_b16 a[112:113], v22 offset:40960
  v_mfma_f32_16x16x32_bf16 v[136:139], a[56:59], a[32:35], v[136:139]
  buffer_load_dwordx4 v8, s[16:19], s12 offen offset:1024  lds
  ds_read_b64_tr_b16 a[114:115], v22 offset:45056
  v_mfma_f32_16x16x32_bf16 v[140:143], a[28:31], a[0:3], v[140:143]
  ds_read_b128 a[68:71], v13 offset:33792
  v_mfma_f32_16x16x32_bf16 v[140:143], a[60:63], a[32:35], v[140:143]
  ds_read_b64_tr_b16 a[84:85], v23 offset:32768
  buffer_load_dwordx4 v8, s[16:19], s12 offen offset:2048  lds
  v_mfma_f32_16x16x32_bf16 v[144:147], a[16:19], a[4:7], v[144:147]
  v_mfma_f32_16x16x32_bf16 v[144:147], a[48:51], a[36:39], v[144:147]
  ds_read_b64_tr_b16 a[86:87], v23 offset:36864
  v_mfma_f32_16x16x32_bf16 v[148:151], a[20:23], a[4:7], v[148:151]
  ds_read_b128 a[100:103], v13 offset:41984
  buffer_load_dwordx4 v8, s[16:19], s12 offen offset:3072  lds
  v_mfma_f32_16x16x32_bf16 v[148:151], a[52:55], a[36:39], v[148:151]
  ds_read_b64_tr_b16 a[116:117], v23 offset:40960
  v_mfma_f32_16x16x32_bf16 v[152:155], a[24:27], a[4:7], v[152:155]
  ds_read_b64_tr_b16 a[118:119], v23 offset:45056
  s_add_u32 s12, s12, s31
  v_mfma_f32_16x16x32_bf16 v[152:155], a[56:59], a[36:39], v[152:155]
  ds_read_b128 a[72:75], v13 offset:34816
  v_mfma_f32_16x16x32_bf16 v[156:159], a[28:31], a[4:7], v[156:159]
  ds_read_b64_tr_b16 a[88:89], v24 offset:32768
  v_mfma_f32_16x16x32_bf16 v[156:159], a[60:63], a[36:39], v[156:159]
  s_add_u32 m0, s27, 65536
  ds_read_b64_tr_b16 a[90:91], v24 offset:36864
  v_mfma_f32_16x16x32_bf16 v[160:163], a[16:19], a[8:11], v[160:163]
  v_mfma_f32_16x16x32_bf16 v[160:163], a[48:51], a[40:43], v[160:163]
  ds_read_b128 a[104:107], v13 offset:43008
  buffer_load_dwordx4 v2, s[96:99], s13 offen offset:0 lds
  v_mfma_f32_16x16x32_bf16 v[164:167], a[20:23], a[8:11], v[164:167]
  ds_read_b64_tr_b16 a[120:121], v24 offset:40960
  v_mfma_f32_16x16x32_bf16 v[164:167], a[52:55], a[40:43], v[164:167]
  ds_read_b64_tr_b16 a[122:123], v24 offset:45056
  v_mfma_f32_16x16x32_bf16 v[168:171], a[24:27], a[8:11], v[168:171]
  ds_read_b128 a[76:79], v13 offset:35840
  buffer_load_dwordx4 v3, s[96:99], s13 offen offset:1024 lds
  v_mfma_f32_16x16x32_bf16 v[168:171], a[56:59], a[40:43], v[168:171]
  ds_read_b64_tr_b16 a[92:93], v25 offset:32768
  v_mfma_f32_16x16x32_bf16 v[172:175], a[28:31], a[8:11], v[172:175]
  ds_read_b64_tr_b16 a[94:95], v25 offset:36864
  buffer_load_dwordx4 v4, s[96:99], s13 offen offset:2048 lds
  v_mfma_f32_16x16x32_bf16 v[172:175], a[60:63], a[40:43], v[172:175]
  ds_read_b128 a[108:111], v13 offset:44032
  v_mfma_f32_16x16x32_bf16 v[176:179], a[16:19], a[12:15], v[176:179]
  ds_read_b64_tr_b16 a[124:125], v25 offset:40960
  v_mfma_f32_16x16x32_bf16 v[176:179], a[48:51], a[44:47], v[176:179]
  buffer_load_dwordx4 v5, s[96:99], s13 offen offset:3072 lds
  v_mfma_f32_16x16x32_bf16 v[180:183], a[20:23], a[12:15], v[180:183]
  ds_read_b64_tr_b16 a[126:127], v25 offset:45056
  v_mfma_f32_16x16x32_bf16 v[180:183], a[52:55], a[44:47], v[180:183]
  s_add_u32 s13, s13, s32
  v_mfma_f32_16x16x32_bf16 v[184:187], a[24:27], a[12:15], v[184:187]
  v_mfma_f32_16x16x32_bf16 v[184:187], a[56:59], a[44:47], v[184:187]
  v_mfma_f32_16x16x32_bf16 v[188:191], a[28:31], a[12:15], v[188:191]
  v_mfma_f32_16x16x32_bf16 v[188:191], a[60:63], a[44:47], v[188:191]
  s_waitcnt vmcnt(30) lgkmcnt(0)
  s_barrier
  s_waitcnt vmcnt(9)
  v_mfma_f32_16x16x32_bf16 v[56:59], a[152:155], a[128:131], v[112:115]
  ds_read_b128 a[0:3], v12 offset:0
  s_add_u32 m0, s15, 98304
  v_mfma_f32_16x16x32_bf16 v[48:51], a[144:147], a[128:131], 0
  ds_read_b64_tr_b16 a[16:17], v18 offset:0
  v_mfma_f32_16x16x32_bf16 v[52:55], a[148:151], a[128:131], 0
  v_mfma_f32_16x16x32_bf16 v[68:71], a[152:155], a[132:135], v[112:115]
  ds_read_b64_tr_b16 a[18:19], v18 offset:4096
  buffer_load_dwordx4 v8, s[16:19], s12 offen offset:0  lds
  v_mfma_f32_16x16x32_bf16 v[60:63], a[144:147], a[132:135], 0
  ds_read_b128 a[32:35], v12 offset:8192
  v_mfma_f32_16x16x32_bf16 v[64:67], a[148:151], a[132:135], 0
  v_mfma_f32_16x16x32_bf16 v[80:83], a[152:155], a[136:139], v[112:115]
  ds_read_b64_tr_b16 a[48:49], v18 offset:8192
  v_mfma_f32_16x16x32_bf16 v[72:75], a[144:147], a[136:139], 0
  buffer_load_dwordx4 v8, s[16:19], s12 offen offset:1024  lds
  ds_read_b64_tr_b16 a[50:51], v18 offset:12288
  v_mfma_f32_16x16x32_bf16 v[76:79], a[148:151], a[136:139], 0
  v_mfma_f32_16x16x32_bf16 v[92:95], a[152:155], a[140:143], v[112:115]
  ds_read_b128 a[4:7], v12 offset:1024
  v_mfma_f32_16x16x32_bf16 v[84:87], a[144:147], a[140:143], 0
  buffer_load_dwordx4 v8, s[16:19], s12 offen offset:2048  lds
  ds_read_b64_tr_b16 a[20:21], v19 offset:0
  v_mfma_f32_16x16x32_bf16 v[88:91], a[148:151], a[140:143], 0
  v_mfma_f32_16x16x32_bf16 v[128:131], a[80:83], a[64:67], v[128:131]
  ds_read_b64_tr_b16 a[22:23], v19 offset:4096
  v_mfma_f32_16x16x32_bf16 v[128:131], a[112:115], a[96:99], v[128:131]
  v_mfma_f32_16x16x32_bf16 v[132:135], a[84:87], a[64:67], v[132:135]
  ds_read_b128 a[36:39], v12 offset:9216
  buffer_load_dwordx4 v8, s[16:19], s12 offen offset:3072  lds
  v_mfma_f32_16x16x32_bf16 v[132:135], a[116:119], a[96:99], v[132:135]
  ds_read_b64_tr_b16 a[52:53], v19 offset:8192
  v_mfma_f32_16x16x32_bf16 v[136:139], a[88:91], a[64:67], v[136:139]
  v_mfma_f32_16x16x32_bf16 v[136:139], a[120:123], a[96:99], v[136:139]
  ds_read_b64_tr_b16 a[54:55], v19 offset:12288
  s_add_u32 s12, s12, s31
  v_mfma_f32_16x16x32_bf16 v[140:143], a[92:95], a[64:67], v[140:143]
  ds_read_b128 a[8:11], v12 offset:2048
  v_mfma_f32_16x16x32_bf16 v[140:143], a[124:127], a[96:99], v[140:143]
  v_mfma_f32_16x16x32_bf16 v[144:147], a[80:83], a[68:71], v[144:147]
  ds_read_b64_tr_b16 a[24:25], v20 offset:0
  v_mfma_f32_16x16x32_bf16 v[144:147], a[112:115], a[100:103], v[144:147]
  s_add_u32 m0, s27, 98304
  ds_read_b64_tr_b16 a[26:27], v20 offset:4096
  v_mfma_f32_16x16x32_bf16 v[148:151], a[84:87], a[68:71], v[148:151]
  v_mfma_f32_16x16x32_bf16 v[148:151], a[116:119], a[100:103], v[148:151]
  ds_read_b128 a[40:43], v12 offset:10240
  v_mfma_f32_16x16x32_bf16 v[152:155], a[88:91], a[68:71], v[152:155]
  buffer_load_dwordx4 v2, s[96:99], s13 offen offset:0 lds
  ds_read_b64_tr_b16 a[56:57], v20 offset:8192
  v_mfma_f32_16x16x32_bf16 v[152:155], a[120:123], a[100:103], v[152:155]
  v_mfma_f32_16x16x32_bf16 v[156:159], a[92:95], a[68:71], v[156:159]
  ds_read_b64_tr_b16 a[58:59], v20 offset:12288
  v_mfma_f32_16x16x32_bf16 v[156:159], a[124:127], a[100:103], v[156:159]
  v_mfma_f32_16x16x32_bf16 v[160:163], a[80:83], a[72:75], v[160:163]
  buffer_load_dwordx4 v3, s[96:99], s13 offen offset:1024 lds
  ds_read_b128 a[12:15], v12 offset:3072
  v_mfma_f32_16x16x32_bf16 v[160:163], a[112:115], a[104:107], v[160:163]
  ds_read_b64_tr_b16 a[28:29], v21 offset:0
  v_mfma_f32_16x16x32_bf16 v[164:167], a[84:87], a[72:75], v[164:167]
  v_mfma_f32_16x16x32_bf16 v[164:167], a[116:119], a[104:107], v[164:167]
  ds_read_b64_tr_b16 a[30:31], v21 offset:4096
  buffer_load_dwordx4 v4, s[96:99], s13 offen offset:2048 lds
  v_mfma_f32_16x16x32_bf16 v[168:171], a[88:91], a[72:75], v[168:171]
  ds_read_b128 a[44:47], v12 offset:11264
  v_mfma_f32_16x16x32_bf16 v[168:171], a[120:123], a[104:107], v[168:171]
  v_mfma_f32_16x16x32_bf16 v[172:175], a[92:95], a[72:75], v[172:175]
  ds_read_b64_tr_b16 a[60:61], v21 offset:8192
  buffer_load_dwordx4 v5, s[96:99], s13 offen offset:3072 lds
  v_mfma_f32_16x16x32_bf16 v[172:175], a[124:127], a[104:107], v[172:175]
  ds_read_b64_tr_b16 a[62:63], v21 offset:12288
  v_mfma_f32_16x16x32_bf16 v[176:179], a[80:83], a[76:79], v[176:179]
  v_mfma_f32_16x16x32_bf16 v[176:179], a[112:115], a[108:111], v[176:179]
  v_mfma_f32_16x16x32_bf16 v[180:183], a[84:87], a[76:79], v[180:183]
  s_add_u32 s13, s13, s32
  v_mfma_f32_16x16x32_bf16 v[180:183], a[116:119], a[108:111], v[180:183]
  v_mfma_f32_16x16x32_bf16 v[184:187], a[88:91], a[76:79], v[184:187]
  v_mfma_f32_16x16x32_bf16 v[184:187], a[120:123], a[108:111], v[184:187]
  v_mfma_f32_16x16x32_bf16 v[188:191], a[92:95], a[76:79], v[188:191]
  v_mfma_f32_16x16x32_bf16 v[188:191], a[124:127], a[108:111], v[188:191]
  s_waitcnt vmcnt(16) lgkmcnt(0)
  s_barrier
  v_mfma_f32_16x16x32_bf16 v[128:131], a[16:19], a[0:3], v[128:131]
  ds_read_b128 a[64:67], v12 offset:32768
  s_lshr_b32 s71, s24, 1
  s_mul_i32 s71, s71, 7
  s_add_u32 s71, s71, 2
  s_lshl_b32 s13, s71, 16
  s_mul_i32 s12, s8, 144
  s_add_u32 s12, s12, s71
  s_lshl_b32 s12, s12, 13
  s_mov_b32 s31, 114688
  s_mov_b32 s32, 917504
  s_and_b32 s69, s24, 1
  s_mul_i32 s69, s69, -24576
  v_add_u32 v2, s69, v2
  s_add_u32 s69, s69, 8192
  v_add_u32 v3, s69, v3
  s_add_u32 s69, s69, 8192
  v_add_u32 v4, s69, v4
  s_add_u32 s69, s69, 8192
  v_add_u32 v5, s69, v5
  v_mfma_f32_16x16x32_bf16 v[128:131], a[48:51], a[32:35], v[128:131]
  v_rcp_f32 v116, v56
  ds_read_b64_tr_b16 a[80:81], v18 offset:32768
  v_rcp_f32 v117, v68
  v_mfma_f32_16x16x32_bf16 v[132:135], a[20:23], a[0:3], v[132:135]
  v_rcp_f32 v118, v80
  ds_read_b64_tr_b16 a[82:83], v18 offset:36864
  v_rcp_f32 v119, v92
  s_add_u32 m0, s15, 0
  v_mfma_f32_16x16x32_bf16 v[132:135], a[52:55], a[32:35], v[132:135]
  s_nop 0
  ds_read_b128 a[96:99], v12 offset:40960
  v_mul_f32 v48, v116, v48
  v_mfma_f32_16x16x32_bf16 v[136:139], a[24:27], a[0:3], v[136:139]
  v_mul_f32 v49, v116, v49
  ds_read_b64_tr_b16 a[112:113], v18 offset:40960
  v_mul_f32 v50, v116, v50
  v_mfma_f32_16x16x32_bf16 v[136:139], a[56:59], a[32:35], v[136:139]
  buffer_load_dwordx4 v8, s[16:19], s12 offen offset:0  lds
  v_mul_f32 v51, v116, v51
  ds_read_b64_tr_b16 a[114:115], v18 offset:45056
  v_mul_f32 v52, v116, v52
  v_mfma_f32_16x16x32_bf16 v[140:143], a[28:31], a[0:3], v[140:143]
  v_mul_f32 v53, v116, v53
  v_mul_f32 v54, v116, v54
  ds_read_b128 a[68:71], v12 offset:33792
  v_mfma_f32_16x16x32_bf16 v[140:143], a[60:63], a[32:35], v[140:143]
  v_mul_f32 v55, v116, v55
  buffer_load_dwordx4 v8, s[16:19], s12 offen offset:1024  lds
  v_cvt_pk_bf16_f32 v96, v48, v49
  ds_read_b64_tr_b16 a[84:85], v19 offset:32768
  v_mfma_f32_16x16x32_bf16 v[144:147], a[16:19], a[4:7], v[144:147]
  v_cvt_pk_bf16_f32 v97, v50, v51
  v_cvt_pk_bf16_f32 v98, v52, v53
  v_mfma_f32_16x16x32_bf16 v[144:147], a[48:51], a[36:39], v[144:147]
  ds_read_b64_tr_b16 a[86:87], v19 offset:36864
  v_cvt_pk_bf16_f32 v99, v54, v55
  buffer_load_dwordx4 v8, s[16:19], s12 offen offset:2048  lds
  buffer_store_dwordx4 v[96:99], v8, s[16:19], s14 offen offset:0 sc1
  v_mfma_f32_16x16x32_bf16 v[148:151], a[20:23], a[4:7], v[148:151]
  ds_read_b128 a[100:103], v12 offset:41984
  v_mul_f32 v60, v117, v60
  v_mfma_f32_16x16x32_bf16 v[148:151], a[52:55], a[36:39], v[148:151]
  v_mul_f32 v61, v117, v61
  ds_read_b64_tr_b16 a[116:117], v19 offset:40960
  v_mul_f32 v62, v117, v62
  v_mfma_f32_16x16x32_bf16 v[152:155], a[24:27], a[4:7], v[152:155]
  buffer_load_dwordx4 v8, s[16:19], s12 offen offset:3072  lds
  v_mul_f32 v63, v117, v63
  ds_read_b64_tr_b16 a[118:119], v19 offset:45056
  v_mul_f32 v64, v117, v64
  v_mfma_f32_16x16x32_bf16 v[152:155], a[56:59], a[36:39], v[152:155]
  v_mul_f32 v65, v117, v65
  ds_read_b128 a[72:75], v12 offset:34816
  v_mul_f32 v66, v117, v66
  v_mfma_f32_16x16x32_bf16 v[156:159], a[28:31], a[4:7], v[156:159]
  v_mul_f32 v67, v117, v67
  s_add_u32 s12, s12, s31
  v_cvt_pk_bf16_f32 v100, v60, v61
  ds_read_b64_tr_b16 a[88:89], v20 offset:32768
  v_mfma_f32_16x16x32_bf16 v[156:159], a[60:63], a[36:39], v[156:159]
  v_cvt_pk_bf16_f32 v101, v62, v63
  v_cvt_pk_bf16_f32 v102, v64, v65
  ds_read_b64_tr_b16 a[90:91], v20 offset:36864
  v_mfma_f32_16x16x32_bf16 v[160:163], a[16:19], a[8:11], v[160:163]
  v_cvt_pk_bf16_f32 v103, v66, v67
  s_add_u32 m0, s27, 0
  buffer_store_dwordx4 v[100:103], v8, s[16:19], s14 offen offset:1024 sc1
  v_mfma_f32_16x16x32_bf16 v[160:163], a[48:51], a[40:43], v[160:163]
  ds_read_b128 a[104:107], v12 offset:43008
  v_mul_f32 v72, v118, v72
  v_mul_f32 v73, v118, v73
  v_mfma_f32_16x16x32_bf16 v[164:167], a[20:23], a[8:11], v[164:167]
  ds_read_b64_tr_b16 a[120:121], v20 offset:40960
  v_mul_f32 v74, v118, v74
  buffer_load_dwordx4 v2, s[96:99], s13 offen offset:0 lds
  v_mul_f32 v75, v118, v75
  v_mfma_f32_16x16x32_bf16 v[164:167], a[52:55], a[40:43], v[164:167]
  ds_read_b64_tr_b16 a[122:123], v20 offset:45056
  v_mul_f32 v76, v118, v76
  v_mul_f32 v77, v118, v77
  v_mfma_f32_16x16x32_bf16 v[168:171], a[24:27], a[8:11], v[168:171]
  ds_read_b128 a[76:79], v12 offset:35840
  v_mul_f32 v78, v118, v78
  v_mfma_f32_16x16x32_bf16 v[168:171], a[56:59], a[40:43], v[168:171]
  v_mul_f32 v79, v118, v79
  buffer_load_dwordx4 v3, s[96:99], s13 offen offset:1024 lds
  ds_read_b64_tr_b16 a[92:93], v21 offset:32768
  v_cvt_pk_bf16_f32 v104, v72, v73
  v_mfma_f32_16x16x32_bf16 v[172:175], a[28:31], a[8:11], v[172:175]
  v_cvt_pk_bf16_f32 v105, v74, v75
  v_cvt_pk_bf16_f32 v106, v76, v77
  ds_read_b64_tr_b16 a[94:95], v21 offset:36864
  v_mfma_f32_16x16x32_bf16 v[172:175], a[60:63], a[40:43], v[172:175]
  v_cvt_pk_bf16_f32 v107, v78, v79
  buffer_load_dwordx4 v4, s[96:99], s13 offen offset:2048 lds
  buffer_store_dwordx4 v[104:107], v8, s[16:19], s14 offen offset:2048 sc1
  ds_read_b128 a[108:111], v12 offset:44032
  v_mfma_f32_16x16x32_bf16 v[176:179], a[16:19], a[12:15], v[176:179]
  v_mul_f32 v84, v119, v84
  v_mul_f32 v85, v119, v85
  ds_read_b64_tr_b16 a[124:125], v21 offset:40960
  v_mfma_f32_16x16x32_bf16 v[176:179], a[48:51], a[44:47], v[176:179]
  v_mul_f32 v86, v119, v86
  v_mul_f32 v87, v119, v87
  buffer_load_dwordx4 v5, s[96:99], s13 offen offset:3072 lds
  v_mfma_f32_16x16x32_bf16 v[180:183], a[20:23], a[12:15], v[180:183]
  ds_read_b64_tr_b16 a[126:127], v21 offset:45056
  v_mul_f32 v88, v119, v88
  v_mul_f32 v89, v119, v89
  v_mfma_f32_16x16x32_bf16 v[180:183], a[52:55], a[44:47], v[180:183]
  v_mul_f32 v90, v119, v90
  v_mul_f32 v91, v119, v91
  v_mfma_f32_16x16x32_bf16 v[184:187], a[24:27], a[12:15], v[184:187]
  s_add_u32 s13, s13, s32
  v_cvt_pk_bf16_f32 v108, v84, v85
  v_cvt_pk_bf16_f32 v109, v86, v87
  v_mfma_f32_16x16x32_bf16 v[184:187], a[56:59], a[44:47], v[184:187]
  v_cvt_pk_bf16_f32 v110, v88, v89
  v_cvt_pk_bf16_f32 v111, v90, v91
  v_mfma_f32_16x16x32_bf16 v[188:191], a[28:31], a[12:15], v[188:191]
  buffer_store_dwordx4 v[108:111], v8, s[16:19], s14 offen offset:3072 sc1
  v_mfma_f32_16x16x32_bf16 v[188:191], a[60:63], a[44:47], v[188:191]
  s_waitcnt vmcnt(20) lgkmcnt(0)
  s_barrier
  v_mfma_f32_16x16x32_bf16 v[128:131], a[80:83], a[64:67], v[128:131]
  ds_read_b128 a[0:3], v13 offset:0
  s_add_u32 m0, s15, 32768
  v_mfma_f32_16x16x32_bf16 v[128:131], a[112:115], a[96:99], v[128:131]
  ds_read_b64_tr_b16 a[16:17], v22 offset:0
  v_mfma_f32_16x16x32_bf16 v[132:135], a[84:87], a[64:67], v[132:135]
  ds_read_b64_tr_b16 a[18:19], v22 offset:4096
  buffer_load_dwordx4 v8, s[16:19], s12 offen offset:0  lds
  v_mfma_f32_16x16x32_bf16 v[132:135], a[116:119], a[96:99], v[132:135]
  ds_read_b128 a[32:35], v13 offset:8192
  v_mfma_f32_16x16x32_bf16 v[136:139], a[88:91], a[64:67], v[136:139]
  ds_read_b64_tr_b16 a[48:49], v22 offset:8192
  v_mfma_f32_16x16x32_bf16 v[136:139], a[120:123], a[96:99], v[136:139]
  buffer_load_dwordx4 v8, s[16:19], s12 offen offset:1024  lds
  ds_read_b64_tr_b16 a[50:51], v22 offset:12288
  v_mfma_f32_16x16x32_bf16 v[140:143], a[92:95], a[64:67], v[140:143]
  ds_read_b128 a[4:7], v13 offset:1024
  v_mfma_f32_16x16x32_bf16 v[140:143], a[124:127], a[96:99], v[140:143]
  ds_read_b64_tr_b16 a[20:21], v23 offset:0
  buffer_load_dwordx4 v8, s[16:19], s12 offen offset:2048  lds
  v_mfma_f32_16x16x32_bf16 v[144:147], a[80:83], a[68:71], v[144:147]
  v_mfma_f32_16x16x32_bf16 v[144:147], a[112:115], a[100:103], v[144:147]
  ds_read_b64_tr_b16 a[22:23], v23 offset:4096
  v_mfma_f32_16x16x32_bf16 v[148:151], a[84:87], a[68:71], v[148:151]
  ds_read_b128 a[36:39], v13 offset:9216
  buffer_load_dwordx4 v8, s[16:19], s12 offen offset:3072  lds
  v_mfma_f32_16x16x32_bf16 v[148:151], a[116:119], a[100:103], v[148:151]
  ds_read_b64_tr_b16 a[52:53], v23 offset:8192
  v_mfma_f32_16x16x32_bf16 v[152:155], a[88:91], a[68:71], v[152:155]
  ds_read_b64_tr_b16 a[54:55], v23 offset:12288
  s_add_u32 s12, s12, s31
  v_mfma_f32_16x16x32_bf16 v[152:155], a[120:123], a[100:103], v[152:155]
  ds_read_b128 a[8:11], v13 offset:2048
  v_mfma_f32_16x16x32_bf16 v[156:159], a[92:95], a[68:71], v[156:159]
  ds_read_b64_tr_b16 a[24:25], v24 offset:0
  v_mfma_f32_16x16x32_bf16 v[156:159], a[124:127], a[100:103], v[156:159]
  s_add_u32 m0, s27, 32768
  ds_read_b64_tr_b16 a[26:27], v24 offset:4096
  v_mfma_f32_16x16x32_bf16 v[160:163], a[80:83], a[72:75], v[160:163]
  v_mfma_f32_16x16x32_bf16 v[160:163], a[112:115], a[104:107], v[160:163]
  ds_read_b128 a[40:43], v13 offset:10240
  buffer_load_dwordx4 v2, s[96:99], s13 offen offset:0 lds
  v_mfma_f32_16x16x32_bf16 v[164:167], a[84:87], a[72:75], v[164:167]
  ds_read_b64_tr_b16 a[56:57], v24 offset:8192
  v_mfma_f32_16x16x32_bf16 v[164:167], a[116:119], a[104:107], v[164:167]
  ds_read_b64_tr_b16 a[58:59], v24 offset:12288
  v_mfma_f32_16x16x32_bf16 v[168:171], a[88:91], a[72:75], v[168:171]
  ds_read_b128 a[12:15], v13 offset:3072
  buffer_load_dwordx4 v3, s[96:99], s13 offen offset:1024 lds
  v_mfma_f32_16x16x32_bf16 v[168:171], a[120:123], a[104:107], v[168:171]
  ds_read_b64_tr_b16 a[28:29], v25 offset:0
  v_mfma_f32_16x16x32_bf16 v[172:175], a[92:95], a[72:75], v[172:175]
  ds_read_b64_tr_b16 a[30:31], v25 offset:4096
  buffer_load_dwordx4 v4, s[96:99], s13 offen offset:2048 lds
  v_mfma_f32_16x16x32_bf16 v[172:175], a[124:127], a[104:107], v[172:175]
  ds_read_b128 a[44:47], v13 offset:11264
  v_mfma_f32_16x16x32_bf16 v[176:179], a[80:83], a[76:79], v[176:179]
  ds_read_b64_tr_b16 a[60:61], v25 offset:8192
  v_mfma_f32_16x16x32_bf16 v[176:179], a[112:115], a[108:111], v[176:179]
  buffer_load_dwordx4 v5, s[96:99], s13 offen offset:3072 lds
  v_mfma_f32_16x16x32_bf16 v[180:183], a[84:87], a[76:79], v[180:183]
  ds_read_b64_tr_b16 a[62:63], v25 offset:12288
  v_mfma_f32_16x16x32_bf16 v[180:183], a[116:119], a[108:111], v[180:183]
  s_add_u32 s13, s13, s32
  v_mfma_f32_16x16x32_bf16 v[184:187], a[88:91], a[76:79], v[184:187]
  v_mfma_f32_16x16x32_bf16 v[184:187], a[120:123], a[108:111], v[184:187]
  v_mfma_f32_16x16x32_bf16 v[188:191], a[92:95], a[76:79], v[188:191]
  v_mfma_f32_16x16x32_bf16 v[188:191], a[124:127], a[108:111], v[188:191]
  s_waitcnt vmcnt(20) lgkmcnt(0)
  s_barrier
  v_mfma_f32_16x16x32_bf16 v[128:131], a[16:19], a[0:3], v[128:131]
  ds_read_b128 a[64:67], v13 offset:32768
  s_add_u32 m0, s15, 65536
  v_mfma_f32_16x16x32_bf16 v[128:131], a[48:51], a[32:35], v[128:131]
  ds_read_b64_tr_b16 a[80:81], v22 offset:32768
  v_mfma_f32_16x16x32_bf16 v[132:135], a[20:23], a[0:3], v[132:135]
  ds_read_b64_tr_b16 a[82:83], v22 offset:36864
  buffer_load_dwordx4 v8, s[16:19], s12 offen offset:0  lds
  v_mfma_f32_16x16x32_bf16 v[132:135], a[52:55], a[32:35], v[132:135]
  ds_read_b128 a[96:99], v13 offset:40960
  v_mfma_f32_16x16x32_bf16 v[136:139], a[24:27], a[0:3], v[136:139]
  ds_read_b64_tr_b16 a[112:113], v22 offset:40960
  v_mfma_f32_16x16x32_bf16 v[136:139], a[56:59], a[32:35], v[136:139]
  buffer_load_dwordx4 v8, s[16:19], s12 offen offset:1024  lds
  ds_read_b64_tr_b16 a[114:115], v22 offset:45056
  v_mfma_f32_16x16x32_bf16 v[140:143], a[28:31], a[0:3], v[140:143]
  ds_read_b128 a[68:71], v13 offset:33792
  v_mfma_f32_16x16x32_bf16 v[140:143], a[60:63], a[32:35], v[140:143]
  ds_read_b64_tr_b16 a[84:85], v23 offset:32768
  buffer_load_dwordx4 v8, s[16:19], s12 offen offset:2048  lds
  v_mfma_f32_16x16x32_bf16 v[144:147], a[16:19], a[4:7], v[144:147]
  v_mfma_f32_16x16x32_bf16 v[144:147], a[48:51], a[36:39], v[144:147]
  ds_read_b64_tr_b16 a[86:87], v23 offset:36864
  v_mfma_f32_16x16x32_bf16 v[148:151], a[20:23], a[4:7], v[148:151]
  ds_read_b128 a[100:103], v13 offset:41984
  buffer_load_dwordx4 v8, s[16:19], s12 offen offset:3072  lds
  v_mfma_f32_16x16x32_bf16 v[148:151], a[52:55], a[36:39], v[148:151]
  ds_read_b64_tr_b16 a[116:117], v23 offset:40960
  v_mfma_f32_16x16x32_bf16 v[152:155], a[24:27], a[4:7], v[152:155]
  ds_read_b64_tr_b16 a[118:119], v23 offset:45056
  s_add_u32 s12, s12, s31
  v_mfma_f32_16x16x32_bf16 v[152:155], a[56:59], a[36:39], v[152:155]
  ds_read_b128 a[72:75], v13 offset:34816
  v_mfma_f32_16x16x32_bf16 v[156:159], a[28:31], a[4:7], v[156:159]
  ds_read_b64_tr_b16 a[88:89], v24 offset:32768
  v_mfma_f32_16x16x32_bf16 v[156:159], a[60:63], a[36:39], v[156:159]
  s_add_u32 m0, s27, 65536
  ds_read_b64_tr_b16 a[90:91], v24 offset:36864
  v_mfma_f32_16x16x32_bf16 v[160:163], a[16:19], a[8:11], v[160:163]
  v_mfma_f32_16x16x32_bf16 v[160:163], a[48:51], a[40:43], v[160:163]
  ds_read_b128 a[104:107], v13 offset:43008
  buffer_load_dwordx4 v2, s[96:99], s13 offen offset:0 lds
  v_mfma_f32_16x16x32_bf16 v[164:167], a[20:23], a[8:11], v[164:167]
  ds_read_b64_tr_b16 a[120:121], v24 offset:40960
  v_mfma_f32_16x16x32_bf16 v[164:167], a[52:55], a[40:43], v[164:167]
  ds_read_b64_tr_b16 a[122:123], v24 offset:45056
  v_mfma_f32_16x16x32_bf16 v[168:171], a[24:27], a[8:11], v[168:171]
  ds_read_b128 a[76:79], v13 offset:35840
  buffer_load_dwordx4 v3, s[96:99], s13 offen offset:1024 lds
  v_mfma_f32_16x16x32_bf16 v[168:171], a[56:59], a[40:43], v[168:171]
  ds_read_b64_tr_b16 a[92:93], v25 offset:32768
  v_mfma_f32_16x16x32_bf16 v[172:175], a[28:31], a[8:11], v[172:175]
  ds_read_b64_tr_b16 a[94:95], v25 offset:36864
  buffer_load_dwordx4 v4, s[96:99], s13 offen offset:2048 lds
  v_mfma_f32_16x16x32_bf16 v[172:175], a[60:63], a[40:43], v[172:175]
  ds_read_b128 a[108:111], v13 offset:44032
  v_mfma_f32_16x16x32_bf16 v[176:179], a[16:19], a[12:15], v[176:179]
  ds_read_b64_tr_b16 a[124:125], v25 offset:40960
  v_mfma_f32_16x16x32_bf16 v[176:179], a[48:51], a[44:47], v[176:179]
  buffer_load_dwordx4 v5, s[96:99], s13 offen offset:3072 lds
  v_mfma_f32_16x16x32_bf16 v[180:183], a[20:23], a[12:15], v[180:183]
  ds_read_b64_tr_b16 a[126:127], v25 offset:45056
  v_mfma_f32_16x16x32_bf16 v[180:183], a[52:55], a[44:47], v[180:183]
  s_add_u32 s13, s13, s32
  v_mfma_f32_16x16x32_bf16 v[184:187], a[24:27], a[12:15], v[184:187]
  v_mfma_f32_16x16x32_bf16 v[184:187], a[56:59], a[44:47], v[184:187]
  v_mfma_f32_16x16x32_bf16 v[188:191], a[28:31], a[12:15], v[188:191]
  v_mfma_f32_16x16x32_bf16 v[188:191], a[60:63], a[44:47], v[188:191]
  s_waitcnt vmcnt(17) lgkmcnt(0)
  s_barrier
  s_waitcnt vmcnt(16)
  v_mfma_f32_16x16x32_bf16 v[128:131], a[80:83], a[64:67], v[128:131]
  ds_read_b128 a[0:3], v12 offset:0
  s_add_u32 m0, s15, 98304
  v_mfma_f32_16x16x32_bf16 v[128:131], a[112:115], a[96:99], v[128:131]
  s_mov_b64 exec, 4
  buffer_store_dwordx2 v[14:15], v0, s[16:19], 0 offen sc1
  s_mov_b64 exec, -1
  ds_read_b64_tr_b16 a[16:17], v18 offset:0
  v_mfma_f32_16x16x32_bf16 v[132:135], a[84:87], a[64:67], v[132:135]
  ds_read_b64_tr_b16 a[18:19], v18 offset:4096
  buffer_load_dwordx4 v8, s[16:19], s12 offen offset:0  lds
  v_mfma_f32_16x16x32_bf16 v[132:135], a[116:119], a[96:99], v[132:135]
  ds_read_b128 a[32:35], v12 offset:8192
  v_mfma_f32_16x16x32_bf16 v[136:139], a[88:91], a[64:67], v[136:139]
  ds_read_b64_tr_b16 a[48:49], v18 offset:8192
  v_mfma_f32_16x16x32_bf16 v[136:139], a[120:123], a[96:99], v[136:139]
  buffer_load_dwordx4 v8, s[16:19], s12 offen offset:1024  lds
  ds_read_b64_tr_b16 a[50:51], v18 offset:12288
  v_mfma_f32_16x16x32_bf16 v[140:143], a[92:95], a[64:67], v[140:143]
  ds_read_b128 a[4:7], v12 offset:1024
  v_mfma_f32_16x16x32_bf16 v[140:143], a[124:127], a[96:99], v[140:143]
  ds_read_b64_tr_b16 a[20:21], v19 offset:0
  buffer_load_dwordx4 v8, s[16:19], s12 offen offset:2048  lds
  v_mfma_f32_16x16x32_bf16 v[144:147], a[80:83], a[68:71], v[144:147]
  v_mfma_f32_16x16x32_bf16 v[144:147], a[112:115], a[100:103], v[144:147]
  ds_read_b64_tr_b16 a[22:23], v19 offset:4096
  v_mfma_f32_16x16x32_bf16 v[148:151], a[84:87], a[68:71], v[148:151]
  ds_read_b128 a[36:39], v12 offset:9216
  buffer_load_dwordx4 v8, s[16:19], s12 offen offset:3072  lds
  v_mfma_f32_16x16x32_bf16 v[148:151], a[116:119], a[100:103], v[148:151]
  ds_read_b64_tr_b16 a[52:53], v19 offset:8192
  v_mfma_f32_16x16x32_bf16 v[152:155], a[88:91], a[68:71], v[152:155]
  ds_read_b64_tr_b16 a[54:55], v19 offset:12288
  s_add_u32 s12, s12, s31
  v_mfma_f32_16x16x32_bf16 v[152:155], a[120:123], a[100:103], v[152:155]
  ds_read_b128 a[8:11], v12 offset:2048
  v_mfma_f32_16x16x32_bf16 v[156:159], a[92:95], a[68:71], v[156:159]
  ds_read_b64_tr_b16 a[24:25], v20 offset:0
  v_mfma_f32_16x16x32_bf16 v[156:159], a[124:127], a[100:103], v[156:159]
  s_add_u32 m0, s27, 98304
  ds_read_b64_tr_b16 a[26:27], v20 offset:4096
  v_mfma_f32_16x16x32_bf16 v[160:163], a[80:83], a[72:75], v[160:163]
  v_mfma_f32_16x16x32_bf16 v[160:163], a[112:115], a[104:107], v[160:163]
  ds_read_b128 a[40:43], v12 offset:10240
  buffer_load_dwordx4 v2, s[96:99], s13 offen offset:0 lds
  v_mfma_f32_16x16x32_bf16 v[164:167], a[84:87], a[72:75], v[164:167]
  ds_read_b64_tr_b16 a[56:57], v20 offset:8192
  v_mfma_f32_16x16x32_bf16 v[164:167], a[116:119], a[104:107], v[164:167]
  ds_read_b64_tr_b16 a[58:59], v20 offset:12288
  v_mfma_f32_16x16x32_bf16 v[168:171], a[88:91], a[72:75], v[168:171]
  ds_read_b128 a[12:15], v12 offset:3072
  buffer_load_dwordx4 v3, s[96:99], s13 offen offset:1024 lds
  v_mfma_f32_16x16x32_bf16 v[168:171], a[120:123], a[104:107], v[168:171]
  ds_read_b64_tr_b16 a[28:29], v21 offset:0
  v_mfma_f32_16x16x32_bf16 v[172:175], a[92:95], a[72:75], v[172:175]
  ds_read_b64_tr_b16 a[30:31], v21 offset:4096
  buffer_load_dwordx4 v4, s[96:99], s13 offen offset:2048 lds
  v_mfma_f32_16x16x32_bf16 v[172:175], a[124:127], a[104:107], v[172:175]
  ds_read_b128 a[44:47], v12 offset:11264
  v_mfma_f32_16x16x32_bf16 v[176:179], a[80:83], a[76:79], v[176:179]
  ds_read_b64_tr_b16 a[60:61], v21 offset:8192
  v_mfma_f32_16x16x32_bf16 v[176:179], a[112:115], a[108:111], v[176:179]
  buffer_load_dwordx4 v5, s[96:99], s13 offen offset:3072 lds
  v_mfma_f32_16x16x32_bf16 v[180:183], a[84:87], a[76:79], v[180:183]
  ds_read_b64_tr_b16 a[62:63], v21 offset:12288
  v_mfma_f32_16x16x32_bf16 v[180:183], a[116:119], a[108:111], v[180:183]
  s_add_u32 s13, s13, s32
  v_mfma_f32_16x16x32_bf16 v[184:187], a[88:91], a[76:79], v[184:187]
  v_mfma_f32_16x16x32_bf16 v[184:187], a[120:123], a[108:111], v[184:187]
  v_mfma_f32_16x16x32_bf16 v[188:191], a[92:95], a[76:79], v[188:191]
  v_mfma_f32_16x16x32_bf16 v[188:191], a[124:127], a[108:111], v[188:191]
  s_waitcnt vmcnt(17) lgkmcnt(0)
  s_barrier
  v_mfma_f32_16x16x32_bf16 v[128:131], a[16:19], a[0:3], v[128:131]
  ds_read_b128 a[64:67], v12 offset:32768
  s_add_u32 m0, s15, 0
  v_mfma_f32_16x16x32_bf16 v[128:131], a[48:51], a[32:35], v[128:131]
  ds_read_b64_tr_b16 a[80:81], v18 offset:32768
  v_mfma_f32_16x16x32_bf16 v[132:135], a[20:23], a[0:3], v[132:135]
  ds_read_b64_tr_b16 a[82:83], v18 offset:36864
  buffer_load_dwordx4 v8, s[16:19], s12 offen offset:0  lds
  v_mfma_f32_16x16x32_bf16 v[132:135], a[52:55], a[32:35], v[132:135]
  ds_read_b128 a[96:99], v12 offset:40960
  v_mfma_f32_16x16x32_bf16 v[136:139], a[24:27], a[0:3], v[136:139]
  ds_read_b64_tr_b16 a[112:113], v18 offset:40960
  v_mfma_f32_16x16x32_bf16 v[136:139], a[56:59], a[32:35], v[136:139]
  buffer_load_dwordx4 v8, s[16:19], s12 offen offset:1024  lds
  ds_read_b64_tr_b16 a[114:115], v18 offset:45056
  v_mfma_f32_16x16x32_bf16 v[140:143], a[28:31], a[0:3], v[140:143]
  ds_read_b128 a[68:71], v12 offset:33792
  v_mfma_f32_16x16x32_bf16 v[140:143], a[60:63], a[32:35], v[140:143]
  ds_read_b64_tr_b16 a[84:85], v19 offset:32768
  buffer_load_dwordx4 v8, s[16:19], s12 offen offset:2048  lds
  v_mfma_f32_16x16x32_bf16 v[144:147], a[16:19], a[4:7], v[144:147]
  v_mfma_f32_16x16x32_bf16 v[144:147], a[48:51], a[36:39], v[144:147]
  ds_read_b64_tr_b16 a[86:87], v19 offset:36864
  v_mfma_f32_16x16x32_bf16 v[148:151], a[20:23], a[4:7], v[148:151]
  ds_read_b128 a[100:103], v12 offset:41984
  buffer_load_dwordx4 v8, s[16:19], s12 offen offset:3072  lds
  v_mfma_f32_16x16x32_bf16 v[148:151], a[52:55], a[36:39], v[148:151]
  ds_read_b64_tr_b16 a[116:117], v19 offset:40960
  v_mfma_f32_16x16x32_bf16 v[152:155], a[24:27], a[4:7], v[152:155]
  ds_read_b64_tr_b16 a[118:119], v19 offset:45056
  s_add_u32 s12, s12, s31
  v_mfma_f32_16x16x32_bf16 v[152:155], a[56:59], a[36:39], v[152:155]
  ds_read_b128 a[72:75], v12 offset:34816
  v_mfma_f32_16x16x32_bf16 v[156:159], a[28:31], a[4:7], v[156:159]
  ds_read_b64_tr_b16 a[88:89], v20 offset:32768
  v_mfma_f32_16x16x32_bf16 v[156:159], a[60:63], a[36:39], v[156:159]
  s_add_u32 m0, s27, 0
  ds_read_b64_tr_b16 a[90:91], v20 offset:36864
  v_mfma_f32_16x16x32_bf16 v[160:163], a[16:19], a[8:11], v[160:163]
  v_mfma_f32_16x16x32_bf16 v[160:163], a[48:51], a[40:43], v[160:163]
  ds_read_b128 a[104:107], v12 offset:43008
  buffer_load_dwordx4 v2, s[96:99], s13 offen offset:0 lds
  v_mfma_f32_16x16x32_bf16 v[164:167], a[20:23], a[8:11], v[164:167]
  ds_read_b64_tr_b16 a[120:121], v20 offset:40960
  v_mfma_f32_16x16x32_bf16 v[164:167], a[52:55], a[40:43], v[164:167]
  ds_read_b64_tr_b16 a[122:123], v20 offset:45056
  v_mfma_f32_16x16x32_bf16 v[168:171], a[24:27], a[8:11], v[168:171]
  ds_read_b128 a[76:79], v12 offset:35840
  buffer_load_dwordx4 v3, s[96:99], s13 offen offset:1024 lds
  v_mfma_f32_16x16x32_bf16 v[168:171], a[56:59], a[40:43], v[168:171]
  ds_read_b64_tr_b16 a[92:93], v21 offset:32768
  v_mfma_f32_16x16x32_bf16 v[172:175], a[28:31], a[8:11], v[172:175]
  ds_read_b64_tr_b16 a[94:95], v21 offset:36864
  buffer_load_dwordx4 v4, s[96:99], s13 offen offset:2048 lds
  v_mfma_f32_16x16x32_bf16 v[172:175], a[60:63], a[40:43], v[172:175]
  ds_read_b128 a[108:111], v12 offset:44032
  v_mfma_f32_16x16x32_bf16 v[176:179], a[16:19], a[12:15], v[176:179]
  ds_read_b64_tr_b16 a[124:125], v21 offset:40960
  v_mfma_f32_16x16x32_bf16 v[176:179], a[48:51], a[44:47], v[176:179]
  buffer_load_dwordx4 v5, s[96:99], s13 offen offset:3072 lds
  v_mfma_f32_16x16x32_bf16 v[180:183], a[20:23], a[12:15], v[180:183]
  ds_read_b64_tr_b16 a[126:127], v21 offset:45056
  v_mfma_f32_16x16x32_bf16 v[180:183], a[52:55], a[44:47], v[180:183]
  s_add_u32 s13, s13, s32
  v_mfma_f32_16x16x32_bf16 v[184:187], a[24:27], a[12:15], v[184:187]
  v_mfma_f32_16x16x32_bf16 v[184:187], a[56:59], a[44:47], v[184:187]
  v_mfma_f32_16x16x32_bf16 v[188:191], a[28:31], a[12:15], v[188:191]
  v_mfma_f32_16x16x32_bf16 v[188:191], a[60:63], a[44:47], v[188:191]
  s_waitcnt vmcnt(17) lgkmcnt(0)
  s_barrier
  v_mfma_f32_16x16x32_bf16 v[128:131], a[80:83], a[64:67], v[128:131]
  ds_read_b128 a[0:3], v13 offset:0
  s_add_u32 m0, s15, 32768
  v_mfma_f32_16x16x32_bf16 v[128:131], a[112:115], a[96:99], v[128:131]
  ds_read_b64_tr_b16 a[16:17], v22 offset:0
  v_mfma_f32_16x16x32_bf16 v[132:135], a[84:87], a[64:67], v[132:135]
  ds_read_b64_tr_b16 a[18:19], v22 offset:4096
  buffer_load_dwordx4 v8, s[16:19], s12 offen offset:0  lds
  v_mfma_f32_16x16x32_bf16 v[132:135], a[116:119], a[96:99], v[132:135]
  ds_read_b128 a[32:35], v13 offset:8192
  v_mfma_f32_16x16x32_bf16 v[136:139], a[88:91], a[64:67], v[136:139]
  ds_read_b64_tr_b16 a[48:49], v22 offset:8192
  v_mfma_f32_16x16x32_bf16 v[136:139], a[120:123], a[96:99], v[136:139]
  buffer_load_dwordx4 v8, s[16:19], s12 offen offset:1024  lds
  ds_read_b64_tr_b16 a[50:51], v22 offset:12288
  v_mfma_f32_16x16x32_bf16 v[140:143], a[92:95], a[64:67], v[140:143]
  ds_read_b128 a[4:7], v13 offset:1024
  v_mfma_f32_16x16x32_bf16 v[140:143], a[124:127], a[96:99], v[140:143]
  ds_read_b64_tr_b16 a[20:21], v23 offset:0
  buffer_load_dwordx4 v8, s[16:19], s12 offen offset:2048  lds
  v_mfma_f32_16x16x32_bf16 v[144:147], a[80:83], a[68:71], v[144:147]
  v_mfma_f32_16x16x32_bf16 v[144:147], a[112:115], a[100:103], v[144:147]
  ds_read_b64_tr_b16 a[22:23], v23 offset:4096
  v_mfma_f32_16x16x32_bf16 v[148:151], a[84:87], a[68:71], v[148:151]
  ds_read_b128 a[36:39], v13 offset:9216
  buffer_load_dwordx4 v8, s[16:19], s12 offen offset:3072  lds
  v_mfma_f32_16x16x32_bf16 v[148:151], a[116:119], a[100:103], v[148:151]
  ds_read_b64_tr_b16 a[52:53], v23 offset:8192
  v_mfma_f32_16x16x32_bf16 v[152:155], a[88:91], a[68:71], v[152:155]
  ds_read_b64_tr_b16 a[54:55], v23 offset:12288
  s_add_u32 s12, s12, s31
  v_mfma_f32_16x16x32_bf16 v[152:155], a[120:123], a[100:103], v[152:155]
  ds_read_b128 a[8:11], v13 offset:2048
  v_mfma_f32_16x16x32_bf16 v[156:159], a[92:95], a[68:71], v[156:159]
  ds_read_b64_tr_b16 a[24:25], v24 offset:0
  v_mfma_f32_16x16x32_bf16 v[156:159], a[124:127], a[100:103], v[156:159]
  s_add_u32 m0, s27, 32768
  ds_read_b64_tr_b16 a[26:27], v24 offset:4096
  v_mfma_f32_16x16x32_bf16 v[160:163], a[80:83], a[72:75], v[160:163]
  v_mfma_f32_16x16x32_bf16 v[160:163], a[112:115], a[104:107], v[160:163]
  ds_read_b128 a[40:43], v13 offset:10240
  buffer_load_dwordx4 v2, s[96:99], s13 offen offset:0 lds
  v_mfma_f32_16x16x32_bf16 v[164:167], a[84:87], a[72:75], v[164:167]
  ds_read_b64_tr_b16 a[56:57], v24 offset:8192
  v_mfma_f32_16x16x32_bf16 v[164:167], a[116:119], a[104:107], v[164:167]
  ds_read_b64_tr_b16 a[58:59], v24 offset:12288
  v_mfma_f32_16x16x32_bf16 v[168:171], a[88:91], a[72:75], v[168:171]
  ds_read_b128 a[12:15], v13 offset:3072
  buffer_load_dwordx4 v3, s[96:99], s13 offen offset:1024 lds
  v_mfma_f32_16x16x32_bf16 v[168:171], a[120:123], a[104:107], v[168:171]
  ds_read_b64_tr_b16 a[28:29], v25 offset:0
  v_mfma_f32_16x16x32_bf16 v[172:175], a[92:95], a[72:75], v[172:175]
  ds_read_b64_tr_b16 a[30:31], v25 offset:4096
  buffer_load_dwordx4 v4, s[96:99], s13 offen offset:2048 lds
  v_mfma_f32_16x16x32_bf16 v[172:175], a[124:127], a[104:107], v[172:175]
  ds_read_b128 a[44:47], v13 offset:11264
  v_mfma_f32_16x16x32_bf16 v[176:179], a[80:83], a[76:79], v[176:179]
  ds_read_b64_tr_b16 a[60:61], v25 offset:8192
  v_mfma_f32_16x16x32_bf16 v[176:179], a[112:115], a[108:111], v[176:179]
  buffer_load_dwordx4 v5, s[96:99], s13 offen offset:3072 lds
  v_mfma_f32_16x16x32_bf16 v[180:183], a[84:87], a[76:79], v[180:183]
  ds_read_b64_tr_b16 a[62:63], v25 offset:12288
  v_mfma_f32_16x16x32_bf16 v[180:183], a[116:119], a[108:111], v[180:183]
  s_add_u32 s13, s13, s32
  v_mfma_f32_16x16x32_bf16 v[184:187], a[88:91], a[76:79], v[184:187]
  v_mfma_f32_16x16x32_bf16 v[184:187], a[120:123], a[108:111], v[184:187]
  v_mfma_f32_16x16x32_bf16 v[188:191], a[92:95], a[76:79], v[188:191]
  v_mfma_f32_16x16x32_bf16 v[188:191], a[124:127], a[108:111], v[188:191]
  s_waitcnt vmcnt(16) lgkmcnt(0)
  s_barrier
  v_mfma_f32_16x16x32_bf16 v[128:131], a[16:19], a[0:3], v[128:131]
  ds_read_b128 a[64:67], v13 offset:32768
  s_add_u32 m0, s15, 65536
  v_mfma_f32_16x16x32_bf16 v[128:131], a[48:51], a[32:35], v[128:131]
  s_lshl_b32 s60, s8, 9
  ds_read_b64_tr_b16 a[80:81], v22 offset:32768
  v_mfma_f32_16x16x32_bf16 v[132:135], a[20:23], a[0:3], v[132:135]
  s_add_u32 s60, s60, 33153024
  ds_read_b64_tr_b16 a[82:83], v22 offset:36864
  buffer_load_dwordx4 v8, s[16:19], s12 offen offset:0  lds
  v_mfma_f32_16x16x32_bf16 v[132:135], a[52:55], a[32:35], v[132:135]
  ds_read_b128 a[96:99], v13 offset:40960
  v_max_u32 v9, 24, v1
  v_mfma_f32_16x16x32_bf16 v[136:139], a[24:27], a[0:3], v[136:139]
  ds_read_b64_tr_b16 a[112:113], v22 offset:40960
  v_lshlrev_b32 v9, 3, v9
  v_mfma_f32_16x16x32_bf16 v[136:139], a[56:59], a[32:35], v[136:139]
  buffer_load_dwordx4 v8, s[16:19], s12 offen offset:1024  lds
  ds_read_b64_tr_b16 a[114:115], v22 offset:45056
  v_add_u32 v9, s60, v9
  v_mfma_f32_16x16x32_bf16 v[140:143], a[28:31], a[0:3], v[140:143]
  ds_read_b128 a[68:71], v13 offset:33792
  v_mfma_f32_16x16x32_bf16 v[140:143], a[60:63], a[32:35], v[140:143]
  buffer_load_dwordx2 v[10:11], v9, s[16:19], 0 offen sc1
  ds_read_b64_tr_b16 a[84:85], v23 offset:32768
  buffer_load_dwordx4 v8, s[16:19], s12 offen offset:2048  lds
  v_mfma_f32_16x16x32_bf16 v[144:147], a[16:19], a[4:7], v[144:147]
  v_mfma_f32_16x16x32_bf16 v[144:147], a[48:51], a[36:39], v[144:147]
  ds_read_b64_tr_b16 a[86:87], v23 offset:36864
  v_mfma_f32_16x16x32_bf16 v[148:151], a[20:23], a[4:7], v[148:151]
  ds_read_b128 a[100:103], v13 offset:41984
  buffer_load_dwordx4 v8, s[16:19], s12 offen offset:3072  lds
  v_mfma_f32_16x16x32_bf16 v[148:151], a[52:55], a[36:39], v[148:151]
  ds_read_b64_tr_b16 a[116:117], v23 offset:40960
  v_mfma_f32_16x16x32_bf16 v[152:155], a[24:27], a[4:7], v[152:155]
  ds_read_b64_tr_b16 a[118:119], v23 offset:45056
  s_add_u32 s12, s12, s31
  v_mfma_f32_16x16x32_bf16 v[152:155], a[56:59], a[36:39], v[152:155]
  ds_read_b128 a[72:75], v13 offset:34816
  v_mfma_f32_16x16x32_bf16 v[156:159], a[28:31], a[4:7], v[156:159]
  ds_read_b64_tr_b16 a[88:89], v24 offset:32768
  v_mfma_f32_16x16x32_bf16 v[156:159], a[60:63], a[36:39], v[156:159]
  s_add_u32 m0, s27, 65536
  ds_read_b64_tr_b16 a[90:91], v24 offset:36864
  v_mfma_f32_16x16x32_bf16 v[160:163], a[16:19], a[8:11], v[160:163]
  v_mfma_f32_16x16x32_bf16 v[160:163], a[48:51], a[40:43], v[160:163]
  ds_read_b128 a[104:107], v13 offset:43008
  buffer_load_dwordx4 v2, s[96:99], s13 offen offset:0 lds
  v_mfma_f32_16x16x32_bf16 v[164:167], a[20:23], a[8:11], v[164:167]
  ds_read_b64_tr_b16 a[120:121], v24 offset:40960
  v_mfma_f32_16x16x32_bf16 v[164:167], a[52:55], a[40:43], v[164:167]
  ds_read_b64_tr_b16 a[122:123], v24 offset:45056
  v_mfma_f32_16x16x32_bf16 v[168:171], a[24:27], a[8:11], v[168:171]
  ds_read_b128 a[76:79], v13 offset:35840
  buffer_load_dwordx4 v3, s[96:99], s13 offen offset:1024 lds
  v_mfma_f32_16x16x32_bf16 v[168:171], a[56:59], a[40:43], v[168:171]
  ds_read_b64_tr_b16 a[92:93], v25 offset:32768
  v_mfma_f32_16x16x32_bf16 v[172:175], a[28:31], a[8:11], v[172:175]
  ds_read_b64_tr_b16 a[94:95], v25 offset:36864
  buffer_load_dwordx4 v4, s[96:99], s13 offen offset:2048 lds
  v_mfma_f32_16x16x32_bf16 v[172:175], a[60:63], a[40:43], v[172:175]
  ds_read_b128 a[108:111], v13 offset:44032
  v_mfma_f32_16x16x32_bf16 v[176:179], a[16:19], a[12:15], v[176:179]
  ds_read_b64_tr_b16 a[124:125], v25 offset:40960
  v_mfma_f32_16x16x32_bf16 v[176:179], a[48:51], a[44:47], v[176:179]
  buffer_load_dwordx4 v5, s[96:99], s13 offen offset:3072 lds
  v_mfma_f32_16x16x32_bf16 v[180:183], a[20:23], a[12:15], v[180:183]
  ds_read_b64_tr_b16 a[126:127], v25 offset:45056
  v_mfma_f32_16x16x32_bf16 v[180:183], a[52:55], a[44:47], v[180:183]
  s_add_u32 s13, s13, s32
  v_mfma_f32_16x16x32_bf16 v[184:187], a[24:27], a[12:15], v[184:187]
  v_mfma_f32_16x16x32_bf16 v[184:187], a[56:59], a[44:47], v[184:187]
  v_mfma_f32_16x16x32_bf16 v[188:191], a[28:31], a[12:15], v[188:191]
  v_mfma_f32_16x16x32_bf16 v[188:191], a[60:63], a[44:47], v[188:191]
  s_waitcnt vmcnt(17) lgkmcnt(0)
  s_barrier
  v_mfma_f32_16x16x32_bf16 v[128:131], a[80:83], a[64:67], v[128:131]
  ds_read_b128 a[0:3], v12 offset:0
  s_add_u32 m0, s15, 98304
  v_mfma_f32_16x16x32_bf16 v[128:131], a[112:115], a[96:99], v[128:131]
  ds_read_b64_tr_b16 a[16:17], v18 offset:0
  v_mfma_f32_16x16x32_bf16 v[132:135], a[84:87], a[64:67], v[132:135]
  ds_read_b64_tr_b16 a[18:19], v18 offset:4096
  buffer_load_dwordx4 v8, s[16:19], s12 offen offset:0  lds
  v_mfma_f32_16x16x32_bf16 v[132:135], a[116:119], a[96:99], v[132:135]
  ds_read_b128 a[32:35], v12 offset:8192
  v_mfma_f32_16x16x32_bf16 v[136:139], a[88:91], a[64:67], v[136:139]
  ds_read_b64_tr_b16 a[48:49], v18 offset:8192
  v_mfma_f32_16x16x32_bf16 v[136:139], a[120:123], a[96:99], v[136:139]
  buffer_load_dwordx4 v8, s[16:19], s12 offen offset:1024  lds
  ds_read_b64_tr_b16 a[50:51], v18 offset:12288
  v_mfma_f32_16x16x32_bf16 v[140:143], a[92:95], a[64:67], v[140:143]
  ds_read_b128 a[4:7], v12 offset:1024
  v_mfma_f32_16x16x32_bf16 v[140:143], a[124:127], a[96:99], v[140:143]
  ds_read_b64_tr_b16 a[20:21], v19 offset:0
  buffer_load_dwordx4 v8, s[16:19], s12 offen offset:2048  lds
  v_mfma_f32_16x16x32_bf16 v[144:147], a[80:83], a[68:71], v[144:147]
  v_mfma_f32_16x16x32_bf16 v[144:147], a[112:115], a[100:103], v[144:147]
  ds_read_b64_tr_b16 a[22:23], v19 offset:4096
  v_mfma_f32_16x16x32_bf16 v[148:151], a[84:87], a[68:71], v[148:151]
  ds_read_b128 a[36:39], v12 offset:9216
  buffer_load_dwordx4 v8, s[16:19], s12 offen offset:3072  lds
  v_mfma_f32_16x16x32_bf16 v[148:151], a[116:119], a[100:103], v[148:151]
  ds_read_b64_tr_b16 a[52:53], v19 offset:8192
  v_mfma_f32_16x16x32_bf16 v[152:155], a[88:91], a[68:71], v[152:155]
  ds_read_b64_tr_b16 a[54:55], v19 offset:12288
  s_add_u32 s12, s12, s31
  v_mfma_f32_16x16x32_bf16 v[152:155], a[120:123], a[100:103], v[152:155]
  ds_read_b128 a[8:11], v12 offset:2048
  v_mfma_f32_16x16x32_bf16 v[156:159], a[92:95], a[68:71], v[156:159]
  ds_read_b64_tr_b16 a[24:25], v20 offset:0
  v_mfma_f32_16x16x32_bf16 v[156:159], a[124:127], a[100:103], v[156:159]
  s_add_u32 m0, s27, 98304
  ds_read_b64_tr_b16 a[26:27], v20 offset:4096
  v_mfma_f32_16x16x32_bf16 v[160:163], a[80:83], a[72:75], v[160:163]
  v_mfma_f32_16x16x32_bf16 v[160:163], a[112:115], a[104:107], v[160:163]
  ds_read_b128 a[40:43], v12 offset:10240
  buffer_load_dwordx4 v2, s[96:99], s13 offen offset:0 lds
  v_mfma_f32_16x16x32_bf16 v[164:167], a[84:87], a[72:75], v[164:167]
  ds_read_b64_tr_b16 a[56:57], v20 offset:8192
  v_mfma_f32_16x16x32_bf16 v[164:167], a[116:119], a[104:107], v[164:167]
  ds_read_b64_tr_b16 a[58:59], v20 offset:12288
  v_mfma_f32_16x16x32_bf16 v[168:171], a[88:91], a[72:75], v[168:171]
  ds_read_b128 a[12:15], v12 offset:3072
  buffer_load_dwordx4 v3, s[96:99], s13 offen offset:1024 lds
  v_mfma_f32_16x16x32_bf16 v[168:171], a[120:123], a[104:107], v[168:171]
  ds_read_b64_tr_b16 a[28:29], v21 offset:0
  v_mfma_f32_16x16x32_bf16 v[172:175], a[92:95], a[72:75], v[172:175]
  ds_read_b64_tr_b16 a[30:31], v21 offset:4096
  buffer_load_dwordx4 v4, s[96:99], s13 offen offset:2048 lds
  v_mfma_f32_16x16x32_bf16 v[172:175], a[124:127], a[104:107], v[172:175]
  ds_read_b128 a[44:47], v12 offset:11264
  v_mfma_f32_16x16x32_bf16 v[176:179], a[80:83], a[76:79], v[176:179]
  ds_read_b64_tr_b16 a[60:61], v21 offset:8192
  v_mfma_f32_16x16x32_bf16 v[176:179], a[112:115], a[108:111], v[176:179]
  buffer_load_dwordx4 v5, s[96:99], s13 offen offset:3072 lds
  v_mfma_f32_16x16x32_bf16 v[180:183], a[84:87], a[76:79], v[180:183]
  ds_read_b64_tr_b16 a[62:63], v21 offset:12288
  v_mfma_f32_16x16x32_bf16 v[180:183], a[116:119], a[108:111], v[180:183]
  s_add_u32 s13, s13, s32
  v_mfma_f32_16x16x32_bf16 v[184:187], a[88:91], a[76:79], v[184:187]
  v_mfma_f32_16x16x32_bf16 v[184:187], a[120:123], a[108:111], v[184:187]
  v_mfma_f32_16x16x32_bf16 v[188:191], a[92:95], a[76:79], v[188:191]
  v_mfma_f32_16x16x32_bf16 v[188:191], a[124:127], a[108:111], v[188:191]
  s_waitcnt vmcnt(17) lgkmcnt(0)
  s_barrier
  s_waitcnt vmcnt(14)
L_p2r1_ow:
  v_cmp_eq_u64 vcc, v[10:11], v[14:15]
  s_nop 1
  s_cmp_eq_u64 vcc, -1
  s_cbranch_scc1 L_p2r1_ook
  s_add_u32 s3, s3, 1
  s_cmp_gt_u32 s3, 0x40000
  s_cbranch_scc1 L_p2r1_ook
  s_sleep 4
  buffer_load_dwordx2 v[10:11], v9, s[16:19], 0 offen sc1
  s_waitcnt vmcnt(0)
  s_branch L_p2r1_ow
L_p2r1_ook:
  v_mfma_f32_16x16x32_bf16 v[128:131], a[16:19], a[0:3], v[128:131]
  ds_read_b128 a[64:67], v12 offset:32768
  s_lshr_b32 s71, s24, 1
  s_add_u32 s71, s71, 12
  s_lshl_b32 s13, s71, 16
  s_lshl_b32 s12, s8, 5
  s_add_u32 s12, s12, s71
  s_lshl_b32 s12, s12, 13
  s_add_u32 s12, s12, 28942336
  s_mov_b32 s31, 16384
  s_mov_b32 s32, 131072
  s_and_b32 s69, s24, 1
  s_mul_i32 s69, s69, -24576
  v_subrev_u32 v2, s69, v2
  s_add_u32 s69, s69, 8192
  v_subrev_u32 v3, s69, v3
  s_add_u32 s69, s69, 8192
  v_subrev_u32 v4, s69, v4
  s_add_u32 s69, s69, 8192
  v_subrev_u32 v5, s69, v5
  v_mfma_f32_16x16x32_bf16 v[128:131], a[48:51], a[32:35], v[128:131]
  ds_read_b64_tr_b16 a[80:81], v18 offset:32768
  v_mfma_f32_16x16x32_bf16 v[132:135], a[20:23], a[0:3], v[132:135]
  ds_read_b64_tr_b16 a[82:83], v18 offset:36864
  s_add_u32 m0, s15, 0
  v_mfma_f32_16x16x32_bf16 v[132:135], a[52:55], a[32:35], v[132:135]
  ds_read_b128 a[96:99], v12 offset:40960
  v_mfma_f32_16x16x32_bf16 v[136:139], a[24:27], a[0:3], v[136:139]
  ds_read_b64_tr_b16 a[112:113], v18 offset:40960
  v_mfma_f32_16x16x32_bf16 v[136:139], a[56:59], a[32:35], v[136:139]
  buffer_load_dwordx4 v8, s[16:19], s12 offen offset:0  lds
  ds_read_b64_tr_b16 a[114:115], v18 offset:45056
  v_mfma_f32_16x16x32_bf16 v[140:143], a[28:31], a[0:3], v[140:143]
  ds_read_b128 a[68:71], v12 offset:33792
  v_mfma_f32_16x16x32_bf16 v[140:143], a[60:63], a[32:35], v[140:143]
  buffer_load_dwordx4 v8, s[16:19], s12 offen offset:1024  lds
  ds_read_b64_tr_b16 a[84:85], v19 offset:32768
  v_mfma_f32_16x16x32_bf16 v[144:147], a[16:19], a[4:7], v[144:147]
  v_mfma_f32_16x16x32_bf16 v[144:147], a[48:51], a[36:39], v[144:147]
  ds_read_b64_tr_b16 a[86:87], v19 offset:36864
  buffer_load_dwordx4 v8, s[16:19], s12 offen offset:2048  lds
  v_mfma_f32_16x16x32_bf16 v[148:151], a[20:23], a[4:7], v[148:151]
  ds_read_b128 a[100:103], v12 offset:41984
  v_mfma_f32_16x16x32_bf16 v[148:151], a[52:55], a[36:39], v[148:151]
  ds_read_b64_tr_b16 a[116:117], v19 offset:40960
  v_mfma_f32_16x16x32_bf16 v[152:155], a[24:27], a[4:7], v[152:155]
  buffer_load_dwordx4 v8, s[16:19], s12 offen offset:3072  lds
  ds_read_b64_tr_b16 a[118:119], v19 offset:45056
  v_mfma_f32_16x16x32_bf16 v[152:155], a[56:59], a[36:39], v[152:155]
  ds_read_b128 a[72:75], v12 offset:34816
  v_mfma_f32_16x16x32_bf16 v[156:159], a[28:31], a[4:7], v[156:159]
  s_add_u32 s12, s12, s31
  ds_read_b64_tr_b16 a[88:89], v20 offset:32768
  v_mfma_f32_16x16x32_bf16 v[156:159], a[60:63], a[36:39], v[156:159]
  ds_read_b64_tr_b16 a[90:91], v20 offset:36864
  v_mfma_f32_16x16x32_bf16 v[160:163], a[16:19], a[8:11], v[160:163]
  s_add_u32 m0, s27, 0
  v_mfma_f32_16x16x32_bf16 v[160:163], a[48:51], a[40:43], v[160:163]
  ds_read_b128 a[104:107], v12 offset:43008
  v_mfma_f32_16x16x32_bf16 v[164:167], a[20:23], a[8:11], v[164:167]
  ds_read_b64_tr_b16 a[120:121], v20 offset:40960
  buffer_load_dwordx4 v2, s[20:23], s13 offen offset:0 lds
  v_mfma_f32_16x16x32_bf16 v[164:167], a[52:55], a[40:43], v[164:167]
  ds_read_b64_tr_b16 a[122:123], v20 offset:45056
  v_mfma_f32_16x16x32_bf16 v[168:171], a[24:27], a[8:11], v[168:171]
  ds_read_b128 a[76:79], v12 offset:35840
  v_mfma_f32_16x16x32_bf16 v[168:171], a[56:59], a[40:43], v[168:171]
  buffer_load_dwordx4 v3, s[20:23], s13 offen offset:1024 lds
  ds_read_b64_tr_b16 a[92:93], v21 offset:32768
  v_mfma_f32_16x16x32_bf16 v[172:175], a[28:31], a[8:11], v[172:175]
  ds_read_b64_tr_b16 a[94:95], v21 offset:36864
  v_mfma_f32_16x16x32_bf16 v[172:175], a[60:63], a[40:43], v[172:175]
  buffer_load_dwordx4 v4, s[20:23], s13 offen offset:2048 lds
  ds_read_b128 a[108:111], v12 offset:44032
  v_mfma_f32_16x16x32_bf16 v[176:179], a[16:19], a[12:15], v[176:179]
  ds_read_b64_tr_b16 a[124:125], v21 offset:40960
  v_mfma_f32_16x16x32_bf16 v[176:179], a[48:51], a[44:47], v[176:179]
  buffer_load_dwordx4 v5, s[20:23], s13 offen offset:3072 lds
  v_mfma_f32_16x16x32_bf16 v[180:183], a[20:23], a[12:15], v[180:183]
  ds_read_b64_tr_b16 a[126:127], v21 offset:45056
  v_mfma_f32_16x16x32_bf16 v[180:183], a[52:55], a[44:47], v[180:183]
  v_mfma_f32_16x16x32_bf16 v[184:187], a[24:27], a[12:15], v[184:187]
  s_add_u32 s13, s13, s32
  v_mfma_f32_16x16x32_bf16 v[184:187], a[56:59], a[44:47], v[184:187]
  v_mfma_f32_16x16x32_bf16 v[188:191], a[28:31], a[12:15], v[188:191]
  v_mfma_f32_16x16x32_bf16 v[188:191], a[60:63], a[44:47], v[188:191]
  s_waitcnt vmcnt(16) lgkmcnt(0)
  s_barrier
  v_mfma_f32_16x16x32_bf16 v[128:131], a[80:83], a[64:67], v[128:131]
  ds_read_b128 a[0:3], v13 offset:0
  s_add_u32 m0, s15, 32768
  v_mfma_f32_16x16x32_bf16 v[128:131], a[112:115], a[96:99], v[128:131]
  ds_read_b64_tr_b16 a[16:17], v22 offset:0
  v_mfma_f32_16x16x32_bf16 v[132:135], a[84:87], a[64:67], v[132:135]
  ds_read_b64_tr_b16 a[18:19], v22 offset:4096
  buffer_load_dwordx4 v8, s[16:19], s12 offen offset:0  lds
  v_mfma_f32_16x16x32_bf16 v[132:135], a[116:119], a[96:99], v[132:135]
  ds_read_b128 a[32:35], v13 offset:8192
  v_mfma_f32_16x16x32_bf16 v[136:139], a[88:91], a[64:67], v[136:139]
  ds_read_b64_tr_b16 a[48:49], v22 offset:8192
  v_mfma_f32_16x16x32_bf16 v[136:139], a[120:123], a[96:99], v[136:139]
  buffer_load_dwordx4 v8, s[16:19], s12 offen offset:1024  lds
  ds_read_b64_tr_b16 a[50:51], v22 offset:12288
  v_mfma_f32_16x16x32_bf16 v[140:143], a[92:95], a[64:67], v[140:143]
  ds_read_b128 a[4:7], v13 offset:1024
  v_mfma_f32_16x16x32_bf16 v[140:143], a[124:127], a[96:99], v[140:143]
  ds_read_b64_tr_b16 a[20:21], v23 offset:0
  buffer_load_dwordx4 v8, s[16:19], s12 offen offset:2048  lds
  v_mfma_f32_16x16x32_bf16 v[144:147], a[80:83], a[68:71], v[144:147]
  v_mfma_f32_16x16x32_bf16 v[144:147], a[112:115], a[100:103], v[144:147]
  ds_read_b64_tr_b16 a[22:23], v23 offset:4096
  v_mfma_f32_16x16x32_bf16 v[148:151], a[84:87], a[68:71], v[148:151]
  ds_read_b128 a[36:39], v13 offset:9216
  buffer_load_dwordx4 v8, s[16:19], s12 offen offset:3072  lds
  v_mfma_f32_16x16x32_bf16 v[148:151], a[116:119], a[100:103], v[148:151]
  ds_read_b64_tr_b16 a[52:53], v23 offset:8192
  v_mfma_f32_16x16x32_bf16 v[152:155], a[88:91], a[68:71], v[152:155]
  ds_read_b64_tr_b16 a[54:55], v23 offset:12288
  s_add_u32 s12, s12, s31
  v_mfma_f32_16x16x32_bf16 v[152:155], a[120:123], a[100:103], v[152:155]
  ds_read_b128 a[8:11], v13 offset:2048
  v_mfma_f32_16x16x32_bf16 v[156:159], a[92:95], a[68:71], v[156:159]
  ds_read_b64_tr_b16 a[24:25], v24 offset:0
  v_mfma_f32_16x16x32_bf16 v[156:159], a[124:127], a[100:103], v[156:159]
  s_add_u32 m0, s27, 32768
  ds_read_b64_tr_b16 a[26:27], v24 offset:4096
  v_mfma_f32_16x16x32_bf16 v[160:163], a[80:83], a[72:75], v[160:163]
  v_mfma_f32_16x16x32_bf16 v[160:163], a[112:115], a[104:107], v[160:163]
  ds_read_b128 a[40:43], v13 offset:10240
  buffer_load_dwordx4 v2, s[20:23], s13 offen offset:0 lds
  v_mfma_f32_16x16x32_bf16 v[164:167], a[84:87], a[72:75], v[164:167]
  ds_read_b64_tr_b16 a[56:57], v24 offset:8192
  v_mfma_f32_16x16x32_bf16 v[164:167], a[116:119], a[104:107], v[164:167]
  ds_read_b64_tr_b16 a[58:59], v24 offset:12288
  v_mfma_f32_16x16x32_bf16 v[168:171], a[88:91], a[72:75], v[168:171]
  ds_read_b128 a[12:15], v13 offset:3072
  buffer_load_dwordx4 v3, s[20:23], s13 offen offset:1024 lds
  v_mfma_f32_16x16x32_bf16 v[168:171], a[120:123], a[104:107], v[168:171]
  ds_read_b64_tr_b16 a[28:29], v25 offset:0
  v_mfma_f32_16x16x32_bf16 v[172:175], a[92:95], a[72:75], v[172:175]
  ds_read_b64_tr_b16 a[30:31], v25 offset:4096
  buffer_load_dwordx4 v4, s[20:23], s13 offen offset:2048 lds
  v_mfma_f32_16x16x32_bf16 v[172:175], a[124:127], a[104:107], v[172:175]
  ds_read_b128 a[44:47], v13 offset:11264
  v_mfma_f32_16x16x32_bf16 v[176:179], a[80:83], a[76:79], v[176:179]
  ds_read_b64_tr_b16 a[60:61], v25 offset:8192
  v_mfma_f32_16x16x32_bf16 v[176:179], a[112:115], a[108:111], v[176:179]
  buffer_load_dwordx4 v5, s[20:23], s13 offen offset:3072 lds
  v_mfma_f32_16x16x32_bf16 v[180:183], a[84:87], a[76:79], v[180:183]
  ds_read_b64_tr_b16 a[62:63], v25 offset:12288
  v_mfma_f32_16x16x32_bf16 v[180:183], a[116:119], a[108:111], v[180:183]
  s_add_u32 s13, s13, s32
  v_mfma_f32_16x16x32_bf16 v[184:187], a[88:91], a[76:79], v[184:187]
  v_mfma_f32_16x16x32_bf16 v[184:187], a[120:123], a[108:111], v[184:187]
  v_mfma_f32_16x16x32_bf16 v[188:191], a[92:95], a[76:79], v[188:191]
  v_mfma_f32_16x16x32_bf16 v[188:191], a[124:127], a[108:111], v[188:191]
  s_waitcnt vmcnt(16) lgkmcnt(0)
  s_barrier
  v_mfma_f32_16x16x32_bf16 v[128:131], a[16:19], a[0:3], v[128:131]
  ds_read_b128 a[64:67], v13 offset:32768
  s_add_u32 m0, s15, 65536
  v_mfma_f32_16x16x32_bf16 v[128:131], a[48:51], a[32:35], v[128:131]
  ds_read_b64_tr_b16 a[80:81], v22 offset:32768
  v_mfma_f32_16x16x32_bf16 v[132:135], a[20:23], a[0:3], v[132:135]
  ds_read_b64_tr_b16 a[82:83], v22 offset:36864
  buffer_load_dwordx4 v8, s[16:19], s12 offen offset:0  lds
  v_mfma_f32_16x16x32_bf16 v[132:135], a[52:55], a[32:35], v[132:135]
  ds_read_b128 a[96:99], v13 offset:40960
  v_mfma_f32_16x16x32_bf16 v[136:139], a[24:27], a[0:3], v[136:139]
  ds_read_b64_tr_b16 a[112:113], v22 offset:40960
  v_mfma_f32_16x16x32_bf16 v[136:139], a[56:59], a[32:35], v[136:139]
  buffer_load_dwordx4 v8, s[16:19], s12 offen offset:1024  lds
  ds_read_b64_tr_b16 a[114:115], v22 offset:45056
  v_mfma_f32_16x16x32_bf16 v[140:143], a[28:31], a[0:3], v[140:143]
  ds_read_b128 a[68:71], v13 offset:33792
  v_mfma_f32_16x16x32_bf16 v[140:143], a[60:63], a[32:35], v[140:143]
  ds_read_b64_tr_b16 a[84:85], v23 offset:32768
  buffer_load_dwordx4 v8, s[16:19], s12 offen offset:2048  lds
  v_mfma_f32_16x16x32_bf16 v[144:147], a[16:19], a[4:7], v[144:147]
  v_mfma_f32_16x16x32_bf16 v[144:147], a[48:51], a[36:39], v[144:147]
  ds_read_b64_tr_b16 a[86:87], v23 offset:36864
  v_mfma_f32_16x16x32_bf16 v[148:151], a[20:23], a[4:7], v[148:151]
  ds_read_b128 a[100:103], v13 offset:41984
  buffer_load_dwordx4 v8, s[16:19], s12 offen offset:3072  lds
  v_mfma_f32_16x16x32_bf16 v[148:151], a[52:55], a[36:39], v[148:151]
  ds_read_b64_tr_b16 a[116:117], v23 offset:40960
  v_mfma_f32_16x16x32_bf16 v[152:155], a[24:27], a[4:7], v[152:155]
  ds_read_b64_tr_b16 a[118:119], v23 offset:45056
  s_add_u32 s12, s12, s31
  v_mfma_f32_16x16x32_bf16 v[152:155], a[56:59], a[36:39], v[152:155]
  ds_read_b128 a[72:75], v13 offset:34816
  v_mfma_f32_16x16x32_bf16 v[156:159], a[28:31], a[4:7], v[156:159]
  ds_read_b64_tr_b16 a[88:89], v24 offset:32768
  v_mfma_f32_16x16x32_bf16 v[156:159], a[60:63], a[36:39], v[156:159]
  s_add_u32 m0, s27, 65536
  ds_read_b64_tr_b16 a[90:91], v24 offset:36864
  v_mfma_f32_16x16x32_bf16 v[160:163], a[16:19], a[8:11], v[160:163]
  v_mfma_f32_16x16x32_bf16 v[160:163], a[48:51], a[40:43], v[160:163]
  ds_read_b128 a[104:107], v13 offset:43008
  buffer_load_dwordx4 v2, s[20:23], s13 offen offset:0 lds
  v_mfma_f32_16x16x32_bf16 v[164:167], a[20:23], a[8:11], v[164:167]
  ds_read_b64_tr_b16 a[120:121], v24 offset:40960
  v_mfma_f32_16x16x32_bf16 v[164:167], a[52:55], a[40:43], v[164:167]
  ds_read_b64_tr_b16 a[122:123], v24 offset:45056
  v_mfma_f32_16x16x32_bf16 v[168:171], a[24:27], a[8:11], v[168:171]
  ds_read_b128 a[76:79], v13 offset:35840
  buffer_load_dwordx4 v3, s[20:23], s13 offen offset:1024 lds
  v_mfma_f32_16x16x32_bf16 v[168:171], a[56:59], a[40:43], v[168:171]
  ds_read_b64_tr_b16 a[92:93], v25 offset:32768
  v_mfma_f32_16x16x32_bf16 v[172:175], a[28:31], a[8:11], v[172:175]
  ds_read_b64_tr_b16 a[94:95], v25 offset:36864
  buffer_load_dwordx4 v4, s[20:23], s13 offen offset:2048 lds
  v_mfma_f32_16x16x32_bf16 v[172:175], a[60:63], a[40:43], v[172:175]
  ds_read_b128 a[108:111], v13 offset:44032
  v_mfma_f32_16x16x32_bf16 v[176:179], a[16:19], a[12:15], v[176:179]
  ds_read_b64_tr_b16 a[124:125], v25 offset:40960
  v_mfma_f32_16x16x32_bf16 v[176:179], a[48:51], a[44:47], v[176:179]
  buffer_load_dwordx4 v5, s[20:23], s13 offen offset:3072 lds
  v_mfma_f32_16x16x32_bf16 v[180:183], a[20:23], a[12:15], v[180:183]
  ds_read_b64_tr_b16 a[126:127], v25 offset:45056
  v_mfma_f32_16x16x32_bf16 v[180:183], a[52:55], a[44:47], v[180:183]
  s_add_u32 s13, s13, s32
  v_mfma_f32_16x16x32_bf16 v[184:187], a[24:27], a[12:15], v[184:187]
  v_mfma_f32_16x16x32_bf16 v[184:187], a[56:59], a[44:47], v[184:187]
  v_mfma_f32_16x16x32_bf16 v[188:191], a[28:31], a[12:15], v[188:191]
  v_mfma_f32_16x16x32_bf16 v[188:191], a[60:63], a[44:47], v[188:191]
  s_waitcnt vmcnt(16) lgkmcnt(0)
  s_barrier
  v_mfma_f32_16x16x32_bf16 v[128:131], a[80:83], a[64:67], v[128:131]
  ds_read_b128 a[0:3], v12 offset:0
  s_add_u32 m0, s15, 98304
  v_mfma_f32_16x16x32_bf16 v[128:131], a[112:115], a[96:99], v[128:131]
  ds_read_b64_tr_b16 a[16:17], v18 offset:0
  v_mfma_f32_16x16x32_bf16 v[132:135], a[84:87], a[64:67], v[132:135]
  ds_read_b64_tr_b16 a[18:19], v18 offset:4096
  buffer_load_dwordx4 v8, s[16:19], s12 offen offset:0  lds
  v_mfma_f32_16x16x32_bf16 v[132:135], a[116:119], a[96:99], v[132:135]
  ds_read_b128 a[32:35], v12 offset:8192
  v_mfma_f32_16x16x32_bf16 v[136:139], a[88:91], a[64:67], v[136:139]
  ds_read_b64_tr_b16 a[48:49], v18 offset:8192
  v_mfma_f32_16x16x32_bf16 v[136:139], a[120:123], a[96:99], v[136:139]
  buffer_load_dwordx4 v8, s[16:19], s12 offen offset:1024  lds
  ds_read_b64_tr_b16 a[50:51], v18 offset:12288
  v_mfma_f32_16x16x32_bf16 v[140:143], a[92:95], a[64:67], v[140:143]
  ds_read_b128 a[4:7], v12 offset:1024
  v_mfma_f32_16x16x32_bf16 v[140:143], a[124:127], a[96:99], v[140:143]
  ds_read_b64_tr_b16 a[20:21], v19 offset:0
  buffer_load_dwordx4 v8, s[16:19], s12 offen offset:2048  lds
  v_mfma_f32_16x16x32_bf16 v[144:147], a[80:83], a[68:71], v[144:147]
  v_mfma_f32_16x16x32_bf16 v[144:147], a[112:115], a[100:103], v[144:147]
  ds_read_b64_tr_b16 a[22:23], v19 offset:4096
  v_mfma_f32_16x16x32_bf16 v[148:151], a[84:87], a[68:71], v[148:151]
  ds_read_b128 a[36:39], v12 offset:9216
  buffer_load_dwordx4 v8, s[16:19], s12 offen offset:3072  lds
  v_mfma_f32_16x16x32_bf16 v[148:151], a[116:119], a[100:103], v[148:151]
  ds_read_b64_tr_b16 a[52:53], v19 offset:8192
  v_mfma_f32_16x16x32_bf16 v[152:155], a[88:91], a[68:71], v[152:155]
  ds_read_b64_tr_b16 a[54:55], v19 offset:12288
  s_add_u32 s12, s12, s31
  v_mfma_f32_16x16x32_bf16 v[152:155], a[120:123], a[100:103], v[152:155]
  ds_read_b128 a[8:11], v12 offset:2048
  v_mfma_f32_16x16x32_bf16 v[156:159], a[92:95], a[68:71], v[156:159]
  ds_read_b64_tr_b16 a[24:25], v20 offset:0
  v_mfma_f32_16x16x32_bf16 v[156:159], a[124:127], a[100:103], v[156:159]
  s_add_u32 m0, s27, 98304
  ds_read_b64_tr_b16 a[26:27], v20 offset:4096
  v_mfma_f32_16x16x32_bf16 v[160:163], a[80:83], a[72:75], v[160:163]
  v_mfma_f32_16x16x32_bf16 v[160:163], a[112:115], a[104:107], v[160:163]
  ds_read_b128 a[40:43], v12 offset:10240
  buffer_load_dwordx4 v2, s[20:23], s13 offen offset:0 lds
  v_mfma_f32_16x16x32_bf16 v[164:167], a[84:87], a[72:75], v[164:167]
  ds_read_b64_tr_b16 a[56:57], v20 offset:8192
  v_mfma_f32_16x16x32_bf16 v[164:167], a[116:119], a[104:107], v[164:167]
  ds_read_b64_tr_b16 a[58:59], v20 offset:12288
  v_mfma_f32_16x16x32_bf16 v[168:171], a[88:91], a[72:75], v[168:171]
  ds_read_b128 a[12:15], v12 offset:3072
  buffer_load_dwordx4 v3, s[20:23], s13 offen offset:1024 lds
  v_mfma_f32_16x16x32_bf16 v[168:171], a[120:123], a[104:107], v[168:171]
  ds_read_b64_tr_b16 a[28:29], v21 offset:0
  v_mfma_f32_16x16x32_bf16 v[172:175], a[92:95], a[72:75], v[172:175]
  ds_read_b64_tr_b16 a[30:31], v21 offset:4096
  buffer_load_dwordx4 v4, s[20:23], s13 offen offset:2048 lds
  v_mfma_f32_16x16x32_bf16 v[172:175], a[124:127], a[104:107], v[172:175]
  ds_read_b128 a[44:47], v12 offset:11264
  v_mfma_f32_16x16x32_bf16 v[176:179], a[80:83], a[76:79], v[176:179]
  ds_read_b64_tr_b16 a[60:61], v21 offset:8192
  v_mfma_f32_16x16x32_bf16 v[176:179], a[112:115], a[108:111], v[176:179]
  buffer_load_dwordx4 v5, s[20:23], s13 offen offset:3072 lds
  v_mfma_f32_16x16x32_bf16 v[180:183], a[84:87], a[76:79], v[180:183]
  ds_read_b64_tr_b16 a[62:63], v21 offset:12288
  v_mfma_f32_16x16x32_bf16 v[180:183], a[116:119], a[108:111], v[180:183]
  s_add_u32 s13, s13, s32
  v_mfma_f32_16x16x32_bf16 v[184:187], a[88:91], a[76:79], v[184:187]
  v_mfma_f32_16x16x32_bf16 v[184:187], a[120:123], a[108:111], v[184:187]
  v_mfma_f32_16x16x32_bf16 v[188:191], a[92:95], a[76:79], v[188:191]
  v_mfma_f32_16x16x32_bf16 v[188:191], a[124:127], a[108:111], v[188:191]
  s_waitcnt vmcnt(16) lgkmcnt(0)
  s_barrier
  v_mfma_f32_16x16x32_bf16 v[192:195], a[16:19], a[0:3], 0
  ds_read_b128 a[64:67], v12 offset:32768
  s_add_u32 m0, s15, 0
  v_mfma_f32_16x16x32_bf16 v[192:195], a[48:51], a[32:35], v[192:195]
  ds_read_b64_tr_b16 a[80:81], v18 offset:32768
  v_mfma_f32_16x16x32_bf16 v[196:199], a[20:23], a[0:3], 0
  ds_read_b64_tr_b16 a[82:83], v18 offset:36864
  buffer_load_dwordx4 v8, s[16:19], s12 offen offset:0  lds
  v_mfma_f32_16x16x32_bf16 v[196:199], a[52:55], a[32:35], v[196:199]
  ds_read_b128 a[96:99], v12 offset:40960
  v_mfma_f32_16x16x32_bf16 v[200:203], a[24:27], a[0:3], 0
  ds_read_b64_tr_b16 a[112:113], v18 offset:40960
  v_mfma_f32_16x16x32_bf16 v[200:203], a[56:59], a[32:35], v[200:203]
  buffer_load_dwordx4 v8, s[16:19], s12 offen offset:1024  lds
  ds_read_b64_tr_b16 a[114:115], v18 offset:45056
  v_mfma_f32_16x16x32_bf16 v[204:207], a[28:31], a[0:3], 0
  ds_read_b128 a[68:71], v12 offset:33792
  v_mfma_f32_16x16x32_bf16 v[204:207], a[60:63], a[32:35], v[204:207]
  ds_read_b64_tr_b16 a[84:85], v19 offset:32768
  buffer_load_dwordx4 v8, s[16:19], s12 offen offset:2048  lds
  v_mfma_f32_16x16x32_bf16 v[208:211], a[16:19], a[4:7], 0
  v_mfma_f32_16x16x32_bf16 v[208:211], a[48:51], a[36:39], v[208:211]
  ds_read_b64_tr_b16 a[86:87], v19 offset:36864
  v_mfma_f32_16x16x32_bf16 v[212:215], a[20:23], a[4:7], 0
  v_sub_f32 v42, 1.0, v38
  ds_read_b128 a[100:103], v12 offset:41984
  buffer_load_dwordx4 v8, s[16:19], s12 offen offset:3072  lds
  v_mfma_f32_16x16x32_bf16 v[212:215], a[52:55], a[36:39], v[212:215]
  v_mul_f32 v128, v42, v128
  ds_read_b64_tr_b16 a[116:117], v19 offset:40960
  v_mfma_f32_16x16x32_bf16 v[216:219], a[24:27], a[4:7], 0
  v_mul_f32 v129, v42, v129
  ds_read_b64_tr_b16 a[118:119], v19 offset:45056
  s_add_u32 s12, s12, s31
  v_mfma_f32_16x16x32_bf16 v[216:219], a[56:59], a[36:39], v[216:219]
  v_mul_f32 v130, v42, v130
  ds_read_b128 a[72:75], v12 offset:34816
  v_mfma_f32_16x16x32_bf16 v[220:223], a[28:31], a[4:7], 0
  v_mul_f32 v131, v42, v131
  ds_read_b64_tr_b16 a[88:89], v20 offset:32768
  v_mfma_f32_16x16x32_bf16 v[220:223], a[60:63], a[36:39], v[220:223]
  s_add_u32 m0, s27, 0
  ds_read_b64_tr_b16 a[90:91], v20 offset:36864
  v_mul_f32 v132, v42, v132
  v_mfma_f32_16x16x32_bf16 v[224:227], a[16:19], a[8:11], 0
  v_mfma_f32_16x16x32_bf16 v[224:227], a[48:51], a[40:43], v[224:227]
  ds_read_b128 a[104:107], v12 offset:43008
  v_mul_f32 v133, v42, v133
  buffer_load_dwordx4 v2, s[20:23], s13 offen offset:0 lds
  v_mfma_f32_16x16x32_bf16 v[228:231], a[20:23], a[8:11], 0
  ds_read_b64_tr_b16 a[120:121], v20 offset:40960
  v_mul_f32 v134, v42, v134
  v_mfma_f32_16x16x32_bf16 v[228:231], a[52:55], a[40:43], v[228:231]
  ds_read_b64_tr_b16 a[122:123], v20 offset:45056
  v_mul_f32 v135, v42, v135
  v_mfma_f32_16x16x32_bf16 v[232:235], a[24:27], a[8:11], 0
  ds_read_b128 a[76:79], v12 offset:35840
  buffer_load_dwordx4 v3, s[20:23], s13 offen offset:1024 lds
  v_mul_f32 v136, v42, v136
  v_mfma_f32_16x16x32_bf16 v[232:235], a[56:59], a[40:43], v[232:235]
  ds_read_b64_tr_b16 a[92:93], v21 offset:32768
  v_mul_f32 v137, v42, v137
  v_mfma_f32_16x16x32_bf16 v[236:239], a[28:31], a[8:11], 0
  ds_read_b64_tr_b16 a[94:95], v21 offset:36864
  buffer_load_dwordx4 v4, s[20:23], s13 offen offset:2048 lds
  v_mul_f32 v138, v42, v138
  v_mfma_f32_16x16x32_bf16 v[236:239], a[60:63], a[40:43], v[236:239]
  ds_read_b128 a[108:111], v12 offset:44032
  v_mfma_f32_16x16x32_bf16 v[240:243], a[16:19], a[12:15], 0
  v_mul_f32 v139, v42, v139
  ds_read_b64_tr_b16 a[124:125], v21 offset:40960
  v_mfma_f32_16x16x32_bf16 v[240:243], a[48:51], a[44:47], v[240:243]
  v_mul_f32 v140, v42, v140
  buffer_load_dwordx4 v5, s[20:23], s13 offen offset:3072 lds
  v_mfma_f32_16x16x32_bf16 v[244:247], a[20:23], a[12:15], 0
  ds_read_b64_tr_b16 a[126:127], v21 offset:45056
  v_mul_f32 v141, v42, v141
  v_mfma_f32_16x16x32_bf16 v[244:247], a[52:55], a[44:47], v[244:247]
  v_mul_f32 v142, v42, v142
  s_add_u32 s13, s13, s32
  v_mfma_f32_16x16x32_bf16 v[248:251], a[24:27], a[12:15], 0
  v_mul_f32 v143, v42, v143
  v_mfma_f32_16x16x32_bf16 v[248:251], a[56:59], a[44:47], v[248:251]
  v_mfma_f32_16x16x32_bf16 v[252:255], a[28:31], a[12:15], 0
  v_mfma_f32_16x16x32_bf16 v[252:255], a[60:63], a[44:47], v[252:255]
  s_waitcnt vmcnt(16) lgkmcnt(0)
  s_barrier
  v_mfma_f32_16x16x32_bf16 v[192:195], a[80:83], a[64:67], v[192:195]
  ds_read_b128 a[0:3], v13 offset:0
  s_add_u32 m0, s15, 32768
  v_mfma_f32_16x16x32_bf16 v[192:195], a[112:115], a[96:99], v[192:195]
  ds_read_b64_tr_b16 a[16:17], v22 offset:0
  v_mfma_f32_16x16x32_bf16 v[196:199], a[84:87], a[64:67], v[196:199]
  ds_read_b64_tr_b16 a[18:19], v22 offset:4096
  buffer_load_dwordx4 v8, s[16:19], s12 offen offset:0  lds
  v_mfma_f32_16x16x32_bf16 v[196:199], a[116:119], a[96:99], v[196:199]
  ds_read_b128 a[32:35], v13 offset:8192
  v_mfma_f32_16x16x32_bf16 v[200:203], a[88:91], a[64:67], v[200:203]
  ds_read_b64_tr_b16 a[48:49], v22 offset:8192
  v_mfma_f32_16x16x32_bf16 v[200:203], a[120:123], a[96:99], v[200:203]
  buffer_load_dwordx4 v8, s[16:19], s12 offen offset:1024  lds
  ds_read_b64_tr_b16 a[50:51], v22 offset:12288
  v_mfma_f32_16x16x32_bf16 v[204:207], a[92:95], a[64:67], v[204:207]
  ds_read_b128 a[4:7], v13 offset:1024
  v_mfma_f32_16x16x32_bf16 v[204:207], a[124:127], a[96:99], v[204:207]
  ds_read_b64_tr_b16 a[20:21], v23 offset:0
  buffer_load_dwordx4 v8, s[16:19], s12 offen offset:2048  lds
  v_mfma_f32_16x16x32_bf16 v[208:211], a[80:83], a[68:71], v[208:211]
  v_mfma_f32_16x16x32_bf16 v[208:211], a[112:115], a[100:103], v[208:211]
  ds_read_b64_tr_b16 a[22:23], v23 offset:4096
  v_mfma_f32_16x16x32_bf16 v[212:215], a[84:87], a[68:71], v[212:215]
  v_sub_f32 v43, 1.0, v39
  ds_read_b128 a[36:39], v13 offset:9216
  buffer_load_dwordx4 v8, s[16:19], s12 offen offset:3072  lds
  v_mfma_f32_16x16x32_bf16 v[212:215], a[116:119], a[100:103], v[212:215]
  v_mul_f32 v144, v43, v144
  ds_read_b64_tr_b16 a[52:53], v23 offset:8192
  v_mfma_f32_16x16x32_bf16 v[216:219], a[88:91], a[68:71], v[216:219]
  v_mul_f32 v145, v43, v145
  ds_read_b64_tr_b16 a[54:55], v23 offset:12288
  s_add_u32 s12, s12, s31
  v_mfma_f32_16x16x32_bf16 v[216:219], a[120:123], a[100:103], v[216:219]
  v_mul_f32 v146, v43, v146
  ds_read_b128 a[8:11], v13 offset:2048
  v_mfma_f32_16x16x32_bf16 v[220:223], a[92:95], a[68:71], v[220:223]
  v_mul_f32 v147, v43, v147
  ds_read_b64_tr_b16 a[24:25], v24 offset:0
  v_mfma_f32_16x16x32_bf16 v[220:223], a[124:127], a[100:103], v[220:223]
  s_add_u32 m0, s27, 32768
  ds_read_b64_tr_b16 a[26:27], v24 offset:4096
  v_mul_f32 v148, v43, v148
  v_mfma_f32_16x16x32_bf16 v[224:227], a[80:83], a[72:75], v[224:227]
  v_mfma_f32_16x16x32_bf16 v[224:227], a[112:115], a[104:107], v[224:227]
  ds_read_b128 a[40:43], v13 offset:10240
  v_mul_f32 v149, v43, v149
  buffer_load_dwordx4 v2, s[20:23], s13 offen offset:0 lds
  v_mfma_f32_16x16x32_bf16 v[228:231], a[84:87], a[72:75], v[228:231]
  ds_read_b64_tr_b16 a[56:57], v24 offset:8192
  v_mul_f32 v150, v43, v150
  v_mfma_f32_16x16x32_bf16 v[228:231], a[116:119], a[104:107], v[228:231]
  ds_read_b64_tr_b16 a[58:59], v24 offset:12288
  v_mul_f32 v151, v43, v151
  v_mfma_f32_16x16x32_bf16 v[232:235], a[88:91], a[72:75], v[232:235]
  ds_read_b128 a[12:15], v13 offset:3072
  buffer_load_dwordx4 v3, s[20:23], s13 offen offset:1024 lds
  v_mul_f32 v152, v43, v152
  v_mfma_f32_16x16x32_bf16 v[232:235], a[120:123], a[104:107], v[232:235]
  ds_read_b64_tr_b16 a[28:29], v25 offset:0
  v_mul_f32 v153, v43, v153
  v_mfma_f32_16x16x32_bf16 v[236:239], a[92:95], a[72:75], v[236:239]
  ds_read_b64_tr_b16 a[30:31], v25 offset:4096
  buffer_load_dwordx4 v4, s[20:23], s13 offen offset:2048 lds
  v_mul_f32 v154, v43, v154
  v_mfma_f32_16x16x32_bf16 v[236:239], a[124:127], a[104:107], v[236:239]
  ds_read_b128 a[44:47], v13 offset:11264
  v_mfma_f32_16x16x32_bf16 v[240:243], a[80:83], a[76:79], v[240:243]
  v_mul_f32 v155, v43, v155
  ds_read_b64_tr_b16 a[60:61], v25 offset:8192
  v_mfma_f32_16x16x32_bf16 v[240:243], a[112:115], a[108:111], v[240:243]
  v_mul_f32 v156, v43, v156
  buffer_load_dwordx4 v5, s[20:23], s13 offen offset:3072 lds
  v_mfma_f32_16x16x32_bf16 v[244:247], a[84:87], a[76:79], v[244:247]
  ds_read_b64_tr_b16 a[62:63], v25 offset:12288
  v_mul_f32 v157, v43, v157
  v_mfma_f32_16x16x32_bf16 v[244:247], a[116:119], a[108:111], v[244:247]
  v_mul_f32 v158, v43, v158
  s_add_u32 s13, s13, s32
  v_mfma_f32_16x16x32_bf16 v[248:251], a[88:91], a[76:79], v[248:251]
  v_mul_f32 v159, v43, v159
  v_mfma_f32_16x16x32_bf16 v[248:251], a[120:123], a[108:111], v[248:251]
  v_mfma_f32_16x16x32_bf16 v[252:255], a[92:95], a[76:79], v[252:255]
  v_mfma_f32_16x16x32_bf16 v[252:255], a[124:127], a[108:111], v[252:255]
  s_waitcnt vmcnt(16) lgkmcnt(0)
  s_barrier
  v_mfma_f32_16x16x32_bf16 v[192:195], a[16:19], a[0:3], v[192:195]
  ds_read_b128 a[64:67], v13 offset:32768
  s_add_u32 m0, s15, 65536
  v_mfma_f32_16x16x32_bf16 v[192:195], a[48:51], a[32:35], v[192:195]
  ds_read_b64_tr_b16 a[80:81], v22 offset:32768
  v_mfma_f32_16x16x32_bf16 v[196:199], a[20:23], a[0:3], v[196:199]
  ds_read_b64_tr_b16 a[82:83], v22 offset:36864
  buffer_load_dwordx4 v8, s[16:19], s12 offen offset:0  lds
  v_mfma_f32_16x16x32_bf16 v[196:199], a[52:55], a[32:35], v[196:199]
  ds_read_b128 a[96:99], v13 offset:40960
  v_mfma_f32_16x16x32_bf16 v[200:203], a[24:27], a[0:3], v[200:203]
  ds_read_b64_tr_b16 a[112:113], v22 offset:40960
  v_mfma_f32_16x16x32_bf16 v[200:203], a[56:59], a[32:35], v[200:203]
  buffer_load_dwordx4 v8, s[16:19], s12 offen offset:1024  lds
  ds_read_b64_tr_b16 a[114:115], v22 offset:45056
  v_mfma_f32_16x16x32_bf16 v[204:207], a[28:31], a[0:3], v[204:207]
  ds_read_b128 a[68:71], v13 offset:33792
  v_mfma_f32_16x16x32_bf16 v[204:207], a[60:63], a[32:35], v[204:207]
  ds_read_b64_tr_b16 a[84:85], v23 offset:32768
  buffer_load_dwordx4 v8, s[16:19], s12 offen offset:2048  lds
  v_mfma_f32_16x16x32_bf16 v[208:211], a[16:19], a[4:7], v[208:211]
  v_mfma_f32_16x16x32_bf16 v[208:211], a[48:51], a[36:39], v[208:211]
  ds_read_b64_tr_b16 a[86:87], v23 offset:36864
  v_mfma_f32_16x16x32_bf16 v[212:215], a[20:23], a[4:7], v[212:215]
  v_sub_f32 v44, 1.0, v40
  ds_read_b128 a[100:103], v13 offset:41984
  buffer_load_dwordx4 v8, s[16:19], s12 offen offset:3072  lds
  v_mfma_f32_16x16x32_bf16 v[212:215], a[52:55], a[36:39], v[212:215]
  v_mul_f32 v160, v44, v160
  ds_read_b64_tr_b16 a[116:117], v23 offset:40960
  v_mfma_f32_16x16x32_bf16 v[216:219], a[24:27], a[4:7], v[216:219]
  v_mul_f32 v161, v44, v161
  ds_read_b64_tr_b16 a[118:119], v23 offset:45056
  s_add_u32 s12, s12, s31
  v_mfma_f32_16x16x32_bf16 v[216:219], a[56:59], a[36:39], v[216:219]
  v_mul_f32 v162, v44, v162
  ds_read_b128 a[72:75], v13 offset:34816
  v_mfma_f32_16x16x32_bf16 v[220:223], a[28:31], a[4:7], v[220:223]
  v_mul_f32 v163, v44, v163
  ds_read_b64_tr_b16 a[88:89], v24 offset:32768
  v_mfma_f32_16x16x32_bf16 v[220:223], a[60:63], a[36:39], v[220:223]
  s_add_u32 m0, s27, 65536
  ds_read_b64_tr_b16 a[90:91], v24 offset:36864
  v_mul_f32 v164, v44, v164
  v_mfma_f32_16x16x32_bf16 v[224:227], a[16:19], a[8:11], v[224:227]
  v_mfma_f32_16x16x32_bf16 v[224:227], a[48:51], a[40:43], v[224:227]
  ds_read_b128 a[104:107], v13 offset:43008
  v_mul_f32 v165, v44, v165
  buffer_load_dwordx4 v2, s[20:23], s13 offen offset:0 lds
  v_mfma_f32_16x16x32_bf16 v[228:231], a[20:23], a[8:11], v[228:231]
  ds_read_b64_tr_b16 a[120:121], v24 offset:40960
  v_mul_f32 v166, v44, v166
  v_mfma_f32_16x16x32_bf16 v[228:231], a[52:55], a[40:43], v[228:231]
  ds_read_b64_tr_b16 a[122:123], v24 offset:45056
  v_mul_f32 v167, v44, v167
  v_mfma_f32_16x16x32_bf16 v[232:235], a[24:27], a[8:11], v[232:235]
  ds_read_b128 a[76:79], v13 offset:35840
  buffer_load_dwordx4 v3, s[20:23], s13 offen offset:1024 lds
  v_mul_f32 v168, v44, v168
  v_mfma_f32_16x16x32_bf16 v[232:235], a[56:59], a[40:43], v[232:235]
  ds_read_b64_tr_b16 a[92:93], v25 offset:32768
  v_mul_f32 v169, v44, v169
  v_mfma_f32_16x16x32_bf16 v[236:239], a[28:31], a[8:11], v[236:239]
  ds_read_b64_tr_b16 a[94:95], v25 offset:36864
  buffer_load_dwordx4 v4, s[20:23], s13 offen offset:2048 lds
  v_mul_f32 v170, v44, v170
  v_mfma_f32_16x16x32_bf16 v[236:239], a[60:63], a[40:43], v[236:239]
  ds_read_b128 a[108:111], v13 offset:44032
  v_mfma_f32_16x16x32_bf16 v[240:243], a[16:19], a[12:15], v[240:243]
  v_mul_f32 v171, v44, v171
  ds_read_b64_tr_b16 a[124:125], v25 offset:40960
  v_mfma_f32_16x16x32_bf16 v[240:243], a[48:51], a[44:47], v[240:243]
  v_mul_f32 v172, v44, v172
  buffer_load_dwordx4 v5, s[20:23], s13 offen offset:3072 lds
  v_mfma_f32_16x16x32_bf16 v[244:247], a[20:23], a[12:15], v[244:247]
  ds_read_b64_tr_b16 a[126:127], v25 offset:45056
  v_mul_f32 v173, v44, v173
  v_mfma_f32_16x16x32_bf16 v[244:247], a[52:55], a[44:47], v[244:247]
  v_mul_f32 v174, v44, v174
  s_add_u32 s13, s13, s32
  v_mfma_f32_16x16x32_bf16 v[248:251], a[24:27], a[12:15], v[248:251]
  v_mul_f32 v175, v44, v175
  v_mfma_f32_16x16x32_bf16 v[248:251], a[56:59], a[44:47], v[248:251]
  v_mfma_f32_16x16x32_bf16 v[252:255], a[28:31], a[12:15], v[252:255]
  v_mfma_f32_16x16x32_bf16 v[252:255], a[60:63], a[44:47], v[252:255]
  s_waitcnt vmcnt(16) lgkmcnt(0)
  s_barrier
  v_mfma_f32_16x16x32_bf16 v[192:195], a[80:83], a[64:67], v[192:195]
  ds_read_b128 a[0:3], v12 offset:0
  s_add_u32 m0, s15, 98304
  v_mfma_f32_16x16x32_bf16 v[192:195], a[112:115], a[96:99], v[192:195]
  ds_read_b64_tr_b16 a[16:17], v18 offset:0
  v_mfma_f32_16x16x32_bf16 v[196:199], a[84:87], a[64:67], v[196:199]
  ds_read_b64_tr_b16 a[18:19], v18 offset:4096
  buffer_load_dwordx4 v8, s[16:19], s12 offen offset:0  lds
  v_mfma_f32_16x16x32_bf16 v[196:199], a[116:119], a[96:99], v[196:199]
  ds_read_b128 a[32:35], v12 offset:8192
  v_mfma_f32_16x16x32_bf16 v[200:203], a[88:91], a[64:67], v[200:203]
  ds_read_b64_tr_b16 a[48:49], v18 offset:8192
  v_mfma_f32_16x16x32_bf16 v[200:203], a[120:123], a[96:99], v[200:203]
  buffer_load_dwordx4 v8, s[16:19], s12 offen offset:1024  lds
  ds_read_b64_tr_b16 a[50:51], v18 offset:12288
  v_mfma_f32_16x16x32_bf16 v[204:207], a[92:95], a[64:67], v[204:207]
  ds_read_b128 a[4:7], v12 offset:1024
  v_mfma_f32_16x16x32_bf16 v[204:207], a[124:127], a[96:99], v[204:207]
  ds_read_b64_tr_b16 a[20:21], v19 offset:0
  buffer_load_dwordx4 v8, s[16:19], s12 offen offset:2048  lds
  v_mfma_f32_16x16x32_bf16 v[208:211], a[80:83], a[68:71], v[208:211]
  v_mfma_f32_16x16x32_bf16 v[208:211], a[112:115], a[100:103], v[208:211]
  ds_read_b64_tr_b16 a[22:23], v19 offset:4096
  v_mfma_f32_16x16x32_bf16 v[212:215], a[84:87], a[68:71], v[212:215]
  v_sub_f32 v45, 1.0, v41
  ds_read_b128 a[36:39], v12 offset:9216
  buffer_load_dwordx4 v8, s[16:19], s12 offen offset:3072  lds
  v_mfma_f32_16x16x32_bf16 v[212:215], a[116:119], a[100:103], v[212:215]
  v_mul_f32 v176, v45, v176
  ds_read_b64_tr_b16 a[52:53], v19 offset:8192
  v_mfma_f32_16x16x32_bf16 v[216:219], a[88:91], a[68:71], v[216:219]
  v_mul_f32 v177, v45, v177
  ds_read_b64_tr_b16 a[54:55], v19 offset:12288
  s_add_u32 s12, s12, s31
  v_mfma_f32_16x16x32_bf16 v[216:219], a[120:123], a[100:103], v[216:219]
  v_mul_f32 v178, v45, v178
  ds_read_b128 a[8:11], v12 offset:2048
  v_mfma_f32_16x16x32_bf16 v[220:223], a[92:95], a[68:71], v[220:223]
  v_mul_f32 v179, v45, v179
  ds_read_b64_tr_b16 a[24:25], v20 offset:0
  v_mfma_f32_16x16x32_bf16 v[220:223], a[124:127], a[100:103], v[220:223]
  s_add_u32 m0, s27, 98304
  ds_read_b64_tr_b16 a[26:27], v20 offset:4096
  v_mul_f32 v180, v45, v180
  v_mfma_f32_16x16x32_bf16 v[224:227], a[80:83], a[72:75], v[224:227]
  v_mfma_f32_16x16x32_bf16 v[224:227], a[112:115], a[104:107], v[224:227]
  ds_read_b128 a[40:43], v12 offset:10240
  v_mul_f32 v181, v45, v181
  buffer_load_dwordx4 v2, s[20:23], s13 offen offset:0 lds
  v_mfma_f32_16x16x32_bf16 v[228:231], a[84:87], a[72:75], v[228:231]
  ds_read_b64_tr_b16 a[56:57], v20 offset:8192
  v_mul_f32 v182, v45, v182
  v_mfma_f32_16x16x32_bf16 v[228:231], a[116:119], a[104:107], v[228:231]
  ds_read_b64_tr_b16 a[58:59], v20 offset:12288
  v_mul_f32 v183, v45, v183
  v_mfma_f32_16x16x32_bf16 v[232:235], a[88:91], a[72:75], v[232:235]
  ds_read_b128 a[12:15], v12 offset:3072
  buffer_load_dwordx4 v3, s[20:23], s13 offen offset:1024 lds
  v_mul_f32 v184, v45, v184
  v_mfma_f32_16x16x32_bf16 v[232:235], a[120:123], a[104:107], v[232:235]
  ds_read_b64_tr_b16 a[28:29], v21 offset:0
  v_mul_f32 v185, v45, v185
  v_mfma_f32_16x16x32_bf16 v[236:239], a[92:95], a[72:75], v[236:239]
  ds_read_b64_tr_b16 a[30:31], v21 offset:4096
  buffer_load_dwordx4 v4, s[20:23], s13 offen offset:2048 lds
  v_mul_f32 v186, v45, v186
  v_mfma_f32_16x16x32_bf16 v[236:239], a[124:127], a[104:107], v[236:239]
  ds_read_b128 a[44:47], v12 offset:11264
  v_mfma_f32_16x16x32_bf16 v[240:243], a[80:83], a[76:79], v[240:243]
  v_mul_f32 v187, v45, v187
  ds_read_b64_tr_b16 a[60:61], v21 offset:8192
  v_mfma_f32_16x16x32_bf16 v[240:243], a[112:115], a[108:111], v[240:243]
  v_mul_f32 v188, v45, v188
  buffer_load_dwordx4 v5, s[20:23], s13 offen offset:3072 lds
  v_mfma_f32_16x16x32_bf16 v[244:247], a[84:87], a[76:79], v[244:247]
  ds_read_b64_tr_b16 a[62:63], v21 offset:12288
  v_mul_f32 v189, v45, v189
  v_mfma_f32_16x16x32_bf16 v[244:247], a[116:119], a[108:111], v[244:247]
  v_mul_f32 v190, v45, v190
  s_add_u32 s13, s13, s32
  v_mfma_f32_16x16x32_bf16 v[248:251], a[88:91], a[76:79], v[248:251]
  v_mul_f32 v191, v45, v191
  v_mfma_f32_16x16x32_bf16 v[248:251], a[120:123], a[108:111], v[248:251]
  v_mfma_f32_16x16x32_bf16 v[252:255], a[92:95], a[76:79], v[252:255]
  v_mfma_f32_16x16x32_bf16 v[252:255], a[124:127], a[108:111], v[252:255]
  s_waitcnt vmcnt(16) lgkmcnt(0)
  s_barrier
  v_mfma_f32_16x16x32_bf16 v[192:195], a[16:19], a[0:3], v[192:195]
  ds_read_b128 a[64:67], v12 offset:32768
  s_add_u32 m0, s15, 0
  v_mfma_f32_16x16x32_bf16 v[192:195], a[48:51], a[32:35], v[192:195]
  ds_read_b64_tr_b16 a[80:81], v18 offset:32768
  v_mfma_f32_16x16x32_bf16 v[196:199], a[20:23], a[0:3], v[196:199]
  ds_read_b64_tr_b16 a[82:83], v18 offset:36864
  buffer_load_dwordx4 v8, s[16:19], s12 offen offset:0  lds
  v_mfma_f32_16x16x32_bf16 v[196:199], a[52:55], a[32:35], v[196:199]
  ds_read_b128 a[96:99], v12 offset:40960
  v_mfma_f32_16x16x32_bf16 v[200:203], a[24:27], a[0:3], v[200:203]
  ds_read_b64_tr_b16 a[112:113], v18 offset:40960
  v_mfma_f32_16x16x32_bf16 v[200:203], a[56:59], a[32:35], v[200:203]
  buffer_load_dwordx4 v8, s[16:19], s12 offen offset:1024  lds
  ds_read_b64_tr_b16 a[114:115], v18 offset:45056
  v_mfma_f32_16x16x32_bf16 v[204:207], a[28:31], a[0:3], v[204:207]
  ds_read_b128 a[68:71], v12 offset:33792
  v_mfma_f32_16x16x32_bf16 v[204:207], a[60:63], a[32:35], v[204:207]
  ds_read_b64_tr_b16 a[84:85], v19 offset:32768
  buffer_load_dwordx4 v8, s[16:19], s12 offen offset:2048  lds
  v_mfma_f32_16x16x32_bf16 v[208:211], a[16:19], a[4:7], v[208:211]
  v_mfma_f32_16x16x32_bf16 v[208:211], a[48:51], a[36:39], v[208:211]
  ds_read_b64_tr_b16 a[86:87], v19 offset:36864
  v_mfma_f32_16x16x32_bf16 v[212:215], a[20:23], a[4:7], v[212:215]
  ds_read_b128 a[100:103], v12 offset:41984
  buffer_load_dwordx4 v8, s[16:19], s12 offen offset:3072  lds
  v_mfma_f32_16x16x32_bf16 v[212:215], a[52:55], a[36:39], v[212:215]
  ds_read_b64_tr_b16 a[116:117], v19 offset:40960
  v_mfma_f32_16x16x32_bf16 v[216:219], a[24:27], a[4:7], v[216:219]
  ds_read_b64_tr_b16 a[118:119], v19 offset:45056
  s_add_u32 s12, s12, s31
  v_mfma_f32_16x16x32_bf16 v[216:219], a[56:59], a[36:39], v[216:219]
  ds_read_b128 a[72:75], v12 offset:34816
  v_mfma_f32_16x16x32_bf16 v[220:223], a[28:31], a[4:7], v[220:223]
  ds_read_b64_tr_b16 a[88:89], v20 offset:32768
  v_mfma_f32_16x16x32_bf16 v[220:223], a[60:63], a[36:39], v[220:223]
  s_add_u32 m0, s27, 0
  ds_read_b64_tr_b16 a[90:91], v20 offset:36864
  v_mfma_f32_16x16x32_bf16 v[224:227], a[16:19], a[8:11], v[224:227]
  v_mfma_f32_16x16x32_bf16 v[224:227], a[48:51], a[40:43], v[224:227]
  ds_read_b128 a[104:107], v12 offset:43008
  buffer_load_dwordx4 v2, s[20:23], s13 offen offset:0 lds
  v_mfma_f32_16x16x32_bf16 v[228:231], a[20:23], a[8:11], v[228:231]
  ds_read_b64_tr_b16 a[120:121], v20 offset:40960
  v_mfma_f32_16x16x32_bf16 v[228:231], a[52:55], a[40:43], v[228:231]
  ds_read_b64_tr_b16 a[122:123], v20 offset:45056
  v_mfma_f32_16x16x32_bf16 v[232:235], a[24:27], a[8:11], v[232:235]
  ds_read_b128 a[76:79], v12 offset:35840
  buffer_load_dwordx4 v3, s[20:23], s13 offen offset:1024 lds
  v_mfma_f32_16x16x32_bf16 v[232:235], a[56:59], a[40:43], v[232:235]
  ds_read_b64_tr_b16 a[92:93], v21 offset:32768
  v_mfma_f32_16x16x32_bf16 v[236:239], a[28:31], a[8:11], v[236:239]
  ds_read_b64_tr_b16 a[94:95], v21 offset:36864
  buffer_load_dwordx4 v4, s[20:23], s13 offen offset:2048 lds
  v_mfma_f32_16x16x32_bf16 v[236:239], a[60:63], a[40:43], v[236:239]
  ds_read_b128 a[108:111], v12 offset:44032
  v_mfma_f32_16x16x32_bf16 v[240:243], a[16:19], a[12:15], v[240:243]
  ds_read_b64_tr_b16 a[124:125], v21 offset:40960
  v_mfma_f32_16x16x32_bf16 v[240:243], a[48:51], a[44:47], v[240:243]
  buffer_load_dwordx4 v5, s[20:23], s13 offen offset:3072 lds
  v_mfma_f32_16x16x32_bf16 v[244:247], a[20:23], a[12:15], v[244:247]
  ds_read_b64_tr_b16 a[126:127], v21 offset:45056
  v_mfma_f32_16x16x32_bf16 v[244:247], a[52:55], a[44:47], v[244:247]
  s_add_u32 s13, s13, s32
  v_mfma_f32_16x16x32_bf16 v[248:251], a[24:27], a[12:15], v[248:251]
  v_mfma_f32_16x16x32_bf16 v[248:251], a[56:59], a[44:47], v[248:251]
  v_mfma_f32_16x16x32_bf16 v[252:255], a[28:31], a[12:15], v[252:255]
  v_mfma_f32_16x16x32_bf16 v[252:255], a[60:63], a[44:47], v[252:255]
  s_waitcnt vmcnt(16) lgkmcnt(0)
  s_barrier
  v_mfma_f32_16x16x32_bf16 v[192:195], a[80:83], a[64:67], v[192:195]
  ds_read_b128 a[0:3], v13 offset:0
  s_add_u32 m0, s15, 32768
  v_mfma_f32_16x16x32_bf16 v[192:195], a[112:115], a[96:99], v[192:195]
  ds_read_b64_tr_b16 a[16:17], v22 offset:0
  v_mfma_f32_16x16x32_bf16 v[196:199], a[84:87], a[64:67], v[196:199]
  ds_read_b64_tr_b16 a[18:19], v22 offset:4096
  buffer_load_dwordx4 v8, s[16:19], s12 offen offset:0  lds
  v_mfma_f32_16x16x32_bf16 v[196:199], a[116:119], a[96:99], v[196:199]
  ds_read_b128 a[32:35], v13 offset:8192
  v_mfma_f32_16x16x32_bf16 v[200:203], a[88:91], a[64:67], v[200:203]
  ds_read_b64_tr_b16 a[48:49], v22 offset:8192
  v_mfma_f32_16x16x32_bf16 v[200:203], a[120:123], a[96:99], v[200:203]
  buffer_load_dwordx4 v8, s[16:19], s12 offen offset:1024  lds
  ds_read_b64_tr_b16 a[50:51], v22 offset:12288
  v_mfma_f32_16x16x32_bf16 v[204:207], a[92:95], a[64:67], v[204:207]
  ds_read_b128 a[4:7], v13 offset:1024
  v_mfma_f32_16x16x32_bf16 v[204:207], a[124:127], a[96:99], v[204:207]
  ds_read_b64_tr_b16 a[20:21], v23 offset:0
  buffer_load_dwordx4 v8, s[16:19], s12 offen offset:2048  lds
  v_mfma_f32_16x16x32_bf16 v[208:211], a[80:83], a[68:71], v[208:211]
  v_mfma_f32_16x16x32_bf16 v[208:211], a[112:115], a[100:103], v[208:211]
  ds_read_b64_tr_b16 a[22:23], v23 offset:4096
  v_mfma_f32_16x16x32_bf16 v[212:215], a[84:87], a[68:71], v[212:215]
  ds_read_b128 a[36:39], v13 offset:9216
  buffer_load_dwordx4 v8, s[16:19], s12 offen offset:3072  lds
  v_mfma_f32_16x16x32_bf16 v[212:215], a[116:119], a[100:103], v[212:215]
  ds_read_b64_tr_b16 a[52:53], v23 offset:8192
  v_mfma_f32_16x16x32_bf16 v[216:219], a[88:91], a[68:71], v[216:219]
  ds_read_b64_tr_b16 a[54:55], v23 offset:12288
  s_add_u32 s12, s12, s31
  v_mfma_f32_16x16x32_bf16 v[216:219], a[120:123], a[100:103], v[216:219]
  ds_read_b128 a[8:11], v13 offset:2048
  v_mfma_f32_16x16x32_bf16 v[220:223], a[92:95], a[68:71], v[220:223]
  ds_read_b64_tr_b16 a[24:25], v24 offset:0
  v_mfma_f32_16x16x32_bf16 v[220:223], a[124:127], a[100:103], v[220:223]
  s_add_u32 m0, s27, 32768
  ds_read_b64_tr_b16 a[26:27], v24 offset:4096
  v_mfma_f32_16x16x32_bf16 v[224:227], a[80:83], a[72:75], v[224:227]
  v_mfma_f32_16x16x32_bf16 v[224:227], a[112:115], a[104:107], v[224:227]
  ds_read_b128 a[40:43], v13 offset:10240
  buffer_load_dwordx4 v2, s[20:23], s13 offen offset:0 lds
  v_mfma_f32_16x16x32_bf16 v[228:231], a[84:87], a[72:75], v[228:231]
  ds_read_b64_tr_b16 a[56:57], v24 offset:8192
  v_mfma_f32_16x16x32_bf16 v[228:231], a[116:119], a[104:107], v[228:231]
  ds_read_b64_tr_b16 a[58:59], v24 offset:12288
  v_mfma_f32_16x16x32_bf16 v[232:235], a[88:91], a[72:75], v[232:235]
  ds_read_b128 a[12:15], v13 offset:3072
  buffer_load_dwordx4 v3, s[20:23], s13 offen offset:1024 lds
  v_mfma_f32_16x16x32_bf16 v[232:235], a[120:123], a[104:107], v[232:235]
  ds_read_b64_tr_b16 a[28:29], v25 offset:0
  v_mfma_f32_16x16x32_bf16 v[236:239], a[92:95], a[72:75], v[236:239]
  ds_read_b64_tr_b16 a[30:31], v25 offset:4096
  buffer_load_dwordx4 v4, s[20:23], s13 offen offset:2048 lds
  v_mfma_f32_16x16x32_bf16 v[236:239], a[124:127], a[104:107], v[236:239]
  ds_read_b128 a[44:47], v13 offset:11264
  v_mfma_f32_16x16x32_bf16 v[240:243], a[80:83], a[76:79], v[240:243]
  ds_read_b64_tr_b16 a[60:61], v25 offset:8192
  v_mfma_f32_16x16x32_bf16 v[240:243], a[112:115], a[108:111], v[240:243]
  buffer_load_dwordx4 v5, s[20:23], s13 offen offset:3072 lds
  v_mfma_f32_16x16x32_bf16 v[244:247], a[84:87], a[76:79], v[244:247]
  ds_read_b64_tr_b16 a[62:63], v25 offset:12288
  v_mfma_f32_16x16x32_bf16 v[244:247], a[116:119], a[108:111], v[244:247]
  s_add_u32 s13, s13, s32
  v_mfma_f32_16x16x32_bf16 v[248:251], a[88:91], a[76:79], v[248:251]
  v_mfma_f32_16x16x32_bf16 v[248:251], a[120:123], a[108:111], v[248:251]
  v_mfma_f32_16x16x32_bf16 v[252:255], a[92:95], a[76:79], v[252:255]
  v_mfma_f32_16x16x32_bf16 v[252:255], a[124:127], a[108:111], v[252:255]
  s_waitcnt vmcnt(16) lgkmcnt(0)
  s_barrier
  v_mfma_f32_16x16x32_bf16 v[192:195], a[16:19], a[0:3], v[192:195]
  ds_read_b128 a[64:67], v13 offset:32768
  v_mfma_f32_16x16x32_bf16 v[192:195], a[48:51], a[32:35], v[192:195]
  ds_read_b64_tr_b16 a[80:81], v22 offset:32768
  v_mfma_f32_16x16x32_bf16 v[196:199], a[20:23], a[0:3], v[196:199]
  ds_read_b64_tr_b16 a[82:83], v22 offset:36864
  v_mfma_f32_16x16x32_bf16 v[196:199], a[52:55], a[32:35], v[196:199]
  ds_read_b128 a[96:99], v13 offset:40960
  v_mfma_f32_16x16x32_bf16 v[200:203], a[24:27], a[0:3], v[200:203]
  ds_read_b64_tr_b16 a[112:113], v22 offset:40960
  v_mfma_f32_16x16x32_bf16 v[200:203], a[56:59], a[32:35], v[200:203]
  ds_read_b64_tr_b16 a[114:115], v22 offset:45056
  v_mfma_f32_16x16x32_bf16 v[204:207], a[28:31], a[0:3], v[204:207]
  ds_read_b128 a[68:71], v13 offset:33792
  v_mfma_f32_16x16x32_bf16 v[204:207], a[60:63], a[32:35], v[204:207]
  ds_read_b64_tr_b16 a[84:85], v23 offset:32768
  v_mfma_f32_16x16x32_bf16 v[208:211], a[16:19], a[4:7], v[208:211]
  v_mfma_f32_16x16x32_bf16 v[208:211], a[48:51], a[36:39], v[208:211]
  ds_read_b64_tr_b16 a[86:87], v23 offset:36864
  v_mfma_f32_16x16x32_bf16 v[212:215], a[20:23], a[4:7], v[212:215]
  ds_read_b128 a[100:103], v13 offset:41984
  v_mfma_f32_16x16x32_bf16 v[212:215], a[52:55], a[36:39], v[212:215]
  ds_read_b64_tr_b16 a[116:117], v23 offset:40960
  v_mfma_f32_16x16x32_bf16 v[216:219], a[24:27], a[4:7], v[216:219]
  ds_read_b64_tr_b16 a[118:119], v23 offset:45056
  v_mfma_f32_16x16x32_bf16 v[216:219], a[56:59], a[36:39], v[216:219]
  ds_read_b128 a[72:75], v13 offset:34816
  v_mfma_f32_16x16x32_bf16 v[220:223], a[28:31], a[4:7], v[220:223]
  ds_read_b64_tr_b16 a[88:89], v24 offset:32768
  v_mfma_f32_16x16x32_bf16 v[220:223], a[60:63], a[36:39], v[220:223]
  ds_read_b64_tr_b16 a[90:91], v24 offset:36864
  v_mfma_f32_16x16x32_bf16 v[224:227], a[16:19], a[8:11], v[224:227]
  v_mfma_f32_16x16x32_bf16 v[224:227], a[48:51], a[40:43], v[224:227]
  ds_read_b128 a[104:107], v13 offset:43008
  v_mfma_f32_16x16x32_bf16 v[228:231], a[20:23], a[8:11], v[228:231]
  ds_read_b64_tr_b16 a[120:121], v24 offset:40960
  v_mfma_f32_16x16x32_bf16 v[228:231], a[52:55], a[40:43], v[228:231]
  ds_read_b64_tr_b16 a[122:123], v24 offset:45056
  v_mfma_f32_16x16x32_bf16 v[232:235], a[24:27], a[8:11], v[232:235]
  ds_read_b128 a[76:79], v13 offset:35840
  v_mfma_f32_16x16x32_bf16 v[232:235], a[56:59], a[40:43], v[232:235]
  ds_read_b64_tr_b16 a[92:93], v25 offset:32768
  v_mfma_f32_16x16x32_bf16 v[236:239], a[28:31], a[8:11], v[236:239]
  ds_read_b64_tr_b16 a[94:95], v25 offset:36864
  v_mfma_f32_16x16x32_bf16 v[236:239], a[60:63], a[40:43], v[236:239]
  ds_read_b128 a[108:111], v13 offset:44032
  v_mfma_f32_16x16x32_bf16 v[240:243], a[16:19], a[12:15], v[240:243]
  ds_read_b64_tr_b16 a[124:125], v25 offset:40960
  v_mfma_f32_16x16x32_bf16 v[240:243], a[48:51], a[44:47], v[240:243]
  v_mfma_f32_16x16x32_bf16 v[244:247], a[20:23], a[12:15], v[244:247]
  ds_read_b64_tr_b16 a[126:127], v25 offset:45056
  v_mfma_f32_16x16x32_bf16 v[244:247], a[52:55], a[44:47], v[244:247]
  v_mfma_f32_16x16x32_bf16 v[248:251], a[24:27], a[12:15], v[248:251]
  v_mfma_f32_16x16x32_bf16 v[248:251], a[56:59], a[44:47], v[248:251]
  v_mfma_f32_16x16x32_bf16 v[252:255], a[28:31], a[12:15], v[252:255]
  v_mfma_f32_16x16x32_bf16 v[252:255], a[60:63], a[44:47], v[252:255]
  s_waitcnt vmcnt(8) lgkmcnt(0)
  s_barrier
  v_mfma_f32_16x16x32_bf16 v[192:195], a[80:83], a[64:67], v[192:195]
  ds_read_b128 a[0:3], v12 offset:0
  v_mfma_f32_16x16x32_bf16 v[192:195], a[112:115], a[96:99], v[192:195]
  s_lshl_b32 s60, s11, 8
  ds_read_b64_tr_b16 a[16:17], v18 offset:0
  v_mfma_f32_16x16x32_bf16 v[196:199], a[84:87], a[64:67], v[196:199]
  s_lshl_b32 s61, s24, 3
  ds_read_b64_tr_b16 a[18:19], v18 offset:4096
  v_mfma_f32_16x16x32_bf16 v[196:199], a[116:119], a[96:99], v[196:199]
  ds_read_b128 a[32:35], v12 offset:8192
  s_add_u32 s60, s60, s61
  v_mfma_f32_16x16x32_bf16 v[200:203], a[88:91], a[64:67], v[200:203]
  ds_read_b64_tr_b16 a[48:49], v18 offset:8192
  s_add_u32 s60, s60, 33161216
  v_mfma_f32_16x16x32_bf16 v[200:203], a[120:123], a[96:99], v[200:203]
  ds_read_b64_tr_b16 a[50:51], v18 offset:12288
  v_mov_b32 v9, s60
  v_mfma_f32_16x16x32_bf16 v[204:207], a[92:95], a[64:67], v[204:207]
  ds_read_b128 a[4:7], v12 offset:1024
  v_mfma_f32_16x16x32_bf16 v[204:207], a[124:127], a[96:99], v[204:207]
  buffer_load_dwordx2 v[10:11], v9, s[16:19], 0 offen sc1
  ds_read_b64_tr_b16 a[20:21], v19 offset:0
  v_mfma_f32_16x16x32_bf16 v[208:211], a[80:83], a[68:71], v[208:211]
  v_mfma_f32_16x16x32_bf16 v[208:211], a[112:115], a[100:103], v[208:211]
  ds_read_b64_tr_b16 a[22:23], v19 offset:4096
  v_mfma_f32_16x16x32_bf16 v[212:215], a[84:87], a[68:71], v[212:215]
  ds_read_b128 a[36:39], v12 offset:9216
  v_mfma_f32_16x16x32_bf16 v[212:215], a[116:119], a[100:103], v[212:215]
  ds_read_b64_tr_b16 a[52:53], v19 offset:8192
  v_mfma_f32_16x16x32_bf16 v[216:219], a[88:91], a[68:71], v[216:219]
  ds_read_b64_tr_b16 a[54:55], v19 offset:12288
  v_mfma_f32_16x16x32_bf16 v[216:219], a[120:123], a[100:103], v[216:219]
  ds_read_b128 a[8:11], v12 offset:2048
  v_mfma_f32_16x16x32_bf16 v[220:223], a[92:95], a[68:71], v[220:223]
  ds_read_b64_tr_b16 a[24:25], v20 offset:0
  v_mfma_f32_16x16x32_bf16 v[220:223], a[124:127], a[100:103], v[220:223]
  ds_read_b64_tr_b16 a[26:27], v20 offset:4096
  v_mfma_f32_16x16x32_bf16 v[224:227], a[80:83], a[72:75], v[224:227]
  v_mfma_f32_16x16x32_bf16 v[224:227], a[112:115], a[104:107], v[224:227]
  ds_read_b128 a[40:43], v12 offset:10240
  v_mfma_f32_16x16x32_bf16 v[228:231], a[84:87], a[72:75], v[228:231]
  ds_read_b64_tr_b16 a[56:57], v20 offset:8192
  v_mfma_f32_16x16x32_bf16 v[228:231], a[116:119], a[104:107], v[228:231]
  ds_read_b64_tr_b16 a[58:59], v20 offset:12288
  v_mfma_f32_16x16x32_bf16 v[232:235], a[88:91], a[72:75], v[232:235]
  ds_read_b128 a[12:15], v12 offset:3072
  v_mfma_f32_16x16x32_bf16 v[232:235], a[120:123], a[104:107], v[232:235]
  ds_read_b64_tr_b16 a[28:29], v21 offset:0
  v_mfma_f32_16x16x32_bf16 v[236:239], a[92:95], a[72:75], v[236:239]
  ds_read_b64_tr_b16 a[30:31], v21 offset:4096
  v_mfma_f32_16x16x32_bf16 v[236:239], a[124:127], a[104:107], v[236:239]
  ds_read_b128 a[44:47], v12 offset:11264
  v_mfma_f32_16x16x32_bf16 v[240:243], a[80:83], a[76:79], v[240:243]
  ds_read_b64_tr_b16 a[60:61], v21 offset:8192
  v_mfma_f32_16x16x32_bf16 v[240:243], a[112:115], a[108:111], v[240:243]
  v_mfma_f32_16x16x32_bf16 v[244:247], a[84:87], a[76:79], v[244:247]
  ds_read_b64_tr_b16 a[62:63], v21 offset:12288
  v_mfma_f32_16x16x32_bf16 v[244:247], a[116:119], a[108:111], v[244:247]
  v_mfma_f32_16x16x32_bf16 v[248:251], a[88:91], a[76:79], v[248:251]
  v_mfma_f32_16x16x32_bf16 v[248:251], a[120:123], a[108:111], v[248:251]
  v_mfma_f32_16x16x32_bf16 v[252:255], a[92:95], a[76:79], v[252:255]
  v_mfma_f32_16x16x32_bf16 v[252:255], a[124:127], a[108:111], v[252:255]
  s_waitcnt vmcnt(1) lgkmcnt(0)
  s_barrier
  s_waitcnt vmcnt(0)
L_p2r1_pw:
  v_cmp_eq_u64 vcc, v[10:11], v[14:15]
  s_nop 1
  s_cmp_eq_u64 vcc, -1
  s_cbranch_scc1 L_p2r1_pok
  s_add_u32 s3, s3, 1
  s_cmp_gt_u32 s3, 0x40000
  s_cbranch_scc1 L_p2r1_pok
  s_sleep 4
  buffer_load_dwordx2 v[10:11], v9, s[16:19], 0 offen sc1
  s_waitcnt vmcnt(0)
  s_branch L_p2r1_pw
L_p2r1_pok:
  v_mfma_f32_16x16x32_bf16 v[192:195], a[16:19], a[0:3], v[192:195]
  ds_read_b128 a[64:67], v12 offset:32768
  v_mfma_f32_16x16x32_bf16 v[192:195], a[48:51], a[32:35], v[192:195]
  s_lshl_b32 s60, s11, 16
  ds_read_b64_tr_b16 a[80:81], v18 offset:32768
  v_mfma_f32_16x16x32_bf16 v[196:199], a[20:23], a[0:3], v[196:199]
  s_lshl_b32 s61, s24, 13
  ds_read_b64_tr_b16 a[82:83], v18 offset:36864
  v_mfma_f32_16x16x32_bf16 v[196:199], a[52:55], a[32:35], v[196:199]
  ds_read_b128 a[96:99], v12 offset:40960
  s_add_u32 s60, s60, s61
  v_mfma_f32_16x16x32_bf16 v[200:203], a[24:27], a[0:3], v[200:203]
  ds_read_b64_tr_b16 a[112:113], v18 offset:40960
  s_add_u32 s60, s60, 20553728
  v_mfma_f32_16x16x32_bf16 v[200:203], a[56:59], a[32:35], v[200:203]
  ds_read_b64_tr_b16 a[114:115], v18 offset:45056
  buffer_load_dwordx4 v[84:87], v17, s[16:19], s60 offen offset:0 sc1
  v_mfma_f32_16x16x32_bf16 v[204:207], a[28:31], a[0:3], v[204:207]
  ds_read_b128 a[68:71], v12 offset:33792
  v_mfma_f32_16x16x32_bf16 v[204:207], a[60:63], a[32:35], v[204:207]
  buffer_load_dwordx4 v[88:91], v17, s[16:19], s60 offen offset:1024 sc1
  ds_read_b64_tr_b16 a[84:85], v19 offset:32768
  v_mfma_f32_16x16x32_bf16 v[208:211], a[16:19], a[4:7], v[208:211]
  buffer_load_dwordx4 v[92:95], v17, s[16:19], s60 offen offset:2048 sc1
  v_mfma_f32_16x16x32_bf16 v[208:211], a[48:51], a[36:39], v[208:211]
  ds_read_b64_tr_b16 a[86:87], v19 offset:36864
  buffer_load_dwordx4 v[96:99], v17, s[16:19], s60 offen offset:3072 sc1
  v_mfma_f32_16x16x32_bf16 v[212:215], a[20:23], a[4:7], v[212:215]
  ds_read_b128 a[100:103], v12 offset:41984
  s_add_u32 s60, s60, 4096
  v_mfma_f32_16x16x32_bf16 v[212:215], a[52:55], a[36:39], v[212:215]
  ds_read_b64_tr_b16 a[116:117], v19 offset:40960
  buffer_load_dwordx4 v[100:103], v17, s[16:19], s60 offen offset:0 sc1
  v_mfma_f32_16x16x32_bf16 v[216:219], a[24:27], a[4:7], v[216:219]
  ds_read_b64_tr_b16 a[118:119], v19 offset:45056
  v_mfma_f32_16x16x32_bf16 v[216:219], a[56:59], a[36:39], v[216:219]
  buffer_load_dwordx4 v[104:107], v17, s[16:19], s60 offen offset:1024 sc1
  ds_read_b128 a[72:75], v12 offset:34816
  v_mfma_f32_16x16x32_bf16 v[220:223], a[28:31], a[4:7], v[220:223]
  buffer_load_dwordx4 v[108:111], v17, s[16:19], s60 offen offset:2048 sc1
  ds_read_b64_tr_b16 a[88:89], v20 offset:32768
  v_mfma_f32_16x16x32_bf16 v[220:223], a[60:63], a[36:39], v[220:223]
  buffer_load_dwordx4 v[112:115], v17, s[16:19], s60 offen offset:3072 sc1
  ds_read_b64_tr_b16 a[90:91], v20 offset:36864
  v_mfma_f32_16x16x32_bf16 v[224:227], a[16:19], a[8:11], v[224:227]
  v_mfma_f32_16x16x32_bf16 v[224:227], a[48:51], a[40:43], v[224:227]
  ds_read_b128 a[104:107], v12 offset:43008
  v_mfma_f32_16x16x32_bf16 v[228:231], a[20:23], a[8:11], v[228:231]
  ds_read_b64_tr_b16 a[120:121], v20 offset:40960
  v_mfma_f32_16x16x32_bf16 v[228:231], a[52:55], a[40:43], v[228:231]
  ds_read_b64_tr_b16 a[122:123], v20 offset:45056
  v_mfma_f32_16x16x32_bf16 v[232:235], a[24:27], a[8:11], v[232:235]
  ds_read_b128 a[76:79], v12 offset:35840
  v_mfma_f32_16x16x32_bf16 v[232:235], a[56:59], a[40:43], v[232:235]
  ds_read_b64_tr_b16 a[92:93], v21 offset:32768
  v_mfma_f32_16x16x32_bf16 v[236:239], a[28:31], a[8:11], v[236:239]
  ds_read_b64_tr_b16 a[94:95], v21 offset:36864
  v_mfma_f32_16x16x32_bf16 v[236:239], a[60:63], a[40:43], v[236:239]
  ds_read_b128 a[108:111], v12 offset:44032
  v_mfma_f32_16x16x32_bf16 v[240:243], a[16:19], a[12:15], v[240:243]
  ds_read_b64_tr_b16 a[124:125], v21 offset:40960
  v_mfma_f32_16x16x32_bf16 v[240:243], a[48:51], a[44:47], v[240:243]
  v_mfma_f32_16x16x32_bf16 v[244:247], a[20:23], a[12:15], v[244:247]
  ds_read_b64_tr_b16 a[126:127], v21 offset:45056
  v_mfma_f32_16x16x32_bf16 v[244:247], a[52:55], a[44:47], v[244:247]
  v_mfma_f32_16x16x32_bf16 v[248:251], a[24:27], a[12:15], v[248:251]
  v_mfma_f32_16x16x32_bf16 v[248:251], a[56:59], a[44:47], v[248:251]
  v_mfma_f32_16x16x32_bf16 v[252:255], a[28:31], a[12:15], v[252:255]
  v_mfma_f32_16x16x32_bf16 v[252:255], a[60:63], a[44:47], v[252:255]
  s_waitcnt lgkmcnt(0)
  v_mfma_f32_16x16x32_bf16 v[192:195], a[80:83], a[64:67], v[192:195]
  v_mfma_f32_16x16x32_bf16 v[192:195], a[112:115], a[96:99], v[192:195]
  v_mfma_f32_16x16x32_bf16 v[196:199], a[84:87], a[64:67], v[196:199]
  v_mfma_f32_16x16x32_bf16 v[196:199], a[116:119], a[96:99], v[196:199]
  v_mfma_f32_16x16x32_bf16 v[200:203], a[88:91], a[64:67], v[200:203]
  v_mfma_f32_16x16x32_bf16 v[200:203], a[120:123], a[96:99], v[200:203]
  v_mfma_f32_16x16x32_bf16 v[204:207], a[92:95], a[64:67], v[204:207]
  v_mfma_f32_16x16x32_bf16 v[204:207], a[124:127], a[96:99], v[204:207]
  v_mfma_f32_16x16x32_bf16 v[208:211], a[80:83], a[68:71], v[208:211]
  v_mfma_f32_16x16x32_bf16 v[208:211], a[112:115], a[100:103], v[208:211]
  v_mfma_f32_16x16x32_bf16 v[212:215], a[84:87], a[68:71], v[212:215]
  v_mfma_f32_16x16x32_bf16 v[212:215], a[116:119], a[100:103], v[212:215]
  v_mfma_f32_16x16x32_bf16 v[216:219], a[88:91], a[68:71], v[216:219]
  v_mfma_f32_16x16x32_bf16 v[216:219], a[120:123], a[100:103], v[216:219]
  v_mfma_f32_16x16x32_bf16 v[220:223], a[92:95], a[68:71], v[220:223]
  v_mfma_f32_16x16x32_bf16 v[220:223], a[124:127], a[100:103], v[220:223]
  v_mfma_f32_16x16x32_bf16 v[224:227], a[80:83], a[72:75], v[224:227]
  v_mfma_f32_16x16x32_bf16 v[224:227], a[112:115], a[104:107], v[224:227]
  v_mfma_f32_16x16x32_bf16 v[228:231], a[84:87], a[72:75], v[228:231]
  v_mfma_f32_16x16x32_bf16 v[228:231], a[116:119], a[104:107], v[228:231]
  v_mfma_f32_16x16x32_bf16 v[232:235], a[88:91], a[72:75], v[232:235]
  v_mfma_f32_16x16x32_bf16 v[232:235], a[120:123], a[104:107], v[232:235]
  v_mfma_f32_16x16x32_bf16 v[236:239], a[92:95], a[72:75], v[236:239]
  v_mfma_f32_16x16x32_bf16 v[236:239], a[124:127], a[104:107], v[236:239]
  v_mfma_f32_16x16x32_bf16 v[240:243], a[80:83], a[76:79], v[240:243]
  v_mfma_f32_16x16x32_bf16 v[240:243], a[112:115], a[108:111], v[240:243]
  v_mfma_f32_16x16x32_bf16 v[244:247], a[84:87], a[76:79], v[244:247]
  v_mfma_f32_16x16x32_bf16 v[244:247], a[116:119], a[108:111], v[244:247]
  v_mfma_f32_16x16x32_bf16 v[248:251], a[88:91], a[76:79], v[248:251]
  v_mfma_f32_16x16x32_bf16 v[248:251], a[120:123], a[108:111], v[248:251]
  v_mfma_f32_16x16x32_bf16 v[252:255], a[92:95], a[76:79], v[252:255]
  v_mfma_f32_16x16x32_bf16 v[252:255], a[124:127], a[108:111], v[252:255]
  v_and_b32 v32, 7, v6
  v_lshlrev_b32 v32, 11, v32
  v_lshrrev_b32 v33, 3, v6
  v_lshlrev_b32 v33, 6, v33
  v_add_u32 v32, v32, v33
  v_bfe_u32 v33, v1, 4, 1
  v_lshlrev_b32 v33, 5, v33
  v_add_u32 v32, v32, v33
  v_lshrrev_b32 v33, 5, v1
  v_lshlrev_b32 v33, 4, v33
  v_add_u32 v34, v32, v33
  v_add_u32 v35, 16384, v34
  s_lshl_b32 s60, s8, 7
  s_and_b32 s61, s24, 1
  s_lshl_b32 s61, s61, 6
  s_add_u32 s60, s60, s61
  s_lshl_b32 s60, s60, 11
  s_lshl_b32 s61, s9, 8
  s_add_u32 s60, s60, s61
  s_lshr_b32 s61, s24, 1
  s_lshl_b32 s61, s61, 7
  s_add_u32 s60, s60, s61
  s_waitcnt vmcnt(0)
  v_pk_fma_f32 v[128:129], v[38:39], v[192:193], v[128:129] op_sel_hi:[0,1,1]
  v_pk_fma_f32 v[130:131], v[38:39], v[194:195], v[130:131] op_sel_hi:[0,1,1]
  v_pk_fma_f32 v[132:133], v[38:39], v[196:197], v[132:133] op_sel_hi:[0,1,1]
  v_pk_fma_f32 v[134:135], v[38:39], v[198:199], v[134:135] op_sel_hi:[0,1,1]
  v_pk_fma_f32 v[136:137], v[38:39], v[200:201], v[136:137] op_sel_hi:[0,1,1]
  v_pk_fma_f32 v[138:139], v[38:39], v[202:203], v[138:139] op_sel_hi:[0,1,1]
  v_pk_fma_f32 v[140:141], v[38:39], v[204:205], v[140:141] op_sel_hi:[0,1,1]
  v_pk_fma_f32 v[142:143], v[38:39], v[206:207], v[142:143] op_sel_hi:[0,1,1]
  v_lshlrev_b32 v48, 16, v84
  v_and_b32 v49, 0xffff0000, v84
  v_lshlrev_b32 v50, 16, v85
  v_and_b32 v51, 0xffff0000, v85
  v_lshlrev_b32 v52, 16, v86
  v_and_b32 v53, 0xffff0000, v86
  v_lshlrev_b32 v54, 16, v87
  v_and_b32 v55, 0xffff0000, v87
  v_lshlrev_b32 v56, 16, v88
  v_and_b32 v57, 0xffff0000, v88
  v_lshlrev_b32 v58, 16, v89
  v_and_b32 v59, 0xffff0000, v89
  v_lshlrev_b32 v60, 16, v90
  v_and_b32 v61, 0xffff0000, v90
  v_lshlrev_b32 v62, 16, v91
  v_and_b32 v63, 0xffff0000, v91
  v_pk_add_f32 v[128:129], v[128:129], v[48:49]
  v_pk_add_f32 v[130:131], v[130:131], v[50:51]
  v_pk_add_f32 v[132:133], v[132:133], v[52:53]
  v_pk_add_f32 v[134:135], v[134:135], v[54:55]
  v_pk_add_f32 v[136:137], v[136:137], v[56:57]
  v_pk_add_f32 v[138:139], v[138:139], v[58:59]
  v_pk_add_f32 v[140:141], v[140:141], v[60:61]
  v_pk_add_f32 v[142:143], v[142:143], v[62:63]
  v_cvt_pk_bf16_f32 v128, v128, v129
  v_cvt_pk_bf16_f32 v129, v130, v131
  v_cvt_pk_bf16_f32 v130, v132, v133
  v_cvt_pk_bf16_f32 v131, v134, v135
  v_cvt_pk_bf16_f32 v136, v136, v137
  v_cvt_pk_bf16_f32 v137, v138, v139
  v_cvt_pk_bf16_f32 v138, v140, v141
  v_cvt_pk_bf16_f32 v139, v142, v143
  s_nop 1
  v_permlane16_swap_b32 v128, v130
  v_permlane16_swap_b32 v129, v131
  v_permlane16_swap_b32 v136, v138
  v_permlane16_swap_b32 v137, v139
  v_mov_b32 v132, v128
  v_mov_b32 v133, v129
  v_mov_b32 v134, v130
  v_mov_b32 v135, v131
  v_mov_b32_dpp v128, v136 row_ror:8 row_mask:0xf bank_mask:0xc
  v_mov_b32_dpp v129, v137 row_ror:8 row_mask:0xf bank_mask:0xc
  v_mov_b32_dpp v130, v138 row_ror:8 row_mask:0xf bank_mask:0xc
  v_mov_b32_dpp v131, v139 row_ror:8 row_mask:0xf bank_mask:0xc
  v_mov_b32_dpp v136, v132 row_ror:8 row_mask:0xf bank_mask:0x3
  v_mov_b32_dpp v137, v133 row_ror:8 row_mask:0xf bank_mask:0x3
  v_mov_b32_dpp v138, v134 row_ror:8 row_mask:0xf bank_mask:0x3
  v_mov_b32_dpp v139, v135 row_ror:8 row_mask:0xf bank_mask:0x3
  buffer_store_dwordx4 v[128:131], v34, s[4:7], s60 offen sc1
  buffer_store_dwordx4 v[136:139], v35, s[4:7], s60 offen sc1
  s_add_u32 s60, s60, 32768
  v_pk_fma_f32 v[144:145], v[38:39], v[208:209], v[144:145] op_sel:[1,0,0] op_sel_hi:[1,1,1]
  v_pk_fma_f32 v[146:147], v[38:39], v[210:211], v[146:147] op_sel:[1,0,0] op_sel_hi:[1,1,1]
  v_pk_fma_f32 v[148:149], v[38:39], v[212:213], v[148:149] op_sel:[1,0,0] op_sel_hi:[1,1,1]
  v_pk_fma_f32 v[150:151], v[38:39], v[214:215], v[150:151] op_sel:[1,0,0] op_sel_hi:[1,1,1]
  v_pk_fma_f32 v[152:153], v[38:39], v[216:217], v[152:153] op_sel:[1,0,0] op_sel_hi:[1,1,1]
  v_pk_fma_f32 v[154:155], v[38:39], v[218:219], v[154:155] op_sel:[1,0,0] op_sel_hi:[1,1,1]
  v_pk_fma_f32 v[156:157], v[38:39], v[220:221], v[156:157] op_sel:[1,0,0] op_sel_hi:[1,1,1]
  v_pk_fma_f32 v[158:159], v[38:39], v[222:223], v[158:159] op_sel:[1,0,0] op_sel_hi:[1,1,1]
  v_lshlrev_b32 v48, 16, v92
  v_and_b32 v49, 0xffff0000, v92
  v_lshlrev_b32 v50, 16, v93
  v_and_b32 v51, 0xffff0000, v93
  v_lshlrev_b32 v52, 16, v94
  v_and_b32 v53, 0xffff0000, v94
  v_lshlrev_b32 v54, 16, v95
  v_and_b32 v55, 0xffff0000, v95
  v_lshlrev_b32 v56, 16, v96
  v_and_b32 v57, 0xffff0000, v96
  v_lshlrev_b32 v58, 16, v97
  v_and_b32 v59, 0xffff0000, v97
  v_lshlrev_b32 v60, 16, v98
  v_and_b32 v61, 0xffff0000, v98
  v_lshlrev_b32 v62, 16, v99
  v_and_b32 v63, 0xffff0000, v99
  v_pk_add_f32 v[144:145], v[144:145], v[48:49]
  v_pk_add_f32 v[146:147], v[146:147], v[50:51]
  v_pk_add_f32 v[148:149], v[148:149], v[52:53]
  v_pk_add_f32 v[150:151], v[150:151], v[54:55]
  v_pk_add_f32 v[152:153], v[152:153], v[56:57]
  v_pk_add_f32 v[154:155], v[154:155], v[58:59]
  v_pk_add_f32 v[156:157], v[156:157], v[60:61]
  v_pk_add_f32 v[158:159], v[158:159], v[62:63]
  v_cvt_pk_bf16_f32 v144, v144, v145
  v_cvt_pk_bf16_f32 v145, v146, v147
  v_cvt_pk_bf16_f32 v146, v148, v149
  v_cvt_pk_bf16_f32 v147, v150, v151
  v_cvt_pk_bf16_f32 v152, v152, v153
  v_cvt_pk_bf16_f32 v153, v154, v155
  v_cvt_pk_bf16_f32 v154, v156, v157
  v_cvt_pk_bf16_f32 v155, v158, v159
  s_nop 1
  v_permlane16_swap_b32 v144, v146
  v_permlane16_swap_b32 v145, v147
  v_permlane16_swap_b32 v152, v154
  v_permlane16_swap_b32 v153, v155
  v_mov_b32 v148, v144
  v_mov_b32 v149, v145
  v_mov_b32 v150, v146
  v_mov_b32 v151, v147
  v_mov_b32_dpp v144, v152 row_ror:8 row_mask:0xf bank_mask:0xc
  v_mov_b32_dpp v145, v153 row_ror:8 row_mask:0xf bank_mask:0xc
  v_mov_b32_dpp v146, v154 row_ror:8 row_mask:0xf bank_mask:0xc
  v_mov_b32_dpp v147, v155 row_ror:8 row_mask:0xf bank_mask:0xc
  v_mov_b32_dpp v152, v148 row_ror:8 row_mask:0xf bank_mask:0x3
  v_mov_b32_dpp v153, v149 row_ror:8 row_mask:0xf bank_mask:0x3
  v_mov_b32_dpp v154, v150 row_ror:8 row_mask:0xf bank_mask:0x3
  v_mov_b32_dpp v155, v151 row_ror:8 row_mask:0xf bank_mask:0x3
  buffer_store_dwordx4 v[144:147], v34, s[4:7], s60 offen sc1
  buffer_store_dwordx4 v[152:155], v35, s[4:7], s60 offen sc1
  s_add_u32 s60, s60, 32768
  v_pk_fma_f32 v[160:161], v[40:41], v[224:225], v[160:161] op_sel_hi:[0,1,1]
  v_pk_fma_f32 v[162:163], v[40:41], v[226:227], v[162:163] op_sel_hi:[0,1,1]
  v_pk_fma_f32 v[164:165], v[40:41], v[228:229], v[164:165] op_sel_hi:[0,1,1]
  v_pk_fma_f32 v[166:167], v[40:41], v[230:231], v[166:167] op_sel_hi:[0,1,1]
  v_pk_fma_f32 v[168:169], v[40:41], v[232:233], v[168:169] op_sel_hi:[0,1,1]
  v_pk_fma_f32 v[170:171], v[40:41], v[234:235], v[170:171] op_sel_hi:[0,1,1]
  v_pk_fma_f32 v[172:173], v[40:41], v[236:237], v[172:173] op_sel_hi:[0,1,1]
  v_pk_fma_f32 v[174:175], v[40:41], v[238:239], v[174:175] op_sel_hi:[0,1,1]
  v_lshlrev_b32 v48, 16, v100
  v_and_b32 v49, 0xffff0000, v100
  v_lshlrev_b32 v50, 16, v101
  v_and_b32 v51, 0xffff0000, v101
  v_lshlrev_b32 v52, 16, v102
  v_and_b32 v53, 0xffff0000, v102
  v_lshlrev_b32 v54, 16, v103
  v_and_b32 v55, 0xffff0000, v103
  v_lshlrev_b32 v56, 16, v104
  v_and_b32 v57, 0xffff0000, v104
  v_lshlrev_b32 v58, 16, v105
  v_and_b32 v59, 0xffff0000, v105
  v_lshlrev_b32 v60, 16, v106
  v_and_b32 v61, 0xffff0000, v106
  v_lshlrev_b32 v62, 16, v107
  v_and_b32 v63, 0xffff0000, v107
  v_pk_add_f32 v[160:161], v[160:161], v[48:49]
  v_pk_add_f32 v[162:163], v[162:163], v[50:51]
  v_pk_add_f32 v[164:165], v[164:165], v[52:53]
  v_pk_add_f32 v[166:167], v[166:167], v[54:55]
  v_pk_add_f32 v[168:169], v[168:169], v[56:57]
  v_pk_add_f32 v[170:171], v[170:171], v[58:59]
  v_pk_add_f32 v[172:173], v[172:173], v[60:61]
  v_pk_add_f32 v[174:175], v[174:175], v[62:63]
  v_cvt_pk_bf16_f32 v160, v160, v161
  v_cvt_pk_bf16_f32 v161, v162, v163
  v_cvt_pk_bf16_f32 v162, v164, v165
  v_cvt_pk_bf16_f32 v163, v166, v167
  v_cvt_pk_bf16_f32 v168, v168, v169
  v_cvt_pk_bf16_f32 v169, v170, v171
  v_cvt_pk_bf16_f32 v170, v172, v173
  v_cvt_pk_bf16_f32 v171, v174, v175
  s_nop 1
  v_permlane16_swap_b32 v160, v162
  v_permlane16_swap_b32 v161, v163
  v_permlane16_swap_b32 v168, v170
  v_permlane16_swap_b32 v169, v171
  v_mov_b32 v164, v160
  v_mov_b32 v165, v161
  v_mov_b32 v166, v162
  v_mov_b32 v167, v163
  v_mov_b32_dpp v160, v168 row_ror:8 row_mask:0xf bank_mask:0xc
  v_mov_b32_dpp v161, v169 row_ror:8 row_mask:0xf bank_mask:0xc
  v_mov_b32_dpp v162, v170 row_ror:8 row_mask:0xf bank_mask:0xc
  v_mov_b32_dpp v163, v171 row_ror:8 row_mask:0xf bank_mask:0xc
  v_mov_b32_dpp v168, v164 row_ror:8 row_mask:0xf bank_mask:0x3
  v_mov_b32_dpp v169, v165 row_ror:8 row_mask:0xf bank_mask:0x3
  v_mov_b32_dpp v170, v166 row_ror:8 row_mask:0xf bank_mask:0x3
  v_mov_b32_dpp v171, v167 row_ror:8 row_mask:0xf bank_mask:0x3
  buffer_store_dwordx4 v[160:163], v34, s[4:7], s60 offen sc1
  buffer_store_dwordx4 v[168:171], v35, s[4:7], s60 offen sc1
  s_add_u32 s60, s60, 32768
  v_pk_fma_f32 v[176:177], v[40:41], v[240:241], v[176:177] op_sel:[1,0,0] op_sel_hi:[1,1,1]
  v_pk_fma_f32 v[178:179], v[40:41], v[242:243], v[178:179] op_sel:[1,0,0] op_sel_hi:[1,1,1]
  v_pk_fma_f32 v[180:181], v[40:41], v[244:245], v[180:181] op_sel:[1,0,0] op_sel_hi:[1,1,1]
  v_pk_fma_f32 v[182:183], v[40:41], v[246:247], v[182:183] op_sel:[1,0,0] op_sel_hi:[1,1,1]
  v_pk_fma_f32 v[184:185], v[40:41], v[248:249], v[184:185] op_sel:[1,0,0] op_sel_hi:[1,1,1]
  v_pk_fma_f32 v[186:187], v[40:41], v[250:251], v[186:187] op_sel:[1,0,0] op_sel_hi:[1,1,1]
  v_pk_fma_f32 v[188:189], v[40:41], v[252:253], v[188:189] op_sel:[1,0,0] op_sel_hi:[1,1,1]
  v_pk_fma_f32 v[190:191], v[40:41], v[254:255], v[190:191] op_sel:[1,0,0] op_sel_hi:[1,1,1]
  v_lshlrev_b32 v48, 16, v108
  v_and_b32 v49, 0xffff0000, v108
  v_lshlrev_b32 v50, 16, v109
  v_and_b32 v51, 0xffff0000, v109
  v_lshlrev_b32 v52, 16, v110
  v_and_b32 v53, 0xffff0000, v110
  v_lshlrev_b32 v54, 16, v111
  v_and_b32 v55, 0xffff0000, v111
  v_lshlrev_b32 v56, 16, v112
  v_and_b32 v57, 0xffff0000, v112
  v_lshlrev_b32 v58, 16, v113
  v_and_b32 v59, 0xffff0000, v113
  v_lshlrev_b32 v60, 16, v114
  v_and_b32 v61, 0xffff0000, v114
  v_lshlrev_b32 v62, 16, v115
  v_and_b32 v63, 0xffff0000, v115
  v_pk_add_f32 v[176:177], v[176:177], v[48:49]
  v_pk_add_f32 v[178:179], v[178:179], v[50:51]
  v_pk_add_f32 v[180:181], v[180:181], v[52:53]
  v_pk_add_f32 v[182:183], v[182:183], v[54:55]
  v_pk_add_f32 v[184:185], v[184:185], v[56:57]
  v_pk_add_f32 v[186:187], v[186:187], v[58:59]
  v_pk_add_f32 v[188:189], v[188:189], v[60:61]
  v_pk_add_f32 v[190:191], v[190:191], v[62:63]
  v_cvt_pk_bf16_f32 v176, v176, v177
  v_cvt_pk_bf16_f32 v177, v178, v179
  v_cvt_pk_bf16_f32 v178, v180, v181
  v_cvt_pk_bf16_f32 v179, v182, v183
  v_cvt_pk_bf16_f32 v184, v184, v185
  v_cvt_pk_bf16_f32 v185, v186, v187
  v_cvt_pk_bf16_f32 v186, v188, v189
  v_cvt_pk_bf16_f32 v187, v190, v191
  s_nop 1
  v_permlane16_swap_b32 v176, v178
  v_permlane16_swap_b32 v177, v179
  v_permlane16_swap_b32 v184, v186
  v_permlane16_swap_b32 v185, v187
  v_mov_b32 v180, v176
  v_mov_b32 v181, v177
  v_mov_b32 v182, v178
  v_mov_b32 v183, v179
  v_mov_b32_dpp v176, v184 row_ror:8 row_mask:0xf bank_mask:0xc
  v_mov_b32_dpp v177, v185 row_ror:8 row_mask:0xf bank_mask:0xc
  v_mov_b32_dpp v178, v186 row_ror:8 row_mask:0xf bank_mask:0xc
  v_mov_b32_dpp v179, v187 row_ror:8 row_mask:0xf bank_mask:0xc
  v_mov_b32_dpp v184, v180 row_ror:8 row_mask:0xf bank_mask:0x3
  v_mov_b32_dpp v185, v181 row_ror:8 row_mask:0xf bank_mask:0x3
  v_mov_b32_dpp v186, v182 row_ror:8 row_mask:0xf bank_mask:0x3
  v_mov_b32_dpp v187, v183 row_ror:8 row_mask:0xf bank_mask:0x3
  buffer_store_dwordx4 v[176:179], v34, s[4:7], s60 offen sc1
  buffer_store_dwordx4 v[184:187], v35, s[4:7], s60 offen sc1
  s_endpgm
L_p2_r0:
  s_barrier
  ds_read_b128 a[0:3], v12 offset:0
  ds_read_b64_tr_b16 a[16:17], v18 offset:0
  ds_read_b64_tr_b16 a[18:19], v18 offset:4096
  ds_read_b128 a[32:35], v12 offset:8192
  ds_read_b64_tr_b16 a[48:49], v18 offset:8192
  ds_read_b64_tr_b16 a[50:51], v18 offset:12288
  ds_read_b128 a[4:7], v12 offset:1024
  ds_read_b64_tr_b16 a[20:21], v19 offset:0
  ds_read_b64_tr_b16 a[22:23], v19 offset:4096
  ds_read_b128 a[36:39], v12 offset:9216
  ds_read_b64_tr_b16 a[52:53], v19 offset:8192
  ds_read_b64_tr_b16 a[54:55], v19 offset:12288
  ds_read_b128 a[8:11], v12 offset:2048
  ds_read_b64_tr_b16 a[24:25], v20 offset:0
  ds_read_b64_tr_b16 a[26:27], v20 offset:4096
  s_add_u32 m0, s15, 98304
  s_nop 0
  buffer_load_dwordx4 v8, s[16:19], s12 offen offset:0  lds
  ds_read_b128 a[40:43], v12 offset:10240
  buffer_load_dwordx4 v8, s[16:19], s12 offen offset:1024  lds
  ds_read_b64_tr_b16 a[56:57], v20 offset:8192
  buffer_load_dwordx4 v8, s[16:19], s12 offen offset:2048  lds
  ds_read_b64_tr_b16 a[58:59], v20 offset:12288
  buffer_load_dwordx4 v8, s[16:19], s12 offen offset:3072  lds
  s_add_u32 s12, s12, s31
  ds_read_b128 a[12:15], v12 offset:3072
  s_add_u32 m0, s27, 98304
  ds_read_b64_tr_b16 a[28:29], v21 offset:0
  buffer_load_dwordx4 v2, s[96:99], s13 offen offset:0 lds
  ds_read_b64_tr_b16 a[30:31], v21 offset:4096
  buffer_load_dwordx4 v3, s[96:99], s13 offen offset:1024 lds
  buffer_load_dwordx4 v4, s[96:99], s13 offen offset:2048 lds
  ds_read_b128 a[44:47], v12 offset:11264
  buffer_load_dwordx4 v5, s[96:99], s13 offen offset:3072 lds
  ds_read_b64_tr_b16 a[60:61], v21 offset:8192
  s_add_u32 s13, s13, s32
  ds_read_b64_tr_b16 a[62:63], v21 offset:12288
  buffer_store_dwordx4 v[240:243], v16, s[16:19], s6 offen offset:0 sc1
  buffer_store_dwordx4 v[244:247], v16, s[16:19], s6 offen offset:2048 sc1
  buffer_store_dwordx4 v[192:195], v17, s[16:19], s4 offen offset:0 sc1
  buffer_store_dwordx4 v[196:199], v17, s[16:19], s4 offen offset:1024 sc1
  buffer_store_dwordx4 v[200:203], v17, s[16:19], s4 offen offset:2048 sc1
  s_waitcnt lgkmcnt(0)
  s_barrier
  v_mfma_f32_16x16x32_bf16 v[128:131], a[16:19], a[0:3], 0
  ds_read_b128 a[64:67], v12 offset:32768
  s_add_u32 m0, s15, 0
  v_mfma_f32_16x16x32_bf16 v[128:131], a[48:51], a[32:35], v[128:131]
  ds_read_b64_tr_b16 a[80:81], v18 offset:32768
  v_mfma_f32_16x16x32_bf16 v[132:135], a[20:23], a[0:3], 0
  buffer_load_dwordx4 v8, s[16:19], s12 offen offset:0  lds
  ds_read_b64_tr_b16 a[82:83], v18 offset:36864
  v_mfma_f32_16x16x32_bf16 v[132:135], a[52:55], a[32:35], v[132:135]
  ds_read_b128 a[96:99], v12 offset:40960
  v_mfma_f32_16x16x32_bf16 v[136:139], a[24:27], a[0:3], 0
  buffer_load_dwordx4 v8, s[16:19], s12 offen offset:1024  lds
  ds_read_b64_tr_b16 a[112:113], v18 offset:40960
  v_mfma_f32_16x16x32_bf16 v[136:139], a[56:59], a[32:35], v[136:139]
  ds_read_b64_tr_b16 a[114:115], v18 offset:45056
  buffer_load_dwordx4 v8, s[16:19], s12 offen offset:2048  lds
  v_mfma_f32_16x16x32_bf16 v[140:143], a[28:31], a[0:3], 0
  ds_read_b128 a[68:71], v12 offset:33792
  v_mfma_f32_16x16x32_bf16 v[140:143], a[60:63], a[32:35], v[140:143]
  buffer_load_dwordx4 v8, s[16:19], s12 offen offset:3072  lds
  ds_read_b64_tr_b16 a[84:85], v19 offset:32768
  v_mfma_f32_16x16x32_bf16 v[144:147], a[16:19], a[4:7], 0
  v_mfma_f32_16x16x32_bf16 v[144:147], a[48:51], a[36:39], v[144:147]
  ds_read_b64_tr_b16 a[86:87], v19 offset:36864
  s_add_u32 s12, s12, s31
  v_mfma_f32_16x16x32_bf16 v[148:151], a[20:23], a[4:7], 0
  ds_read_b128 a[100:103], v12 offset:41984
  v_mfma_f32_16x16x32_bf16 v[148:151], a[52:55], a[36:39], v[148:151]
  s_add_u32 m0, s27, 0
  ds_read_b64_tr_b16 a[116:117], v19 offset:40960
  v_mfma_f32_16x16x32_bf16 v[152:155], a[24:27], a[4:7], 0
  ds_read_b64_tr_b16 a[118:119], v19 offset:45056
  buffer_load_dwordx4 v2, s[96:99], s13 offen offset:0 lds
  v_mfma_f32_16x16x32_bf16 v[152:155], a[56:59], a[36:39], v[152:155]
  ds_read_b128 a[72:75], v12 offset:34816
  v_mfma_f32_16x16x32_bf16 v[156:159], a[28:31], a[4:7], 0
  buffer_load_dwordx4 v3, s[96:99], s13 offen offset:1024 lds
  ds_read_b64_tr_b16 a[88:89], v20 offset:32768
  v_mfma_f32_16x16x32_bf16 v[156:159], a[60:63], a[36:39], v[156:159]
  ds_read_b64_tr_b16 a[90:91], v20 offset:36864
  v_mfma_f32_16x16x32_bf16 v[160:163], a[16:19], a[8:11], 0
  buffer_load_dwordx4 v4, s[96:99], s13 offen offset:2048 lds
  v_mfma_f32_16x16x32_bf16 v[160:163], a[48:51], a[40:43], v[160:163]
  ds_read_b128 a[104:107], v12 offset:43008
  v_mfma_f32_16x16x32_bf16 v[164:167], a[20:23], a[8:11], 0
  buffer_load_dwordx4 v5, s[96:99], s13 offen offset:3072 lds
  ds_read_b64_tr_b16 a[120:121], v20 offset:40960
  v_mfma_f32_16x16x32_bf16 v[164:167], a[52:55], a[40:43], v[164:167]
  ds_read_b64_tr_b16 a[122:123], v20 offset:45056
  s_add_u32 s13, s13, s32
  v_mfma_f32_16x16x32_bf16 v[168:171], a[24:27], a[8:11], 0
  ds_read_b128 a[76:79], v12 offset:35840
  v_mfma_f32_16x16x32_bf16 v[168:171], a[56:59], a[40:43], v[168:171]
  ds_read_b64_tr_b16 a[92:93], v21 offset:32768
  buffer_store_dwordx4 v[204:207], v17, s[16:19], s4 offen offset:3072 sc1
  v_mfma_f32_16x16x32_bf16 v[172:175], a[28:31], a[8:11], 0
  ds_read_b64_tr_b16 a[94:95], v21 offset:36864
  v_mfma_f32_16x16x32_bf16 v[172:175], a[60:63], a[40:43], v[172:175]
  buffer_store_dwordx4 v[224:227], v17, s[16:19], s5 offen offset:0 sc1
  ds_read_b128 a[108:111], v12 offset:44032
  v_mfma_f32_16x16x32_bf16 v[176:179], a[16:19], a[12:15], 0
  ds_read_b64_tr_b16 a[124:125], v21 offset:40960
  v_mfma_f32_16x16x32_bf16 v[176:179], a[48:51], a[44:47], v[176:179]
  buffer_store_dwordx4 v[228:231], v17, s[16:19], s5 offen offset:1024 sc1
  v_mfma_f32_16x16x32_bf16 v[180:183], a[20:23], a[12:15], 0
  ds_read_b64_tr_b16 a[126:127], v21 offset:45056
  buffer_store_dwordx4 v[232:235], v17, s[16:19], s5 offen offset:2048 sc1
  v_mfma_f32_16x16x32_bf16 v[180:183], a[52:55], a[44:47], v[180:183]
  v_mfma_f32_16x16x32_bf16 v[184:187], a[24:27], a[12:15], 0
  buffer_store_dwordx4 v[236:239], v17, s[16:19], s5 offen offset:3072 sc1
  v_mfma_f32_16x16x32_bf16 v[184:187], a[56:59], a[44:47], v[184:187]
  v_mfma_f32_16x16x32_bf16 v[188:191], a[28:31], a[12:15], 0
  v_mfma_f32_16x16x32_bf16 v[188:191], a[60:63], a[44:47], v[188:191]
  s_waitcnt lgkmcnt(0)
  s_barrier
  s_waitcnt vmcnt(26)
  v_mfma_f32_16x16x32_bf16 v[128:131], a[80:83], a[64:67], v[128:131]
  ds_read_b128 a[0:3], v13 offset:0
  s_add_u32 m0, s15, 32768
  v_mfma_f32_16x16x32_bf16 v[128:131], a[112:115], a[96:99], v[128:131]
  s_mov_b64 exec, 2
  buffer_store_dwordx2 v[14:15], v0, s[16:19], 0 offen sc1
  s_mov_b64 exec, -1
  ds_read_b64_tr_b16 a[16:17], v22 offset:0
  v_mfma_f32_16x16x32_bf16 v[132:135], a[84:87], a[64:67], v[132:135]
  ds_read_b64_tr_b16 a[18:19], v22 offset:4096
  buffer_load_dwordx4 v8, s[16:19], s12 offen offset:0  lds
  v_mfma_f32_16x16x32_bf16 v[132:135], a[116:119], a[96:99], v[132:135]
  ds_read_b128 a[32:35], v13 offset:8192
  v_mfma_f32_16x16x32_bf16 v[136:139], a[88:91], a[64:67], v[136:139]
  ds_read_b64_tr_b16 a[48:49], v22 offset:8192
  v_mfma_f32_16x16x32_bf16 v[136:139], a[120:123], a[96:99], v[136:139]
  buffer_load_dwordx4 v8, s[16:19], s12 offen offset:1024  lds
  ds_read_b64_tr_b16 a[50:51], v22 offset:12288
  v_mfma_f32_16x16x32_bf16 v[140:143], a[92:95], a[64:67], v[140:143]
  ds_read_b128 a[4:7], v13 offset:1024
  v_mfma_f32_16x16x32_bf16 v[140:143], a[124:127], a[96:99], v[140:143]
  ds_read_b64_tr_b16 a[20:21], v23 offset:0
  buffer_load_dwordx4 v8, s[16:19], s12 offen offset:2048  lds
  v_mfma_f32_16x16x32_bf16 v[144:147], a[80:83], a[68:71], v[144:147]
  v_mfma_f32_16x16x32_bf16 v[144:147], a[112:115], a[100:103], v[144:147]
  ds_read_b64_tr_b16 a[22:23], v23 offset:4096
  v_mfma_f32_16x16x32_bf16 v[148:151], a[84:87], a[68:71], v[148:151]
  ds_read_b128 a[36:39], v13 offset:9216
  buffer_load_dwordx4 v8, s[16:19], s12 offen offset:3072  lds
  v_mfma_f32_16x16x32_bf16 v[148:151], a[116:119], a[100:103], v[148:151]
  ds_read_b64_tr_b16 a[52:53], v23 offset:8192
  v_mfma_f32_16x16x32_bf16 v[152:155], a[88:91], a[68:71], v[152:155]
  ds_read_b64_tr_b16 a[54:55], v23 offset:12288
  s_add_u32 s12, s12, s31
  v_mfma_f32_16x16x32_bf16 v[152:155], a[120:123], a[100:103], v[152:155]
  ds_read_b128 a[8:11], v13 offset:2048
  v_mfma_f32_16x16x32_bf16 v[156:159], a[92:95], a[68:71], v[156:159]
  ds_read_b64_tr_b16 a[24:25], v24 offset:0
  v_mfma_f32_16x16x32_bf16 v[156:159], a[124:127], a[100:103], v[156:159]
  s_add_u32 m0, s27, 32768
  ds_read_b64_tr_b16 a[26:27], v24 offset:4096
  v_mfma_f32_16x16x32_bf16 v[160:163], a[80:83], a[72:75], v[160:163]
  v_mfma_f32_16x16x32_bf16 v[160:163], a[112:115], a[104:107], v[160:163]
  ds_read_b128 a[40:43], v13 offset:10240
  buffer_load_dwordx4 v2, s[96:99], s13 offen offset:0 lds
  v_mfma_f32_16x16x32_bf16 v[164:167], a[84:87], a[72:75], v[164:167]
  ds_read_b64_tr_b16 a[56:57], v24 offset:8192
  v_mfma_f32_16x16x32_bf16 v[164:167], a[116:119], a[104:107], v[164:167]
  ds_read_b64_tr_b16 a[58:59], v24 offset:12288
  v_mfma_f32_16x16x32_bf16 v[168:171], a[88:91], a[72:75], v[168:171]
  ds_read_b128 a[12:15], v13 offset:3072
  buffer_load_dwordx4 v3, s[96:99], s13 offen offset:1024 lds
  v_mfma_f32_16x16x32_bf16 v[168:171], a[120:123], a[104:107], v[168:171]
  ds_read_b64_tr_b16 a[28:29], v25 offset:0
  v_mfma_f32_16x16x32_bf16 v[172:175], a[92:95], a[72:75], v[172:175]
  ds_read_b64_tr_b16 a[30:31], v25 offset:4096
  buffer_load_dwordx4 v4, s[96:99], s13 offen offset:2048 lds
  v_mfma_f32_16x16x32_bf16 v[172:175], a[124:127], a[104:107], v[172:175]
  ds_read_b128 a[44:47], v13 offset:11264
  v_mfma_f32_16x16x32_bf16 v[176:179], a[80:83], a[76:79], v[176:179]
  ds_read_b64_tr_b16 a[60:61], v25 offset:8192
  v_mfma_f32_16x16x32_bf16 v[176:179], a[112:115], a[108:111], v[176:179]
  buffer_load_dwordx4 v5, s[96:99], s13 offen offset:3072 lds
  v_mfma_f32_16x16x32_bf16 v[180:183], a[84:87], a[76:79], v[180:183]
  ds_read_b64_tr_b16 a[62:63], v25 offset:12288
  v_mfma_f32_16x16x32_bf16 v[180:183], a[116:119], a[108:111], v[180:183]
  s_add_u32 s13, s13, s32
  v_mfma_f32_16x16x32_bf16 v[184:187], a[88:91], a[76:79], v[184:187]
  v_mfma_f32_16x16x32_bf16 v[184:187], a[120:123], a[108:111], v[184:187]
  v_mfma_f32_16x16x32_bf16 v[188:191], a[92:95], a[76:79], v[188:191]
  v_mfma_f32_16x16x32_bf16 v[188:191], a[124:127], a[108:111], v[188:191]
  s_waitcnt vmcnt(27) lgkmcnt(0)
  s_barrier
  v_mfma_f32_16x16x32_bf16 v[128:131], a[16:19], a[0:3], v[128:131]
  ds_read_b128 a[64:67], v13 offset:32768
  s_add_u32 m0, s15, 65536
  v_mfma_f32_16x16x32_bf16 v[128:131], a[48:51], a[32:35], v[128:131]
  ds_read_b64_tr_b16 a[80:81], v22 offset:32768
  v_mfma_f32_16x16x32_bf16 v[132:135], a[20:23], a[0:3], v[132:135]
  ds_read_b64_tr_b16 a[82:83], v22 offset:36864
  buffer_load_dwordx4 v8, s[16:19], s12 offen offset:0  lds
  v_mfma_f32_16x16x32_bf16 v[132:135], a[52:55], a[32:35], v[132:135]
  ds_read_b128 a[96:99], v13 offset:40960
  v_mfma_f32_16x16x32_bf16 v[136:139], a[24:27], a[0:3], v[136:139]
  ds_read_b64_tr_b16 a[112:113], v22 offset:40960
  v_mfma_f32_16x16x32_bf16 v[136:139], a[56:59], a[32:35], v[136:139]
  buffer_load_dwordx4 v8, s[16:19], s12 offen offset:1024  lds
  ds_read_b64_tr_b16 a[114:115], v22 offset:45056
  v_mfma_f32_16x16x32_bf16 v[140:143], a[28:31], a[0:3], v[140:143]
  ds_read_b128 a[68:71], v13 offset:33792
  v_mfma_f32_16x16x32_bf16 v[140:143], a[60:63], a[32:35], v[140:143]
  ds_read_b64_tr_b16 a[84:85], v23 offset:32768
  buffer_load_dwordx4 v8, s[16:19], s12 offen offset:2048  lds
  v_mfma_f32_16x16x32_bf16 v[144:147], a[16:19], a[4:7], v[144:147]
  v_mfma_f32_16x16x32_bf16 v[144:147], a[48:51], a[36:39], v[144:147]
  ds_read_b64_tr_b16 a[86:87], v23 offset:36864
  v_mfma_f32_16x16x32_bf16 v[148:151], a[20:23], a[4:7], v[148:151]
  ds_read_b128 a[100:103], v13 offset:41984
  buffer_load_dwordx4 v8, s[16:19], s12 offen offset:3072  lds
  v_mfma_f32_16x16x32_bf16 v[148:151], a[52:55], a[36:39], v[148:151]
  ds_read_b64_tr_b16 a[116:117], v23 offset:40960
  v_mfma_f32_16x16x32_bf16 v[152:155], a[24:27], a[4:7], v[152:155]
  ds_read_b64_tr_b16 a[118:119], v23 offset:45056
  s_add_u32 s12, s12, s31
  v_mfma_f32_16x16x32_bf16 v[152:155], a[56:59], a[36:39], v[152:155]
  ds_read_b128 a[72:75], v13 offset:34816
  v_mfma_f32_16x16x32_bf16 v[156:159], a[28:31], a[4:7], v[156:159]
  ds_read_b64_tr_b16 a[88:89], v24 offset:32768
  v_mfma_f32_16x16x32_bf16 v[156:159], a[60:63], a[36:39], v[156:159]
  s_add_u32 m0, s27, 65536
  ds_read_b64_tr_b16 a[90:91], v24 offset:36864
  v_mfma_f32_16x16x32_bf16 v[160:163], a[16:19], a[8:11], v[160:163]
  v_mfma_f32_16x16x32_bf16 v[160:163], a[48:51], a[40:43], v[160:163]
  ds_read_b128 a[104:107], v13 offset:43008
  buffer_load_dwordx4 v2, s[96:99], s13 offen offset:0 lds
  v_mfma_f32_16x16x32_bf16 v[164:167], a[20:23], a[8:11], v[164:167]
  ds_read_b64_tr_b16 a[120:121], v24 offset:40960
  v_mfma_f32_16x16x32_bf16 v[164:167], a[52:55], a[40:43], v[164:167]
  ds_read_b64_tr_b16 a[122:123], v24 offset:45056
  v_mfma_f32_16x16x32_bf16 v[168:171], a[24:27], a[8:11], v[168:171]
  ds_read_b128 a[76:79], v13 offset:35840
  buffer_load_dwordx4 v3, s[96:99], s13 offen offset:1024 lds
  v_mfma_f32_16x16x32_bf16 v[168:171], a[56:59], a[40:43], v[168:171]
  ds_read_b64_tr_b16 a[92:93], v25 offset:32768
  v_mfma_f32_16x16x32_bf16 v[172:175], a[28:31], a[8:11], v[172:175]
  ds_read_b64_tr_b16 a[94:95], v25 offset:36864
  buffer_load_dwordx4 v4, s[96:99], s13 offen offset:2048 lds
  v_mfma_f32_16x16x32_bf16 v[172:175], a[60:63], a[40:43], v[172:175]
  ds_read_b128 a[108:111], v13 offset:44032
  v_mfma_f32_16x16x32_bf16 v[176:179], a[16:19], a[12:15], v[176:179]
  ds_read_b64_tr_b16 a[124:125], v25 offset:40960
  v_mfma_f32_16x16x32_bf16 v[176:179], a[48:51], a[44:47], v[176:179]
  buffer_load_dwordx4 v5, s[96:99], s13 offen offset:3072 lds
  v_mfma_f32_16x16x32_bf16 v[180:183], a[20:23], a[12:15], v[180:183]
  ds_read_b64_tr_b16 a[126:127], v25 offset:45056
  v_mfma_f32_16x16x32_bf16 v[180:183], a[52:55], a[44:47], v[180:183]
  s_add_u32 s13, s13, s32
  v_mfma_f32_16x16x32_bf16 v[184:187], a[24:27], a[12:15], v[184:187]
  v_mfma_f32_16x16x32_bf16 v[184:187], a[56:59], a[44:47], v[184:187]
  v_mfma_f32_16x16x32_bf16 v[188:191], a[28:31], a[12:15], v[188:191]
  v_mfma_f32_16x16x32_bf16 v[188:191], a[60:63], a[44:47], v[188:191]
  s_waitcnt vmcnt(22) lgkmcnt(0)
  s_barrier
  s_waitcnt vmcnt(17)
  v_mfma_f32_16x16x32_bf16 v[128:131], a[80:83], a[64:67], v[128:131]
  ds_read_b128 a[0:3], v12 offset:0
  s_add_u32 m0, s15, 98304
  v_mfma_f32_16x16x32_bf16 v[128:131], a[112:115], a[96:99], v[128:131]
  s_and_b32 s60, s2, 3
  ds_read_b64_tr_b16 a[16:17], v18 offset:0
  v_mfma_f32_16x16x32_bf16 v[132:135], a[84:87], a[64:67], v[132:135]
  s_cmp_eq_u32 s60, s24
  s_cselect_b32 s30, 1, 0
  ds_read_b64_tr_b16 a[18:19], v18 offset:4096
  buffer_load_dwordx4 v8, s[16:19], s12 offen offset:0  lds
  v_mfma_f32_16x16x32_bf16 v[132:135], a[116:119], a[96:99], v[132:135]
  ds_read_b128 a[32:35], v12 offset:8192
  s_cmp_lt_u32 s2, 192
  s_cselect_b32 s30, s30, 0
  v_mfma_f32_16x16x32_bf16 v[136:139], a[88:91], a[64:67], v[136:139]
  ds_read_b64_tr_b16 a[48:49], v18 offset:8192
  s_mul_i32 s28, s2, 171
  v_mfma_f32_16x16x32_bf16 v[136:139], a[120:123], a[96:99], v[136:139]
  buffer_load_dwordx4 v8, s[16:19], s12 offen offset:1024  lds
  ds_read_b64_tr_b16 a[50:51], v18 offset:12288
  s_lshr_b32 s28, s28, 10
  v_mfma_f32_16x16x32_bf16 v[140:143], a[92:95], a[64:67], v[140:143]
  ds_read_b128 a[4:7], v12 offset:1024
  s_min_u32 s28, s28, 31
  v_mfma_f32_16x16x32_bf16 v[140:143], a[124:127], a[96:99], v[140:143]
  ds_read_b64_tr_b16 a[20:21], v19 offset:0
  buffer_load_dwordx4 v8, s[16:19], s12 offen offset:2048  lds
  v_mfma_f32_16x16x32_bf16 v[144:147], a[80:83], a[68:71], v[144:147]
  s_lshr_b32 s60, s28, 1
  v_mfma_f32_16x16x32_bf16 v[144:147], a[112:115], a[100:103], v[144:147]
  ds_read_b64_tr_b16 a[22:23], v19 offset:4096
  s_lshl_b32 s60, s60, 9
  v_mfma_f32_16x16x32_bf16 v[148:151], a[84:87], a[68:71], v[148:151]
  ds_read_b128 a[36:39], v12 offset:9216
  buffer_load_dwordx4 v8, s[16:19], s12 offen offset:3072  lds
  s_add_u32 s60, s60, 33144832
  v_mfma_f32_16x16x32_bf16 v[148:151], a[116:119], a[100:103], v[148:151]
  ds_read_b64_tr_b16 a[52:53], v19 offset:8192
  v_and_b32 v122, 31, v1
  v_mfma_f32_16x16x32_bf16 v[152:155], a[88:91], a[68:71], v[152:155]
  ds_read_b64_tr_b16 a[54:55], v19 offset:12288
  s_add_u32 s12, s12, s31
  v_lshlrev_b32 v122, 3, v122
  v_mfma_f32_16x16x32_bf16 v[152:155], a[120:123], a[100:103], v[152:155]
  ds_read_b128 a[8:11], v12 offset:2048
  v_mfma_f32_16x16x32_bf16 v[156:159], a[92:95], a[68:71], v[156:159]
  v_add_u32 v122, s60, v122
  ds_read_b64_tr_b16 a[24:25], v20 offset:0
  v_mfma_f32_16x16x32_bf16 v[156:159], a[124:127], a[100:103], v[156:159]
  buffer_load_dwordx2 v[120:121], v122, s[16:19], 0 offen sc1
  s_add_u32 m0, s27, 98304
  ds_read_b64_tr_b16 a[26:27], v20 offset:4096
  v_mfma_f32_16x16x32_bf16 v[160:163], a[80:83], a[72:75], v[160:163]
  s_mov_b64 exec, 16
  buffer_store_dwordx2 v[14:15], v0, s[16:19], 0 offen sc1
  s_mov_b64 exec, -1
  v_mfma_f32_16x16x32_bf16 v[160:163], a[112:115], a[104:107], v[160:163]
  ds_read_b128 a[40:43], v12 offset:10240
  s_mov_b32 s4, s52
  buffer_load_dwordx4 v2, s[96:99], s13 offen offset:0 lds
  v_mfma_f32_16x16x32_bf16 v[164:167], a[84:87], a[72:75], v[164:167]
  ds_read_b64_tr_b16 a[56:57], v20 offset:8192
  s_and_b32 s5, s53, 0xffff
  v_mfma_f32_16x16x32_bf16 v[164:167], a[116:119], a[104:107], v[164:167]
  ds_read_b64_tr_b16 a[58:59], v20 offset:12288
  v_mfma_f32_16x16x32_bf16 v[168:171], a[88:91], a[72:75], v[168:171]
  s_mov_b32 s6, 4194304
  ds_read_b128 a[12:15], v12 offset:3072
  buffer_load_dwordx4 v3, s[96:99], s13 offen offset:1024 lds
  v_mfma_f32_16x16x32_bf16 v[168:171], a[120:123], a[104:107], v[168:171]
  s_mov_b32 s7, 0x20000
  ds_read_b64_tr_b16 a[28:29], v21 offset:0
  v_mfma_f32_16x16x32_bf16 v[172:175], a[92:95], a[72:75], v[172:175]
  ds_read_b64_tr_b16 a[30:31], v21 offset:4096
  buffer_load_dwordx4 v4, s[96:99], s13 offen offset:2048 lds
  v_mfma_f32_16x16x32_bf16 v[172:175], a[124:127], a[104:107], v[172:175]
  ds_read_b128 a[44:47], v12 offset:11264
  v_mfma_f32_16x16x32_bf16 v[176:179], a[80:83], a[76:79], v[176:179]
  ds_read_b64_tr_b16 a[60:61], v21 offset:8192
  v_mfma_f32_16x16x32_bf16 v[176:179], a[112:115], a[108:111], v[176:179]
  buffer_load_dwordx4 v5, s[96:99], s13 offen offset:3072 lds
  v_mfma_f32_16x16x32_bf16 v[180:183], a[84:87], a[76:79], v[180:183]
  ds_read_b64_tr_b16 a[62:63], v21 offset:12288
  v_mfma_f32_16x16x32_bf16 v[180:183], a[116:119], a[108:111], v[180:183]
  s_add_u32 s13, s13, s32
  v_mfma_f32_16x16x32_bf16 v[184:187], a[88:91], a[76:79], v[184:187]
  v_mfma_f32_16x16x32_bf16 v[184:187], a[120:123], a[108:111], v[184:187]
  v_mfma_f32_16x16x32_bf16 v[188:191], a[92:95], a[76:79], v[188:191]
  v_mfma_f32_16x16x32_bf16 v[188:191], a[124:127], a[108:111], v[188:191]
  s_waitcnt vmcnt(18) lgkmcnt(0)
  s_barrier
  v_mfma_f32_16x16x32_bf16 v[128:131], a[16:19], a[0:3], v[128:131]
  ds_read_b128 a[64:67], v12 offset:32768
  s_add_u32 m0, s15, 0
  v_mfma_f32_16x16x32_bf16 v[128:131], a[48:51], a[32:35], v[128:131]
  ds_read_b64_tr_b16 a[80:81], v18 offset:32768
  v_mfma_f32_16x16x32_bf16 v[132:135], a[20:23], a[0:3], v[132:135]
  ds_read_b64_tr_b16 a[82:83], v18 offset:36864
  buffer_load_dwordx4 v8, s[16:19], s12 offen offset:0  lds
  v_mfma_f32_16x16x32_bf16 v[132:135], a[52:55], a[32:35], v[132:135]
  ds_read_b128 a[96:99], v12 offset:40960
  v_mfma_f32_16x16x32_bf16 v[136:139], a[24:27], a[0:3], v[136:139]
  ds_read_b64_tr_b16 a[112:113], v18 offset:40960
  v_mfma_f32_16x16x32_bf16 v[136:139], a[56:59], a[32:35], v[136:139]
  buffer_load_dwordx4 v8, s[16:19], s12 offen offset:1024  lds
  ds_read_b64_tr_b16 a[114:115], v18 offset:45056
  v_mfma_f32_16x16x32_bf16 v[140:143], a[28:31], a[0:3], v[140:143]
  ds_read_b128 a[68:71], v12 offset:33792
  v_mfma_f32_16x16x32_bf16 v[140:143], a[60:63], a[32:35], v[140:143]
  ds_read_b64_tr_b16 a[84:85], v19 offset:32768
  buffer_load_dwordx4 v8, s[16:19], s12 offen offset:2048  lds
  v_mfma_f32_16x16x32_bf16 v[144:147], a[16:19], a[4:7], v[144:147]
  v_mfma_f32_16x16x32_bf16 v[144:147], a[48:51], a[36:39], v[144:147]
  ds_read_b64_tr_b16 a[86:87], v19 offset:36864
  v_mfma_f32_16x16x32_bf16 v[148:151], a[20:23], a[4:7], v[148:151]
  ds_read_b128 a[100:103], v12 offset:41984
  buffer_load_dwordx4 v8, s[16:19], s12 offen offset:3072  lds
  v_mfma_f32_16x16x32_bf16 v[148:151], a[52:55], a[36:39], v[148:151]
  ds_read_b64_tr_b16 a[116:117], v19 offset:40960
  v_mfma_f32_16x16x32_bf16 v[152:155], a[24:27], a[4:7], v[152:155]
  ds_read_b64_tr_b16 a[118:119], v19 offset:45056
  s_add_u32 s12, s12, s31
  v_mfma_f32_16x16x32_bf16 v[152:155], a[56:59], a[36:39], v[152:155]
  ds_read_b128 a[72:75], v12 offset:34816
  v_mfma_f32_16x16x32_bf16 v[156:159], a[28:31], a[4:7], v[156:159]
  ds_read_b64_tr_b16 a[88:89], v20 offset:32768
  v_mfma_f32_16x16x32_bf16 v[156:159], a[60:63], a[36:39], v[156:159]
  s_add_u32 m0, s27, 0
  ds_read_b64_tr_b16 a[90:91], v20 offset:36864
  v_mfma_f32_16x16x32_bf16 v[160:163], a[16:19], a[8:11], v[160:163]
  v_mfma_f32_16x16x32_bf16 v[160:163], a[48:51], a[40:43], v[160:163]
  ds_read_b128 a[104:107], v12 offset:43008
  buffer_load_dwordx4 v2, s[96:99], s13 offen offset:0 lds
  v_mfma_f32_16x16x32_bf16 v[164:167], a[20:23], a[8:11], v[164:167]
  ds_read_b64_tr_b16 a[120:121], v20 offset:40960
  v_mfma_f32_16x16x32_bf16 v[164:167], a[52:55], a[40:43], v[164:167]
  ds_read_b64_tr_b16 a[122:123], v20 offset:45056
  v_mfma_f32_16x16x32_bf16 v[168:171], a[24:27], a[8:11], v[168:171]
  ds_read_b128 a[76:79], v12 offset:35840
  buffer_load_dwordx4 v3, s[96:99], s13 offen offset:1024 lds
  v_mfma_f32_16x16x32_bf16 v[168:171], a[56:59], a[40:43], v[168:171]
  ds_read_b64_tr_b16 a[92:93], v21 offset:32768
  v_mfma_f32_16x16x32_bf16 v[172:175], a[28:31], a[8:11], v[172:175]
  ds_read_b64_tr_b16 a[94:95], v21 offset:36864
  buffer_load_dwordx4 v4, s[96:99], s13 offen offset:2048 lds
  v_mfma_f32_16x16x32_bf16 v[172:175], a[60:63], a[40:43], v[172:175]
  ds_read_b128 a[108:111], v12 offset:44032
  v_mfma_f32_16x16x32_bf16 v[176:179], a[16:19], a[12:15], v[176:179]
  ds_read_b64_tr_b16 a[124:125], v21 offset:40960
  v_mfma_f32_16x16x32_bf16 v[176:179], a[48:51], a[44:47], v[176:179]
  buffer_load_dwordx4 v5, s[96:99], s13 offen offset:3072 lds
  v_mfma_f32_16x16x32_bf16 v[180:183], a[20:23], a[12:15], v[180:183]
  ds_read_b64_tr_b16 a[126:127], v21 offset:45056
  v_mfma_f32_16x16x32_bf16 v[180:183], a[52:55], a[44:47], v[180:183]
  s_add_u32 s13, s13, s32
  v_mfma_f32_16x16x32_bf16 v[184:187], a[24:27], a[12:15], v[184:187]
  v_mfma_f32_16x16x32_bf16 v[184:187], a[56:59], a[44:47], v[184:187]
  v_mfma_f32_16x16x32_bf16 v[188:191], a[28:31], a[12:15], v[188:191]
  v_mfma_f32_16x16x32_bf16 v[188:191], a[60:63], a[44:47], v[188:191]
  s_cmp_eq_u32 s30, 0
  s_cbranch_scc1 L_p2r0_nr1
  s_waitcnt vmcnt(13)
L_p2r0_qw:
  v_cmp_eq_u64 vcc, v[120:121], v[14:15]
  s_nop 1
  s_cmp_eq_u64 vcc, -1
  s_cbranch_scc1 L_p2r0_qok
  s_add_u32 s3, s3, 1
  s_cmp_gt_u32 s3, 0x40000
  s_cbranch_scc1 L_p2r0_qok
  s_sleep 4
  buffer_load_dwordx2 v[120:121], v122, s[16:19], 0 offen sc1
  s_waitcnt vmcnt(0)
  s_branch L_p2r0_qw
L_p2r0_qok:
  s_lshr_b32 s60, s28, 1
  s_mul_i32 s60, s60, 84
  s_add_u32 s60, s60, s2
  s_lshl_b32 s60, s60, 10
  s_add_u32 s60, s60, 18874368
  buffer_load_dwordx4 v[48:51], v17, s[16:19], s60 offen
  s_add_u32 s60, s60, 12288
  buffer_load_dwordx4 v[52:55], v17, s[16:19], s60 offen
  s_add_u32 s60, s60, 12288
  buffer_load_dwordx4 v[56:59], v17, s[16:19], s60 offen
  s_add_u32 s60, s60, 12288
  buffer_load_dwordx4 v[60:63], v17, s[16:19], s60 offen
  s_add_u32 s60, s60, 12288
  buffer_load_dwordx4 v[64:67], v17, s[16:19], s60 offen
  s_add_u32 s60, s60, 12288
  buffer_load_dwordx4 v[68:71], v17, s[16:19], s60 offen
  s_add_u32 s60, s60, 12288
  buffer_load_dwordx4 v[72:75], v17, s[16:19], s60 offen
  s_add_u32 s60, s60, 12288
  buffer_load_dwordx4 v[76:79], v17, s[16:19], s60 offen
L_p2r0_nr1:
  s_waitcnt vmcnt(18) lgkmcnt(0)
  s_barrier
  v_mfma_f32_16x16x32_bf16 v[128:131], a[80:83], a[64:67], v[128:131]
  ds_read_b128 a[0:3], v13 offset:0
  s_add_u32 m0, s15, 32768
  v_mfma_f32_16x16x32_bf16 v[128:131], a[112:115], a[96:99], v[128:131]
  ds_read_b64_tr_b16 a[16:17], v22 offset:0
  v_mfma_f32_16x16x32_bf16 v[132:135], a[84:87], a[64:67], v[132:135]
  ds_read_b64_tr_b16 a[18:19], v22 offset:4096
  buffer_load_dwordx4 v8, s[16:19], s12 offen offset:0  lds
  v_mfma_f32_16x16x32_bf16 v[132:135], a[116:119], a[96:99], v[132:135]
  ds_read_b128 a[32:35], v13 offset:8192
  v_mfma_f32_16x16x32_bf16 v[136:139], a[88:91], a[64:67], v[136:139]
  ds_read_b64_tr_b16 a[48:49], v22 offset:8192
  v_mfma_f32_16x16x32_bf16 v[136:139], a[120:123], a[96:99], v[136:139]
  buffer_load_dwordx4 v8, s[16:19], s12 offen offset:1024  lds
  ds_read_b64_tr_b16 a[50:51], v22 offset:12288
  v_mfma_f32_16x16x32_bf16 v[140:143], a[92:95], a[64:67], v[140:143]
  ds_read_b128 a[4:7], v13 offset:1024
  v_mfma_f32_16x16x32_bf16 v[140:143], a[124:127], a[96:99], v[140:143]
  ds_read_b64_tr_b16 a[20:21], v23 offset:0
  buffer_load_dwordx4 v8, s[16:19], s12 offen offset:2048  lds
  v_mfma_f32_16x16x32_bf16 v[144:147], a[80:83], a[68:71], v[144:147]
  v_mfma_f32_16x16x32_bf16 v[144:147], a[112:115], a[100:103], v[144:147]
  ds_read_b64_tr_b16 a[22:23], v23 offset:4096
  v_mfma_f32_16x16x32_bf16 v[148:151], a[84:87], a[68:71], v[148:151]
  ds_read_b128 a[36:39], v13 offset:9216
  buffer_load_dwordx4 v8, s[16:19], s12 offen offset:3072  lds
  v_mfma_f32_16x16x32_bf16 v[148:151], a[116:119], a[100:103], v[148:151]
  ds_read_b64_tr_b16 a[52:53], v23 offset:8192
  v_mfma_f32_16x16x32_bf16 v[152:155], a[88:91], a[68:71], v[152:155]
  ds_read_b64_tr_b16 a[54:55], v23 offset:12288
  s_add_u32 s12, s12, s31
  v_mfma_f32_16x16x32_bf16 v[152:155], a[120:123], a[100:103], v[152:155]
  ds_read_b128 a[8:11], v13 offset:2048
  v_mfma_f32_16x16x32_bf16 v[156:159], a[92:95], a[68:71], v[156:159]
  ds_read_b64_tr_b16 a[24:25], v24 offset:0
  v_mfma_f32_16x16x32_bf16 v[156:159], a[124:127], a[100:103], v[156:159]
  s_add_u32 m0, s27, 32768
  ds_read_b64_tr_b16 a[26:27], v24 offset:4096
  v_mfma_f32_16x16x32_bf16 v[160:163], a[80:83], a[72:75], v[160:163]
  v_mfma_f32_16x16x32_bf16 v[160:163], a[112:115], a[104:107], v[160:163]
  ds_read_b128 a[40:43], v13 offset:10240
  buffer_load_dwordx4 v2, s[96:99], s13 offen offset:0 lds
  v_mfma_f32_16x16x32_bf16 v[164:167], a[84:87], a[72:75], v[164:167]
  ds_read_b64_tr_b16 a[56:57], v24 offset:8192
  v_mfma_f32_16x16x32_bf16 v[164:167], a[116:119], a[104:107], v[164:167]
  ds_read_b64_tr_b16 a[58:59], v24 offset:12288
  v_mfma_f32_16x16x32_bf16 v[168:171], a[88:91], a[72:75], v[168:171]
  ds_read_b128 a[12:15], v13 offset:3072
  buffer_load_dwordx4 v3, s[96:99], s13 offen offset:1024 lds
  v_mfma_f32_16x16x32_bf16 v[168:171], a[120:123], a[104:107], v[168:171]
  ds_read_b64_tr_b16 a[28:29], v25 offset:0
  v_mfma_f32_16x16x32_bf16 v[172:175], a[92:95], a[72:75], v[172:175]
  ds_read_b64_tr_b16 a[30:31], v25 offset:4096
  buffer_load_dwordx4 v4, s[96:99], s13 offen offset:2048 lds
  v_mfma_f32_16x16x32_bf16 v[172:175], a[124:127], a[104:107], v[172:175]
  ds_read_b128 a[44:47], v13 offset:11264
  v_mfma_f32_16x16x32_bf16 v[176:179], a[80:83], a[76:79], v[176:179]
  ds_read_b64_tr_b16 a[60:61], v25 offset:8192
  v_mfma_f32_16x16x32_bf16 v[176:179], a[112:115], a[108:111], v[176:179]
  buffer_load_dwordx4 v5, s[96:99], s13 offen offset:3072 lds
  v_mfma_f32_16x16x32_bf16 v[180:183], a[84:87], a[76:79], v[180:183]
  ds_read_b64_tr_b16 a[62:63], v25 offset:12288
  v_mfma_f32_16x16x32_bf16 v[180:183], a[116:119], a[108:111], v[180:183]
  s_add_u32 s13, s13, s32
  v_mfma_f32_16x16x32_bf16 v[184:187], a[88:91], a[76:79], v[184:187]
  v_mfma_f32_16x16x32_bf16 v[184:187], a[120:123], a[108:111], v[184:187]
  v_mfma_f32_16x16x32_bf16 v[188:191], a[92:95], a[76:79], v[188:191]
  v_mfma_f32_16x16x32_bf16 v[188:191], a[124:127], a[108:111], v[188:191]
  s_waitcnt vmcnt(16) lgkmcnt(0)
  s_barrier
  v_mfma_f32_16x16x32_bf16 v[128:131], a[16:19], a[0:3], v[128:131]
  ds_read_b128 a[64:67], v13 offset:32768
  s_add_u32 m0, s15, 65536
  v_mfma_f32_16x16x32_bf16 v[128:131], a[48:51], a[32:35], v[128:131]
  ds_read_b64_tr_b16 a[80:81], v22 offset:32768
  v_mfma_f32_16x16x32_bf16 v[132:135], a[20:23], a[0:3], v[132:135]
  ds_read_b64_tr_b16 a[82:83], v22 offset:36864
  buffer_load_dwordx4 v8, s[16:19], s12 offen offset:0  lds
  v_mfma_f32_16x16x32_bf16 v[132:135], a[52:55], a[32:35], v[132:135]
  ds_read_b128 a[96:99], v13 offset:40960
  v_mfma_f32_16x16x32_bf16 v[136:139], a[24:27], a[0:3], v[136:139]
  ds_read_b64_tr_b16 a[112:113], v22 offset:40960
  v_mfma_f32_16x16x32_bf16 v[136:139], a[56:59], a[32:35], v[136:139]
  buffer_load_dwordx4 v8, s[16:19], s12 offen offset:1024  lds
  ds_read_b64_tr_b16 a[114:115], v22 offset:45056
  v_mfma_f32_16x16x32_bf16 v[140:143], a[28:31], a[0:3], v[140:143]
  ds_read_b128 a[68:71], v13 offset:33792
  v_mfma_f32_16x16x32_bf16 v[140:143], a[60:63], a[32:35], v[140:143]
  ds_read_b64_tr_b16 a[84:85], v23 offset:32768
  buffer_load_dwordx4 v8, s[16:19], s12 offen offset:2048  lds
  v_mfma_f32_16x16x32_bf16 v[144:147], a[16:19], a[4:7], v[144:147]
  v_mfma_f32_16x16x32_bf16 v[144:147], a[48:51], a[36:39], v[144:147]
  ds_read_b64_tr_b16 a[86:87], v23 offset:36864
  v_mfma_f32_16x16x32_bf16 v[148:151], a[20:23], a[4:7], v[148:151]
  ds_read_b128 a[100:103], v13 offset:41984
  buffer_load_dwordx4 v8, s[16:19], s12 offen offset:3072  lds
  v_mfma_f32_16x16x32_bf16 v[148:151], a[52:55], a[36:39], v[148:151]
  ds_read_b64_tr_b16 a[116:117], v23 offset:40960
  v_mfma_f32_16x16x32_bf16 v[152:155], a[24:27], a[4:7], v[152:155]
  ds_read_b64_tr_b16 a[118:119], v23 offset:45056
  s_add_u32 s12, s12, s31
  v_mfma_f32_16x16x32_bf16 v[152:155], a[56:59], a[36:39], v[152:155]
  ds_read_b128 a[72:75], v13 offset:34816
  v_mfma_f32_16x16x32_bf16 v[156:159], a[28:31], a[4:7], v[156:159]
  ds_read_b64_tr_b16 a[88:89], v24 offset:32768
  v_mfma_f32_16x16x32_bf16 v[156:159], a[60:63], a[36:39], v[156:159]
  s_add_u32 m0, s27, 65536
  ds_read_b64_tr_b16 a[90:91], v24 offset:36864
  v_mfma_f32_16x16x32_bf16 v[160:163], a[16:19], a[8:11], v[160:163]
  v_mfma_f32_16x16x32_bf16 v[160:163], a[48:51], a[40:43], v[160:163]
  ds_read_b128 a[104:107], v13 offset:43008
  buffer_load_dwordx4 v2, s[96:99], s13 offen offset:0 lds
  v_mfma_f32_16x16x32_bf16 v[164:167], a[20:23], a[8:11], v[164:167]
  ds_read_b64_tr_b16 a[120:121], v24 offset:40960
  v_mfma_f32_16x16x32_bf16 v[164:167], a[52:55], a[40:43], v[164:167]
  ds_read_b64_tr_b16 a[122:123], v24 offset:45056
  v_mfma_f32_16x16x32_bf16 v[168:171], a[24:27], a[8:11], v[168:171]
  ds_read_b128 a[76:79], v13 offset:35840
  buffer_load_dwordx4 v3, s[96:99], s13 offen offset:1024 lds
  v_mfma_f32_16x16x32_bf16 v[168:171], a[56:59], a[40:43], v[168:171]
  ds_read_b64_tr_b16 a[92:93], v25 offset:32768
  v_mfma_f32_16x16x32_bf16 v[172:175], a[28:31], a[8:11], v[172:175]
  ds_read_b64_tr_b16 a[94:95], v25 offset:36864
  buffer_load_dwordx4 v4, s[96:99], s13 offen offset:2048 lds
  v_mfma_f32_16x16x32_bf16 v[172:175], a[60:63], a[40:43], v[172:175]
  ds_read_b128 a[108:111], v13 offset:44032
  v_mfma_f32_16x16x32_bf16 v[176:179], a[16:19], a[12:15], v[176:179]
  ds_read_b64_tr_b16 a[124:125], v25 offset:40960
  v_mfma_f32_16x16x32_bf16 v[176:179], a[48:51], a[44:47], v[176:179]
  buffer_load_dwordx4 v5, s[96:99], s13 offen offset:3072 lds
  v_mfma_f32_16x16x32_bf16 v[180:183], a[20:23], a[12:15], v[180:183]
  ds_read_b64_tr_b16 a[126:127], v25 offset:45056
  v_mfma_f32_16x16x32_bf16 v[180:183], a[52:55], a[44:47], v[180:183]
  s_add_u32 s13, s13, s32
  v_mfma_f32_16x16x32_bf16 v[184:187], a[24:27], a[12:15], v[184:187]
  v_mfma_f32_16x16x32_bf16 v[184:187], a[56:59], a[44:47], v[184:187]
  v_mfma_f32_16x16x32_bf16 v[188:191], a[28:31], a[12:15], v[188:191]
  v_mfma_f32_16x16x32_bf16 v[188:191], a[60:63], a[44:47], v[188:191]
  s_cmp_eq_u32 s30, 0
  s_cbranch_scc1 L_p2r0_nr2
  s_waitcnt vmcnt(16)
  v_pk_add_f32 v[48:49], v[48:49], v[52:53]
  v_pk_add_f32 v[50:51], v[50:51], v[54:55]
  v_pk_add_f32 v[56:57], v[56:57], v[60:61]
  v_pk_add_f32 v[58:59], v[58:59], v[62:63]
  v_pk_add_f32 v[64:65], v[64:65], v[68:69]
  v_pk_add_f32 v[66:67], v[66:67], v[70:71]
  v_pk_add_f32 v[72:73], v[72:73], v[76:77]
  v_pk_add_f32 v[74:75], v[74:75], v[78:79]
  v_pk_add_f32 v[48:49], v[48:49], v[56:57]
  v_pk_add_f32 v[50:51], v[50:51], v[58:59]
  v_pk_add_f32 v[64:65], v[64:65], v[72:73]
  v_pk_add_f32 v[66:67], v[66:67], v[74:75]
  v_pk_add_f32 v[48:49], v[48:49], v[64:65]
  v_pk_add_f32 v[50:51], v[50:51], v[66:67]
  v_cvt_pk_bf16_f32 v48, v48, v49
  v_cvt_pk_bf16_f32 v49, v50, v51
  s_mul_i32 s60, s28, 6
  s_sub_u32 s60, s2, s60
  s_cmp_ge_u32 s60, 3
  s_cselect_b32 s61, 1, 0
  s_mul_i32 s62, s61, 3
  s_sub_u32 s60, s60, s62
  s_mul_i32 s62, s28, 3
  s_add_u32 s60, s60, s62
  s_lshl_b32 s60, s60, 10
  s_lshl_b32 s61, s61, 9
  s_add_u32 s60, s60, s61
  s_add_u32 s60, s60, 20447232
  v_lshlrev_b32 v30, 3, v1
  buffer_store_dwordx2 v[48:49], v30, s[16:19], s60 offen sc1
L_p2r0_nr2:
  s_waitcnt vmcnt(16) lgkmcnt(0)
  s_barrier
  v_mfma_f32_16x16x32_bf16 v[128:131], a[80:83], a[64:67], v[128:131]
  ds_read_b128 a[0:3], v12 offset:0
  s_add_u32 m0, s15, 98304
  v_mfma_f32_16x16x32_bf16 v[128:131], a[112:115], a[96:99], v[128:131]
  ds_read_b64_tr_b16 a[16:17], v18 offset:0
  v_mfma_f32_16x16x32_bf16 v[132:135], a[84:87], a[64:67], v[132:135]
  ds_read_b64_tr_b16 a[18:19], v18 offset:4096
  buffer_load_dwordx4 v8, s[16:19], s12 offen offset:0  lds
  v_mfma_f32_16x16x32_bf16 v[132:135], a[116:119], a[96:99], v[132:135]
  ds_read_b128 a[32:35], v12 offset:8192
  v_mfma_f32_16x16x32_bf16 v[136:139], a[88:91], a[64:67], v[136:139]
  ds_read_b64_tr_b16 a[48:49], v18 offset:8192
  v_mfma_f32_16x16x32_bf16 v[136:139], a[120:123], a[96:99], v[136:139]
  buffer_load_dwordx4 v8, s[16:19], s12 offen offset:1024  lds
  ds_read_b64_tr_b16 a[50:51], v18 offset:12288
  v_mfma_f32_16x16x32_bf16 v[140:143], a[92:95], a[64:67], v[140:143]
  ds_read_b128 a[4:7], v12 offset:1024
  v_mfma_f32_16x16x32_bf16 v[140:143], a[124:127], a[96:99], v[140:143]
  ds_read_b64_tr_b16 a[20:21], v19 offset:0
  buffer_load_dwordx4 v8, s[16:19], s12 offen offset:2048  lds
  v_mfma_f32_16x16x32_bf16 v[144:147], a[80:83], a[68:71], v[144:147]
  v_mfma_f32_16x16x32_bf16 v[144:147], a[112:115], a[100:103], v[144:147]
  ds_read_b64_tr_b16 a[22:23], v19 offset:4096
  v_mfma_f32_16x16x32_bf16 v[148:151], a[84:87], a[68:71], v[148:151]
  ds_read_b128 a[36:39], v12 offset:9216
  buffer_load_dwordx4 v8, s[16:19], s12 offen offset:3072  lds
  v_mfma_f32_16x16x32_bf16 v[148:151], a[116:119], a[100:103], v[148:151]
  ds_read_b64_tr_b16 a[52:53], v19 offset:8192
  v_mfma_f32_16x16x32_bf16 v[152:155], a[88:91], a[68:71], v[152:155]
  ds_read_b64_tr_b16 a[54:55], v19 offset:12288
  s_add_u32 s12, s12, s31
  v_mfma_f32_16x16x32_bf16 v[152:155], a[120:123], a[100:103], v[152:155]
  ds_read_b128 a[8:11], v12 offset:2048
  v_mfma_f32_16x16x32_bf16 v[156:159], a[92:95], a[68:71], v[156:159]
  ds_read_b64_tr_b16 a[24:25], v20 offset:0
  v_mfma_f32_16x16x32_bf16 v[156:159], a[124:127], a[100:103], v[156:159]
  s_add_u32 m0, s27, 98304
  ds_read_b64_tr_b16 a[26:27], v20 offset:4096
  v_mfma_f32_16x16x32_bf16 v[160:163], a[80:83], a[72:75], v[160:163]
  v_mfma_f32_16x16x32_bf16 v[160:163], a[112:115], a[104:107], v[160:163]
  ds_read_b128 a[40:43], v12 offset:10240
  buffer_load_dwordx4 v2, s[96:99], s13 offen offset:0 lds
  v_mfma_f32_16x16x32_bf16 v[164:167], a[84:87], a[72:75], v[164:167]
  ds_read_b64_tr_b16 a[56:57], v20 offset:8192
  v_mfma_f32_16x16x32_bf16 v[164:167], a[116:119], a[104:107], v[164:167]
  ds_read_b64_tr_b16 a[58:59], v20 offset:12288
  v_mfma_f32_16x16x32_bf16 v[168:171], a[88:91], a[72:75], v[168:171]
  ds_read_b128 a[12:15], v12 offset:3072
  buffer_load_dwordx4 v3, s[96:99], s13 offen offset:1024 lds
  v_mfma_f32_16x16x32_bf16 v[168:171], a[120:123], a[104:107], v[168:171]
  ds_read_b64_tr_b16 a[28:29], v21 offset:0
  v_mfma_f32_16x16x32_bf16 v[172:175], a[92:95], a[72:75], v[172:175]
  ds_read_b64_tr_b16 a[30:31], v21 offset:4096
  buffer_load_dwordx4 v4, s[96:99], s13 offen offset:2048 lds
  v_mfma_f32_16x16x32_bf16 v[172:175], a[124:127], a[104:107], v[172:175]
  ds_read_b128 a[44:47], v12 offset:11264
  v_mfma_f32_16x16x32_bf16 v[176:179], a[80:83], a[76:79], v[176:179]
  ds_read_b64_tr_b16 a[60:61], v21 offset:8192
  v_mfma_f32_16x16x32_bf16 v[176:179], a[112:115], a[108:111], v[176:179]
  buffer_load_dwordx4 v5, s[96:99], s13 offen offset:3072 lds
  v_mfma_f32_16x16x32_bf16 v[180:183], a[84:87], a[76:79], v[180:183]
  ds_read_b64_tr_b16 a[62:63], v21 offset:12288
  v_mfma_f32_16x16x32_bf16 v[180:183], a[116:119], a[108:111], v[180:183]
  s_add_u32 s13, s13, s32
  v_mfma_f32_16x16x32_bf16 v[184:187], a[88:91], a[76:79], v[184:187]
  v_mfma_f32_16x16x32_bf16 v[184:187], a[120:123], a[108:111], v[184:187]
  v_mfma_f32_16x16x32_bf16 v[188:191], a[92:95], a[76:79], v[188:191]
  v_mfma_f32_16x16x32_bf16 v[188:191], a[124:127], a[108:111], v[188:191]
  s_waitcnt vmcnt(16) lgkmcnt(0)
  s_barrier
  v_mfma_f32_16x16x32_bf16 v[128:131], a[16:19], a[0:3], v[128:131]
  ds_read_b128 a[64:67], v12 offset:32768
  s_add_u32 m0, s15, 0
  v_mfma_f32_16x16x32_bf16 v[128:131], a[48:51], a[32:35], v[128:131]
  ds_read_b64_tr_b16 a[80:81], v18 offset:32768
  v_mfma_f32_16x16x32_bf16 v[132:135], a[20:23], a[0:3], v[132:135]
  ds_read_b64_tr_b16 a[82:83], v18 offset:36864
  buffer_load_dwordx4 v8, s[16:19], s12 offen offset:0  lds
  v_mfma_f32_16x16x32_bf16 v[132:135], a[52:55], a[32:35], v[132:135]
  ds_read_b128 a[96:99], v12 offset:40960
  v_mfma_f32_16x16x32_bf16 v[136:139], a[24:27], a[0:3], v[136:139]
  ds_read_b64_tr_b16 a[112:113], v18 offset:40960
  v_mfma_f32_16x16x32_bf16 v[136:139], a[56:59], a[32:35], v[136:139]
  buffer_load_dwordx4 v8, s[16:19], s12 offen offset:1024  lds
  ds_read_b64_tr_b16 a[114:115], v18 offset:45056
  v_mfma_f32_16x16x32_bf16 v[140:143], a[28:31], a[0:3], v[140:143]
  ds_read_b128 a[68:71], v12 offset:33792
  v_mfma_f32_16x16x32_bf16 v[140:143], a[60:63], a[32:35], v[140:143]
  ds_read_b64_tr_b16 a[84:85], v19 offset:32768
  buffer_load_dwordx4 v8, s[16:19], s12 offen offset:2048  lds
  v_mfma_f32_16x16x32_bf16 v[144:147], a[16:19], a[4:7], v[144:147]
  v_mfma_f32_16x16x32_bf16 v[144:147], a[48:51], a[36:39], v[144:147]
  ds_read_b64_tr_b16 a[86:87], v19 offset:36864
  v_mfma_f32_16x16x32_bf16 v[148:151], a[20:23], a[4:7], v[148:151]
  ds_read_b128 a[100:103], v12 offset:41984
  buffer_load_dwordx4 v8, s[16:19], s12 offen offset:3072  lds
  v_mfma_f32_16x16x32_bf16 v[148:151], a[52:55], a[36:39], v[148:151]
  ds_read_b64_tr_b16 a[116:117], v19 offset:40960
  v_mfma_f32_16x16x32_bf16 v[152:155], a[24:27], a[4:7], v[152:155]
  ds_read_b64_tr_b16 a[118:119], v19 offset:45056
  s_add_u32 s12, s12, s31
  v_mfma_f32_16x16x32_bf16 v[152:155], a[56:59], a[36:39], v[152:155]
  ds_read_b128 a[72:75], v12 offset:34816
  v_mfma_f32_16x16x32_bf16 v[156:159], a[28:31], a[4:7], v[156:159]
  ds_read_b64_tr_b16 a[88:89], v20 offset:32768
  v_mfma_f32_16x16x32_bf16 v[156:159], a[60:63], a[36:39], v[156:159]
  s_add_u32 m0, s27, 0
  ds_read_b64_tr_b16 a[90:91], v20 offset:36864
  v_mfma_f32_16x16x32_bf16 v[160:163], a[16:19], a[8:11], v[160:163]
  v_mfma_f32_16x16x32_bf16 v[160:163], a[48:51], a[40:43], v[160:163]
  ds_read_b128 a[104:107], v12 offset:43008
  buffer_load_dwordx4 v2, s[96:99], s13 offen offset:0 lds
  v_mfma_f32_16x16x32_bf16 v[164:167], a[20:23], a[8:11], v[164:167]
  ds_read_b64_tr_b16 a[120:121], v20 offset:40960
  v_mfma_f32_16x16x32_bf16 v[164:167], a[52:55], a[40:43], v[164:167]
  ds_read_b64_tr_b16 a[122:123], v20 offset:45056
  v_mfma_f32_16x16x32_bf16 v[168:171], a[24:27], a[8:11], v[168:171]
  ds_read_b128 a[76:79], v12 offset:35840
  buffer_load_dwordx4 v3, s[96:99], s13 offen offset:1024 lds
  v_mfma_f32_16x16x32_bf16 v[168:171], a[56:59], a[40:43], v[168:171]
  ds_read_b64_tr_b16 a[92:93], v21 offset:32768
  v_mfma_f32_16x16x32_bf16 v[172:175], a[28:31], a[8:11], v[172:175]
  ds_read_b64_tr_b16 a[94:95], v21 offset:36864
  buffer_load_dwordx4 v4, s[96:99], s13 offen offset:2048 lds
  v_mfma_f32_16x16x32_bf16 v[172:175], a[60:63], a[40:43], v[172:175]
  ds_read_b128 a[108:111], v12 offset:44032
  v_mfma_f32_16x16x32_bf16 v[176:179], a[16:19], a[12:15], v[176:179]
  ds_read_b64_tr_b16 a[124:125], v21 offset:40960
  v_mfma_f32_16x16x32_bf16 v[176:179], a[48:51], a[44:47], v[176:179]
  buffer_load_dwordx4 v5, s[96:99], s13 offen offset:3072 lds
  v_mfma_f32_16x16x32_bf16 v[180:183], a[20:23], a[12:15], v[180:183]
  ds_read_b64_tr_b16 a[126:127], v21 offset:45056
  v_mfma_f32_16x16x32_bf16 v[180:183], a[52:55], a[44:47], v[180:183]
  s_add_u32 s13, s13, s32
  v_mfma_f32_16x16x32_bf16 v[184:187], a[24:27], a[12:15], v[184:187]
  v_mfma_f32_16x16x32_bf16 v[184:187], a[56:59], a[44:47], v[184:187]
  v_mfma_f32_16x16x32_bf16 v[188:191], a[28:31], a[12:15], v[188:191]
  v_mfma_f32_16x16x32_bf16 v[188:191], a[60:63], a[44:47], v[188:191]
  s_cmp_eq_u32 s30, 0
  s_cbranch_scc1 L_p2r0_nr3
  s_waitcnt vmcnt(16)
  s_mov_b64 exec, 32
  buffer_store_dwordx2 v[14:15], v0, s[16:19], 0 offen sc1
  s_mov_b64 exec, -1
L_p2r0_nr3:
  s_waitcnt vmcnt(16) lgkmcnt(0)
  s_barrier
  v_mfma_f32_16x16x32_bf16 v[128:131], a[80:83], a[64:67], v[128:131]
  ds_read_b128 a[0:3], v13 offset:0
  s_add_u32 m0, s15, 32768
  v_mfma_f32_16x16x32_bf16 v[128:131], a[112:115], a[96:99], v[128:131]
  ds_read_b64_tr_b16 a[16:17], v22 offset:0
  v_mfma_f32_16x16x32_bf16 v[132:135], a[84:87], a[64:67], v[132:135]
  ds_read_b64_tr_b16 a[18:19], v22 offset:4096
  buffer_load_dwordx4 v8, s[16:19], s12 offen offset:0  lds
  v_mfma_f32_16x16x32_bf16 v[132:135], a[116:119], a[96:99], v[132:135]
  ds_read_b128 a[32:35], v13 offset:8192
  v_mfma_f32_16x16x32_bf16 v[136:139], a[88:91], a[64:67], v[136:139]
  ds_read_b64_tr_b16 a[48:49], v22 offset:8192
  v_mfma_f32_16x16x32_bf16 v[136:139], a[120:123], a[96:99], v[136:139]
  buffer_load_dwordx4 v8, s[16:19], s12 offen offset:1024  lds
  ds_read_b64_tr_b16 a[50:51], v22 offset:12288
  v_mfma_f32_16x16x32_bf16 v[140:143], a[92:95], a[64:67], v[140:143]
  ds_read_b128 a[4:7], v13 offset:1024
  v_mfma_f32_16x16x32_bf16 v[140:143], a[124:127], a[96:99], v[140:143]
  ds_read_b64_tr_b16 a[20:21], v23 offset:0
  buffer_load_dwordx4 v8, s[16:19], s12 offen offset:2048  lds
  v_mfma_f32_16x16x32_bf16 v[144:147], a[80:83], a[68:71], v[144:147]
  v_mfma_f32_16x16x32_bf16 v[144:147], a[112:115], a[100:103], v[144:147]
  ds_read_b64_tr_b16 a[22:23], v23 offset:4096
  v_mfma_f32_16x16x32_bf16 v[148:151], a[84:87], a[68:71], v[148:151]
  ds_read_b128 a[36:39], v13 offset:9216
  buffer_load_dwordx4 v8, s[16:19], s12 offen offset:3072  lds
  v_mfma_f32_16x16x32_bf16 v[148:151], a[116:119], a[100:103], v[148:151]
  ds_read_b64_tr_b16 a[52:53], v23 offset:8192
  v_mfma_f32_16x16x32_bf16 v[152:155], a[88:91], a[68:71], v[152:155]
  ds_read_b64_tr_b16 a[54:55], v23 offset:12288
  s_add_u32 s12, s12, s31
  v_mfma_f32_16x16x32_bf16 v[152:155], a[120:123], a[100:103], v[152:155]
  ds_read_b128 a[8:11], v13 offset:2048
  v_mfma_f32_16x16x32_bf16 v[156:159], a[92:95], a[68:71], v[156:159]
  ds_read_b64_tr_b16 a[24:25], v24 offset:0
  v_mfma_f32_16x16x32_bf16 v[156:159], a[124:127], a[100:103], v[156:159]
  s_add_u32 m0, s27, 32768
  ds_read_b64_tr_b16 a[26:27], v24 offset:4096
  v_mfma_f32_16x16x32_bf16 v[160:163], a[80:83], a[72:75], v[160:163]
  v_mfma_f32_16x16x32_bf16 v[160:163], a[112:115], a[104:107], v[160:163]
  ds_read_b128 a[40:43], v13 offset:10240
  buffer_load_dwordx4 v2, s[96:99], s13 offen offset:0 lds
  v_mfma_f32_16x16x32_bf16 v[164:167], a[84:87], a[72:75], v[164:167]
  ds_read_b64_tr_b16 a[56:57], v24 offset:8192
  v_mfma_f32_16x16x32_bf16 v[164:167], a[116:119], a[104:107], v[164:167]
  ds_read_b64_tr_b16 a[58:59], v24 offset:12288
  v_mfma_f32_16x16x32_bf16 v[168:171], a[88:91], a[72:75], v[168:171]
  ds_read_b128 a[12:15], v13 offset:3072
  buffer_load_dwordx4 v3, s[96:99], s13 offen offset:1024 lds
  v_mfma_f32_16x16x32_bf16 v[168:171], a[120:123], a[104:107], v[168:171]
  ds_read_b64_tr_b16 a[28:29], v25 offset:0
  v_mfma_f32_16x16x32_bf16 v[172:175], a[92:95], a[72:75], v[172:175]
  ds_read_b64_tr_b16 a[30:31], v25 offset:4096
  buffer_load_dwordx4 v4, s[96:99], s13 offen offset:2048 lds
  v_mfma_f32_16x16x32_bf16 v[172:175], a[124:127], a[104:107], v[172:175]
  ds_read_b128 a[44:47], v13 offset:11264
  v_mfma_f32_16x16x32_bf16 v[176:179], a[80:83], a[76:79], v[176:179]
  ds_read_b64_tr_b16 a[60:61], v25 offset:8192
  v_mfma_f32_16x16x32_bf16 v[176:179], a[112:115], a[108:111], v[176:179]
  buffer_load_dwordx4 v5, s[96:99], s13 offen offset:3072 lds
  v_mfma_f32_16x16x32_bf16 v[180:183], a[84:87], a[76:79], v[180:183]
  ds_read_b64_tr_b16 a[62:63], v25 offset:12288
  v_mfma_f32_16x16x32_bf16 v[180:183], a[116:119], a[108:111], v[180:183]
  s_add_u32 s13, s13, s32
  v_mfma_f32_16x16x32_bf16 v[184:187], a[88:91], a[76:79], v[184:187]
  v_mfma_f32_16x16x32_bf16 v[184:187], a[120:123], a[108:111], v[184:187]
  v_mfma_f32_16x16x32_bf16 v[188:191], a[92:95], a[76:79], v[188:191]
  v_mfma_f32_16x16x32_bf16 v[188:191], a[124:127], a[108:111], v[188:191]
  s_waitcnt vmcnt(16) lgkmcnt(0)
  s_barrier
  v_mfma_f32_16x16x32_bf16 v[128:131], a[16:19], a[0:3], v[128:131]
  ds_read_b128 a[64:67], v13 offset:32768
  s_add_u32 m0, s15, 65536
  v_mfma_f32_16x16x32_bf16 v[128:131], a[48:51], a[32:35], v[128:131]
  s_lshl_b32 s60, s8, 9
  ds_read_b64_tr_b16 a[80:81], v22 offset:32768
  v_mfma_f32_16x16x32_bf16 v[132:135], a[20:23], a[0:3], v[132:135]
  s_add_u32 s60, s60, 33136640
  ds_read_b64_tr_b16 a[82:83], v22 offset:36864
  buffer_load_dwordx4 v8, s[16:19], s12 offen offset:0  lds
  v_mfma_f32_16x16x32_bf16 v[132:135], a[52:55], a[32:35], v[132:135]
  ds_read_b128 a[96:99], v13 offset:40960
  v_lshlrev_b32 v9, 3, v1
  v_mfma_f32_16x16x32_bf16 v[136:139], a[24:27], a[0:3], v[136:139]
  ds_read_b64_tr_b16 a[112:113], v22 offset:40960
  v_add_u32 v9, s60, v9
  v_mfma_f32_16x16x32_bf16 v[136:139], a[56:59], a[32:35], v[136:139]
  buffer_load_dwordx4 v8, s[16:19], s12 offen offset:1024  lds
  ds_read_b64_tr_b16 a[114:115], v22 offset:45056
  buffer_load_dwordx2 v[10:11], v9, s[16:19], 0 offen sc1
  v_mfma_f32_16x16x32_bf16 v[140:143], a[28:31], a[0:3], v[140:143]
  ds_read_b128 a[68:71], v13 offset:33792
  v_mfma_f32_16x16x32_bf16 v[140:143], a[60:63], a[32:35], v[140:143]
  ds_read_b64_tr_b16 a[84:85], v23 offset:32768
  buffer_load_dwordx4 v8, s[16:19], s12 offen offset:2048  lds
  v_mfma_f32_16x16x32_bf16 v[144:147], a[16:19], a[4:7], v[144:147]
  v_mfma_f32_16x16x32_bf16 v[144:147], a[48:51], a[36:39], v[144:147]
  ds_read_b64_tr_b16 a[86:87], v23 offset:36864
  v_mfma_f32_16x16x32_bf16 v[148:151], a[20:23], a[4:7], v[148:151]
  ds_read_b128 a[100:103], v13 offset:41984
  buffer_load_dwordx4 v8, s[16:19], s12 offen offset:3072  lds
  v_mfma_f32_16x16x32_bf16 v[148:151], a[52:55], a[36:39], v[148:151]
  ds_read_b64_tr_b16 a[116:117], v23 offset:40960
  v_mfma_f32_16x16x32_bf16 v[152:155], a[24:27], a[4:7], v[152:155]
  ds_read_b64_tr_b16 a[118:119], v23 offset:45056
  s_add_u32 s12, s12, s31
  v_mfma_f32_16x16x32_bf16 v[152:155], a[56:59], a[36:39], v[152:155]
  ds_read_b128 a[72:75], v13 offset:34816
  v_mfma_f32_16x16x32_bf16 v[156:159], a[28:31], a[4:7], v[156:159]
  ds_read_b64_tr_b16 a[88:89], v24 offset:32768
  v_mfma_f32_16x16x32_bf16 v[156:159], a[60:63], a[36:39], v[156:159]
  s_add_u32 m0, s27, 65536
  ds_read_b64_tr_b16 a[90:91], v24 offset:36864
  v_mfma_f32_16x16x32_bf16 v[160:163], a[16:19], a[8:11], v[160:163]
  v_mfma_f32_16x16x32_bf16 v[160:163], a[48:51], a[40:43], v[160:163]
  ds_read_b128 a[104:107], v13 offset:43008
  buffer_load_dwordx4 v2, s[96:99], s13 offen offset:0 lds
  v_mfma_f32_16x16x32_bf16 v[164:167], a[20:23], a[8:11], v[164:167]
  ds_read_b64_tr_b16 a[120:121], v24 offset:40960
  v_mfma_f32_16x16x32_bf16 v[164:167], a[52:55], a[40:43], v[164:167]
  ds_read_b64_tr_b16 a[122:123], v24 offset:45056
  v_mfma_f32_16x16x32_bf16 v[168:171], a[24:27], a[8:11], v[168:171]
  ds_read_b128 a[76:79], v13 offset:35840
  buffer_load_dwordx4 v3, s[96:99], s13 offen offset:1024 lds
  v_mfma_f32_16x16x32_bf16 v[168:171], a[56:59], a[40:43], v[168:171]
  ds_read_b64_tr_b16 a[92:93], v25 offset:32768
  v_mfma_f32_16x16x32_bf16 v[172:175], a[28:31], a[8:11], v[172:175]
  ds_read_b64_tr_b16 a[94:95], v25 offset:36864
  buffer_load_dwordx4 v4, s[96:99], s13 offen offset:2048 lds
  v_mfma_f32_16x16x32_bf16 v[172:175], a[60:63], a[40:43], v[172:175]
  ds_read_b128 a[108:111], v13 offset:44032
  v_mfma_f32_16x16x32_bf16 v[176:179], a[16:19], a[12:15], v[176:179]
  ds_read_b64_tr_b16 a[124:125], v25 offset:40960
  v_mfma_f32_16x16x32_bf16 v[176:179], a[48:51], a[44:47], v[176:179]
  buffer_load_dwordx4 v5, s[96:99], s13 offen offset:3072 lds
  v_mfma_f32_16x16x32_bf16 v[180:183], a[20:23], a[12:15], v[180:183]
  ds_read_b64_tr_b16 a[126:127], v25 offset:45056
  v_mfma_f32_16x16x32_bf16 v[180:183], a[52:55], a[44:47], v[180:183]
  s_add_u32 s13, s13, s32
  v_mfma_f32_16x16x32_bf16 v[184:187], a[24:27], a[12:15], v[184:187]
  v_mfma_f32_16x16x32_bf16 v[184:187], a[56:59], a[44:47], v[184:187]
  v_mfma_f32_16x16x32_bf16 v[188:191], a[28:31], a[12:15], v[188:191]
  v_mfma_f32_16x16x32_bf16 v[188:191], a[60:63], a[44:47], v[188:191]
  s_waitcnt vmcnt(17) lgkmcnt(0)
  s_barrier
  v_mfma_f32_16x16x32_bf16 v[128:131], a[80:83], a[64:67], v[128:131]
  ds_read_b128 a[0:3], v12 offset:0
  s_add_u32 m0, s15, 98304
  v_mfma_f32_16x16x32_bf16 v[128:131], a[112:115], a[96:99], v[128:131]
  s_and_b32 s28, s2, 31
  ds_read_b64_tr_b16 a[16:17], v18 offset:0
  v_mfma_f32_16x16x32_bf16 v[132:135], a[84:87], a[64:67], v[132:135]
  s_lshr_b32 s29, s2, 5
  ds_read_b64_tr_b16 a[18:19], v18 offset:4096
  buffer_load_dwordx4 v8, s[16:19], s12 offen offset:0  lds
  v_mfma_f32_16x16x32_bf16 v[132:135], a[116:119], a[96:99], v[132:135]
  ds_read_b128 a[32:35], v12 offset:8192
  s_lshr_b32 s60, s28, 1
  v_mfma_f32_16x16x32_bf16 v[136:139], a[88:91], a[64:67], v[136:139]
  ds_read_b64_tr_b16 a[48:49], v18 offset:8192
  s_lshl_b32 s60, s60, 4
  v_mfma_f32_16x16x32_bf16 v[136:139], a[120:123], a[96:99], v[136:139]
  buffer_load_dwordx4 v8, s[16:19], s12 offen offset:1024  lds
  ds_read_b64_tr_b16 a[50:51], v18 offset:12288
  s_add_u32 s60, s60, s29
  v_mfma_f32_16x16x32_bf16 v[140:143], a[92:95], a[64:67], v[140:143]
  ds_read_b128 a[4:7], v12 offset:1024
  v_mfma_f32_16x16x32_bf16 v[140:143], a[124:127], a[96:99], v[140:143]
  s_lshl_b32 s60, s60, 2
  ds_read_b64_tr_b16 a[20:21], v19 offset:0
  buffer_load_dwordx4 v8, s[16:19], s12 offen offset:2048  lds
  v_mfma_f32_16x16x32_bf16 v[144:147], a[80:83], a[68:71], v[144:147]
  s_add_u32 s60, s60, s24
  v_mfma_f32_16x16x32_bf16 v[144:147], a[112:115], a[100:103], v[144:147]
  ds_read_b64_tr_b16 a[22:23], v19 offset:4096
  s_lshl_b32 s60, s60, 3
  v_mfma_f32_16x16x32_bf16 v[148:151], a[84:87], a[68:71], v[148:151]
  ds_read_b128 a[36:39], v12 offset:9216
  buffer_load_dwordx4 v8, s[16:19], s12 offen offset:3072  lds
  s_add_u32 s60, s60, 33145088
  v_mfma_f32_16x16x32_bf16 v[148:151], a[116:119], a[100:103], v[148:151]
  ds_read_b64_tr_b16 a[52:53], v19 offset:8192
  s_lshl_b32 s61, s28, 6
  v_mfma_f32_16x16x32_bf16 v[152:155], a[88:91], a[68:71], v[152:155]
  ds_read_b64_tr_b16 a[54:55], v19 offset:12288
  s_add_u32 s12, s12, s31
  v_mfma_f32_16x16x32_bf16 v[152:155], a[120:123], a[100:103], v[152:155]
  s_add_u32 s61, s61, 33210368
  ds_read_b128 a[8:11], v12 offset:2048
  v_mfma_f32_16x16x32_bf16 v[156:159], a[92:95], a[68:71], v[156:159]
  v_lshlrev_b32 v122, 3, v1
  ds_read_b64_tr_b16 a[24:25], v20 offset:0
  v_mfma_f32_16x16x32_bf16 v[156:159], a[124:127], a[100:103], v[156:159]
  v_add_u32 v122, s61, v122
  s_add_u32 m0, s27, 98304
  ds_read_b64_tr_b16 a[26:27], v20 offset:4096
  v_mfma_f32_16x16x32_bf16 v[160:163], a[80:83], a[72:75], v[160:163]
  v_mov_b32 v30, s60
  v_mfma_f32_16x16x32_bf16 v[160:163], a[112:115], a[104:107], v[160:163]
  ds_read_b128 a[40:43], v12 offset:10240
  v_cmp_gt_u32 s[62:63], 6, v1
  buffer_load_dwordx4 v2, s[96:99], s13 offen offset:0 lds
  v_mfma_f32_16x16x32_bf16 v[164:167], a[84:87], a[72:75], v[164:167]
  ds_read_b64_tr_b16 a[56:57], v20 offset:8192
  v_mfma_f32_16x16x32_bf16 v[164:167], a[116:119], a[104:107], v[164:167]
  s_nop 1
  ds_read_b64_tr_b16 a[58:59], v20 offset:12288
  v_mfma_f32_16x16x32_bf16 v[168:171], a[88:91], a[72:75], v[168:171]
  v_cndmask_b32 v122, v30, v122, s[62:63]
  ds_read_b128 a[12:15], v12 offset:3072
  buffer_load_dwordx4 v3, s[96:99], s13 offen offset:1024 lds
  v_mfma_f32_16x16x32_bf16 v[168:171], a[120:123], a[104:107], v[168:171]
  s_lshl_b32 s29, s29, 1
  ds_read_b64_tr_b16 a[28:29], v21 offset:0
  v_mfma_f32_16x16x32_bf16 v[172:175], a[92:95], a[72:75], v[172:175]
  s_lshr_b32 s60, s24, 1
  ds_read_b64_tr_b16 a[30:31], v21 offset:4096
  buffer_load_dwordx4 v4, s[96:99], s13 offen offset:2048 lds
  v_mfma_f32_16x16x32_bf16 v[172:175], a[124:127], a[104:107], v[172:175]
  ds_read_b128 a[44:47], v12 offset:11264
  s_add_u32 s29, s29, s60
  v_mfma_f32_16x16x32_bf16 v[176:179], a[80:83], a[76:79], v[176:179]
  ds_read_b64_tr_b16 a[60:61], v21 offset:8192
  v_mfma_f32_16x16x32_bf16 v[176:179], a[112:115], a[108:111], v[176:179]
  buffer_load_dwordx2 v[120:121], v122, s[16:19], 0 offen sc1
  buffer_load_dwordx4 v5, s[96:99], s13 offen offset:3072 lds
  v_mfma_f32_16x16x32_bf16 v[180:183], a[84:87], a[76:79], v[180:183]
  ds_read_b64_tr_b16 a[62:63], v21 offset:12288
  v_mfma_f32_16x16x32_bf16 v[180:183], a[116:119], a[108:111], v[180:183]
  s_add_u32 s13, s13, s32
  v_mfma_f32_16x16x32_bf16 v[184:187], a[88:91], a[76:79], v[184:187]
  v_mfma_f32_16x16x32_bf16 v[184:187], a[120:123], a[108:111], v[184:187]
  v_mfma_f32_16x16x32_bf16 v[188:191], a[92:95], a[76:79], v[188:191]
  v_mfma_f32_16x16x32_bf16 v[188:191], a[124:127], a[108:111], v[188:191]
  s_waitcnt vmcnt(18) lgkmcnt(0)
  s_barrier
  s_waitcnt vmcnt(15)
L_p2r0_lw:
  v_cmp_eq_u64 vcc, v[10:11], v[14:15]
  s_nop 1
  s_cmp_eq_u64 vcc, -1
  s_cbranch_scc1 L_p2r0_lok
  s_add_u32 s3, s3, 1
  s_cmp_gt_u32 s3, 0x40000
  s_cbranch_scc1 L_p2r0_lok
  s_sleep 4
  buffer_load_dwordx2 v[10:11], v9, s[16:19], 0 offen sc1
  s_waitcnt vmcnt(0)
  s_branch L_p2r0_lw
L_p2r0_lok:
  v_mfma_f32_16x16x32_bf16 v[128:131], a[16:19], a[0:3], v[128:131]
  ds_read_b128 a[64:67], v12 offset:32768
  s_lshr_b32 s71, s24, 1
  s_mul_i32 s71, s71, 1
  s_add_u32 s71, s71, 5
  s_lshl_b32 s13, s71, 16
  s_mul_i32 s12, s8, 144
  s_add_u32 s12, s12, s71
  s_lshl_b32 s12, s12, 13
  s_mov_b32 s31, 57344
  s_mov_b32 s32, 458752
  v_mfma_f32_16x16x32_bf16 v[128:131], a[48:51], a[32:35], v[128:131]
  ds_read_b64_tr_b16 a[80:81], v18 offset:32768
  v_mfma_f32_16x16x32_bf16 v[132:135], a[20:23], a[0:3], v[132:135]
  ds_read_b64_tr_b16 a[82:83], v18 offset:36864
  s_add_u32 m0, s15, 0
  v_mfma_f32_16x16x32_bf16 v[132:135], a[52:55], a[32:35], v[132:135]
  ds_read_b128 a[96:99], v12 offset:40960
  v_mfma_f32_16x16x32_bf16 v[136:139], a[24:27], a[0:3], v[136:139]
  ds_read_b64_tr_b16 a[112:113], v18 offset:40960
  v_mfma_f32_16x16x32_bf16 v[136:139], a[56:59], a[32:35], v[136:139]
  buffer_load_dwordx4 v8, s[16:19], s12 offen offset:0  lds
  ds_read_b64_tr_b16 a[114:115], v18 offset:45056
  v_mfma_f32_16x16x32_bf16 v[140:143], a[28:31], a[0:3], v[140:143]
  ds_read_b128 a[68:71], v12 offset:33792
  v_mfma_f32_16x16x32_bf16 v[140:143], a[60:63], a[32:35], v[140:143]
  buffer_load_dwordx4 v8, s[16:19], s12 offen offset:1024  lds
  ds_read_b64_tr_b16 a[84:85], v19 offset:32768
  v_mfma_f32_16x16x32_bf16 v[144:147], a[16:19], a[4:7], v[144:147]
  v_mfma_f32_16x16x32_bf16 v[144:147], a[48:51], a[36:39], v[144:147]
  ds_read_b64_tr_b16 a[86:87], v19 offset:36864
  buffer_load_dwordx4 v8, s[16:19], s12 offen offset:2048  lds
  v_mfma_f32_16x16x32_bf16 v[148:151], a[20:23], a[4:7], v[148:151]
  ds_read_b128 a[100:103], v12 offset:41984
  v_mfma_f32_16x16x32_bf16 v[148:151], a[52:55], a[36:39], v[148:151]
  ds_read_b64_tr_b16 a[116:117], v19 offset:40960
  v_mfma_f32_16x16x32_bf16 v[152:155], a[24:27], a[4:7], v[152:155]
  buffer_load_dwordx4 v8, s[16:19], s12 offen offset:3072  lds
  ds_read_b64_tr_b16 a[118:119], v19 offset:45056
  v_mfma_f32_16x16x32_bf16 v[152:155], a[56:59], a[36:39], v[152:155]
  ds_read_b128 a[72:75], v12 offset:34816
  v_mfma_f32_16x16x32_bf16 v[156:159], a[28:31], a[4:7], v[156:159]
  s_add_u32 s12, s12, s31
  ds_read_b64_tr_b16 a[88:89], v20 offset:32768
  v_mfma_f32_16x16x32_bf16 v[156:159], a[60:63], a[36:39], v[156:159]
  ds_read_b64_tr_b16 a[90:91], v20 offset:36864
  v_mfma_f32_16x16x32_bf16 v[160:163], a[16:19], a[8:11], v[160:163]
  s_add_u32 m0, s27, 0
  v_mfma_f32_16x16x32_bf16 v[160:163], a[48:51], a[40:43], v[160:163]
  ds_read_b128 a[104:107], v12 offset:43008
  v_mfma_f32_16x16x32_bf16 v[164:167], a[20:23], a[8:11], v[164:167]
  ds_read_b64_tr_b16 a[120:121], v20 offset:40960
  buffer_load_dwordx4 v2, s[96:99], s13 offen offset:0 lds
  v_mfma_f32_16x16x32_bf16 v[164:167], a[52:55], a[40:43], v[164:167]
  ds_read_b64_tr_b16 a[122:123], v20 offset:45056
  v_mfma_f32_16x16x32_bf16 v[168:171], a[24:27], a[8:11], v[168:171]
  ds_read_b128 a[76:79], v12 offset:35840
  v_mfma_f32_16x16x32_bf16 v[168:171], a[56:59], a[40:43], v[168:171]
  buffer_load_dwordx4 v3, s[96:99], s13 offen offset:1024 lds
  ds_read_b64_tr_b16 a[92:93], v21 offset:32768
  v_mfma_f32_16x16x32_bf16 v[172:175], a[28:31], a[8:11], v[172:175]
  ds_read_b64_tr_b16 a[94:95], v21 offset:36864
  v_mfma_f32_16x16x32_bf16 v[172:175], a[60:63], a[40:43], v[172:175]
  buffer_load_dwordx4 v4, s[96:99], s13 offen offset:2048 lds
  ds_read_b128 a[108:111], v12 offset:44032
  v_mfma_f32_16x16x32_bf16 v[176:179], a[16:19], a[12:15], v[176:179]
  ds_read_b64_tr_b16 a[124:125], v21 offset:40960
  v_mfma_f32_16x16x32_bf16 v[176:179], a[48:51], a[44:47], v[176:179]
  buffer_load_dwordx4 v5, s[96:99], s13 offen offset:3072 lds
  v_mfma_f32_16x16x32_bf16 v[180:183], a[20:23], a[12:15], v[180:183]
  ds_read_b64_tr_b16 a[126:127], v21 offset:45056
  v_mfma_f32_16x16x32_bf16 v[180:183], a[52:55], a[44:47], v[180:183]
  v_mfma_f32_16x16x32_bf16 v[184:187], a[24:27], a[12:15], v[184:187]
  s_add_u32 s13, s13, s32
  v_mfma_f32_16x16x32_bf16 v[184:187], a[56:59], a[44:47], v[184:187]
  v_mfma_f32_16x16x32_bf16 v[188:191], a[28:31], a[12:15], v[188:191]
  v_mfma_f32_16x16x32_bf16 v[188:191], a[60:63], a[44:47], v[188:191]
  s_waitcnt vmcnt(17) lgkmcnt(0)
  s_barrier
  s_waitcnt vmcnt(9)
L_p2r0_kw:
  v_cmp_eq_u64 vcc, v[120:121], v[14:15]
  s_nop 1
  s_cmp_eq_u64 vcc, -1
  s_cbranch_scc1 L_p2r0_kok
  s_add_u32 s3, s3, 1
  s_cmp_gt_u32 s3, 0x40000
  s_cbranch_scc1 L_p2r0_kok
  s_sleep 4
  buffer_load_dwordx2 v[120:121], v122, s[16:19], 0 offen sc1
  s_waitcnt vmcnt(0)
  s_branch L_p2r0_kw
L_p2r0_kok:
  v_mfma_f32_16x16x32_bf16 v[128:131], a[80:83], a[64:67], v[128:131]
  ds_read_b128 a[0:3], v13 offset:0
  s_add_u32 m0, s15, 32768
  v_mfma_f32_16x16x32_bf16 v[128:131], a[112:115], a[96:99], v[128:131]
  v_lshlrev_b32 v31, 2, v6
  ds_read_b64_tr_b16 a[16:17], v22 offset:0
  s_lshl_b32 s60, s8, 9
  v_mfma_f32_16x16x32_bf16 v[132:135], a[84:87], a[64:67], v[132:135]
  ds_read_b64_tr_b16 a[18:19], v22 offset:4096
  s_and_b32 s61, s24, 1
  buffer_load_dwordx4 v8, s[16:19], s12 offen offset:0  lds
  v_mfma_f32_16x16x32_bf16 v[132:135], a[116:119], a[96:99], v[132:135]
  ds_read_b128 a[32:35], v13 offset:8192
  s_lshl_b32 s61, s61, 8
  v_mfma_f32_16x16x32_bf16 v[136:139], a[88:91], a[64:67], v[136:139]
  s_add_u32 s60, s60, s61
  ds_read_b64_tr_b16 a[48:49], v22 offset:8192
  v_mfma_f32_16x16x32_bf16 v[136:139], a[120:123], a[96:99], v[136:139]
  s_add_u32 s60, s60, 20545536
  buffer_load_dwordx4 v8, s[16:19], s12 offen offset:1024  lds
  ds_read_b64_tr_b16 a[50:51], v22 offset:12288
  v_mfma_f32_16x16x32_bf16 v[140:143], a[92:95], a[64:67], v[140:143]
  buffer_load_dword v38, v31, s[16:19], s60 offen offset:0
  ds_read_b128 a[4:7], v13 offset:1024
  v_mfma_f32_16x16x32_bf16 v[140:143], a[124:127], a[96:99], v[140:143]
  buffer_load_dword v39, v31, s[16:19], s60 offen offset:64
  buffer_load_dword v40, v31, s[16:19], s60 offen offset:128
  ds_read_b64_tr_b16 a[20:21], v23 offset:0
  buffer_load_dwordx4 v8, s[16:19], s12 offen offset:2048  lds
  v_mfma_f32_16x16x32_bf16 v[144:147], a[80:83], a[68:71], v[144:147]
  buffer_load_dword v41, v31, s[16:19], s60 offen offset:192
  v_mfma_f32_16x16x32_bf16 v[144:147], a[112:115], a[100:103], v[144:147]
  ds_read_b64_tr_b16 a[22:23], v23 offset:4096
  s_mul_i32 s60, s28, 3072
  v_mfma_f32_16x16x32_bf16 v[148:151], a[84:87], a[68:71], v[148:151]
  ds_read_b128 a[36:39], v13 offset:9216
  s_add_u32 s60, s60, 20447232
  buffer_load_dwordx4 v8, s[16:19], s12 offen offset:3072  lds
  v_mfma_f32_16x16x32_bf16 v[148:151], a[116:119], a[100:103], v[148:151]
  v_lshlrev_b32 v30, 3, v1
  ds_read_b64_tr_b16 a[52:53], v23 offset:8192
  v_mfma_f32_16x16x32_bf16 v[152:155], a[88:91], a[68:71], v[152:155]
  buffer_load_dwordx2 a[144:145], v30, s[16:19], s60 offen offset:0
  ds_read_b64_tr_b16 a[54:55], v23 offset:12288
  s_add_u32 s12, s12, s31
  v_mfma_f32_16x16x32_bf16 v[152:155], a[120:123], a[100:103], v[152:155]
  buffer_load_dwordx2 a[146:147], v30, s[16:19], s60 offen offset:512
  ds_read_b128 a[8:11], v13 offset:2048
  buffer_load_dwordx2 a[148:149], v30, s[16:19], s60 offen offset:1024
  v_mfma_f32_16x16x32_bf16 v[156:159], a[92:95], a[68:71], v[156:159]
  buffer_load_dwordx2 a[150:151], v30, s[16:19], s60 offen offset:1536
  ds_read_b64_tr_b16 a[24:25], v24 offset:0
  v_mfma_f32_16x16x32_bf16 v[156:159], a[124:127], a[100:103], v[156:159]
  s_add_u32 m0, s27, 32768
  buffer_load_dwordx2 a[152:153], v30, s[16:19], s60 offen offset:2048
  ds_read_b64_tr_b16 a[26:27], v24 offset:4096
  v_mfma_f32_16x16x32_bf16 v[160:163], a[80:83], a[72:75], v[160:163]
  buffer_load_dwordx2 a[154:155], v30, s[16:19], s60 offen offset:2560
  v_mfma_f32_16x16x32_bf16 v[160:163], a[112:115], a[104:107], v[160:163]
  ds_read_b128 a[40:43], v13 offset:10240
  s_mul_i32 s60, s29, 144
  buffer_load_dwordx4 v2, s[96:99], s13 offen offset:0 lds
  v_mfma_f32_16x16x32_bf16 v[164:167], a[84:87], a[72:75], v[164:167]
  ds_read_b64_tr_b16 a[56:57], v24 offset:8192
  s_add_u32 s60, s60, s28
  v_mfma_f32_16x16x32_bf16 v[164:167], a[116:119], a[104:107], v[164:167]
  s_add_u32 s60, s60, 112
  ds_read_b64_tr_b16 a[58:59], v24 offset:12288
  s_lshl_b32 s60, s60, 13
  v_mfma_f32_16x16x32_bf16 v[168:171], a[88:91], a[72:75], v[168:171]
  ds_read_b128 a[12:15], v13 offset:3072
  buffer_load_dwordx4 v3, s[96:99], s13 offen offset:1024 lds
  buffer_load_dwordx4 a[128:131], v8, s[16:19], s60 offen offset:0
  v_mfma_f32_16x16x32_bf16 v[168:171], a[120:123], a[104:107], v[168:171]
  ds_read_b64_tr_b16 a[28:29], v25 offset:0
  buffer_load_dwordx4 a[132:135], v8, s[16:19], s60 offen offset:1024
  v_mfma_f32_16x16x32_bf16 v[172:175], a[92:95], a[72:75], v[172:175]
  buffer_load_dwordx4 a[136:139], v8, s[16:19], s60 offen offset:2048
  ds_read_b64_tr_b16 a[30:31], v25 offset:4096
  buffer_load_dwordx4 v4, s[96:99], s13 offen offset:2048 lds
  v_mfma_f32_16x16x32_bf16 v[172:175], a[124:127], a[104:107], v[172:175]
  buffer_load_dwordx4 a[140:143], v8, s[16:19], s60 offen offset:3072
  ds_read_b128 a[44:47], v13 offset:11264
  v_mfma_f32_16x16x32_bf16 v[176:179], a[80:83], a[76:79], v[176:179]
  s_lshl_b32 s14, s29, 5
  ds_read_b64_tr_b16 a[60:61], v25 offset:8192
  v_mfma_f32_16x16x32_bf16 v[176:179], a[112:115], a[108:111], v[176:179]
  s_add_u32 s14, s14, s28
  buffer_load_dwordx4 v5, s[96:99], s13 offen offset:3072 lds
  s_lshl_b32 s14, s14, 13
  v_mfma_f32_16x16x32_bf16 v[180:183], a[84:87], a[76:79], v[180:183]
  ds_read_b64_tr_b16 a[62:63], v25 offset:12288
  s_add_u32 s14, s14, 28942336
  v_mfma_f32_16x16x32_bf16 v[180:183], a[116:119], a[108:111], v[180:183]
  v_mov_b32 v112, 0x358637bd
  s_add_u32 s13, s13, s32
  v_mfma_f32_16x16x32_bf16 v[184:187], a[88:91], a[76:79], v[184:187]
  v_mov_b32 v113, 0x358637bd
  v_mfma_f32_16x16x32_bf16 v[184:187], a[120:123], a[108:111], v[184:187]
  v_mov_b32 v114, 0x358637bd
  v_mfma_f32_16x16x32_bf16 v[188:191], a[92:95], a[76:79], v[188:191]
  v_mov_b32 v115, 0x358637bd
  v_mfma_f32_16x16x32_bf16 v[188:191], a[124:127], a[108:111], v[188:191]
  s_waitcnt vmcnt(30) lgkmcnt(0)
  s_barrier
  v_mfma_f32_16x16x32_bf16 v[128:131], a[16:19], a[0:3], v[128:131]
  ds_read_b128 a[64:67], v13 offset:32768
  s_add_u32 m0, s15, 65536
  v_mfma_f32_16x16x32_bf16 v[128:131], a[48:51], a[32:35], v[128:131]
  ds_read_b64_tr_b16 a[80:81], v22 offset:32768
  v_mfma_f32_16x16x32_bf16 v[132:135], a[20:23], a[0:3], v[132:135]
  ds_read_b64_tr_b16 a[82:83], v22 offset:36864
  buffer_load_dwordx4 v8, s[16:19], s12 offen offset:0  lds
  v_mfma_f32_16x16x32_bf16 v[132:135], a[52:55], a[32:35], v[132:135]
  ds_read_b128 a[96:99], v13 offset:40960
  v_mfma_f32_16x16x32_bf16 v[136:139], a[24:27], a[0:3], v[136:139]
  ds_read_b64_tr_b16 a[112:113], v22 offset:40960
  v_mfma_f32_16x16x32_bf16 v[136:139], a[56:59], a[32:35], v[136:139]
  buffer_load_dwordx4 v8, s[16:19], s12 offen offset:1024  lds
  ds_read_b64_tr_b16 a[114:115], v22 offset:45056
  v_mfma_f32_16x16x32_bf16 v[140:143], a[28:31], a[0:3], v[140:143]
  ds_read_b128 a[68:71], v13 offset:33792
  v_mfma_f32_16x16x32_bf16 v[140:143], a[60:63], a[32:35], v[140:143]
  ds_read_b64_tr_b16 a[84:85], v23 offset:32768
  buffer_load_dwordx4 v8, s[16:19], s12 offen offset:2048  lds
  v_mfma_f32_16x16x32_bf16 v[144:147], a[16:19], a[4:7], v[144:147]
  v_mfma_f32_16x16x32_bf16 v[144:147], a[48:51], a[36:39], v[144:147]
  ds_read_b64_tr_b16 a[86:87], v23 offset:36864
  v_mfma_f32_16x16x32_bf16 v[148:151], a[20:23], a[4:7], v[148:151]
  ds_read_b128 a[100:103], v13 offset:41984
  buffer_load_dwordx4 v8, s[16:19], s12 offen offset:3072  lds
  v_mfma_f32_16x16x32_bf16 v[148:151], a[52:55], a[36:39], v[148:151]
  ds_read_b64_tr_b16 a[116:117], v23 offset:40960
  v_mfma_f32_16x16x32_bf16 v[152:155], a[24:27], a[4:7], v[152:155]
  ds_read_b64_tr_b16 a[118:119], v23 offset:45056
  s_add_u32 s12, s12, s31
  v_mfma_f32_16x16x32_bf16 v[152:155], a[56:59], a[36:39], v[152:155]
  ds_read_b128 a[72:75], v13 offset:34816
  v_mfma_f32_16x16x32_bf16 v[156:159], a[28:31], a[4:7], v[156:159]
  ds_read_b64_tr_b16 a[88:89], v24 offset:32768
  v_mfma_f32_16x16x32_bf16 v[156:159], a[60:63], a[36:39], v[156:159]
  s_add_u32 m0, s27, 65536
  ds_read_b64_tr_b16 a[90:91], v24 offset:36864
  v_mfma_f32_16x16x32_bf16 v[160:163], a[16:19], a[8:11], v[160:163]
  v_mfma_f32_16x16x32_bf16 v[160:163], a[48:51], a[40:43], v[160:163]
  ds_read_b128 a[104:107], v13 offset:43008
  buffer_load_dwordx4 v2, s[96:99], s13 offen offset:0 lds
  v_mfma_f32_16x16x32_bf16 v[164:167], a[20:23], a[8:11], v[164:167]
  ds_read_b64_tr_b16 a[120:121], v24 offset:40960
  v_mfma_f32_16x16x32_bf16 v[164:167], a[52:55], a[40:43], v[164:167]
  ds_read_b64_tr_b16 a[122:123], v24 offset:45056
  v_mfma_f32_16x16x32_bf16 v[168:171], a[24:27], a[8:11], v[168:171]
  ds_read_b128 a[76:79], v13 offset:35840
  buffer_load_dwordx4 v3, s[96:99], s13 offen offset:1024 lds
  v_mfma_f32_16x16x32_bf16 v[168:171], a[56:59], a[40:43], v[168:171]
  ds_read_b64_tr_b16 a[92:93], v25 offset:32768
  v_mfma_f32_16x16x32_bf16 v[172:175], a[28:31], a[8:11], v[172:175]
  ds_read_b64_tr_b16 a[94:95], v25 offset:36864
  buffer_load_dwordx4 v4, s[96:99], s13 offen offset:2048 lds
  v_mfma_f32_16x16x32_bf16 v[172:175], a[60:63], a[40:43], v[172:175]
  ds_read_b128 a[108:111], v13 offset:44032
  v_mfma_f32_16x16x32_bf16 v[176:179], a[16:19], a[12:15], v[176:179]
  ds_read_b64_tr_b16 a[124:125], v25 offset:40960
  v_mfma_f32_16x16x32_bf16 v[176:179], a[48:51], a[44:47], v[176:179]
  buffer_load_dwordx4 v5, s[96:99], s13 offen offset:3072 lds
  v_mfma_f32_16x16x32_bf16 v[180:183], a[20:23], a[12:15], v[180:183]
  ds_read_b64_tr_b16 a[126:127], v25 offset:45056
  v_mfma_f32_16x16x32_bf16 v[180:183], a[52:55], a[44:47], v[180:183]
  s_add_u32 s13, s13, s32
  v_mfma_f32_16x16x32_bf16 v[184:187], a[24:27], a[12:15], v[184:187]
  v_mfma_f32_16x16x32_bf16 v[184:187], a[56:59], a[44:47], v[184:187]
  v_mfma_f32_16x16x32_bf16 v[188:191], a[28:31], a[12:15], v[188:191]
  v_mfma_f32_16x16x32_bf16 v[188:191], a[60:63], a[44:47], v[188:191]
  s_waitcnt vmcnt(30) lgkmcnt(0)
  s_barrier
  s_waitcnt vmcnt(9)
  v_mfma_f32_16x16x32_bf16 v[56:59], a[152:155], a[128:131], v[112:115]
  ds_read_b128 a[0:3], v12 offset:0
  s_add_u32 m0, s15, 98304
  v_mfma_f32_16x16x32_bf16 v[48:51], a[144:147], a[128:131], 0
  ds_read_b64_tr_b16 a[16:17], v18 offset:0
  v_mfma_f32_16x16x32_bf16 v[52:55], a[148:151], a[128:131], 0
  v_mfma_f32_16x16x32_bf16 v[68:71], a[152:155], a[132:135], v[112:115]
  ds_read_b64_tr_b16 a[18:19], v18 offset:4096
  buffer_load_dwordx4 v8, s[16:19], s12 offen offset:0  lds
  v_mfma_f32_16x16x32_bf16 v[60:63], a[144:147], a[132:135], 0
  ds_read_b128 a[32:35], v12 offset:8192
  v_mfma_f32_16x16x32_bf16 v[64:67], a[148:151], a[132:135], 0
  v_mfma_f32_16x16x32_bf16 v[80:83], a[152:155], a[136:139], v[112:115]
  ds_read_b64_tr_b16 a[48:49], v18 offset:8192
  v_mfma_f32_16x16x32_bf16 v[72:75], a[144:147], a[136:139], 0
  buffer_load_dwordx4 v8, s[16:19], s12 offen offset:1024  lds
  ds_read_b64_tr_b16 a[50:51], v18 offset:12288
  v_mfma_f32_16x16x32_bf16 v[76:79], a[148:151], a[136:139], 0
  v_mfma_f32_16x16x32_bf16 v[92:95], a[152:155], a[140:143], v[112:115]
  ds_read_b128 a[4:7], v12 offset:1024
  v_mfma_f32_16x16x32_bf16 v[84:87], a[144:147], a[140:143], 0
  buffer_load_dwordx4 v8, s[16:19], s12 offen offset:2048  lds
  ds_read_b64_tr_b16 a[20:21], v19 offset:0
  v_mfma_f32_16x16x32_bf16 v[88:91], a[148:151], a[140:143], 0
  v_mfma_f32_16x16x32_bf16 v[128:131], a[80:83], a[64:67], v[128:131]
  ds_read_b64_tr_b16 a[22:23], v19 offset:4096
  v_mfma_f32_16x16x32_bf16 v[128:131], a[112:115], a[96:99], v[128:131]
  v_mfma_f32_16x16x32_bf16 v[132:135], a[84:87], a[64:67], v[132:135]
  ds_read_b128 a[36:39], v12 offset:9216
  buffer_load_dwordx4 v8, s[16:19], s12 offen offset:3072  lds
  v_mfma_f32_16x16x32_bf16 v[132:135], a[116:119], a[96:99], v[132:135]
  ds_read_b64_tr_b16 a[52:53], v19 offset:8192
  v_mfma_f32_16x16x32_bf16 v[136:139], a[88:91], a[64:67], v[136:139]
  v_mfma_f32_16x16x32_bf16 v[136:139], a[120:123], a[96:99], v[136:139]
  ds_read_b64_tr_b16 a[54:55], v19 offset:12288
  s_add_u32 s12, s12, s31
  v_mfma_f32_16x16x32_bf16 v[140:143], a[92:95], a[64:67], v[140:143]
  ds_read_b128 a[8:11], v12 offset:2048
  v_mfma_f32_16x16x32_bf16 v[140:143], a[124:127], a[96:99], v[140:143]
  v_mfma_f32_16x16x32_bf16 v[144:147], a[80:83], a[68:71], v[144:147]
  ds_read_b64_tr_b16 a[24:25], v20 offset:0
  v_mfma_f32_16x16x32_bf16 v[144:147], a[112:115], a[100:103], v[144:147]
  s_add_u32 m0, s27, 98304
  ds_read_b64_tr_b16 a[26:27], v20 offset:4096
  v_mfma_f32_16x16x32_bf16 v[148:151], a[84:87], a[68:71], v[148:151]
  v_mfma_f32_16x16x32_bf16 v[148:151], a[116:119], a[100:103], v[148:151]
  ds_read_b128 a[40:43], v12 offset:10240
  v_mfma_f32_16x16x32_bf16 v[152:155], a[88:91], a[68:71], v[152:155]
  buffer_load_dwordx4 v2, s[96:99], s13 offen offset:0 lds
  ds_read_b64_tr_b16 a[56:57], v20 offset:8192
  v_mfma_f32_16x16x32_bf16 v[152:155], a[120:123], a[100:103], v[152:155]
  v_mfma_f32_16x16x32_bf16 v[156:159], a[92:95], a[68:71], v[156:159]
  ds_read_b64_tr_b16 a[58:59], v20 offset:12288
  v_mfma_f32_16x16x32_bf16 v[156:159], a[124:127], a[100:103], v[156:159]
  v_mfma_f32_16x16x32_bf16 v[160:163], a[80:83], a[72:75], v[160:163]
  buffer_load_dwordx4 v3, s[96:99], s13 offen offset:1024 lds
  ds_read_b128 a[12:15], v12 offset:3072
  v_mfma_f32_16x16x32_bf16 v[160:163], a[112:115], a[104:107], v[160:163]
  ds_read_b64_tr_b16 a[28:29], v21 offset:0
  v_mfma_f32_16x16x32_bf16 v[164:167], a[84:87], a[72:75], v[164:167]
  v_mfma_f32_16x16x32_bf16 v[164:167], a[116:119], a[104:107], v[164:167]
  ds_read_b64_tr_b16 a[30:31], v21 offset:4096
  buffer_load_dwordx4 v4, s[96:99], s13 offen offset:2048 lds
  v_mfma_f32_16x16x32_bf16 v[168:171], a[88:91], a[72:75], v[168:171]
  ds_read_b128 a[44:47], v12 offset:11264
  v_mfma_f32_16x16x32_bf16 v[168:171], a[120:123], a[104:107], v[168:171]
  v_mfma_f32_16x16x32_bf16 v[172:175], a[92:95], a[72:75], v[172:175]
  ds_read_b64_tr_b16 a[60:61], v21 offset:8192
  buffer_load_dwordx4 v5, s[96:99], s13 offen offset:3072 lds
  v_mfma_f32_16x16x32_bf16 v[172:175], a[124:127], a[104:107], v[172:175]
  ds_read_b64_tr_b16 a[62:63], v21 offset:12288
  v_mfma_f32_16x16x32_bf16 v[176:179], a[80:83], a[76:79], v[176:179]
  v_mfma_f32_16x16x32_bf16 v[176:179], a[112:115], a[108:111], v[176:179]
  v_mfma_f32_16x16x32_bf16 v[180:183], a[84:87], a[76:79], v[180:183]
  s_add_u32 s13, s13, s32
  v_mfma_f32_16x16x32_bf16 v[180:183], a[116:119], a[108:111], v[180:183]
  v_mfma_f32_16x16x32_bf16 v[184:187], a[88:91], a[76:79], v[184:187]
  v_mfma_f32_16x16x32_bf16 v[184:187], a[120:123], a[108:111], v[184:187]
  v_mfma_f32_16x16x32_bf16 v[188:191], a[92:95], a[76:79], v[188:191]
  v_mfma_f32_16x16x32_bf16 v[188:191], a[124:127], a[108:111], v[188:191]
  s_waitcnt vmcnt(16) lgkmcnt(0)
  s_barrier
  v_mfma_f32_16x16x32_bf16 v[128:131], a[16:19], a[0:3], v[128:131]
  ds_read_b128 a[64:67], v12 offset:32768
  s_add_u32 m0, s15, 0
  v_mfma_f32_16x16x32_bf16 v[128:131], a[48:51], a[32:35], v[128:131]
  v_rcp_f32 v116, v56
  ds_read_b64_tr_b16 a[80:81], v18 offset:32768
  v_rcp_f32 v117, v68
  v_mfma_f32_16x16x32_bf16 v[132:135], a[20:23], a[0:3], v[132:135]
  v_rcp_f32 v118, v80
  ds_read_b64_tr_b16 a[82:83], v18 offset:36864
  v_rcp_f32 v119, v92
  buffer_load_dwordx4 v8, s[16:19], s12 offen offset:0  lds
  v_mfma_f32_16x16x32_bf16 v[132:135], a[52:55], a[32:35], v[132:135]
  s_nop 0
  ds_read_b128 a[96:99], v12 offset:40960
  v_mul_f32 v48, v116, v48
  v_mfma_f32_16x16x32_bf16 v[136:139], a[24:27], a[0:3], v[136:139]
  v_mul_f32 v49, v116, v49
  ds_read_b64_tr_b16 a[112:113], v18 offset:40960
  v_mul_f32 v50, v116, v50
  v_mfma_f32_16x16x32_bf16 v[136:139], a[56:59], a[32:35], v[136:139]
  v_mul_f32 v51, v116, v51
  buffer_load_dwordx4 v8, s[16:19], s12 offen offset:1024  lds
  ds_read_b64_tr_b16 a[114:115], v18 offset:45056
  v_mul_f32 v52, v116, v52
  v_mfma_f32_16x16x32_bf16 v[140:143], a[28:31], a[0:3], v[140:143]
  v_mul_f32 v53, v116, v53
  v_mul_f32 v54, v116, v54
  ds_read_b128 a[68:71], v12 offset:33792
  v_mfma_f32_16x16x32_bf16 v[140:143], a[60:63], a[32:35], v[140:143]
  v_mul_f32 v55, v116, v55
  v_cvt_pk_bf16_f32 v96, v48, v49
  ds_read_b64_tr_b16 a[84:85], v19 offset:32768
  buffer_load_dwordx4 v8, s[16:19], s12 offen offset:2048  lds
  v_mfma_f32_16x16x32_bf16 v[144:147], a[16:19], a[4:7], v[144:147]
  v_cvt_pk_bf16_f32 v97, v50, v51
  v_cvt_pk_bf16_f32 v98, v52, v53
  v_mfma_f32_16x16x32_bf16 v[144:147], a[48:51], a[36:39], v[144:147]
  ds_read_b64_tr_b16 a[86:87], v19 offset:36864
  v_cvt_pk_bf16_f32 v99, v54, v55
  buffer_store_dwordx4 v[96:99], v8, s[16:19], s14 offen offset:0 sc1
  v_mfma_f32_16x16x32_bf16 v[148:151], a[20:23], a[4:7], v[148:151]
  ds_read_b128 a[100:103], v12 offset:41984
  buffer_load_dwordx4 v8, s[16:19], s12 offen offset:3072  lds
  v_mul_f32 v60, v117, v60
  v_mfma_f32_16x16x32_bf16 v[148:151], a[52:55], a[36:39], v[148:151]
  v_mul_f32 v61, v117, v61
  ds_read_b64_tr_b16 a[116:117], v19 offset:40960
  v_mul_f32 v62, v117, v62
  v_mfma_f32_16x16x32_bf16 v[152:155], a[24:27], a[4:7], v[152:155]
  v_mul_f32 v63, v117, v63
  ds_read_b64_tr_b16 a[118:119], v19 offset:45056
  v_mul_f32 v64, v117, v64
  s_add_u32 s12, s12, s31
  v_mfma_f32_16x16x32_bf16 v[152:155], a[56:59], a[36:39], v[152:155]
  v_mul_f32 v65, v117, v65
  ds_read_b128 a[72:75], v12 offset:34816
  v_mul_f32 v66, v117, v66
  v_mfma_f32_16x16x32_bf16 v[156:159], a[28:31], a[4:7], v[156:159]
  v_mul_f32 v67, v117, v67
  v_cvt_pk_bf16_f32 v100, v60, v61
  ds_read_b64_tr_b16 a[88:89], v20 offset:32768
  v_mfma_f32_16x16x32_bf16 v[156:159], a[60:63], a[36:39], v[156:159]
  v_cvt_pk_bf16_f32 v101, v62, v63
  s_add_u32 m0, s27, 0
  v_cvt_pk_bf16_f32 v102, v64, v65
  ds_read_b64_tr_b16 a[90:91], v20 offset:36864
  v_mfma_f32_16x16x32_bf16 v[160:163], a[16:19], a[8:11], v[160:163]
  v_cvt_pk_bf16_f32 v103, v66, v67
  buffer_store_dwordx4 v[100:103], v8, s[16:19], s14 offen offset:1024 sc1
  v_mfma_f32_16x16x32_bf16 v[160:163], a[48:51], a[40:43], v[160:163]
  ds_read_b128 a[104:107], v12 offset:43008
  v_mul_f32 v72, v118, v72
  v_mul_f32 v73, v118, v73
  buffer_load_dwordx4 v2, s[96:99], s13 offen offset:0 lds
  v_mfma_f32_16x16x32_bf16 v[164:167], a[20:23], a[8:11], v[164:167]
  ds_read_b64_tr_b16 a[120:121], v20 offset:40960
  v_mul_f32 v74, v118, v74
  v_mul_f32 v75, v118, v75
  v_mfma_f32_16x16x32_bf16 v[164:167], a[52:55], a[40:43], v[164:167]
  ds_read_b64_tr_b16 a[122:123], v20 offset:45056
  v_mul_f32 v76, v118, v76
  v_mul_f32 v77, v118, v77
  v_mfma_f32_16x16x32_bf16 v[168:171], a[24:27], a[8:11], v[168:171]
  ds_read_b128 a[76:79], v12 offset:35840
  buffer_load_dwordx4 v3, s[96:99], s13 offen offset:1024 lds
  v_mul_f32 v78, v118, v78
  v_mfma_f32_16x16x32_bf16 v[168:171], a[56:59], a[40:43], v[168:171]
  v_mul_f32 v79, v118, v79
  ds_read_b64_tr_b16 a[92:93], v21 offset:32768
  v_cvt_pk_bf16_f32 v104, v72, v73
  v_mfma_f32_16x16x32_bf16 v[172:175], a[28:31], a[8:11], v[172:175]
  v_cvt_pk_bf16_f32 v105, v74, v75
  v_cvt_pk_bf16_f32 v106, v76, v77
  ds_read_b64_tr_b16 a[94:95], v21 offset:36864
  buffer_load_dwordx4 v4, s[96:99], s13 offen offset:2048 lds
  v_mfma_f32_16x16x32_bf16 v[172:175], a[60:63], a[40:43], v[172:175]
  v_cvt_pk_bf16_f32 v107, v78, v79
  buffer_store_dwordx4 v[104:107], v8, s[16:19], s14 offen offset:2048 sc1
  ds_read_b128 a[108:111], v12 offset:44032
  v_mfma_f32_16x16x32_bf16 v[176:179], a[16:19], a[12:15], v[176:179]
  v_mul_f32 v84, v119, v84
  v_mul_f32 v85, v119, v85
  ds_read_b64_tr_b16 a[124:125], v21 offset:40960
  v_mfma_f32_16x16x32_bf16 v[176:179], a[48:51], a[44:47], v[176:179]
  v_mul_f32 v86, v119, v86
  buffer_load_dwordx4 v5, s[96:99], s13 offen offset:3072 lds
  v_mul_f32 v87, v119, v87
  v_mfma_f32_16x16x32_bf16 v[180:183], a[20:23], a[12:15], v[180:183]
  ds_read_b64_tr_b16 a[126:127], v21 offset:45056
  v_mul_f32 v88, v119, v88
  v_mul_f32 v89, v119, v89
  v_mfma_f32_16x16x32_bf16 v[180:183], a[52:55], a[44:47], v[180:183]
  v_mul_f32 v90, v119, v90
  v_mul_f32 v91, v119, v91
  s_add_u32 s13, s13, s32
  v_mfma_f32_16x16x32_bf16 v[184:187], a[24:27], a[12:15], v[184:187]
  v_cvt_pk_bf16_f32 v108, v84, v85
  v_cvt_pk_bf16_f32 v109, v86, v87
  v_mfma_f32_16x16x32_bf16 v[184:187], a[56:59], a[44:47], v[184:187]
  v_cvt_pk_bf16_f32 v110, v88, v89
  v_cvt_pk_bf16_f32 v111, v90, v91
  v_mfma_f32_16x16x32_bf16 v[188:191], a[28:31], a[12:15], v[188:191]
  buffer_store_dwordx4 v[108:111], v8, s[16:19], s14 offen offset:3072 sc1
  v_mfma_f32_16x16x32_bf16 v[188:191], a[60:63], a[44:47], v[188:191]
  s_waitcnt vmcnt(20) lgkmcnt(0)
  s_barrier
  v_mfma_f32_16x16x32_bf16 v[128:131], a[80:83], a[64:67], v[128:131]
  ds_read_b128 a[0:3], v13 offset:0
  s_add_u32 m0, s15, 32768
  v_mfma_f32_16x16x32_bf16 v[128:131], a[112:115], a[96:99], v[128:131]
  ds_read_b64_tr_b16 a[16:17], v22 offset:0
  v_mfma_f32_16x16x32_bf16 v[132:135], a[84:87], a[64:67], v[132:135]
  ds_read_b64_tr_b16 a[18:19], v22 offset:4096
  buffer_load_dwordx4 v8, s[16:19], s12 offen offset:0  lds
  v_mfma_f32_16x16x32_bf16 v[132:135], a[116:119], a[96:99], v[132:135]
  ds_read_b128 a[32:35], v13 offset:8192
  v_mfma_f32_16x16x32_bf16 v[136:139], a[88:91], a[64:67], v[136:139]
  ds_read_b64_tr_b16 a[48:49], v22 offset:8192
  v_mfma_f32_16x16x32_bf16 v[136:139], a[120:123], a[96:99], v[136:139]
  buffer_load_dwordx4 v8, s[16:19], s12 offen offset:1024  lds
  ds_read_b64_tr_b16 a[50:51], v22 offset:12288
  v_mfma_f32_16x16x32_bf16 v[140:143], a[92:95], a[64:67], v[140:143]
  ds_read_b128 a[4:7], v13 offset:1024
  v_mfma_f32_16x16x32_bf16 v[140:143], a[124:127], a[96:99], v[140:143]
  ds_read_b64_tr_b16 a[20:21], v23 offset:0
  buffer_load_dwordx4 v8, s[16:19], s12 offen offset:2048  lds
  v_mfma_f32_16x16x32_bf16 v[144:147], a[80:83], a[68:71], v[144:147]
  v_mfma_f32_16x16x32_bf16 v[144:147], a[112:115], a[100:103], v[144:147]
  ds_read_b64_tr_b16 a[22:23], v23 offset:4096
  v_mfma_f32_16x16x32_bf16 v[148:151], a[84:87], a[68:71], v[148:151]
  ds_read_b128 a[36:39], v13 offset:9216
  buffer_load_dwordx4 v8, s[16:19], s12 offen offset:3072  lds
  v_mfma_f32_16x16x32_bf16 v[148:151], a[116:119], a[100:103], v[148:151]
  ds_read_b64_tr_b16 a[52:53], v23 offset:8192
  v_mfma_f32_16x16x32_bf16 v[152:155], a[88:91], a[68:71], v[152:155]
  ds_read_b64_tr_b16 a[54:55], v23 offset:12288
  s_add_u32 s12, s12, s31
  v_mfma_f32_16x16x32_bf16 v[152:155], a[120:123], a[100:103], v[152:155]
  ds_read_b128 a[8:11], v13 offset:2048
  v_mfma_f32_16x16x32_bf16 v[156:159], a[92:95], a[68:71], v[156:159]
  ds_read_b64_tr_b16 a[24:25], v24 offset:0
  v_mfma_f32_16x16x32_bf16 v[156:159], a[124:127], a[100:103], v[156:159]
  s_add_u32 m0, s27, 32768
  ds_read_b64_tr_b16 a[26:27], v24 offset:4096
  v_mfma_f32_16x16x32_bf16 v[160:163], a[80:83], a[72:75], v[160:163]
  v_mfma_f32_16x16x32_bf16 v[160:163], a[112:115], a[104:107], v[160:163]
  ds_read_b128 a[40:43], v13 offset:10240
  buffer_load_dwordx4 v2, s[96:99], s13 offen offset:0 lds
  v_mfma_f32_16x16x32_bf16 v[164:167], a[84:87], a[72:75], v[164:167]
  ds_read_b64_tr_b16 a[56:57], v24 offset:8192
  v_mfma_f32_16x16x32_bf16 v[164:167], a[116:119], a[104:107], v[164:167]
  ds_read_b64_tr_b16 a[58:59], v24 offset:12288
  v_mfma_f32_16x16x32_bf16 v[168:171], a[88:91], a[72:75], v[168:171]
  ds_read_b128 a[12:15], v13 offset:3072
  buffer_load_dwordx4 v3, s[96:99], s13 offen offset:1024 lds
  v_mfma_f32_16x16x32_bf16 v[168:171], a[120:123], a[104:107], v[168:171]
  ds_read_b64_tr_b16 a[28:29], v25 offset:0
  v_mfma_f32_16x16x32_bf16 v[172:175], a[92:95], a[72:75], v[172:175]
  ds_read_b64_tr_b16 a[30:31], v25 offset:4096
  buffer_load_dwordx4 v4, s[96:99], s13 offen offset:2048 lds
  v_mfma_f32_16x16x32_bf16 v[172:175], a[124:127], a[104:107], v[172:175]
  ds_read_b128 a[44:47], v13 offset:11264
  v_mfma_f32_16x16x32_bf16 v[176:179], a[80:83], a[76:79], v[176:179]
  ds_read_b64_tr_b16 a[60:61], v25 offset:8192
  v_mfma_f32_16x16x32_bf16 v[176:179], a[112:115], a[108:111], v[176:179]
  buffer_load_dwordx4 v5, s[96:99], s13 offen offset:3072 lds
  v_mfma_f32_16x16x32_bf16 v[180:183], a[84:87], a[76:79], v[180:183]
  ds_read_b64_tr_b16 a[62:63], v25 offset:12288
  v_mfma_f32_16x16x32_bf16 v[180:183], a[116:119], a[108:111], v[180:183]
  s_add_u32 s13, s13, s32
  v_mfma_f32_16x16x32_bf16 v[184:187], a[88:91], a[76:79], v[184:187]
  v_mfma_f32_16x16x32_bf16 v[184:187], a[120:123], a[108:111], v[184:187]
  v_mfma_f32_16x16x32_bf16 v[188:191], a[92:95], a[76:79], v[188:191]
  v_mfma_f32_16x16x32_bf16 v[188:191], a[124:127], a[108:111], v[188:191]
  s_waitcnt vmcnt(20) lgkmcnt(0)
  s_barrier
  v_mfma_f32_16x16x32_bf16 v[128:131], a[16:19], a[0:3], v[128:131]
  ds_read_b128 a[64:67], v13 offset:32768
  s_add_u32 m0, s15, 65536
  v_mfma_f32_16x16x32_bf16 v[128:131], a[48:51], a[32:35], v[128:131]
  ds_read_b64_tr_b16 a[80:81], v22 offset:32768
  v_mfma_f32_16x16x32_bf16 v[132:135], a[20:23], a[0:3], v[132:135]
  ds_read_b64_tr_b16 a[82:83], v22 offset:36864
  buffer_load_dwordx4 v8, s[16:19], s12 offen offset:0  lds
  v_mfma_f32_16x16x32_bf16 v[132:135], a[52:55], a[32:35], v[132:135]
  ds_read_b128 a[96:99], v13 offset:40960
  v_mfma_f32_16x16x32_bf16 v[136:139], a[24:27], a[0:3], v[136:139]
  ds_read_b64_tr_b16 a[112:113], v22 offset:40960
  v_mfma_f32_16x16x32_bf16 v[136:139], a[56:59], a[32:35], v[136:139]
  buffer_load_dwordx4 v8, s[16:19], s12 offen offset:1024  lds
  ds_read_b64_tr_b16 a[114:115], v22 offset:45056
  v_mfma_f32_16x16x32_bf16 v[140:143], a[28:31], a[0:3], v[140:143]
  ds_read_b128 a[68:71], v13 offset:33792
  v_mfma_f32_16x16x32_bf16 v[140:143], a[60:63], a[32:35], v[140:143]
  ds_read_b64_tr_b16 a[84:85], v23 offset:32768
  buffer_load_dwordx4 v8, s[16:19], s12 offen offset:2048  lds
  v_mfma_f32_16x16x32_bf16 v[144:147], a[16:19], a[4:7], v[144:147]
  v_mfma_f32_16x16x32_bf16 v[144:147], a[48:51], a[36:39], v[144:147]
  ds_read_b64_tr_b16 a[86:87], v23 offset:36864
  v_mfma_f32_16x16x32_bf16 v[148:151], a[20:23], a[4:7], v[148:151]
  ds_read_b128 a[100:103], v13 offset:41984
  buffer_load_dwordx4 v8, s[16:19], s12 offen offset:3072  lds
  v_mfma_f32_16x16x32_bf16 v[148:151], a[52:55], a[36:39], v[148:151]
  ds_read_b64_tr_b16 a[116:117], v23 offset:40960
  v_mfma_f32_16x16x32_bf16 v[152:155], a[24:27], a[4:7], v[152:155]
  ds_read_b64_tr_b16 a[118:119], v23 offset:45056
  s_add_u32 s12, s12, s31
  v_mfma_f32_16x16x32_bf16 v[152:155], a[56:59], a[36:39], v[152:155]
  ds_read_b128 a[72:75], v13 offset:34816
  v_mfma_f32_16x16x32_bf16 v[156:159], a[28:31], a[4:7], v[156:159]
  ds_read_b64_tr_b16 a[88:89], v24 offset:32768
  v_mfma_f32_16x16x32_bf16 v[156:159], a[60:63], a[36:39], v[156:159]
  s_add_u32 m0, s27, 65536
  ds_read_b64_tr_b16 a[90:91], v24 offset:36864
  v_mfma_f32_16x16x32_bf16 v[160:163], a[16:19], a[8:11], v[160:163]
  v_mfma_f32_16x16x32_bf16 v[160:163], a[48:51], a[40:43], v[160:163]
  ds_read_b128 a[104:107], v13 offset:43008
  buffer_load_dwordx4 v2, s[96:99], s13 offen offset:0 lds
  v_mfma_f32_16x16x32_bf16 v[164:167], a[20:23], a[8:11], v[164:167]
  ds_read_b64_tr_b16 a[120:121], v24 offset:40960
  v_mfma_f32_16x16x32_bf16 v[164:167], a[52:55], a[40:43], v[164:167]
  ds_read_b64_tr_b16 a[122:123], v24 offset:45056
  v_mfma_f32_16x16x32_bf16 v[168:171], a[24:27], a[8:11], v[168:171]
  ds_read_b128 a[76:79], v13 offset:35840
  buffer_load_dwordx4 v3, s[96:99], s13 offen offset:1024 lds
  v_mfma_f32_16x16x32_bf16 v[168:171], a[56:59], a[40:43], v[168:171]
  ds_read_b64_tr_b16 a[92:93], v25 offset:32768
  v_mfma_f32_16x16x32_bf16 v[172:175], a[28:31], a[8:11], v[172:175]
  ds_read_b64_tr_b16 a[94:95], v25 offset:36864
  buffer_load_dwordx4 v4, s[96:99], s13 offen offset:2048 lds
  v_mfma_f32_16x16x32_bf16 v[172:175], a[60:63], a[40:43], v[172:175]
  ds_read_b128 a[108:111], v13 offset:44032
  v_mfma_f32_16x16x32_bf16 v[176:179], a[16:19], a[12:15], v[176:179]
  ds_read_b64_tr_b16 a[124:125], v25 offset:40960
  v_mfma_f32_16x16x32_bf16 v[176:179], a[48:51], a[44:47], v[176:179]
  buffer_load_dwordx4 v5, s[96:99], s13 offen offset:3072 lds
  v_mfma_f32_16x16x32_bf16 v[180:183], a[20:23], a[12:15], v[180:183]
  ds_read_b64_tr_b16 a[126:127], v25 offset:45056
  v_mfma_f32_16x16x32_bf16 v[180:183], a[52:55], a[44:47], v[180:183]
  s_add_u32 s13, s13, s32
  v_mfma_f32_16x16x32_bf16 v[184:187], a[24:27], a[12:15], v[184:187]
  v_mfma_f32_16x16x32_bf16 v[184:187], a[56:59], a[44:47], v[184:187]
  v_mfma_f32_16x16x32_bf16 v[188:191], a[28:31], a[12:15], v[188:191]
  v_mfma_f32_16x16x32_bf16 v[188:191], a[60:63], a[44:47], v[188:191]
  s_waitcnt vmcnt(17) lgkmcnt(0)
  s_barrier
  s_waitcnt vmcnt(16)
  v_mfma_f32_16x16x32_bf16 v[128:131], a[80:83], a[64:67], v[128:131]
  ds_read_b128 a[0:3], v12 offset:0
  s_add_u32 m0, s15, 98304
  v_mfma_f32_16x16x32_bf16 v[128:131], a[112:115], a[96:99], v[128:131]
  s_mov_b64 exec, 4
  buffer_store_dwordx2 v[14:15], v0, s[16:19], 0 offen sc1
  s_mov_b64 exec, -1
  ds_read_b64_tr_b16 a[16:17], v18 offset:0
  v_mfma_f32_16x16x32_bf16 v[132:135], a[84:87], a[64:67], v[132:135]
  ds_read_b64_tr_b16 a[18:19], v18 offset:4096
  buffer_load_dwordx4 v8, s[16:19], s12 offen offset:0  lds
  v_mfma_f32_16x16x32_bf16 v[132:135], a[116:119], a[96:99], v[132:135]
  ds_read_b128 a[32:35], v12 offset:8192
  v_mfma_f32_16x16x32_bf16 v[136:139], a[88:91], a[64:67], v[136:139]
  ds_read_b64_tr_b16 a[48:49], v18 offset:8192
  v_mfma_f32_16x16x32_bf16 v[136:139], a[120:123], a[96:99], v[136:139]
  buffer_load_dwordx4 v8, s[16:19], s12 offen offset:1024  lds
  ds_read_b64_tr_b16 a[50:51], v18 offset:12288
  v_mfma_f32_16x16x32_bf16 v[140:143], a[92:95], a[64:67], v[140:143]
  ds_read_b128 a[4:7], v12 offset:1024
  v_mfma_f32_16x16x32_bf16 v[140:143], a[124:127], a[96:99], v[140:143]
  ds_read_b64_tr_b16 a[20:21], v19 offset:0
  buffer_load_dwordx4 v8, s[16:19], s12 offen offset:2048  lds
  v_mfma_f32_16x16x32_bf16 v[144:147], a[80:83], a[68:71], v[144:147]
  v_mfma_f32_16x16x32_bf16 v[144:147], a[112:115], a[100:103], v[144:147]
  ds_read_b64_tr_b16 a[22:23], v19 offset:4096
  v_mfma_f32_16x16x32_bf16 v[148:151], a[84:87], a[68:71], v[148:151]
  ds_read_b128 a[36:39], v12 offset:9216
  buffer_load_dwordx4 v8, s[16:19], s12 offen offset:3072  lds
  v_mfma_f32_16x16x32_bf16 v[148:151], a[116:119], a[100:103], v[148:151]
  ds_read_b64_tr_b16 a[52:53], v19 offset:8192
  v_mfma_f32_16x16x32_bf16 v[152:155], a[88:91], a[68:71], v[152:155]
  ds_read_b64_tr_b16 a[54:55], v19 offset:12288
  s_add_u32 s12, s12, s31
  v_mfma_f32_16x16x32_bf16 v[152:155], a[120:123], a[100:103], v[152:155]
  ds_read_b128 a[8:11], v12 offset:2048
  v_mfma_f32_16x16x32_bf16 v[156:159], a[92:95], a[68:71], v[156:159]
  ds_read_b64_tr_b16 a[24:25], v20 offset:0
  v_mfma_f32_16x16x32_bf16 v[156:159], a[124:127], a[100:103], v[156:159]
  s_add_u32 m0, s27, 98304
  ds_read_b64_tr_b16 a[26:27], v20 offset:4096
  v_mfma_f32_16x16x32_bf16 v[160:163], a[80:83], a[72:75], v[160:163]
  v_mfma_f32_16x16x32_bf16 v[160:163], a[112:115], a[104:107], v[160:163]
  ds_read_b128 a[40:43], v12 offset:10240
  buffer_load_dwordx4 v2, s[96:99], s13 offen offset:0 lds
  v_mfma_f32_16x16x32_bf16 v[164:167], a[84:87], a[72:75], v[164:167]
  ds_read_b64_tr_b16 a[56:57], v20 offset:8192
  v_mfma_f32_16x16x32_bf16 v[164:167], a[116:119], a[104:107], v[164:167]
  ds_read_b64_tr_b16 a[58:59], v20 offset:12288
  v_mfma_f32_16x16x32_bf16 v[168:171], a[88:91], a[72:75], v[168:171]
  ds_read_b128 a[12:15], v12 offset:3072
  buffer_load_dwordx4 v3, s[96:99], s13 offen offset:1024 lds
  v_mfma_f32_16x16x32_bf16 v[168:171], a[120:123], a[104:107], v[168:171]
  ds_read_b64_tr_b16 a[28:29], v21 offset:0
  v_mfma_f32_16x16x32_bf16 v[172:175], a[92:95], a[72:75], v[172:175]
  ds_read_b64_tr_b16 a[30:31], v21 offset:4096
  buffer_load_dwordx4 v4, s[96:99], s13 offen offset:2048 lds
  v_mfma_f32_16x16x32_bf16 v[172:175], a[124:127], a[104:107], v[172:175]
  ds_read_b128 a[44:47], v12 offset:11264
  v_mfma_f32_16x16x32_bf16 v[176:179], a[80:83], a[76:79], v[176:179]
  ds_read_b64_tr_b16 a[60:61], v21 offset:8192
  v_mfma_f32_16x16x32_bf16 v[176:179], a[112:115], a[108:111], v[176:179]
  buffer_load_dwordx4 v5, s[96:99], s13 offen offset:3072 lds
  v_mfma_f32_16x16x32_bf16 v[180:183], a[84:87], a[76:79], v[180:183]
  ds_read_b64_tr_b16 a[62:63], v21 offset:12288
  v_mfma_f32_16x16x32_bf16 v[180:183], a[116:119], a[108:111], v[180:183]
  s_add_u32 s13, s13, s32
  v_mfma_f32_16x16x32_bf16 v[184:187], a[88:91], a[76:79], v[184:187]
  v_mfma_f32_16x16x32_bf16 v[184:187], a[120:123], a[108:111], v[184:187]
  v_mfma_f32_16x16x32_bf16 v[188:191], a[92:95], a[76:79], v[188:191]
  v_mfma_f32_16x16x32_bf16 v[188:191], a[124:127], a[108:111], v[188:191]
  s_waitcnt vmcnt(17) lgkmcnt(0)
  s_barrier
  v_mfma_f32_16x16x32_bf16 v[128:131], a[16:19], a[0:3], v[128:131]
  ds_read_b128 a[64:67], v12 offset:32768
  s_add_u32 m0, s15, 0
  v_mfma_f32_16x16x32_bf16 v[128:131], a[48:51], a[32:35], v[128:131]
  ds_read_b64_tr_b16 a[80:81], v18 offset:32768
  v_mfma_f32_16x16x32_bf16 v[132:135], a[20:23], a[0:3], v[132:135]
  ds_read_b64_tr_b16 a[82:83], v18 offset:36864
  buffer_load_dwordx4 v8, s[16:19], s12 offen offset:0  lds
  v_mfma_f32_16x16x32_bf16 v[132:135], a[52:55], a[32:35], v[132:135]
  ds_read_b128 a[96:99], v12 offset:40960
  v_mfma_f32_16x16x32_bf16 v[136:139], a[24:27], a[0:3], v[136:139]
  ds_read_b64_tr_b16 a[112:113], v18 offset:40960
  v_mfma_f32_16x16x32_bf16 v[136:139], a[56:59], a[32:35], v[136:139]
  buffer_load_dwordx4 v8, s[16:19], s12 offen offset:1024  lds
  ds_read_b64_tr_b16 a[114:115], v18 offset:45056
  v_mfma_f32_16x16x32_bf16 v[140:143], a[28:31], a[0:3], v[140:143]
  ds_read_b128 a[68:71], v12 offset:33792
  v_mfma_f32_16x16x32_bf16 v[140:143], a[60:63], a[32:35], v[140:143]
  ds_read_b64_tr_b16 a[84:85], v19 offset:32768
  buffer_load_dwordx4 v8, s[16:19], s12 offen offset:2048  lds
  v_mfma_f32_16x16x32_bf16 v[144:147], a[16:19], a[4:7], v[144:147]
  v_mfma_f32_16x16x32_bf16 v[144:147], a[48:51], a[36:39], v[144:147]
  ds_read_b64_tr_b16 a[86:87], v19 offset:36864
  v_mfma_f32_16x16x32_bf16 v[148:151], a[20:23], a[4:7], v[148:151]
  ds_read_b128 a[100:103], v12 offset:41984
  buffer_load_dwordx4 v8, s[16:19], s12 offen offset:3072  lds
  v_mfma_f32_16x16x32_bf16 v[148:151], a[52:55], a[36:39], v[148:151]
  ds_read_b64_tr_b16 a[116:117], v19 offset:40960
  v_mfma_f32_16x16x32_bf16 v[152:155], a[24:27], a[4:7], v[152:155]
  ds_read_b64_tr_b16 a[118:119], v19 offset:45056
  s_add_u32 s12, s12, s31
  v_mfma_f32_16x16x32_bf16 v[152:155], a[56:59], a[36:39], v[152:155]
  ds_read_b128 a[72:75], v12 offset:34816
  v_mfma_f32_16x16x32_bf16 v[156:159], a[28:31], a[4:7], v[156:159]
  ds_read_b64_tr_b16 a[88:89], v20 offset:32768
  v_mfma_f32_16x16x32_bf16 v[156:159], a[60:63], a[36:39], v[156:159]
  s_add_u32 m0, s27, 0
  ds_read_b64_tr_b16 a[90:91], v20 offset:36864
  v_mfma_f32_16x16x32_bf16 v[160:163], a[16:19], a[8:11], v[160:163]
  v_mfma_f32_16x16x32_bf16 v[160:163], a[48:51], a[40:43], v[160:163]
  ds_read_b128 a[104:107], v12 offset:43008
  buffer_load_dwordx4 v2, s[96:99], s13 offen offset:0 lds
  v_mfma_f32_16x16x32_bf16 v[164:167], a[20:23], a[8:11], v[164:167]
  ds_read_b64_tr_b16 a[120:121], v20 offset:40960
  v_mfma_f32_16x16x32_bf16 v[164:167], a[52:55], a[40:43], v[164:167]
  ds_read_b64_tr_b16 a[122:123], v20 offset:45056
  v_mfma_f32_16x16x32_bf16 v[168:171], a[24:27], a[8:11], v[168:171]
  ds_read_b128 a[76:79], v12 offset:35840
  buffer_load_dwordx4 v3, s[96:99], s13 offen offset:1024 lds
  v_mfma_f32_16x16x32_bf16 v[168:171], a[56:59], a[40:43], v[168:171]
  ds_read_b64_tr_b16 a[92:93], v21 offset:32768
  v_mfma_f32_16x16x32_bf16 v[172:175], a[28:31], a[8:11], v[172:175]
  ds_read_b64_tr_b16 a[94:95], v21 offset:36864
  buffer_load_dwordx4 v4, s[96:99], s13 offen offset:2048 lds
  v_mfma_f32_16x16x32_bf16 v[172:175], a[60:63], a[40:43], v[172:175]
  ds_read_b128 a[108:111], v12 offset:44032
  v_mfma_f32_16x16x32_bf16 v[176:179], a[16:19], a[12:15], v[176:179]
  ds_read_b64_tr_b16 a[124:125], v21 offset:40960
  v_mfma_f32_16x16x32_bf16 v[176:179], a[48:51], a[44:47], v[176:179]
  buffer_load_dwordx4 v5, s[96:99], s13 offen offset:3072 lds
  v_mfma_f32_16x16x32_bf16 v[180:183], a[20:23], a[12:15], v[180:183]
  ds_read_b64_tr_b16 a[126:127], v21 offset:45056
  v_mfma_f32_16x16x32_bf16 v[180:183], a[52:55], a[44:47], v[180:183]
  s_add_u32 s13, s13, s32
  v_mfma_f32_16x16x32_bf16 v[184:187], a[24:27], a[12:15], v[184:187]
  v_mfma_f32_16x16x32_bf16 v[184:187], a[56:59], a[44:47], v[184:187]
  v_mfma_f32_16x16x32_bf16 v[188:191], a[28:31], a[12:15], v[188:191]
  v_mfma_f32_16x16x32_bf16 v[188:191], a[60:63], a[44:47], v[188:191]
  s_waitcnt vmcnt(17) lgkmcnt(0)
  s_barrier
  v_mfma_f32_16x16x32_bf16 v[128:131], a[80:83], a[64:67], v[128:131]
  ds_read_b128 a[0:3], v13 offset:0
  s_add_u32 m0, s15, 32768
  v_mfma_f32_16x16x32_bf16 v[128:131], a[112:115], a[96:99], v[128:131]
  ds_read_b64_tr_b16 a[16:17], v22 offset:0
  v_mfma_f32_16x16x32_bf16 v[132:135], a[84:87], a[64:67], v[132:135]
  ds_read_b64_tr_b16 a[18:19], v22 offset:4096
  buffer_load_dwordx4 v8, s[16:19], s12 offen offset:0  lds
  v_mfma_f32_16x16x32_bf16 v[132:135], a[116:119], a[96:99], v[132:135]
  ds_read_b128 a[32:35], v13 offset:8192
  v_mfma_f32_16x16x32_bf16 v[136:139], a[88:91], a[64:67], v[136:139]
  ds_read_b64_tr_b16 a[48:49], v22 offset:8192
  v_mfma_f32_16x16x32_bf16 v[136:139], a[120:123], a[96:99], v[136:139]
  buffer_load_dwordx4 v8, s[16:19], s12 offen offset:1024  lds
  ds_read_b64_tr_b16 a[50:51], v22 offset:12288
  v_mfma_f32_16x16x32_bf16 v[140:143], a[92:95], a[64:67], v[140:143]
  ds_read_b128 a[4:7], v13 offset:1024
  v_mfma_f32_16x16x32_bf16 v[140:143], a[124:127], a[96:99], v[140:143]
  ds_read_b64_tr_b16 a[20:21], v23 offset:0
  buffer_load_dwordx4 v8, s[16:19], s12 offen offset:2048  lds
  v_mfma_f32_16x16x32_bf16 v[144:147], a[80:83], a[68:71], v[144:147]
  v_mfma_f32_16x16x32_bf16 v[144:147], a[112:115], a[100:103], v[144:147]
  ds_read_b64_tr_b16 a[22:23], v23 offset:4096
  v_mfma_f32_16x16x32_bf16 v[148:151], a[84:87], a[68:71], v[148:151]
  ds_read_b128 a[36:39], v13 offset:9216
  buffer_load_dwordx4 v8, s[16:19], s12 offen offset:3072  lds
  v_mfma_f32_16x16x32_bf16 v[148:151], a[116:119], a[100:103], v[148:151]
  ds_read_b64_tr_b16 a[52:53], v23 offset:8192
  v_mfma_f32_16x16x32_bf16 v[152:155], a[88:91], a[68:71], v[152:155]
  ds_read_b64_tr_b16 a[54:55], v23 offset:12288
  s_add_u32 s12, s12, s31
  v_mfma_f32_16x16x32_bf16 v[152:155], a[120:123], a[100:103], v[152:155]
  ds_read_b128 a[8:11], v13 offset:2048
  v_mfma_f32_16x16x32_bf16 v[156:159], a[92:95], a[68:71], v[156:159]
  ds_read_b64_tr_b16 a[24:25], v24 offset:0
  v_mfma_f32_16x16x32_bf16 v[156:159], a[124:127], a[100:103], v[156:159]
  s_add_u32 m0, s27, 32768
  ds_read_b64_tr_b16 a[26:27], v24 offset:4096
  v_mfma_f32_16x16x32_bf16 v[160:163], a[80:83], a[72:75], v[160:163]
  v_mfma_f32_16x16x32_bf16 v[160:163], a[112:115], a[104:107], v[160:163]
  ds_read_b128 a[40:43], v13 offset:10240
  buffer_load_dwordx4 v2, s[96:99], s13 offen offset:0 lds
  v_mfma_f32_16x16x32_bf16 v[164:167], a[84:87], a[72:75], v[164:167]
  ds_read_b64_tr_b16 a[56:57], v24 offset:8192
  v_mfma_f32_16x16x32_bf16 v[164:167], a[116:119], a[104:107], v[164:167]
  ds_read_b64_tr_b16 a[58:59], v24 offset:12288
  v_mfma_f32_16x16x32_bf16 v[168:171], a[88:91], a[72:75], v[168:171]
  ds_read_b128 a[12:15], v13 offset:3072
  buffer_load_dwordx4 v3, s[96:99], s13 offen offset:1024 lds
  v_mfma_f32_16x16x32_bf16 v[168:171], a[120:123], a[104:107], v[168:171]
  ds_read_b64_tr_b16 a[28:29], v25 offset:0
  v_mfma_f32_16x16x32_bf16 v[172:175], a[92:95], a[72:75], v[172:175]
  ds_read_b64_tr_b16 a[30:31], v25 offset:4096
  buffer_load_dwordx4 v4, s[96:99], s13 offen offset:2048 lds
  v_mfma_f32_16x16x32_bf16 v[172:175], a[124:127], a[104:107], v[172:175]
  ds_read_b128 a[44:47], v13 offset:11264
  v_mfma_f32_16x16x32_bf16 v[176:179], a[80:83], a[76:79], v[176:179]
  ds_read_b64_tr_b16 a[60:61], v25 offset:8192
  v_mfma_f32_16x16x32_bf16 v[176:179], a[112:115], a[108:111], v[176:179]
  buffer_load_dwordx4 v5, s[96:99], s13 offen offset:3072 lds
  v_mfma_f32_16x16x32_bf16 v[180:183], a[84:87], a[76:79], v[180:183]
  ds_read_b64_tr_b16 a[62:63], v25 offset:12288
  v_mfma_f32_16x16x32_bf16 v[180:183], a[116:119], a[108:111], v[180:183]
  s_add_u32 s13, s13, s32
  v_mfma_f32_16x16x32_bf16 v[184:187], a[88:91], a[76:79], v[184:187]
  v_mfma_f32_16x16x32_bf16 v[184:187], a[120:123], a[108:111], v[184:187]
  v_mfma_f32_16x16x32_bf16 v[188:191], a[92:95], a[76:79], v[188:191]
  v_mfma_f32_16x16x32_bf16 v[188:191], a[124:127], a[108:111], v[188:191]
  s_waitcnt vmcnt(16) lgkmcnt(0)
  s_barrier
  v_mfma_f32_16x16x32_bf16 v[128:131], a[16:19], a[0:3], v[128:131]
  ds_read_b128 a[64:67], v13 offset:32768
  s_add_u32 m0, s15, 65536
  v_mfma_f32_16x16x32_bf16 v[128:131], a[48:51], a[32:35], v[128:131]
  s_lshl_b32 s60, s8, 9
  ds_read_b64_tr_b16 a[80:81], v22 offset:32768
  v_mfma_f32_16x16x32_bf16 v[132:135], a[20:23], a[0:3], v[132:135]
  s_add_u32 s60, s60, 33153024
  ds_read_b64_tr_b16 a[82:83], v22 offset:36864
  buffer_load_dwordx4 v8, s[16:19], s12 offen offset:0  lds
  v_mfma_f32_16x16x32_bf16 v[132:135], a[52:55], a[32:35], v[132:135]
  ds_read_b128 a[96:99], v13 offset:40960
  v_min_u32 v9, 23, v1
  v_mfma_f32_16x16x32_bf16 v[136:139], a[24:27], a[0:3], v[136:139]
  ds_read_b64_tr_b16 a[112:113], v22 offset:40960
  v_lshlrev_b32 v9, 3, v9
  v_mfma_f32_16x16x32_bf16 v[136:139], a[56:59], a[32:35], v[136:139]
  buffer_load_dwordx4 v8, s[16:19], s12 offen offset:1024  lds
  ds_read_b64_tr_b16 a[114:115], v22 offset:45056
  v_add_u32 v9, s60, v9
  v_mfma_f32_16x16x32_bf16 v[140:143], a[28:31], a[0:3], v[140:143]
  ds_read_b128 a[68:71], v13 offset:33792
  v_mfma_f32_16x16x32_bf16 v[140:143], a[60:63], a[32:35], v[140:143]
  buffer_load_dwordx2 v[10:11], v9, s[16:19], 0 offen sc1
  ds_read_b64_tr_b16 a[84:85], v23 offset:32768
  buffer_load_dwordx4 v8, s[16:19], s12 offen offset:2048  lds
  v_mfma_f32_16x16x32_bf16 v[144:147], a[16:19], a[4:7], v[144:147]
  v_mfma_f32_16x16x32_bf16 v[144:147], a[48:51], a[36:39], v[144:147]
  ds_read_b64_tr_b16 a[86:87], v23 offset:36864
  v_mfma_f32_16x16x32_bf16 v[148:151], a[20:23], a[4:7], v[148:151]
  ds_read_b128 a[100:103], v13 offset:41984
  buffer_load_dwordx4 v8, s[16:19], s12 offen offset:3072  lds
  v_mfma_f32_16x16x32_bf16 v[148:151], a[52:55], a[36:39], v[148:151]
  ds_read_b64_tr_b16 a[116:117], v23 offset:40960
  v_mfma_f32_16x16x32_bf16 v[152:155], a[24:27], a[4:7], v[152:155]
  ds_read_b64_tr_b16 a[118:119], v23 offset:45056
  s_add_u32 s12, s12, s31
  v_mfma_f32_16x16x32_bf16 v[152:155], a[56:59], a[36:39], v[152:155]
  ds_read_b128 a[72:75], v13 offset:34816
  v_mfma_f32_16x16x32_bf16 v[156:159], a[28:31], a[4:7], v[156:159]
  ds_read_b64_tr_b16 a[88:89], v24 offset:32768
  v_mfma_f32_16x16x32_bf16 v[156:159], a[60:63], a[36:39], v[156:159]
  s_add_u32 m0, s27, 65536
  ds_read_b64_tr_b16 a[90:91], v24 offset:36864
  v_mfma_f32_16x16x32_bf16 v[160:163], a[16:19], a[8:11], v[160:163]
  v_mfma_f32_16x16x32_bf16 v[160:163], a[48:51], a[40:43], v[160:163]
  ds_read_b128 a[104:107], v13 offset:43008
  buffer_load_dwordx4 v2, s[96:99], s13 offen offset:0 lds
  v_mfma_f32_16x16x32_bf16 v[164:167], a[20:23], a[8:11], v[164:167]
  ds_read_b64_tr_b16 a[120:121], v24 offset:40960
  v_mfma_f32_16x16x32_bf16 v[164:167], a[52:55], a[40:43], v[164:167]
  ds_read_b64_tr_b16 a[122:123], v24 offset:45056
  v_mfma_f32_16x16x32_bf16 v[168:171], a[24:27], a[8:11], v[168:171]
  ds_read_b128 a[76:79], v13 offset:35840
  buffer_load_dwordx4 v3, s[96:99], s13 offen offset:1024 lds
  v_mfma_f32_16x16x32_bf16 v[168:171], a[56:59], a[40:43], v[168:171]
  ds_read_b64_tr_b16 a[92:93], v25 offset:32768
  v_mfma_f32_16x16x32_bf16 v[172:175], a[28:31], a[8:11], v[172:175]
  ds_read_b64_tr_b16 a[94:95], v25 offset:36864
  buffer_load_dwordx4 v4, s[96:99], s13 offen offset:2048 lds
  v_mfma_f32_16x16x32_bf16 v[172:175], a[60:63], a[40:43], v[172:175]
  ds_read_b128 a[108:111], v13 offset:44032
  v_mfma_f32_16x16x32_bf16 v[176:179], a[16:19], a[12:15], v[176:179]
  ds_read_b64_tr_b16 a[124:125], v25 offset:40960
  v_mfma_f32_16x16x32_bf16 v[176:179], a[48:51], a[44:47], v[176:179]
  buffer_load_dwordx4 v5, s[96:99], s13 offen offset:3072 lds
  v_mfma_f32_16x16x32_bf16 v[180:183], a[20:23], a[12:15], v[180:183]
  ds_read_b64_tr_b16 a[126:127], v25 offset:45056
  v_mfma_f32_16x16x32_bf16 v[180:183], a[52:55], a[44:47], v[180:183]
  s_add_u32 s13, s13, s32
  v_mfma_f32_16x16x32_bf16 v[184:187], a[24:27], a[12:15], v[184:187]
  v_mfma_f32_16x16x32_bf16 v[184:187], a[56:59], a[44:47], v[184:187]
  v_mfma_f32_16x16x32_bf16 v[188:191], a[28:31], a[12:15], v[188:191]
  v_mfma_f32_16x16x32_bf16 v[188:191], a[60:63], a[44:47], v[188:191]
  s_waitcnt vmcnt(17) lgkmcnt(0)
  s_barrier
  v_mfma_f32_16x16x32_bf16 v[128:131], a[80:83], a[64:67], v[128:131]
  ds_read_b128 a[0:3], v12 offset:0
  s_add_u32 m0, s15, 98304
  v_mfma_f32_16x16x32_bf16 v[128:131], a[112:115], a[96:99], v[128:131]
  ds_read_b64_tr_b16 a[16:17], v18 offset:0
  v_mfma_f32_16x16x32_bf16 v[132:135], a[84:87], a[64:67], v[132:135]
  ds_read_b64_tr_b16 a[18:19], v18 offset:4096
  buffer_load_dwordx4 v8, s[16:19], s12 offen offset:0  lds
  v_mfma_f32_16x16x32_bf16 v[132:135], a[116:119], a[96:99], v[132:135]
  ds_read_b128 a[32:35], v12 offset:8192
  v_mfma_f32_16x16x32_bf16 v[136:139], a[88:91], a[64:67], v[136:139]
  ds_read_b64_tr_b16 a[48:49], v18 offset:8192
  v_mfma_f32_16x16x32_bf16 v[136:139], a[120:123], a[96:99], v[136:139]
  buffer_load_dwordx4 v8, s[16:19], s12 offen offset:1024  lds
  ds_read_b64_tr_b16 a[50:51], v18 offset:12288
  v_mfma_f32_16x16x32_bf16 v[140:143], a[92:95], a[64:67], v[140:143]
  ds_read_b128 a[4:7], v12 offset:1024
  v_mfma_f32_16x16x32_bf16 v[140:143], a[124:127], a[96:99], v[140:143]
  ds_read_b64_tr_b16 a[20:21], v19 offset:0
  buffer_load_dwordx4 v8, s[16:19], s12 offen offset:2048  lds
  v_mfma_f32_16x16x32_bf16 v[144:147], a[80:83], a[68:71], v[144:147]
  v_mfma_f32_16x16x32_bf16 v[144:147], a[112:115], a[100:103], v[144:147]
  ds_read_b64_tr_b16 a[22:23], v19 offset:4096
  v_mfma_f32_16x16x32_bf16 v[148:151], a[84:87], a[68:71], v[148:151]
  ds_read_b128 a[36:39], v12 offset:9216
  buffer_load_dwordx4 v8, s[16:19], s12 offen offset:3072  lds
  v_mfma_f32_16x16x32_bf16 v[148:151], a[116:119], a[100:103], v[148:151]
  ds_read_b64_tr_b16 a[52:53], v19 offset:8192
  v_mfma_f32_16x16x32_bf16 v[152:155], a[88:91], a[68:71], v[152:155]
  ds_read_b64_tr_b16 a[54:55], v19 offset:12288
  s_add_u32 s12, s12, s31
  v_mfma_f32_16x16x32_bf16 v[152:155], a[120:123], a[100:103], v[152:155]
  ds_read_b128 a[8:11], v12 offset:2048
  v_mfma_f32_16x16x32_bf16 v[156:159], a[92:95], a[68:71], v[156:159]
  ds_read_b64_tr_b16 a[24:25], v20 offset:0
  v_mfma_f32_16x16x32_bf16 v[156:159], a[124:127], a[100:103], v[156:159]
  s_add_u32 m0, s27, 98304
  ds_read_b64_tr_b16 a[26:27], v20 offset:4096
  v_mfma_f32_16x16x32_bf16 v[160:163], a[80:83], a[72:75], v[160:163]
  v_mfma_f32_16x16x32_bf16 v[160:163], a[112:115], a[104:107], v[160:163]
  ds_read_b128 a[40:43], v12 offset:10240
  buffer_load_dwordx4 v2, s[96:99], s13 offen offset:0 lds
  v_mfma_f32_16x16x32_bf16 v[164:167], a[84:87], a[72:75], v[164:167]
  ds_read_b64_tr_b16 a[56:57], v20 offset:8192
  v_mfma_f32_16x16x32_bf16 v[164:167], a[116:119], a[104:107], v[164:167]
  ds_read_b64_tr_b16 a[58:59], v20 offset:12288
  v_mfma_f32_16x16x32_bf16 v[168:171], a[88:91], a[72:75], v[168:171]
  ds_read_b128 a[12:15], v12 offset:3072
  buffer_load_dwordx4 v3, s[96:99], s13 offen offset:1024 lds
  v_mfma_f32_16x16x32_bf16 v[168:171], a[120:123], a[104:107], v[168:171]
  ds_read_b64_tr_b16 a[28:29], v21 offset:0
  v_mfma_f32_16x16x32_bf16 v[172:175], a[92:95], a[72:75], v[172:175]
  ds_read_b64_tr_b16 a[30:31], v21 offset:4096
  buffer_load_dwordx4 v4, s[96:99], s13 offen offset:2048 lds
  v_mfma_f32_16x16x32_bf16 v[172:175], a[124:127], a[104:107], v[172:175]
  ds_read_b128 a[44:47], v12 offset:11264
  v_mfma_f32_16x16x32_bf16 v[176:179], a[80:83], a[76:79], v[176:179]
  ds_read_b64_tr_b16 a[60:61], v21 offset:8192
  v_mfma_f32_16x16x32_bf16 v[176:179], a[112:115], a[108:111], v[176:179]
  buffer_load_dwordx4 v5, s[96:99], s13 offen offset:3072 lds
  v_mfma_f32_16x16x32_bf16 v[180:183], a[84:87], a[76:79], v[180:183]
  ds_read_b64_tr_b16 a[62:63], v21 offset:12288
  v_mfma_f32_16x16x32_bf16 v[180:183], a[116:119], a[108:111], v[180:183]
  s_add_u32 s13, s13, s32
  v_mfma_f32_16x16x32_bf16 v[184:187], a[88:91], a[76:79], v[184:187]
  v_mfma_f32_16x16x32_bf16 v[184:187], a[120:123], a[108:111], v[184:187]
  v_mfma_f32_16x16x32_bf16 v[188:191], a[92:95], a[76:79], v[188:191]
  v_mfma_f32_16x16x32_bf16 v[188:191], a[124:127], a[108:111], v[188:191]
  s_waitcnt vmcnt(17) lgkmcnt(0)
  s_barrier
  s_waitcnt vmcnt(14)
L_p2r0_ow:
  v_cmp_eq_u64 vcc, v[10:11], v[14:15]
  s_nop 1
  s_cmp_eq_u64 vcc, -1
  s_cbranch_scc1 L_p2r0_ook
  s_add_u32 s3, s3, 1
  s_cmp_gt_u32 s3, 0x40000
  s_cbranch_scc1 L_p2r0_ook
  s_sleep 4
  buffer_load_dwordx2 v[10:11], v9, s[16:19], 0 offen sc1
  s_waitcnt vmcnt(0)
  s_branch L_p2r0_ow
L_p2r0_ook:
  v_mfma_f32_16x16x32_bf16 v[128:131], a[16:19], a[0:3], v[128:131]
  ds_read_b128 a[64:67], v12 offset:32768
  s_lshr_b32 s71, s24, 1
  s_lshl_b32 s13, s71, 16
  s_lshl_b32 s12, s8, 5
  s_add_u32 s12, s12, s71
  s_lshl_b32 s12, s12, 13
  s_add_u32 s12, s12, 28942336
  s_mov_b32 s31, 16384
  s_mov_b32 s32, 131072
  v_mfma_f32_16x16x32_bf16 v[128:131], a[48:51], a[32:35], v[128:131]
  ds_read_b64_tr_b16 a[80:81], v18 offset:32768
  v_mfma_f32_16x16x32_bf16 v[132:135], a[20:23], a[0:3], v[132:135]
  ds_read_b64_tr_b16 a[82:83], v18 offset:36864
  s_add_u32 m0, s15, 0
  v_mfma_f32_16x16x32_bf16 v[132:135], a[52:55], a[32:35], v[132:135]
  ds_read_b128 a[96:99], v12 offset:40960
  v_mfma_f32_16x16x32_bf16 v[136:139], a[24:27], a[0:3], v[136:139]
  ds_read_b64_tr_b16 a[112:113], v18 offset:40960
  v_mfma_f32_16x16x32_bf16 v[136:139], a[56:59], a[32:35], v[136:139]
  buffer_load_dwordx4 v8, s[16:19], s12 offen offset:0  lds
  ds_read_b64_tr_b16 a[114:115], v18 offset:45056
  v_mfma_f32_16x16x32_bf16 v[140:143], a[28:31], a[0:3], v[140:143]
  ds_read_b128 a[68:71], v12 offset:33792
  v_mfma_f32_16x16x32_bf16 v[140:143], a[60:63], a[32:35], v[140:143]
  buffer_load_dwordx4 v8, s[16:19], s12 offen offset:1024  lds
  ds_read_b64_tr_b16 a[84:85], v19 offset:32768
  v_mfma_f32_16x16x32_bf16 v[144:147], a[16:19], a[4:7], v[144:147]
  v_mfma_f32_16x16x32_bf16 v[144:147], a[48:51], a[36:39], v[144:147]
  ds_read_b64_tr_b16 a[86:87], v19 offset:36864
  buffer_load_dwordx4 v8, s[16:19], s12 offen offset:2048  lds
  v_mfma_f32_16x16x32_bf16 v[148:151], a[20:23], a[4:7], v[148:151]
  ds_read_b128 a[100:103], v12 offset:41984
  v_mfma_f32_16x16x32_bf16 v[148:151], a[52:55], a[36:39], v[148:151]
  ds_read_b64_tr_b16 a[116:117], v19 offset:40960
  v_mfma_f32_16x16x32_bf16 v[152:155], a[24:27], a[4:7], v[152:155]
  buffer_load_dwordx4 v8, s[16:19], s12 offen offset:3072  lds
  ds_read_b64_tr_b16 a[118:119], v19 offset:45056
  v_mfma_f32_16x16x32_bf16 v[152:155], a[56:59], a[36:39], v[152:155]
  ds_read_b128 a[72:75], v12 offset:34816
  v_mfma_f32_16x16x32_bf16 v[156:159], a[28:31], a[4:7], v[156:159]
  s_add_u32 s12, s12, s31
  ds_read_b64_tr_b16 a[88:89], v20 offset:32768
  v_mfma_f32_16x16x32_bf16 v[156:159], a[60:63], a[36:39], v[156:159]
  ds_read_b64_tr_b16 a[90:91], v20 offset:36864
  v_mfma_f32_16x16x32_bf16 v[160:163], a[16:19], a[8:11], v[160:163]
  s_add_u32 m0, s27, 0
  v_mfma_f32_16x16x32_bf16 v[160:163], a[48:51], a[40:43], v[160:163]
  ds_read_b128 a[104:107], v12 offset:43008
  v_mfma_f32_16x16x32_bf16 v[164:167], a[20:23], a[8:11], v[164:167]
  ds_read_b64_tr_b16 a[120:121], v20 offset:40960
  buffer_load_dwordx4 v2, s[20:23], s13 offen offset:0 lds
  v_mfma_f32_16x16x32_bf16 v[164:167], a[52:55], a[40:43], v[164:167]
  ds_read_b64_tr_b16 a[122:123], v20 offset:45056
  v_mfma_f32_16x16x32_bf16 v[168:171], a[24:27], a[8:11], v[168:171]
  ds_read_b128 a[76:79], v12 offset:35840
  v_mfma_f32_16x16x32_bf16 v[168:171], a[56:59], a[40:43], v[168:171]
  buffer_load_dwordx4 v3, s[20:23], s13 offen offset:1024 lds
  ds_read_b64_tr_b16 a[92:93], v21 offset:32768
  v_mfma_f32_16x16x32_bf16 v[172:175], a[28:31], a[8:11], v[172:175]
  ds_read_b64_tr_b16 a[94:95], v21 offset:36864
  v_mfma_f32_16x16x32_bf16 v[172:175], a[60:63], a[40:43], v[172:175]
  buffer_load_dwordx4 v4, s[20:23], s13 offen offset:2048 lds
  ds_read_b128 a[108:111], v12 offset:44032
  v_mfma_f32_16x16x32_bf16 v[176:179], a[16:19], a[12:15], v[176:179]
  ds_read_b64_tr_b16 a[124:125], v21 offset:40960
  v_mfma_f32_16x16x32_bf16 v[176:179], a[48:51], a[44:47], v[176:179]
  buffer_load_dwordx4 v5, s[20:23], s13 offen offset:3072 lds
  v_mfma_f32_16x16x32_bf16 v[180:183], a[20:23], a[12:15], v[180:183]
  ds_read_b64_tr_b16 a[126:127], v21 offset:45056
  v_mfma_f32_16x16x32_bf16 v[180:183], a[52:55], a[44:47], v[180:183]
  v_mfma_f32_16x16x32_bf16 v[184:187], a[24:27], a[12:15], v[184:187]
  s_add_u32 s13, s13, s32
  v_mfma_f32_16x16x32_bf16 v[184:187], a[56:59], a[44:47], v[184:187]
  v_mfma_f32_16x16x32_bf16 v[188:191], a[28:31], a[12:15], v[188:191]
  v_mfma_f32_16x16x32_bf16 v[188:191], a[60:63], a[44:47], v[188:191]
  s_waitcnt vmcnt(16) lgkmcnt(0)
  s_barrier
  v_mfma_f32_16x16x32_bf16 v[128:131], a[80:83], a[64:67], v[128:131]
  ds_read_b128 a[0:3], v13 offset:0
  s_add_u32 m0, s15, 32768
  v_mfma_f32_16x16x32_bf16 v[128:131], a[112:115], a[96:99], v[128:131]
  ds_read_b64_tr_b16 a[16:17], v22 offset:0
  v_mfma_f32_16x16x32_bf16 v[132:135], a[84:87], a[64:67], v[132:135]
  ds_read_b64_tr_b16 a[18:19], v22 offset:4096
  buffer_load_dwordx4 v8, s[16:19], s12 offen offset:0  lds
  v_mfma_f32_16x16x32_bf16 v[132:135], a[116:119], a[96:99], v[132:135]
  ds_read_b128 a[32:35], v13 offset:8192
  v_mfma_f32_16x16x32_bf16 v[136:139], a[88:91], a[64:67], v[136:139]
  ds_read_b64_tr_b16 a[48:49], v22 offset:8192
  v_mfma_f32_16x16x32_bf16 v[136:139], a[120:123], a[96:99], v[136:139]
  buffer_load_dwordx4 v8, s[16:19], s12 offen offset:1024  lds
  ds_read_b64_tr_b16 a[50:51], v22 offset:12288
  v_mfma_f32_16x16x32_bf16 v[140:143], a[92:95], a[64:67], v[140:143]
  ds_read_b128 a[4:7], v13 offset:1024
  v_mfma_f32_16x16x32_bf16 v[140:143], a[124:127], a[96:99], v[140:143]
  ds_read_b64_tr_b16 a[20:21], v23 offset:0
  buffer_load_dwordx4 v8, s[16:19], s12 offen offset:2048  lds
  v_mfma_f32_16x16x32_bf16 v[144:147], a[80:83], a[68:71], v[144:147]
  v_mfma_f32_16x16x32_bf16 v[144:147], a[112:115], a[100:103], v[144:147]
  ds_read_b64_tr_b16 a[22:23], v23 offset:4096
  v_mfma_f32_16x16x32_bf16 v[148:151], a[84:87], a[68:71], v[148:151]
  ds_read_b128 a[36:39], v13 offset:9216
  buffer_load_dwordx4 v8, s[16:19], s12 offen offset:3072  lds
  v_mfma_f32_16x16x32_bf16 v[148:151], a[116:119], a[100:103], v[148:151]
  ds_read_b64_tr_b16 a[52:53], v23 offset:8192
  v_mfma_f32_16x16x32_bf16 v[152:155], a[88:91], a[68:71], v[152:155]
  ds_read_b64_tr_b16 a[54:55], v23 offset:12288
  s_add_u32 s12, s12, s31
  v_mfma_f32_16x16x32_bf16 v[152:155], a[120:123], a[100:103], v[152:155]
  ds_read_b128 a[8:11], v13 offset:2048
  v_mfma_f32_16x16x32_bf16 v[156:159], a[92:95], a[68:71], v[156:159]
  ds_read_b64_tr_b16 a[24:25], v24 offset:0
  v_mfma_f32_16x16x32_bf16 v[156:159], a[124:127], a[100:103], v[156:159]
  s_add_u32 m0, s27, 32768
  ds_read_b64_tr_b16 a[26:27], v24 offset:4096
  v_mfma_f32_16x16x32_bf16 v[160:163], a[80:83], a[72:75], v[160:163]
  v_mfma_f32_16x16x32_bf16 v[160:163], a[112:115], a[104:107], v[160:163]
  ds_read_b128 a[40:43], v13 offset:10240
  buffer_load_dwordx4 v2, s[20:23], s13 offen offset:0 lds
  v_mfma_f32_16x16x32_bf16 v[164:167], a[84:87], a[72:75], v[164:167]
  ds_read_b64_tr_b16 a[56:57], v24 offset:8192
  v_mfma_f32_16x16x32_bf16 v[164:167], a[116:119], a[104:107], v[164:167]
  ds_read_b64_tr_b16 a[58:59], v24 offset:12288
  v_mfma_f32_16x16x32_bf16 v[168:171], a[88:91], a[72:75], v[168:171]
  ds_read_b128 a[12:15], v13 offset:3072
  buffer_load_dwordx4 v3, s[20:23], s13 offen offset:1024 lds
  v_mfma_f32_16x16x32_bf16 v[168:171], a[120:123], a[104:107], v[168:171]
  ds_read_b64_tr_b16 a[28:29], v25 offset:0
  v_mfma_f32_16x16x32_bf16 v[172:175], a[92:95], a[72:75], v[172:175]
  ds_read_b64_tr_b16 a[30:31], v25 offset:4096
  buffer_load_dwordx4 v4, s[20:23], s13 offen offset:2048 lds
  v_mfma_f32_16x16x32_bf16 v[172:175], a[124:127], a[104:107], v[172:175]
  ds_read_b128 a[44:47], v13 offset:11264
  v_mfma_f32_16x16x32_bf16 v[176:179], a[80:83], a[76:79], v[176:179]
  ds_read_b64_tr_b16 a[60:61], v25 offset:8192
  v_mfma_f32_16x16x32_bf16 v[176:179], a[112:115], a[108:111], v[176:179]
  buffer_load_dwordx4 v5, s[20:23], s13 offen offset:3072 lds
  v_mfma_f32_16x16x32_bf16 v[180:183], a[84:87], a[76:79], v[180:183]
  ds_read_b64_tr_b16 a[62:63], v25 offset:12288
  v_mfma_f32_16x16x32_bf16 v[180:183], a[116:119], a[108:111], v[180:183]
  s_add_u32 s13, s13, s32
  v_mfma_f32_16x16x32_bf16 v[184:187], a[88:91], a[76:79], v[184:187]
  v_mfma_f32_16x16x32_bf16 v[184:187], a[120:123], a[108:111], v[184:187]
  v_mfma_f32_16x16x32_bf16 v[188:191], a[92:95], a[76:79], v[188:191]
  v_mfma_f32_16x16x32_bf16 v[188:191], a[124:127], a[108:111], v[188:191]
  s_waitcnt vmcnt(16) lgkmcnt(0)
  s_barrier
  v_mfma_f32_16x16x32_bf16 v[128:131], a[16:19], a[0:3], v[128:131]
  ds_read_b128 a[64:67], v13 offset:32768
  s_add_u32 m0, s15, 65536
  v_mfma_f32_16x16x32_bf16 v[128:131], a[48:51], a[32:35], v[128:131]
  ds_read_b64_tr_b16 a[80:81], v22 offset:32768
  v_mfma_f32_16x16x32_bf16 v[132:135], a[20:23], a[0:3], v[132:135]
  ds_read_b64_tr_b16 a[82:83], v22 offset:36864
  buffer_load_dwordx4 v8, s[16:19], s12 offen offset:0  lds
  v_mfma_f32_16x16x32_bf16 v[132:135], a[52:55], a[32:35], v[132:135]
  ds_read_b128 a[96:99], v13 offset:40960
  v_mfma_f32_16x16x32_bf16 v[136:139], a[24:27], a[0:3], v[136:139]
  ds_read_b64_tr_b16 a[112:113], v22 offset:40960
  v_mfma_f32_16x16x32_bf16 v[136:139], a[56:59], a[32:35], v[136:139]
  buffer_load_dwordx4 v8, s[16:19], s12 offen offset:1024  lds
  ds_read_b64_tr_b16 a[114:115], v22 offset:45056
  v_mfma_f32_16x16x32_bf16 v[140:143], a[28:31], a[0:3], v[140:143]
  ds_read_b128 a[68:71], v13 offset:33792
  v_mfma_f32_16x16x32_bf16 v[140:143], a[60:63], a[32:35], v[140:143]
  ds_read_b64_tr_b16 a[84:85], v23 offset:32768
  buffer_load_dwordx4 v8, s[16:19], s12 offen offset:2048  lds
  v_mfma_f32_16x16x32_bf16 v[144:147], a[16:19], a[4:7], v[144:147]
  v_mfma_f32_16x16x32_bf16 v[144:147], a[48:51], a[36:39], v[144:147]
  ds_read_b64_tr_b16 a[86:87], v23 offset:36864
  v_mfma_f32_16x16x32_bf16 v[148:151], a[20:23], a[4:7], v[148:151]
  ds_read_b128 a[100:103], v13 offset:41984
  buffer_load_dwordx4 v8, s[16:19], s12 offen offset:3072  lds
  v_mfma_f32_16x16x32_bf16 v[148:151], a[52:55], a[36:39], v[148:151]
  ds_read_b64_tr_b16 a[116:117], v23 offset:40960
  v_mfma_f32_16x16x32_bf16 v[152:155], a[24:27], a[4:7], v[152:155]
  ds_read_b64_tr_b16 a[118:119], v23 offset:45056
  s_add_u32 s12, s12, s31
  v_mfma_f32_16x16x32_bf16 v[152:155], a[56:59], a[36:39], v[152:155]
  ds_read_b128 a[72:75], v13 offset:34816
  v_mfma_f32_16x16x32_bf16 v[156:159], a[28:31], a[4:7], v[156:159]
  ds_read_b64_tr_b16 a[88:89], v24 offset:32768
  v_mfma_f32_16x16x32_bf16 v[156:159], a[60:63], a[36:39], v[156:159]
  s_add_u32 m0, s27, 65536
  ds_read_b64_tr_b16 a[90:91], v24 offset:36864
  v_mfma_f32_16x16x32_bf16 v[160:163], a[16:19], a[8:11], v[160:163]
  v_mfma_f32_16x16x32_bf16 v[160:163], a[48:51], a[40:43], v[160:163]
  ds_read_b128 a[104:107], v13 offset:43008
  buffer_load_dwordx4 v2, s[20:23], s13 offen offset:0 lds
  v_mfma_f32_16x16x32_bf16 v[164:167], a[20:23], a[8:11], v[164:167]
  ds_read_b64_tr_b16 a[120:121], v24 offset:40960
  v_mfma_f32_16x16x32_bf16 v[164:167], a[52:55], a[40:43], v[164:167]
  ds_read_b64_tr_b16 a[122:123], v24 offset:45056
  v_mfma_f32_16x16x32_bf16 v[168:171], a[24:27], a[8:11], v[168:171]
  ds_read_b128 a[76:79], v13 offset:35840
  buffer_load_dwordx4 v3, s[20:23], s13 offen offset:1024 lds
  v_mfma_f32_16x16x32_bf16 v[168:171], a[56:59], a[40:43], v[168:171]
  ds_read_b64_tr_b16 a[92:93], v25 offset:32768
  v_mfma_f32_16x16x32_bf16 v[172:175], a[28:31], a[8:11], v[172:175]
  ds_read_b64_tr_b16 a[94:95], v25 offset:36864
  buffer_load_dwordx4 v4, s[20:23], s13 offen offset:2048 lds
  v_mfma_f32_16x16x32_bf16 v[172:175], a[60:63], a[40:43], v[172:175]
  ds_read_b128 a[108:111], v13 offset:44032
  v_mfma_f32_16x16x32_bf16 v[176:179], a[16:19], a[12:15], v[176:179]
  ds_read_b64_tr_b16 a[124:125], v25 offset:40960
  v_mfma_f32_16x16x32_bf16 v[176:179], a[48:51], a[44:47], v[176:179]
  buffer_load_dwordx4 v5, s[20:23], s13 offen offset:3072 lds
  v_mfma_f32_16x16x32_bf16 v[180:183], a[20:23], a[12:15], v[180:183]
  ds_read_b64_tr_b16 a[126:127], v25 offset:45056
  v_mfma_f32_16x16x32_bf16 v[180:183], a[52:55], a[44:47], v[180:183]
  s_add_u32 s13, s13, s32
  v_mfma_f32_16x16x32_bf16 v[184:187], a[24:27], a[12:15], v[184:187]
  v_mfma_f32_16x16x32_bf16 v[184:187], a[56:59], a[44:47], v[184:187]
  v_mfma_f32_16x16x32_bf16 v[188:191], a[28:31], a[12:15], v[188:191]
  v_mfma_f32_16x16x32_bf16 v[188:191], a[60:63], a[44:47], v[188:191]
  s_waitcnt vmcnt(16) lgkmcnt(0)
  s_barrier
  v_mfma_f32_16x16x32_bf16 v[128:131], a[80:83], a[64:67], v[128:131]
  ds_read_b128 a[0:3], v12 offset:0
  s_add_u32 m0, s15, 98304
  v_mfma_f32_16x16x32_bf16 v[128:131], a[112:115], a[96:99], v[128:131]
  ds_read_b64_tr_b16 a[16:17], v18 offset:0
  v_mfma_f32_16x16x32_bf16 v[132:135], a[84:87], a[64:67], v[132:135]
  ds_read_b64_tr_b16 a[18:19], v18 offset:4096
  buffer_load_dwordx4 v8, s[16:19], s12 offen offset:0  lds
  v_mfma_f32_16x16x32_bf16 v[132:135], a[116:119], a[96:99], v[132:135]
  ds_read_b128 a[32:35], v12 offset:8192
  v_mfma_f32_16x16x32_bf16 v[136:139], a[88:91], a[64:67], v[136:139]
  ds_read_b64_tr_b16 a[48:49], v18 offset:8192
  v_mfma_f32_16x16x32_bf16 v[136:139], a[120:123], a[96:99], v[136:139]
  buffer_load_dwordx4 v8, s[16:19], s12 offen offset:1024  lds
  ds_read_b64_tr_b16 a[50:51], v18 offset:12288
  v_mfma_f32_16x16x32_bf16 v[140:143], a[92:95], a[64:67], v[140:143]
  ds_read_b128 a[4:7], v12 offset:1024
  v_mfma_f32_16x16x32_bf16 v[140:143], a[124:127], a[96:99], v[140:143]
  ds_read_b64_tr_b16 a[20:21], v19 offset:0
  buffer_load_dwordx4 v8, s[16:19], s12 offen offset:2048  lds
  v_mfma_f32_16x16x32_bf16 v[144:147], a[80:83], a[68:71], v[144:147]
  v_mfma_f32_16x16x32_bf16 v[144:147], a[112:115], a[100:103], v[144:147]
  ds_read_b64_tr_b16 a[22:23], v19 offset:4096
  v_mfma_f32_16x16x32_bf16 v[148:151], a[84:87], a[68:71], v[148:151]
  ds_read_b128 a[36:39], v12 offset:9216
  buffer_load_dwordx4 v8, s[16:19], s12 offen offset:3072  lds
  v_mfma_f32_16x16x32_bf16 v[148:151], a[116:119], a[100:103], v[148:151]
  ds_read_b64_tr_b16 a[52:53], v19 offset:8192
  v_mfma_f32_16x16x32_bf16 v[152:155], a[88:91], a[68:71], v[152:155]
  ds_read_b64_tr_b16 a[54:55], v19 offset:12288
  s_add_u32 s12, s12, s31
  v_mfma_f32_16x16x32_bf16 v[152:155], a[120:123], a[100:103], v[152:155]
  ds_read_b128 a[8:11], v12 offset:2048
  v_mfma_f32_16x16x32_bf16 v[156:159], a[92:95], a[68:71], v[156:159]
  ds_read_b64_tr_b16 a[24:25], v20 offset:0
  v_mfma_f32_16x16x32_bf16 v[156:159], a[124:127], a[100:103], v[156:159]
  s_add_u32 m0, s27, 98304
  ds_read_b64_tr_b16 a[26:27], v20 offset:4096
  v_mfma_f32_16x16x32_bf16 v[160:163], a[80:83], a[72:75], v[160:163]
  v_mfma_f32_16x16x32_bf16 v[160:163], a[112:115], a[104:107], v[160:163]
  ds_read_b128 a[40:43], v12 offset:10240
  buffer_load_dwordx4 v2, s[20:23], s13 offen offset:0 lds
  v_mfma_f32_16x16x32_bf16 v[164:167], a[84:87], a[72:75], v[164:167]
  ds_read_b64_tr_b16 a[56:57], v20 offset:8192
  v_mfma_f32_16x16x32_bf16 v[164:167], a[116:119], a[104:107], v[164:167]
  ds_read_b64_tr_b16 a[58:59], v20 offset:12288
  v_mfma_f32_16x16x32_bf16 v[168:171], a[88:91], a[72:75], v[168:171]
  ds_read_b128 a[12:15], v12 offset:3072
  buffer_load_dwordx4 v3, s[20:23], s13 offen offset:1024 lds
  v_mfma_f32_16x16x32_bf16 v[168:171], a[120:123], a[104:107], v[168:171]
  ds_read_b64_tr_b16 a[28:29], v21 offset:0
  v_mfma_f32_16x16x32_bf16 v[172:175], a[92:95], a[72:75], v[172:175]
  ds_read_b64_tr_b16 a[30:31], v21 offset:4096
  buffer_load_dwordx4 v4, s[20:23], s13 offen offset:2048 lds
  v_mfma_f32_16x16x32_bf16 v[172:175], a[124:127], a[104:107], v[172:175]
  ds_read_b128 a[44:47], v12 offset:11264
  v_mfma_f32_16x16x32_bf16 v[176:179], a[80:83], a[76:79], v[176:179]
  ds_read_b64_tr_b16 a[60:61], v21 offset:8192
  v_mfma_f32_16x16x32_bf16 v[176:179], a[112:115], a[108:111], v[176:179]
  buffer_load_dwordx4 v5, s[20:23], s13 offen offset:3072 lds
  v_mfma_f32_16x16x32_bf16 v[180:183], a[84:87], a[76:79], v[180:183]
  ds_read_b64_tr_b16 a[62:63], v21 offset:12288
  v_mfma_f32_16x16x32_bf16 v[180:183], a[116:119], a[108:111], v[180:183]
  s_add_u32 s13, s13, s32
  v_mfma_f32_16x16x32_bf16 v[184:187], a[88:91], a[76:79], v[184:187]
  v_mfma_f32_16x16x32_bf16 v[184:187], a[120:123], a[108:111], v[184:187]
  v_mfma_f32_16x16x32_bf16 v[188:191], a[92:95], a[76:79], v[188:191]
  v_mfma_f32_16x16x32_bf16 v[188:191], a[124:127], a[108:111], v[188:191]
  s_waitcnt vmcnt(16) lgkmcnt(0)
  s_barrier
  v_mfma_f32_16x16x32_bf16 v[192:195], a[16:19], a[0:3], 0
  ds_read_b128 a[64:67], v12 offset:32768
  s_add_u32 m0, s15, 0
  v_mfma_f32_16x16x32_bf16 v[192:195], a[48:51], a[32:35], v[192:195]
  ds_read_b64_tr_b16 a[80:81], v18 offset:32768
  v_mfma_f32_16x16x32_bf16 v[196:199], a[20:23], a[0:3], 0
  ds_read_b64_tr_b16 a[82:83], v18 offset:36864
  buffer_load_dwordx4 v8, s[16:19], s12 offen offset:0  lds
  v_mfma_f32_16x16x32_bf16 v[196:199], a[52:55], a[32:35], v[196:199]
  ds_read_b128 a[96:99], v12 offset:40960
  v_mfma_f32_16x16x32_bf16 v[200:203], a[24:27], a[0:3], 0
  ds_read_b64_tr_b16 a[112:113], v18 offset:40960
  v_mfma_f32_16x16x32_bf16 v[200:203], a[56:59], a[32:35], v[200:203]
  buffer_load_dwordx4 v8, s[16:19], s12 offen offset:1024  lds
  ds_read_b64_tr_b16 a[114:115], v18 offset:45056
  v_mfma_f32_16x16x32_bf16 v[204:207], a[28:31], a[0:3], 0
  ds_read_b128 a[68:71], v12 offset:33792
  v_mfma_f32_16x16x32_bf16 v[204:207], a[60:63], a[32:35], v[204:207]
  ds_read_b64_tr_b16 a[84:85], v19 offset:32768
  buffer_load_dwordx4 v8, s[16:19], s12 offen offset:2048  lds
  v_mfma_f32_16x16x32_bf16 v[208:211], a[16:19], a[4:7], 0
  v_mfma_f32_16x16x32_bf16 v[208:211], a[48:51], a[36:39], v[208:211]
  ds_read_b64_tr_b16 a[86:87], v19 offset:36864
  v_mfma_f32_16x16x32_bf16 v[212:215], a[20:23], a[4:7], 0
  v_sub_f32 v42, 1.0, v38
  ds_read_b128 a[100:103], v12 offset:41984
  buffer_load_dwordx4 v8, s[16:19], s12 offen offset:3072  lds
  v_mfma_f32_16x16x32_bf16 v[212:215], a[52:55], a[36:39], v[212:215]
  v_mul_f32 v128, v42, v128
  ds_read_b64_tr_b16 a[116:117], v19 offset:40960
  v_mfma_f32_16x16x32_bf16 v[216:219], a[24:27], a[4:7], 0
  v_mul_f32 v129, v42, v129
  ds_read_b64_tr_b16 a[118:119], v19 offset:45056
  s_add_u32 s12, s12, s31
  v_mfma_f32_16x16x32_bf16 v[216:219], a[56:59], a[36:39], v[216:219]
  v_mul_f32 v130, v42, v130
  ds_read_b128 a[72:75], v12 offset:34816
  v_mfma_f32_16x16x32_bf16 v[220:223], a[28:31], a[4:7], 0
  v_mul_f32 v131, v42, v131
  ds_read_b64_tr_b16 a[88:89], v20 offset:32768
  v_mfma_f32_16x16x32_bf16 v[220:223], a[60:63], a[36:39], v[220:223]
  s_add_u32 m0, s27, 0
  ds_read_b64_tr_b16 a[90:91], v20 offset:36864
  v_mul_f32 v132, v42, v132
  v_mfma_f32_16x16x32_bf16 v[224:227], a[16:19], a[8:11], 0
  v_mfma_f32_16x16x32_bf16 v[224:227], a[48:51], a[40:43], v[224:227]
  ds_read_b128 a[104:107], v12 offset:43008
  v_mul_f32 v133, v42, v133
  buffer_load_dwordx4 v2, s[20:23], s13 offen offset:0 lds
  v_mfma_f32_16x16x32_bf16 v[228:231], a[20:23], a[8:11], 0
  ds_read_b64_tr_b16 a[120:121], v20 offset:40960
  v_mul_f32 v134, v42, v134
  v_mfma_f32_16x16x32_bf16 v[228:231], a[52:55], a[40:43], v[228:231]
  ds_read_b64_tr_b16 a[122:123], v20 offset:45056
  v_mul_f32 v135, v42, v135
  v_mfma_f32_16x16x32_bf16 v[232:235], a[24:27], a[8:11], 0
  ds_read_b128 a[76:79], v12 offset:35840
  buffer_load_dwordx4 v3, s[20:23], s13 offen offset:1024 lds
  v_mul_f32 v136, v42, v136
  v_mfma_f32_16x16x32_bf16 v[232:235], a[56:59], a[40:43], v[232:235]
  ds_read_b64_tr_b16 a[92:93], v21 offset:32768
  v_mul_f32 v137, v42, v137
  v_mfma_f32_16x16x32_bf16 v[236:239], a[28:31], a[8:11], 0
  ds_read_b64_tr_b16 a[94:95], v21 offset:36864
  buffer_load_dwordx4 v4, s[20:23], s13 offen offset:2048 lds
  v_mul_f32 v138, v42, v138
  v_mfma_f32_16x16x32_bf16 v[236:239], a[60:63], a[40:43], v[236:239]
  ds_read_b128 a[108:111], v12 offset:44032
  v_mfma_f32_16x16x32_bf16 v[240:243], a[16:19], a[12:15], 0
  v_mul_f32 v139, v42, v139
  ds_read_b64_tr_b16 a[124:125], v21 offset:40960
  v_mfma_f32_16x16x32_bf16 v[240:243], a[48:51], a[44:47], v[240:243]
  v_mul_f32 v140, v42, v140
  buffer_load_dwordx4 v5, s[20:23], s13 offen offset:3072 lds
  v_mfma_f32_16x16x32_bf16 v[244:247], a[20:23], a[12:15], 0
  ds_read_b64_tr_b16 a[126:127], v21 offset:45056
  v_mul_f32 v141, v42, v141
  v_mfma_f32_16x16x32_bf16 v[244:247], a[52:55], a[44:47], v[244:247]
  v_mul_f32 v142, v42, v142
  s_add_u32 s13, s13, s32
  v_mfma_f32_16x16x32_bf16 v[248:251], a[24:27], a[12:15], 0
  v_mul_f32 v143, v42, v143
  v_mfma_f32_16x16x32_bf16 v[248:251], a[56:59], a[44:47], v[248:251]
  v_mfma_f32_16x16x32_bf16 v[252:255], a[28:31], a[12:15], 0
  v_mfma_f32_16x16x32_bf16 v[252:255], a[60:63], a[44:47], v[252:255]
  s_waitcnt vmcnt(16) lgkmcnt(0)
  s_barrier
  v_mfma_f32_16x16x32_bf16 v[192:195], a[80:83], a[64:67], v[192:195]
  ds_read_b128 a[0:3], v13 offset:0
  s_add_u32 m0, s15, 32768
  v_mfma_f32_16x16x32_bf16 v[192:195], a[112:115], a[96:99], v[192:195]
  ds_read_b64_tr_b16 a[16:17], v22 offset:0
  v_mfma_f32_16x16x32_bf16 v[196:199], a[84:87], a[64:67], v[196:199]
  ds_read_b64_tr_b16 a[18:19], v22 offset:4096
  buffer_load_dwordx4 v8, s[16:19], s12 offen offset:0  lds
  v_mfma_f32_16x16x32_bf16 v[196:199], a[116:119], a[96:99], v[196:199]
  ds_read_b128 a[32:35], v13 offset:8192
  v_mfma_f32_16x16x32_bf16 v[200:203], a[88:91], a[64:67], v[200:203]
  ds_read_b64_tr_b16 a[48:49], v22 offset:8192
  v_mfma_f32_16x16x32_bf16 v[200:203], a[120:123], a[96:99], v[200:203]
  buffer_load_dwordx4 v8, s[16:19], s12 offen offset:1024  lds
  ds_read_b64_tr_b16 a[50:51], v22 offset:12288
  v_mfma_f32_16x16x32_bf16 v[204:207], a[92:95], a[64:67], v[204:207]
  ds_read_b128 a[4:7], v13 offset:1024
  v_mfma_f32_16x16x32_bf16 v[204:207], a[124:127], a[96:99], v[204:207]
  ds_read_b64_tr_b16 a[20:21], v23 offset:0
  buffer_load_dwordx4 v8, s[16:19], s12 offen offset:2048  lds
  v_mfma_f32_16x16x32_bf16 v[208:211], a[80:83], a[68:71], v[208:211]
  v_mfma_f32_16x16x32_bf16 v[208:211], a[112:115], a[100:103], v[208:211]
  ds_read_b64_tr_b16 a[22:23], v23 offset:4096
  v_mfma_f32_16x16x32_bf16 v[212:215], a[84:87], a[68:71], v[212:215]
  v_sub_f32 v43, 1.0, v39
  ds_read_b128 a[36:39], v13 offset:9216
  buffer_load_dwordx4 v8, s[16:19], s12 offen offset:3072  lds
  v_mfma_f32_16x16x32_bf16 v[212:215], a[116:119], a[100:103], v[212:215]
  v_mul_f32 v144, v43, v144
  ds_read_b64_tr_b16 a[52:53], v23 offset:8192
  v_mfma_f32_16x16x32_bf16 v[216:219], a[88:91], a[68:71], v[216:219]
  v_mul_f32 v145, v43, v145
  ds_read_b64_tr_b16 a[54:55], v23 offset:12288
  s_add_u32 s12, s12, s31
  v_mfma_f32_16x16x32_bf16 v[216:219], a[120:123], a[100:103], v[216:219]
  v_mul_f32 v146, v43, v146
  ds_read_b128 a[8:11], v13 offset:2048
  v_mfma_f32_16x16x32_bf16 v[220:223], a[92:95], a[68:71], v[220:223]
  v_mul_f32 v147, v43, v147
  ds_read_b64_tr_b16 a[24:25], v24 offset:0
  v_mfma_f32_16x16x32_bf16 v[220:223], a[124:127], a[100:103], v[220:223]
  s_add_u32 m0, s27, 32768
  ds_read_b64_tr_b16 a[26:27], v24 offset:4096
  v_mul_f32 v148, v43, v148
  v_mfma_f32_16x16x32_bf16 v[224:227], a[80:83], a[72:75], v[224:227]
  v_mfma_f32_16x16x32_bf16 v[224:227], a[112:115], a[104:107], v[224:227]
  ds_read_b128 a[40:43], v13 offset:10240
  v_mul_f32 v149, v43, v149
  buffer_load_dwordx4 v2, s[20:23], s13 offen offset:0 lds
  v_mfma_f32_16x16x32_bf16 v[228:231], a[84:87], a[72:75], v[228:231]
  ds_read_b64_tr_b16 a[56:57], v24 offset:8192
  v_mul_f32 v150, v43, v150
  v_mfma_f32_16x16x32_bf16 v[228:231], a[116:119], a[104:107], v[228:231]
  ds_read_b64_tr_b16 a[58:59], v24 offset:12288
  v_mul_f32 v151, v43, v151
  v_mfma_f32_16x16x32_bf16 v[232:235], a[88:91], a[72:75], v[232:235]
  ds_read_b128 a[12:15], v13 offset:3072
  buffer_load_dwordx4 v3, s[20:23], s13 offen offset:1024 lds
  v_mul_f32 v152, v43, v152
  v_mfma_f32_16x16x32_bf16 v[232:235], a[120:123], a[104:107], v[232:235]
  ds_read_b64_tr_b16 a[28:29], v25 offset:0
  v_mul_f32 v153, v43, v153
  v_mfma_f32_16x16x32_bf16 v[236:239], a[92:95], a[72:75], v[236:239]
  ds_read_b64_tr_b16 a[30:31], v25 offset:4096
  buffer_load_dwordx4 v4, s[20:23], s13 offen offset:2048 lds
  v_mul_f32 v154, v43, v154
  v_mfma_f32_16x16x32_bf16 v[236:239], a[124:127], a[104:107], v[236:239]
  ds_read_b128 a[44:47], v13 offset:11264
  v_mfma_f32_16x16x32_bf16 v[240:243], a[80:83], a[76:79], v[240:243]
  v_mul_f32 v155, v43, v155
  ds_read_b64_tr_b16 a[60:61], v25 offset:8192
  v_mfma_f32_16x16x32_bf16 v[240:243], a[112:115], a[108:111], v[240:243]
  v_mul_f32 v156, v43, v156
  buffer_load_dwordx4 v5, s[20:23], s13 offen offset:3072 lds
  v_mfma_f32_16x16x32_bf16 v[244:247], a[84:87], a[76:79], v[244:247]
  ds_read_b64_tr_b16 a[62:63], v25 offset:12288
  v_mul_f32 v157, v43, v157
  v_mfma_f32_16x16x32_bf16 v[244:247], a[116:119], a[108:111], v[244:247]
  v_mul_f32 v158, v43, v158
  s_add_u32 s13, s13, s32
  v_mfma_f32_16x16x32_bf16 v[248:251], a[88:91], a[76:79], v[248:251]
  v_mul_f32 v159, v43, v159
  v_mfma_f32_16x16x32_bf16 v[248:251], a[120:123], a[108:111], v[248:251]
  v_mfma_f32_16x16x32_bf16 v[252:255], a[92:95], a[76:79], v[252:255]
  v_mfma_f32_16x16x32_bf16 v[252:255], a[124:127], a[108:111], v[252:255]
  s_waitcnt vmcnt(16) lgkmcnt(0)
  s_barrier
  v_mfma_f32_16x16x32_bf16 v[192:195], a[16:19], a[0:3], v[192:195]
  ds_read_b128 a[64:67], v13 offset:32768
  v_mfma_f32_16x16x32_bf16 v[192:195], a[48:51], a[32:35], v[192:195]
  ds_read_b64_tr_b16 a[80:81], v22 offset:32768
  v_mfma_f32_16x16x32_bf16 v[196:199], a[20:23], a[0:3], v[196:199]
  ds_read_b64_tr_b16 a[82:83], v22 offset:36864
  v_mfma_f32_16x16x32_bf16 v[196:199], a[52:55], a[32:35], v[196:199]
  ds_read_b128 a[96:99], v13 offset:40960
  v_mfma_f32_16x16x32_bf16 v[200:203], a[24:27], a[0:3], v[200:203]
  ds_read_b64_tr_b16 a[112:113], v22 offset:40960
  v_mfma_f32_16x16x32_bf16 v[200:203], a[56:59], a[32:35], v[200:203]
  ds_read_b64_tr_b16 a[114:115], v22 offset:45056
  v_mfma_f32_16x16x32_bf16 v[204:207], a[28:31], a[0:3], v[204:207]
  ds_read_b128 a[68:71], v13 offset:33792
  v_mfma_f32_16x16x32_bf16 v[204:207], a[60:63], a[32:35], v[204:207]
  ds_read_b64_tr_b16 a[84:85], v23 offset:32768
  v_mfma_f32_16x16x32_bf16 v[208:211], a[16:19], a[4:7], v[208:211]
  v_mfma_f32_16x16x32_bf16 v[208:211], a[48:51], a[36:39], v[208:211]
  ds_read_b64_tr_b16 a[86:87], v23 offset:36864
  v_mfma_f32_16x16x32_bf16 v[212:215], a[20:23], a[4:7], v[212:215]
  v_sub_f32 v44, 1.0, v40
  ds_read_b128 a[100:103], v13 offset:41984
  v_mfma_f32_16x16x32_bf16 v[212:215], a[52:55], a[36:39], v[212:215]
  v_mul_f32 v160, v44, v160
  ds_read_b64_tr_b16 a[116:117], v23 offset:40960
  v_mfma_f32_16x16x32_bf16 v[216:219], a[24:27], a[4:7], v[216:219]
  v_mul_f32 v161, v44, v161
  ds_read_b64_tr_b16 a[118:119], v23 offset:45056
  v_mfma_f32_16x16x32_bf16 v[216:219], a[56:59], a[36:39], v[216:219]
  v_mul_f32 v162, v44, v162
  ds_read_b128 a[72:75], v13 offset:34816
  v_mfma_f32_16x16x32_bf16 v[220:223], a[28:31], a[4:7], v[220:223]
  v_mul_f32 v163, v44, v163
  ds_read_b64_tr_b16 a[88:89], v24 offset:32768
  v_mfma_f32_16x16x32_bf16 v[220:223], a[60:63], a[36:39], v[220:223]
  ds_read_b64_tr_b16 a[90:91], v24 offset:36864
  v_mul_f32 v164, v44, v164
  v_mfma_f32_16x16x32_bf16 v[224:227], a[16:19], a[8:11], v[224:227]
  v_mfma_f32_16x16x32_bf16 v[224:227], a[48:51], a[40:43], v[224:227]
  ds_read_b128 a[104:107], v13 offset:43008
  v_mul_f32 v165, v44, v165
  v_mfma_f32_16x16x32_bf16 v[228:231], a[20:23], a[8:11], v[228:231]
  ds_read_b64_tr_b16 a[120:121], v24 offset:40960
  v_mul_f32 v166, v44, v166
  v_mfma_f32_16x16x32_bf16 v[228:231], a[52:55], a[40:43], v[228:231]
  ds_read_b64_tr_b16 a[122:123], v24 offset:45056
  v_mul_f32 v167, v44, v167
  v_mfma_f32_16x16x32_bf16 v[232:235], a[24:27], a[8:11], v[232:235]
  ds_read_b128 a[76:79], v13 offset:35840
  v_mul_f32 v168, v44, v168
  v_mfma_f32_16x16x32_bf16 v[232:235], a[56:59], a[40:43], v[232:235]
  ds_read_b64_tr_b16 a[92:93], v25 offset:32768
  v_mul_f32 v169, v44, v169
  v_mfma_f32_16x16x32_bf16 v[236:239], a[28:31], a[8:11], v[236:239]
  ds_read_b64_tr_b16 a[94:95], v25 offset:36864
  v_mul_f32 v170, v44, v170
  v_mfma_f32_16x16x32_bf16 v[236:239], a[60:63], a[40:43], v[236:239]
  ds_read_b128 a[108:111], v13 offset:44032
  v_mfma_f32_16x16x32_bf16 v[240:243], a[16:19], a[12:15], v[240:243]
  v_mul_f32 v171, v44, v171
  ds_read_b64_tr_b16 a[124:125], v25 offset:40960
  v_mfma_f32_16x16x32_bf16 v[240:243], a[48:51], a[44:47], v[240:243]
  v_mul_f32 v172, v44, v172
  v_mfma_f32_16x16x32_bf16 v[244:247], a[20:23], a[12:15], v[244:247]
  ds_read_b64_tr_b16 a[126:127], v25 offset:45056
  v_mul_f32 v173, v44, v173
  v_mfma_f32_16x16x32_bf16 v[244:247], a[52:55], a[44:47], v[244:247]
  v_mul_f32 v174, v44, v174
  v_mfma_f32_16x16x32_bf16 v[248:251], a[24:27], a[12:15], v[248:251]
  v_mul_f32 v175, v44, v175
  v_mfma_f32_16x16x32_bf16 v[248:251], a[56:59], a[44:47], v[248:251]
  v_mfma_f32_16x16x32_bf16 v[252:255], a[28:31], a[12:15], v[252:255]
  v_mfma_f32_16x16x32_bf16 v[252:255], a[60:63], a[44:47], v[252:255]
  s_waitcnt vmcnt(8) lgkmcnt(0)
  s_barrier
  v_mfma_f32_16x16x32_bf16 v[192:195], a[80:83], a[64:67], v[192:195]
  ds_read_b128 a[0:3], v12 offset:0
  v_mfma_f32_16x16x32_bf16 v[192:195], a[112:115], a[96:99], v[192:195]
  ds_read_b64_tr_b16 a[16:17], v18 offset:0
  v_mfma_f32_16x16x32_bf16 v[196:199], a[84:87], a[64:67], v[196:199]
  ds_read_b64_tr_b16 a[18:19], v18 offset:4096
  v_mfma_f32_16x16x32_bf16 v[196:199], a[116:119], a[96:99], v[196:199]
  ds_read_b128 a[32:35], v12 offset:8192
  v_mfma_f32_16x16x32_bf16 v[200:203], a[88:91], a[64:67], v[200:203]
  ds_read_b64_tr_b16 a[48:49], v18 offset:8192
  v_mfma_f32_16x16x32_bf16 v[200:203], a[120:123], a[96:99], v[200:203]
  ds_read_b64_tr_b16 a[50:51], v18 offset:12288
  v_mfma_f32_16x16x32_bf16 v[204:207], a[92:95], a[64:67], v[204:207]
  ds_read_b128 a[4:7], v12 offset:1024
  v_mfma_f32_16x16x32_bf16 v[204:207], a[124:127], a[96:99], v[204:207]
  ds_read_b64_tr_b16 a[20:21], v19 offset:0
  v_mfma_f32_16x16x32_bf16 v[208:211], a[80:83], a[68:71], v[208:211]
  v_mfma_f32_16x16x32_bf16 v[208:211], a[112:115], a[100:103], v[208:211]
  ds_read_b64_tr_b16 a[22:23], v19 offset:4096
  v_mfma_f32_16x16x32_bf16 v[212:215], a[84:87], a[68:71], v[212:215]
  v_sub_f32 v45, 1.0, v41
  ds_read_b128 a[36:39], v12 offset:9216
  v_mfma_f32_16x16x32_bf16 v[212:215], a[116:119], a[100:103], v[212:215]
  v_mul_f32 v176, v45, v176
  ds_read_b64_tr_b16 a[52:53], v19 offset:8192
  v_mfma_f32_16x16x32_bf16 v[216:219], a[88:91], a[68:71], v[216:219]
  v_mul_f32 v177, v45, v177
  ds_read_b64_tr_b16 a[54:55], v19 offset:12288
  v_mfma_f32_16x16x32_bf16 v[216:219], a[120:123], a[100:103], v[216:219]
  v_mul_f32 v178, v45, v178
  ds_read_b128 a[8:11], v12 offset:2048
  v_mfma_f32_16x16x32_bf16 v[220:223], a[92:95], a[68:71], v[220:223]
  v_mul_f32 v179, v45, v179
  ds_read_b64_tr_b16 a[24:25], v20 offset:0
  v_mfma_f32_16x16x32_bf16 v[220:223], a[124:127], a[100:103], v[220:223]
  ds_read_b64_tr_b16 a[26:27], v20 offset:4096
  v_mul_f32 v180, v45, v180
  v_mfma_f32_16x16x32_bf16 v[224:227], a[80:83], a[72:75], v[224:227]
  v_mfma_f32_16x16x32_bf16 v[224:227], a[112:115], a[104:107], v[224:227]
  ds_read_b128 a[40:43], v12 offset:10240
  v_mul_f32 v181, v45, v181
  v_mfma_f32_16x16x32_bf16 v[228:231], a[84:87], a[72:75], v[228:231]
  ds_read_b64_tr_b16 a[56:57], v20 offset:8192
  v_mul_f32 v182, v45, v182
  v_mfma_f32_16x16x32_bf16 v[228:231], a[116:119], a[104:107], v[228:231]
  ds_read_b64_tr_b16 a[58:59], v20 offset:12288
  v_mul_f32 v183, v45, v183
  v_mfma_f32_16x16x32_bf16 v[232:235], a[88:91], a[72:75], v[232:235]
  ds_read_b128 a[12:15], v12 offset:3072
  v_mul_f32 v184, v45, v184
  v_mfma_f32_16x16x32_bf16 v[232:235], a[120:123], a[104:107], v[232:235]
  ds_read_b64_tr_b16 a[28:29], v21 offset:0
  v_mul_f32 v185, v45, v185
  v_mfma_f32_16x16x32_bf16 v[236:239], a[92:95], a[72:75], v[236:239]
  ds_read_b64_tr_b16 a[30:31], v21 offset:4096
  v_mul_f32 v186, v45, v186
  v_mfma_f32_16x16x32_bf16 v[236:239], a[124:127], a[104:107], v[236:239]
  ds_read_b128 a[44:47], v12 offset:11264
  v_mfma_f32_16x16x32_bf16 v[240:243], a[80:83], a[76:79], v[240:243]
  v_mul_f32 v187, v45, v187
  ds_read_b64_tr_b16 a[60:61], v21 offset:8192
  v_mfma_f32_16x16x32_bf16 v[240:243], a[112:115], a[108:111], v[240:243]
  v_mul_f32 v188, v45, v188
  v_mfma_f32_16x16x32_bf16 v[244:247], a[84:87], a[76:79], v[244:247]
  ds_read_b64_tr_b16 a[62:63], v21 offset:12288
  v_mul_f32 v189, v45, v189
  v_mfma_f32_16x16x32_bf16 v[244:247], a[116:119], a[108:111], v[244:247]
  v_mul_f32 v190, v45, v190
  v_mfma_f32_16x16x32_bf16 v[248:251], a[88:91], a[76:79], v[248:251]
  v_mul_f32 v191, v45, v191
  v_mfma_f32_16x16x32_bf16 v[248:251], a[120:123], a[108:111], v[248:251]
  v_mfma_f32_16x16x32_bf16 v[252:255], a[92:95], a[76:79], v[252:255]
  v_mfma_f32_16x16x32_bf16 v[252:255], a[124:127], a[108:111], v[252:255]
  s_waitcnt vmcnt(0) lgkmcnt(0)
  s_barrier
  v_mfma_f32_16x16x32_bf16 v[192:195], a[16:19], a[0:3], v[192:195]
  ds_read_b128 a[64:67], v12 offset:32768
  v_mfma_f32_16x16x32_bf16 v[192:195], a[48:51], a[32:35], v[192:195]
  ds_read_b64_tr_b16 a[80:81], v18 offset:32768
  v_mfma_f32_16x16x32_bf16 v[196:199], a[20:23], a[0:3], v[196:199]
  ds_read_b64_tr_b16 a[82:83], v18 offset:36864
  v_mfma_f32_16x16x32_bf16 v[196:199], a[52:55], a[32:35], v[196:199]
  ds_read_b128 a[96:99], v12 offset:40960
  v_mfma_f32_16x16x32_bf16 v[200:203], a[24:27], a[0:3], v[200:203]
  ds_read_b64_tr_b16 a[112:113], v18 offset:40960
  v_mfma_f32_16x16x32_bf16 v[200:203], a[56:59], a[32:35], v[200:203]
  ds_read_b64_tr_b16 a[114:115], v18 offset:45056
  v_mfma_f32_16x16x32_bf16 v[204:207], a[28:31], a[0:3], v[204:207]
  ds_read_b128 a[68:71], v12 offset:33792
  v_mfma_f32_16x16x32_bf16 v[204:207], a[60:63], a[32:35], v[204:207]
  ds_read_b64_tr_b16 a[84:85], v19 offset:32768
  v_mfma_f32_16x16x32_bf16 v[208:211], a[16:19], a[4:7], v[208:211]
  v_mfma_f32_16x16x32_bf16 v[208:211], a[48:51], a[36:39], v[208:211]
  ds_read_b64_tr_b16 a[86:87], v19 offset:36864
  v_mfma_f32_16x16x32_bf16 v[212:215], a[20:23], a[4:7], v[212:215]
  ds_read_b128 a[100:103], v12 offset:41984
  v_mfma_f32_16x16x32_bf16 v[212:215], a[52:55], a[36:39], v[212:215]
  ds_read_b64_tr_b16 a[116:117], v19 offset:40960
  v_mfma_f32_16x16x32_bf16 v[216:219], a[24:27], a[4:7], v[216:219]
  ds_read_b64_tr_b16 a[118:119], v19 offset:45056
  v_mfma_f32_16x16x32_bf16 v[216:219], a[56:59], a[36:39], v[216:219]
  ds_read_b128 a[72:75], v12 offset:34816
  v_mfma_f32_16x16x32_bf16 v[220:223], a[28:31], a[4:7], v[220:223]
  ds_read_b64_tr_b16 a[88:89], v20 offset:32768
  v_mfma_f32_16x16x32_bf16 v[220:223], a[60:63], a[36:39], v[220:223]
  ds_read_b64_tr_b16 a[90:91], v20 offset:36864
  v_mfma_f32_16x16x32_bf16 v[224:227], a[16:19], a[8:11], v[224:227]
  v_mfma_f32_16x16x32_bf16 v[224:227], a[48:51], a[40:43], v[224:227]
  ds_read_b128 a[104:107], v12 offset:43008
  v_mfma_f32_16x16x32_bf16 v[228:231], a[20:23], a[8:11], v[228:231]
  ds_read_b64_tr_b16 a[120:121], v20 offset:40960
  v_mfma_f32_16x16x32_bf16 v[228:231], a[52:55], a[40:43], v[228:231]
  ds_read_b64_tr_b16 a[122:123], v20 offset:45056
  v_mfma_f32_16x16x32_bf16 v[232:235], a[24:27], a[8:11], v[232:235]
  ds_read_b128 a[76:79], v12 offset:35840
  v_mfma_f32_16x16x32_bf16 v[232:235], a[56:59], a[40:43], v[232:235]
  ds_read_b64_tr_b16 a[92:93], v21 offset:32768
  v_mfma_f32_16x16x32_bf16 v[236:239], a[28:31], a[8:11], v[236:239]
  ds_read_b64_tr_b16 a[94:95], v21 offset:36864
  v_mfma_f32_16x16x32_bf16 v[236:239], a[60:63], a[40:43], v[236:239]
  ds_read_b128 a[108:111], v12 offset:44032
  v_mfma_f32_16x16x32_bf16 v[240:243], a[16:19], a[12:15], v[240:243]
  ds_read_b64_tr_b16 a[124:125], v21 offset:40960
  v_mfma_f32_16x16x32_bf16 v[240:243], a[48:51], a[44:47], v[240:243]
  v_mfma_f32_16x16x32_bf16 v[244:247], a[20:23], a[12:15], v[244:247]
  ds_read_b64_tr_b16 a[126:127], v21 offset:45056
  v_mfma_f32_16x16x32_bf16 v[244:247], a[52:55], a[44:47], v[244:247]
  v_mfma_f32_16x16x32_bf16 v[248:251], a[24:27], a[12:15], v[248:251]
  v_mfma_f32_16x16x32_bf16 v[248:251], a[56:59], a[44:47], v[248:251]
  v_mfma_f32_16x16x32_bf16 v[252:255], a[28:31], a[12:15], v[252:255]
  v_mfma_f32_16x16x32_bf16 v[252:255], a[60:63], a[44:47], v[252:255]
  s_waitcnt lgkmcnt(0)
  v_mfma_f32_16x16x32_bf16 v[192:195], a[80:83], a[64:67], v[192:195]
  v_mfma_f32_16x16x32_bf16 v[192:195], a[112:115], a[96:99], v[192:195]
  v_mfma_f32_16x16x32_bf16 v[196:199], a[84:87], a[64:67], v[196:199]
  v_mfma_f32_16x16x32_bf16 v[196:199], a[116:119], a[96:99], v[196:199]
  v_mfma_f32_16x16x32_bf16 v[200:203], a[88:91], a[64:67], v[200:203]
  v_mfma_f32_16x16x32_bf16 v[200:203], a[120:123], a[96:99], v[200:203]
  v_mfma_f32_16x16x32_bf16 v[204:207], a[92:95], a[64:67], v[204:207]
  v_mfma_f32_16x16x32_bf16 v[204:207], a[124:127], a[96:99], v[204:207]
  v_mfma_f32_16x16x32_bf16 v[208:211], a[80:83], a[68:71], v[208:211]
  v_mfma_f32_16x16x32_bf16 v[208:211], a[112:115], a[100:103], v[208:211]
  v_mfma_f32_16x16x32_bf16 v[212:215], a[84:87], a[68:71], v[212:215]
  v_mfma_f32_16x16x32_bf16 v[212:215], a[116:119], a[100:103], v[212:215]
  v_mfma_f32_16x16x32_bf16 v[216:219], a[88:91], a[68:71], v[216:219]
  v_mfma_f32_16x16x32_bf16 v[216:219], a[120:123], a[100:103], v[216:219]
  v_mfma_f32_16x16x32_bf16 v[220:223], a[92:95], a[68:71], v[220:223]
  v_mfma_f32_16x16x32_bf16 v[220:223], a[124:127], a[100:103], v[220:223]
  v_mfma_f32_16x16x32_bf16 v[224:227], a[80:83], a[72:75], v[224:227]
  v_mfma_f32_16x16x32_bf16 v[224:227], a[112:115], a[104:107], v[224:227]
  v_mfma_f32_16x16x32_bf16 v[228:231], a[84:87], a[72:75], v[228:231]
  v_mfma_f32_16x16x32_bf16 v[228:231], a[116:119], a[104:107], v[228:231]
  v_mfma_f32_16x16x32_bf16 v[232:235], a[88:91], a[72:75], v[232:235]
  v_mfma_f32_16x16x32_bf16 v[232:235], a[120:123], a[104:107], v[232:235]
  v_mfma_f32_16x16x32_bf16 v[236:239], a[92:95], a[72:75], v[236:239]
  v_mfma_f32_16x16x32_bf16 v[236:239], a[124:127], a[104:107], v[236:239]
  v_mfma_f32_16x16x32_bf16 v[240:243], a[80:83], a[76:79], v[240:243]
  v_mfma_f32_16x16x32_bf16 v[240:243], a[112:115], a[108:111], v[240:243]
  v_mfma_f32_16x16x32_bf16 v[244:247], a[84:87], a[76:79], v[244:247]
  v_mfma_f32_16x16x32_bf16 v[244:247], a[116:119], a[108:111], v[244:247]
  v_mfma_f32_16x16x32_bf16 v[248:251], a[88:91], a[76:79], v[248:251]
  v_mfma_f32_16x16x32_bf16 v[248:251], a[120:123], a[108:111], v[248:251]
  v_mfma_f32_16x16x32_bf16 v[252:255], a[92:95], a[76:79], v[252:255]
  v_mfma_f32_16x16x32_bf16 v[252:255], a[124:127], a[108:111], v[252:255]
  s_lshl_b32 s60, s11, 16
  s_lshl_b32 s61, s24, 13
  s_add_u32 s60, s60, s61
  s_add_u32 s60, s60, 20553728
  s_nop 7
  v_pk_fma_f32 v[128:129], v[38:39], v[192:193], v[128:129] op_sel_hi:[0,1,1]
  v_pk_fma_f32 v[130:131], v[38:39], v[194:195], v[130:131] op_sel_hi:[0,1,1]
  v_pk_fma_f32 v[132:133], v[38:39], v[196:197], v[132:133] op_sel_hi:[0,1,1]
  v_pk_fma_f32 v[134:135], v[38:39], v[198:199], v[134:135] op_sel_hi:[0,1,1]
  v_pk_fma_f32 v[136:137], v[38:39], v[200:201], v[136:137] op_sel_hi:[0,1,1]
  v_pk_fma_f32 v[138:139], v[38:39], v[202:203], v[138:139] op_sel_hi:[0,1,1]
  v_pk_fma_f32 v[140:141], v[38:39], v[204:205], v[140:141] op_sel_hi:[0,1,1]
  v_pk_fma_f32 v[142:143], v[38:39], v[206:207], v[142:143] op_sel_hi:[0,1,1]
  v_cvt_pk_bf16_f32 v128, v128, v129
  v_cvt_pk_bf16_f32 v129, v130, v131
  v_cvt_pk_bf16_f32 v130, v132, v133
  v_cvt_pk_bf16_f32 v131, v134, v135
  buffer_store_dwordx4 v[128:131], v17, s[16:19], s60 offen offset:0 sc1
  v_cvt_pk_bf16_f32 v136, v136, v137
  v_cvt_pk_bf16_f32 v137, v138, v139
  v_cvt_pk_bf16_f32 v138, v140, v141
  v_cvt_pk_bf16_f32 v139, v142, v143
  buffer_store_dwordx4 v[136:139], v17, s[16:19], s60 offen offset:1024 sc1
  v_pk_fma_f32 v[144:145], v[38:39], v[208:209], v[144:145] op_sel:[1,0,0] op_sel_hi:[1,1,1]
  v_pk_fma_f32 v[146:147], v[38:39], v[210:211], v[146:147] op_sel:[1,0,0] op_sel_hi:[1,1,1]
  v_pk_fma_f32 v[148:149], v[38:39], v[212:213], v[148:149] op_sel:[1,0,0] op_sel_hi:[1,1,1]
  v_pk_fma_f32 v[150:151], v[38:39], v[214:215], v[150:151] op_sel:[1,0,0] op_sel_hi:[1,1,1]
  v_pk_fma_f32 v[152:153], v[38:39], v[216:217], v[152:153] op_sel:[1,0,0] op_sel_hi:[1,1,1]
  v_pk_fma_f32 v[154:155], v[38:39], v[218:219], v[154:155] op_sel:[1,0,0] op_sel_hi:[1,1,1]
  v_pk_fma_f32 v[156:157], v[38:39], v[220:221], v[156:157] op_sel:[1,0,0] op_sel_hi:[1,1,1]
  v_pk_fma_f32 v[158:159], v[38:39], v[222:223], v[158:159] op_sel:[1,0,0] op_sel_hi:[1,1,1]
  v_cvt_pk_bf16_f32 v144, v144, v145
  v_cvt_pk_bf16_f32 v145, v146, v147
  v_cvt_pk_bf16_f32 v146, v148, v149
  v_cvt_pk_bf16_f32 v147, v150, v151
  buffer_store_dwordx4 v[144:147], v17, s[16:19], s60 offen offset:2048 sc1
  v_cvt_pk_bf16_f32 v152, v152, v153
  v_cvt_pk_bf16_f32 v153, v154, v155
  v_cvt_pk_bf16_f32 v154, v156, v157
  v_cvt_pk_bf16_f32 v155, v158, v159
  buffer_store_dwordx4 v[152:155], v17, s[16:19], s60 offen offset:3072 sc1
  s_add_u32 s60, s60, 4096
  v_pk_fma_f32 v[160:161], v[40:41], v[224:225], v[160:161] op_sel_hi:[0,1,1]
  v_pk_fma_f32 v[162:163], v[40:41], v[226:227], v[162:163] op_sel_hi:[0,1,1]
  v_pk_fma_f32 v[164:165], v[40:41], v[228:229], v[164:165] op_sel_hi:[0,1,1]
  v_pk_fma_f32 v[166:167], v[40:41], v[230:231], v[166:167] op_sel_hi:[0,1,1]
  v_pk_fma_f32 v[168:169], v[40:41], v[232:233], v[168:169] op_sel_hi:[0,1,1]
  v_pk_fma_f32 v[170:171], v[40:41], v[234:235], v[170:171] op_sel_hi:[0,1,1]
  v_pk_fma_f32 v[172:173], v[40:41], v[236:237], v[172:173] op_sel_hi:[0,1,1]
  v_pk_fma_f32 v[174:175], v[40:41], v[238:239], v[174:175] op_sel_hi:[0,1,1]
  v_cvt_pk_bf16_f32 v160, v160, v161
  v_cvt_pk_bf16_f32 v161, v162, v163
  v_cvt_pk_bf16_f32 v162, v164, v165
  v_cvt_pk_bf16_f32 v163, v166, v167
  buffer_store_dwordx4 v[160:163], v17, s[16:19], s60 offen offset:0 sc1
  v_cvt_pk_bf16_f32 v168, v168, v169
  v_cvt_pk_bf16_f32 v169, v170, v171
  v_cvt_pk_bf16_f32 v170, v172, v173
  v_cvt_pk_bf16_f32 v171, v174, v175
  buffer_store_dwordx4 v[168:171], v17, s[16:19], s60 offen offset:1024 sc1
  v_pk_fma_f32 v[176:177], v[40:41], v[240:241], v[176:177] op_sel:[1,0,0] op_sel_hi:[1,1,1]
  v_pk_fma_f32 v[178:179], v[40:41], v[242:243], v[178:179] op_sel:[1,0,0] op_sel_hi:[1,1,1]
  v_pk_fma_f32 v[180:181], v[40:41], v[244:245], v[180:181] op_sel:[1,0,0] op_sel_hi:[1,1,1]
  v_pk_fma_f32 v[182:183], v[40:41], v[246:247], v[182:183] op_sel:[1,0,0] op_sel_hi:[1,1,1]
  v_pk_fma_f32 v[184:185], v[40:41], v[248:249], v[184:185] op_sel:[1,0,0] op_sel_hi:[1,1,1]
  v_pk_fma_f32 v[186:187], v[40:41], v[250:251], v[186:187] op_sel:[1,0,0] op_sel_hi:[1,1,1]
  v_pk_fma_f32 v[188:189], v[40:41], v[252:253], v[188:189] op_sel:[1,0,0] op_sel_hi:[1,1,1]
  v_pk_fma_f32 v[190:191], v[40:41], v[254:255], v[190:191] op_sel:[1,0,0] op_sel_hi:[1,1,1]
  v_cvt_pk_bf16_f32 v176, v176, v177
  v_cvt_pk_bf16_f32 v177, v178, v179
  v_cvt_pk_bf16_f32 v178, v180, v181
  v_cvt_pk_bf16_f32 v179, v182, v183
  buffer_store_dwordx4 v[176:179], v17, s[16:19], s60 offen offset:2048 sc1
  v_cvt_pk_bf16_f32 v184, v184, v185
  v_cvt_pk_bf16_f32 v185, v186, v187
  v_cvt_pk_bf16_f32 v186, v188, v189
  v_cvt_pk_bf16_f32 v187, v190, v191
  buffer_store_dwordx4 v[184:187], v17, s[16:19], s60 offen offset:3072 sc1
  s_waitcnt vmcnt(0)
  s_mov_b64 exec, 8
  buffer_store_dwordx2 v[14:15], v0, s[16:19], 0 offen sc1
  s_mov_b64 exec, -1
  s_endpgm
L_k1_exit:
  s_endpgm
L_code_end:
.section .rodata,"a"
.p2align 6
.amdhsa_kernel gated_mix__linear_attn_block__dense_activation_mish__prompt_kernel
  .amdhsa_next_free_vgpr 416
  .amdhsa_next_free_sgpr 102
  .amdhsa_accum_offset 256
  .amdhsa_group_segment_fixed_size 0
  .amdhsa_kernarg_size 88
  .amdhsa_user_sgpr_count 2
  .amdhsa_user_sgpr_kernarg_segment_ptr 1
  .amdhsa_system_sgpr_workgroup_id_x 1
.end_amdhsa_kernel
```
